```python
import torch

def _softmax(x, axis=-1):
    return torch.softmax(x, dim=axis)
def _gelu(x):
    return torch.nn.functional.gelu(x, approximate="tanh")
def _silu(x):
    return torch.nn.functional.silu(x)
def _sigmoid(x):
    return torch.sigmoid(x)
def _layernorm(x, axis=-1, eps=1e-5):
    m = x.mean(dim=axis, keepdim=True)
    v = x.var(dim=axis, keepdim=True, unbiased=False)
    return (x - m) / torch.sqrt(v + eps)
def _scatter_add(tgt, idx, src, axis=0):
    return tgt.clone().index_add_(axis, idx, src)
def _segment_sum(src, seg, n):
    out = torch.zeros((n,) + src.shape[1:], dtype=src.dtype)
    return out.index_add_(0, seg, src)
def _pad(x, pw):
    flat = tuple(v for pair in reversed(pw) for v in pair)
    return torch.nn.functional.pad(x, flat)

kernel_name = 'recurrent_scan__spectral_gfnet__dense_activation_relu__prompt'

def setup_inputs():

    _w = (lambda a: (lambda t: t.to(torch.bfloat16) if t.is_floating_point() else t)(torch.as_tensor(a)))
    def _A_setup():
        B, S, D = 1, 2048, 640
        Df = D // 2 + 1
        return {
            "x": _w((lambda *s: torch.randn(*s, dtype=torch.bfloat16) * 0.05)(B, S, D)),
            "w_r": _w((lambda *s: torch.randn(*s, dtype=torch.bfloat16) * 0.05)(S, Df) * 0.02),
            "w_i": _w((lambda *s: torch.randn(*s, dtype=torch.bfloat16) * 0.1)(S, Df) * 0.02),
        }
    _A_in = _A_setup()

    def _B_setup():
        B, S, D, Dff = 1, 2048, 640, 1728
        return {
            "x": _w((lambda *s: torch.randn(*s, dtype=torch.bfloat16) * 0.05)(B, S, D)),
            "w1": _w((lambda *s: torch.randn(*s, dtype=torch.bfloat16) * 0.05)(D, Dff)),
            "w2": _w((lambda *s: torch.randn(*s, dtype=torch.bfloat16) * 0.05)(Dff, D)),
        }
    _B_in = _B_setup()

    return {
        "A_x": _A_in["x"],
        "A_w_r": _A_in["w_r"],
        "A_w_i": _A_in["w_i"],
        "B_x": _B_in["x"],
        "B_w1": _B_in["w1"],
        "B_w2": _B_in["w2"],
    }

def reference(A_x, A_w_r, A_w_i, B_x, B_w1, B_w2):
    def _A_ref(x, w_r, w_i):
        B, S, D = x.shape
        X = (lambda x, axes=(-2,-1): torch.fft.rfft2(x.float(), dim=axes))(x, axes=(-2, -1))
        W = w_r + 1j * w_i
        X = X * W
        y = (lambda x, s, axes=(-2,-1): torch.fft.irfft2(x, s=s, dim=axes).to(torch.bfloat16))(X, (S, D), axes=(-2, -1))
        return y

    def _B_ref(x, w1, w2):
        h = torch.einsum("bsd,df->bsf", x, w1)
        zero = torch.zeros_like(h)
        h = torch.maximum(h, zero)
        return torch.einsum("bsf,fd->bsd", h, w2)

    x = A_x
    xn = _layernorm(x, axis=-1)
    s = _A_ref(xn, A_w_r, A_w_i)
    g = _silu(_B_ref(xn, B_w1, B_w2))
    return x + s * g
```

```asm
; @launch grid=(256,1,1) block=(256,1,1) lds=163840
.amdgcn_target "amdgcn-amd-amdhsa--gfx950"
.text
.globl recurrent_scan__spectral_gfnet__dense_activation_relu__prompt_kernel
.p2align 8
.type recurrent_scan__spectral_gfnet__dense_activation_relu__prompt_kernel,@function
recurrent_scan__spectral_gfnet__dense_activation_relu__prompt_kernel:
s_cmp_ge_u32 s2, 256
s_cbranch_scc1 L_end
s_load_dwordx2 s[4:5], s[0:1], 0
s_load_dwordx2 s[12:13], s[0:1], 8
s_load_dwordx2 s[16:17], s[0:1], 16
s_load_dwordx2 s[24:25], s[0:1], 40
s_load_dwordx2 s[8:9], s[0:1], 64
v_lshrrev_b32 v2, 6, v0
v_and_b32 v1, 63, v0
s_and_b32 s54, s2, 7
s_lshr_b32 s55, s2, 3
v_readfirstlane_b32 s52, v2
s_lshl_b32 s53, s54, 5
s_add_u32 s53, s53, s55
s_and_b32 s92, s53, 7
s_lshl_b32 s92, s92, 2
s_add_u32 s92, s92, s52
s_lshl_b32 s92, s92, 6
s_lshr_b32 s93, s53, 3
s_add_u32 s92, s92, s93
s_mul_i32 s92, s92, 1280
v_lshrrev_b32 v3, 5, v1
v_and_b32 v4, 31, v1
v_mul_u32_u24 v5, 40960, v3
v_lshl_add_u32 v5, v4, 3, v5
s_mov_b32 s6, 2621440
s_mov_b32 s7, 0x20000
s_getpc_b64 s[96:97]
L_pc:
s_sub_u32 s96, s96, L_pc-recurrent_scan__spectral_gfnet__dense_activation_relu__prompt_kernel
s_subb_u32 s97, s97, 0
s_mov_b32 s98, tab_pf-recurrent_scan__spectral_gfnet__dense_activation_relu__prompt_kernel
s_mov_b32 s99, 0x20000
s_lshl_b32 s94, s55, 2
s_add_u32 s94, s94, s52
s_lshl_b32 s94, s94, 7
v_lshlrev_b32 v7, 14, v1
v_lshrrev_b32_e64 v20, 3, v1
v_mul_u32_u24 v8, 40960, v20
v_lshrrev_b32 v9, 4, v1
v_and_b32 v2, 7, v1
v_xor_b32_e64 v9, v9, v2
v_lshl_add_u32 v152, v9, 4, v8
s_waitcnt lgkmcnt(0)
s_nop 0
buffer_load_dwordx2 v[10:11], v5, s[4:7], s92 offen offset:0
buffer_load_dwordx2 v[12:13], v5, s[4:7], s92 offen offset:256
buffer_load_dwordx2 v[14:15], v5, s[4:7], s92 offen offset:512
buffer_load_dwordx2 v[16:17], v5, s[4:7], s92 offen offset:768
buffer_load_dwordx2 v[18:19], v5, s[4:7], s92 offen offset:1024
s_mov_b64 exec, 0x7f
buffer_load_dword v5, v7, s[96:99], s94 offen
s_mov_b64 exec, -1
s_add_u32 s32, s96, tab_data-recurrent_scan__spectral_gfnet__dense_activation_relu__prompt_kernel
s_addc_u32 s33, s97, 0
s_lshl_b32 s93, s2, 6
s_nop 0
s_add_u32 s93, s93, 49152
s_load_dwordx16 s[36:51], s[32:33], s93
s_load_dword s56, s[8:9], 0
s_load_dwordx2 s[20:21], s[0:1], 32
s_load_dwordx2 s[28:29], s[0:1], 48
s_mov_b32 s14, 1314816
s_mov_b32 s15, 0x20000
s_mov_b32 s18, 1314816
s_mov_b32 s19, 0x20000
s_mov_b32 s26, 2211840
s_mov_b32 s27, 0x20000
v_subrev_u32_e64 v151, s52, v0
v_min_u32 v150, 160, v151
v_lshlrev_b32 v150, 2, v150
v_lshlrev_b32 v6, 4, v1
s_mov_b32 s34, 65536
s_mov_b32 s35, 0x20000
s_mul_i32 s72, s52, 3072
s_add_u32 m0, s72, 108544
v_add_u32 v121, 108544, v6
buffer_load_dwordx4 v6, s[32:35], s72 offen offset:0 lds
buffer_load_dwordx4 v6, s[32:35], s72 offen offset:1024 lds
buffer_load_dwordx4 v6, s[32:35], s72 offen offset:2048 lds
s_and_b32 s77, s53, 1
s_lshl_b32 s77, s77, 5
s_lshr_b32 s72, s53, 3
s_add_u32 s77, s77, s72
s_bfe_u32 s72, s53, 0x10002
s_lshl_b32 s72, s72, 10
s_add_u32 s77, s77, s72
s_bfe_u32 s72, s53, 0x10001
s_lshl_b32 s72, s72, 8
s_add_u32 s77, s77, s72
s_mul_i32 s77, s77, 642
s_and_b32 s77, s77, -4
s_nop 0
buffer_load_dword v184, v150, s[12:15], s77 offen
buffer_load_dword v185, v150, s[16:19], s77 offen
s_add_u32 s77, s77, 41088
buffer_load_dword v186, v150, s[12:15], s77 offen
buffer_load_dword v187, v150, s[16:19], s77 offen
s_add_u32 s77, s77, 41088
buffer_load_dword v188, v150, s[12:15], s77 offen
buffer_load_dword v189, v150, s[16:19], s77 offen
s_add_u32 s77, s77, 41088
buffer_load_dword v190, v150, s[12:15], s77 offen
buffer_load_dword v191, v150, s[16:19], s77 offen
s_add_u32 s77, s77, 205440
buffer_load_dword v192, v150, s[12:15], s77 offen
buffer_load_dword v193, v150, s[16:19], s77 offen
s_add_u32 s77, s77, 41088
buffer_load_dword v194, v150, s[12:15], s77 offen
buffer_load_dword v195, v150, s[16:19], s77 offen
s_add_u32 s77, s77, 41088
buffer_load_dword v196, v150, s[12:15], s77 offen
buffer_load_dword v197, v150, s[16:19], s77 offen
s_add_u32 s77, s77, 41088
buffer_load_dword v198, v150, s[12:15], s77 offen
buffer_load_dword v199, v150, s[16:19], s77 offen
s_lshl_b32 s72, s52, 10
s_add_u32 m0, s72, 151808
s_mul_i32 s77, s53, 10240
s_add_u32 s77, s77, s72
buffer_load_dwordx4 v6, s[24:27], s77 offen lds
s_lshl_b32 s72, s52, 10
s_add_u32 m0, s72, 155904
s_mul_i32 s77, s53, 10240
s_add_u32 s77, s77, s72
s_add_u32 s77, s77, 4096
buffer_load_dwordx4 v6, s[24:27], s77 offen lds
s_lshl_b32 s72, s52, 10
s_add_u32 m0, s72, 160000
s_mul_i32 s77, s53, 10240
s_add_u32 s77, s77, s72
s_add_u32 s77, s77, 8192
s_cmp_ge_u32 s52, 2
s_cselect_b32 m0, 163840, m0
s_nop 0
buffer_load_dwordx4 v6, s[24:27], s77 offen lds
s_lshr_b32 s97, s52, 1
s_and_b32 s98, s52, 1
s_lshl_b32 s98, s98, 10
s_add_u32 s97, s97, s98
s_mul_i32 s97, s97, 1280
v_add_u32 v152, s97, v152
v_xor_b32 v153, 64, v152
v_add_u32 v153, 327680, v153
v_add_u32 v154, 655360, v152
v_add_u32 v155, 655360, v153
s_mul_i32 s97, s52, 55296
s_mov_b32 s22, 2211840
s_mov_b32 s23, 0x20000
v_mul_u32_u24 v8, 3456, v20
v_bfe_u32 v9, v1, 4, 1
v_lshlrev_b32 v9, 2, v9
v_xor_b32 v9, v9, v2
v_lshl_add_u32 v156, v9, 4, v8
v_add_u32_e64 v156, s97, v156
v_add_u32 v157, 27648, v156
s_lshl_b32 s75, s52, 12
s_lshl_b32 s76, s52, 11
v_lshrrev_b32 v7, 1, v4
v_cvt_f32_u32 v7, v7
v_mul_f32 v7, 0x3acccccd, v7
v_lshlrev_b32 v8, 3, v3
v_cvt_f32_u32 v8, v8
v_mul_f32_e64 v8, v8, v7
v_fmamk_f32 v9, v7, 0x00000000, v8
v_cos_f32 v84, v9
v_sin_f32 v100, v9
v_fmamk_f32 v9, v7, 0x3f800000, v8
v_cos_f32 v85, v9
v_sin_f32 v101, v9
v_fmamk_f32 v9, v7, 0x40000000, v8
v_cos_f32 v86, v9
v_sin_f32 v102, v9
v_fmamk_f32 v9, v7, 0x40400000, v8
v_cos_f32 v87, v9
v_sin_f32 v103, v9
v_fmamk_f32 v9, v7, 0x40800000, v8
v_cos_f32 v88, v9
v_sin_f32 v104, v9
v_fmamk_f32 v9, v7, 0x40a00000, v8
v_cos_f32 v89, v9
v_sin_f32 v105, v9
v_fmamk_f32 v9, v7, 0x40c00000, v8
v_cos_f32 v90, v9
v_sin_f32 v106, v9
v_fmamk_f32 v9, v7, 0x40e00000, v8
v_cos_f32 v91, v9
v_sin_f32 v107, v9
v_fmamk_f32 v9, v7, 0x41800000, v8
v_cos_f32 v92, v9
v_sin_f32 v108, v9
v_fmamk_f32 v9, v7, 0x41880000, v8
v_cos_f32 v93, v9
v_sin_f32 v109, v9
v_fmamk_f32 v9, v7, 0x41900000, v8
v_cos_f32 v94, v9
v_sin_f32 v110, v9
v_fmamk_f32 v9, v7, 0x41980000, v8
v_cos_f32 v95, v9
v_sin_f32 v111, v9
v_fmamk_f32 v9, v7, 0x41a00000, v8
v_cos_f32 v96, v9
v_sin_f32 v112, v9
v_fmamk_f32 v9, v7, 0x41a80000, v8
v_cos_f32 v97, v9
v_sin_f32 v113, v9
v_fmamk_f32 v9, v7, 0x41b00000, v8
v_cos_f32 v98, v9
v_sin_f32 v114, v9
v_fmamk_f32 v9, v7, 0x41b80000, v8
v_cos_f32 v99, v9
v_sin_f32 v115, v9
v_lshrrev_b32 v7, 4, v1
v_xor_b32 v7, v7, v1
v_and_b32 v7, 1, v7
v_cmp_eq_u32 vcc, 0, v7
v_mov_b32 v8, 0x3f803f80
v_lshlrev_b32 v252, 4, v0
v_cndmask_b32 v124, 0, v8, vcc
v_mov_b32 v125, v124
v_mov_b32 v126, v124
v_mov_b32_e64 v127, v124
v_add_u32 v253, 131072, v252
s_mul_i32 s92, s52, 2560
s_add_u32 s92, s92, 98304
v_mul_u32_u24 v7, 1280, v3
v_lshl_add_u32 v7, v4, 3, v7
v_add_u32_e64 v221, s92, v7
v_bfe_u32 v7, v1, 2, 2
v_lshlrev_b32_e64 v7, 6, v7
v_bfe_u32 v8, v1, 4, 1
v_lshl_or_b32 v7, v8, 5, v7
v_mul_u32_u24 v220, 0x8000, v8
v_and_b32_e64 v8, 1, v1
v_lshl_or_b32 v7, v8, 4, v7
v_bfe_u32 v8, v1, 1, 1
v_lshl_or_b32 v7, v8, 3, v7
v_lshl_or_b32 v220, v220, 16, v220
v_add_u32_e64 v223, s92, v7
v_lshl_add_u32 v222, v3, 9, v223
s_waitcnt lgkmcnt(0)
s_nop 0
s_mov_b32 s10, 268435456
s_mov_b32 s11, 0x20000
s_mov_b32 s30, 2621440
s_mov_b32 s31, 0x20000
s_mul_i32 s56, s56, 1664525
s_add_u32 s56, s56, 1013904223
s_mul_i32 s97, s52, 5120
s_add_u32 s44, s44, s97
s_waitcnt vmcnt(23)
s_mul_i32 s77, s52, 3072
s_add_u32 s77, s77, 24576
buffer_load_dwordx4 v[128:131], v6, s[32:35], s77 offen offset:0
v_lshlrev_b32_e64 v20, 16, v10
v_and_b32 v21, 0xffff0000, v10
v_lshlrev_b32_e64 v22, 16, v11
v_and_b32 v23, 0xffff0000, v11
v_lshlrev_b32_e64 v24, 16, v12
v_and_b32 v25, 0xffff0000, v12
v_lshlrev_b32_e64 v26, 16, v13
v_and_b32 v27, 0xffff0000, v13
v_lshlrev_b32_e64 v28, 16, v14
v_and_b32 v29, 0xffff0000, v14
v_lshlrev_b32_e64 v30, 16, v15
v_and_b32 v31, 0xffff0000, v15
buffer_load_dwordx4 v[136:139], v6, s[32:35], s77 offen offset:1024
v_lshlrev_b32_e64 v32, 16, v16
v_and_b32 v33, 0xffff0000, v16
v_lshlrev_b32_e64 v34, 16, v17
v_and_b32 v35, 0xffff0000, v17
v_lshlrev_b32_e64 v36, 16, v18
v_and_b32 v37, 0xffff0000, v18
v_lshlrev_b32_e64 v38, 16, v19
v_and_b32 v39, 0xffff0000, v19
v_pk_add_f32 v[8:9], v[20:21], v[22:23]
v_pk_add_f32 v[10:11], v[24:25], v[26:27]
v_pk_add_f32 v[8:9], v[8:9], v[28:29]
v_pk_add_f32 v[10:11], v[10:11], v[30:31]
v_pk_add_f32 v[8:9], v[8:9], v[32:33]
v_pk_add_f32 v[10:11], v[10:11], v[34:35]
buffer_load_dwordx4 v[140:143], v6, s[32:35], s77 offen offset:2048
v_pk_add_f32 v[8:9], v[8:9], v[36:37]
v_pk_add_f32 v[10:11], v[10:11], v[38:39]
v_pk_add_f32 v[8:9], v[8:9], v[10:11]
v_add_f32 v8, v8, v9
s_nop 1
v_add_f32_dpp v8, v8, v8 row_ror:8 row_mask:0xf bank_mask:0xf
s_nop 1
v_add_f32_dpp v8, v8, v8 row_ror:4 row_mask:0xf bank_mask:0xf
s_nop 1
v_add_f32_dpp v8, v8, v8 row_ror:2 row_mask:0xf bank_mask:0xf
s_nop 1
v_add_f32_dpp v8, v8, v8 row_ror:1 row_mask:0xf bank_mask:0xf
v_mov_b32 v9, v8
s_nop 1
v_permlane16_swap_b32 v9, v8
v_add_f32_e64 v8, v8, v9
v_mul_f32 v8, 0x3acccccd, v8
v_pk_add_f32 v[20:21], v[20:21], v[8:9] op_sel_hi:[1,0] neg_lo:[0,1] neg_hi:[0,1]
v_pk_add_f32 v[22:23], v[22:23], v[8:9] op_sel_hi:[1,0] neg_lo:[0,1] neg_hi:[0,1]
s_lshl_b32 s77, s38, 2
s_add_u32 s77, s77, s52
s_lshl_b32 s77, s77, 10
s_nop 0
s_add_u32 s77, s77, 36864
buffer_load_dwordx4 v[132:135], v6, s[32:35], s77 offen
v_pk_add_f32 v[24:25], v[24:25], v[8:9] op_sel_hi:[1,0] neg_lo:[0,1] neg_hi:[0,1]
v_pk_add_f32 v[26:27], v[26:27], v[8:9] op_sel_hi:[1,0] neg_lo:[0,1] neg_hi:[0,1]
v_pk_add_f32 v[28:29], v[28:29], v[8:9] op_sel_hi:[1,0] neg_lo:[0,1] neg_hi:[0,1]
v_pk_add_f32 v[30:31], v[30:31], v[8:9] op_sel_hi:[1,0] neg_lo:[0,1] neg_hi:[0,1]
v_pk_add_f32 v[32:33], v[32:33], v[8:9] op_sel_hi:[1,0] neg_lo:[0,1] neg_hi:[0,1]
v_pk_add_f32 v[34:35], v[34:35], v[8:9] op_sel_hi:[1,0] neg_lo:[0,1] neg_hi:[0,1]
v_pk_add_f32 v[36:37], v[36:37], v[8:9] op_sel_hi:[1,0] neg_lo:[0,1] neg_hi:[0,1]
v_pk_add_f32 v[38:39], v[38:39], v[8:9] op_sel_hi:[1,0] neg_lo:[0,1] neg_hi:[0,1]
v_pk_mul_f32 v[10:11], v[20:21], v[20:21]
v_pk_mul_f32 v[12:13], v[22:23], v[22:23]
s_mul_i32 s77, s52, 3072
s_add_u32 s77, s77, 12288
buffer_load_dwordx4 v[208:211], v6, s[32:35], s77 offen offset:0
v_pk_fma_f32 v[10:11], v[24:25], v[24:25], v[10:11]
v_pk_fma_f32 v[12:13], v[26:27], v[26:27], v[12:13]
v_pk_fma_f32 v[10:11], v[28:29], v[28:29], v[10:11]
v_pk_fma_f32 v[12:13], v[30:31], v[30:31], v[12:13]
v_pk_fma_f32 v[10:11], v[32:33], v[32:33], v[10:11]
v_pk_fma_f32 v[12:13], v[34:35], v[34:35], v[12:13]
v_pk_fma_f32 v[10:11], v[36:37], v[36:37], v[10:11]
v_pk_fma_f32 v[12:13], v[38:39], v[38:39], v[12:13]
v_pk_add_f32 v[10:11], v[10:11], v[12:13]
v_add_f32 v10, v10, v11
s_nop 1
v_add_f32_dpp v10, v10, v10 row_ror:8 row_mask:0xf bank_mask:0xf
s_nop 1
v_add_f32_dpp v10, v10, v10 row_ror:4 row_mask:0xf bank_mask:0xf
buffer_load_dwordx4 v[212:215], v6, s[32:35], s77 offen offset:1024
s_nop 0
v_add_f32_dpp v10, v10, v10 row_ror:2 row_mask:0xf bank_mask:0xf
s_nop 1
v_add_f32_dpp v10, v10, v10 row_ror:1 row_mask:0xf bank_mask:0xf
v_mov_b32 v11, v10
s_nop 1
v_permlane16_swap_b32 v11, v10
v_add_f32_e64 v10, v10, v11
v_mul_f32 v10, 0x3acccccd, v10
v_cvt_pk_bf16_f32 v12, v8, v10
v_and_b32 v13, 0xffff0000, v12
v_add_f32 v13, 0x3727c5ac, v13
v_cvt_pk_bf16_f32 v13, v13, v13
v_and_b32 v13, 0xffff0000, v13
v_sqrt_f32 v13, v13
v_lshlrev_b32 v15, 16, v12
v_cvt_pk_bf16_f32 v13, v13, v13
v_and_b32 v13, 0xffff0000, v13
buffer_load_dwordx4 v[216:219], v6, s[32:35], s77 offen offset:2048
v_rcp_f32 v14, v13
v_sub_f32 v15, v8, v15
v_mul_f32_e64 v15, v15, v14
s_waitcnt vmcnt(26)
s_waitcnt vmcnt(7)
s_barrier
s_add_u32 s72, s42, 0
s_cmp_ge_u32 s72, 10
s_cselect_b32 s73, 10, 0
s_sub_u32 s72, s72, s73
s_lshl_b32 s73, s72, 7
s_mul_i32 s74, s72, 221184
s_add_u32 s73, s73, s45
s_add_u32 s74, s74, s46
s_add_u32 m0, s75, 0
s_nop 0
buffer_load_dwordx4 v152, s[4:7], s73 offen lds
v_pk_fma_f32 v[20:21], v[20:21], v[14:15], v[14:15] op_sel:[0,0,1] op_sel_hi:[1,0,1]
ds_read_b128 a[208:211], v121 offset:0
v_pk_fma_f32 v[22:23], v[22:23], v[14:15], v[14:15] op_sel:[0,0,1] op_sel_hi:[1,0,1]
ds_read_b128 a[212:215], v121 offset:1024
s_add_u32 m0, s76, 16384
s_nop 0
s_nop 0
buffer_load_dwordx4 v156, s[20:23], s74 offen offset:0 lds
v_cvt_pk_bf16_f32 v40, v20, v21
v_cvt_pk_bf16_f32 v41, v22, v23
ds_write_b64 v221, v[40:41] offset:0
v_pk_fma_f32 v[24:25], v[24:25], v[14:15], v[14:15] op_sel:[0,0,1] op_sel_hi:[1,0,1]
ds_read_b128 a[216:219], v121 offset:2048
v_pk_fma_f32 v[26:27], v[26:27], v[14:15], v[14:15] op_sel:[0,0,1] op_sel_hi:[1,0,1]
ds_read_b128 a[220:223], v121 offset:3072
v_cvt_pk_bf16_f32 v42, v24, v25
v_cvt_pk_bf16_f32 v43, v26, v27
ds_write_b64 v221, v[42:43] offset:256
v_pk_fma_f32 v[28:29], v[28:29], v[14:15], v[14:15] op_sel:[0,0,1] op_sel_hi:[1,0,1]
ds_read_b128 a[224:227], v121 offset:4096
v_pk_fma_f32 v[30:31], v[30:31], v[14:15], v[14:15] op_sel:[0,0,1] op_sel_hi:[1,0,1]
s_add_u32 m0, s75, 1024
s_nop 0
s_nop 0
buffer_load_dwordx4 v153, s[4:7], s73 offen lds
ds_read_b128 a[228:231], v121 offset:5120
v_cvt_pk_bf16_f32 v44, v28, v29
v_cvt_pk_bf16_f32 v45, v30, v31
ds_write_b64 v221, v[44:45] offset:512
v_pk_fma_f32 v[32:33], v[32:33], v[14:15], v[14:15] op_sel:[0,0,1] op_sel_hi:[1,0,1]
v_pk_fma_f32 v[34:35], v[34:35], v[14:15], v[14:15] op_sel:[0,0,1] op_sel_hi:[1,0,1]
v_cvt_pk_bf16_f32 v46, v32, v33
v_cvt_pk_bf16_f32 v47, v34, v35
ds_write_b64 v221, v[46:47] offset:768
v_pk_fma_f32 v[36:37], v[36:37], v[14:15], v[14:15] op_sel:[0,0,1] op_sel_hi:[1,0,1]
v_pk_fma_f32 v[38:39], v[38:39], v[14:15], v[14:15] op_sel:[0,0,1] op_sel_hi:[1,0,1]
v_cvt_pk_bf16_f32 v48, v36, v37
v_cvt_pk_bf16_f32 v49, v38, v39
s_add_u32 m0, s76, 24448
s_nop 0
buffer_load_dwordx4 v156, s[20:23], s74 offen offset:128 lds
ds_write_b64 v221, v[48:49] offset:1024
v_and_b32 v12, 0xffff, v12
v_or_b32 v12, v12, v13
v_mov_b32 v13, s56
s_lshl_b32 s92, s53, 6
s_lshl_b32 s93, s52, 4
s_add_u32 s92, s92, s93
s_add_u32 s92, s92, 65536
v_lshlrev_b32 v2, 3, v3
s_waitcnt lgkmcnt(0)
s_add_u32 m0, s75, 2048
s_nop 0
s_nop 0
buffer_load_dwordx4 v154, s[4:7], s73 offen lds
ds_read_b64_tr_b16 v[40:41], v222 offset:0
ds_read_b64_tr_b16 v[42:43], v222 offset:256
ds_read_b64_tr_b16 v[44:45], v222 offset:1024
ds_read_b64_tr_b16 v[46:47], v222 offset:1280
ds_read_b64_tr_b16 v[48:49], v223 offset:2048
ds_read_b64_tr_b16 v[50:51], v223 offset:2304
s_add_u32 m0, s76, 17408
s_nop 0
s_nop 0
buffer_load_dwordx4 v157, s[20:23], s74 offen offset:0 lds
ds_read_b128 a[232:235], v121 offset:6144
ds_read_b128 a[236:239], v121 offset:7168
ds_read_b128 a[240:243], v121 offset:8192
ds_read_b128 a[244:247], v121 offset:9216
ds_read_b128 a[248:251], v121 offset:10240
ds_read_b128 a[252:255], v121 offset:11264
s_mov_b32 exec_lo, 1
s_mov_b32 exec_hi, 1
buffer_store_dwordx2 v[12:13], v2, s[8:11], s92 offen sc1
s_mov_b64 exec, -1
s_waitcnt lgkmcnt(10)
s_add_u32 m0, s75, 3072
s_nop 0
buffer_load_dwordx4 v155, s[4:7], s73 offen lds
s_add_u32 m0, s76, 25472
s_nop 0
buffer_load_dwordx4 v157, s[20:23], s74 offen offset:128 lds
v_mfma_f32_32x32x16_bf16 v[52:67], v[40:43], a[208:211], 0
v_mfma_f32_32x32x16_bf16 v[68:83], v[40:43], a[220:223], 0
s_waitcnt lgkmcnt(8)
v_mfma_f32_32x32x16_bf16 v[52:67], v[44:47], a[212:215], v[52:67]
v_mfma_f32_32x32x16_bf16 v[68:83], v[44:47], a[224:227], v[68:83]
s_waitcnt lgkmcnt(6)
v_mfma_f32_32x32x16_bf16 v[52:67], v[48:51], a[216:219], v[52:67]
v_mfma_f32_32x32x16_bf16 v[68:83], v[48:51], a[228:231], v[68:83]
s_add_u32 s72, s42, 1
s_cmp_ge_u32 s72, 10
s_cselect_b32 s73, 10, 0
s_sub_u32 s72, s72, s73
s_lshl_b32 s73, s72, 7
s_mul_i32 s74, s72, 221184
s_add_u32 s73, s73, s45
s_add_u32 s74, s74, s46
s_add_u32 m0, s75, 32768
s_nop 0
buffer_load_dwordx4 v152, s[4:7], s73 offen lds
s_waitcnt vmcnt(10)
s_nop 0
ds_read_b64_tr_b16 a[24:25], v138 offset:0
ds_read_b64_tr_b16 a[26:27], v138 offset:5120
ds_read_b64_tr_b16 a[28:29], v139 offset:0
ds_read_b64_tr_b16 a[30:31], v139 offset:5120
ds_read_b64_tr_b16 a[32:33], v140 offset:0
s_add_u32 m0, s76, 49152
s_nop 0
s_nop 0
buffer_load_dwordx4 v156, s[20:23], s74 offen offset:0 lds
ds_read_b64_tr_b16 a[34:35], v140 offset:5120
v_pk_mul_f32 v[8:9], v[52:53], v[84:85]
v_pk_mul_f32 v[10:11], v[68:69], v[84:85]
v_pk_fma_f32 v[8:9], v[68:69], v[100:101], v[8:9]
v_pk_fma_f32 v[10:11], v[52:53], v[100:101], v[10:11] neg_lo:[1,0,0] neg_hi:[1,0,0]
v_cvt_pk_bf16_f32 v160, v8, v9
v_cvt_pk_bf16_f32 v168, v10, v11
v_pk_mul_f32 v[12:13], v[54:55], v[86:87]
v_pk_mul_f32 v[14:15], v[70:71], v[86:87]
v_pk_fma_f32 v[12:13], v[70:71], v[102:103], v[12:13]
v_pk_fma_f32 v[14:15], v[54:55], v[102:103], v[14:15] neg_lo:[1,0,0] neg_hi:[1,0,0]
s_waitcnt lgkmcnt(4)
s_nop 0
buffer_store_dwordx4 a[24:27], v141, s[8:11], s48 offen sc1
v_cvt_pk_bf16_f32 v161, v12, v13
v_cvt_pk_bf16_f32 v169, v14, v15
v_pk_mul_f32 v[8:9], v[56:57], v[88:89]
v_pk_mul_f32 v[10:11], v[72:73], v[88:89]
v_pk_fma_f32 v[8:9], v[72:73], v[104:105], v[8:9]
s_add_u32 m0, s75, 33792
s_nop 0
buffer_load_dwordx4 v153, s[4:7], s73 offen lds
v_pk_fma_f32 v[10:11], v[56:57], v[104:105], v[10:11] neg_lo:[1,0,0] neg_hi:[1,0,0]
v_cvt_pk_bf16_f32 v162, v8, v9
v_cvt_pk_bf16_f32 v170, v10, v11
v_pk_mul_f32 v[12:13], v[58:59], v[90:91]
s_waitcnt lgkmcnt(2)
buffer_store_dwordx4 a[28:31], v142, s[8:11], s48 offen sc1
v_pk_mul_f32 v[14:15], v[74:75], v[90:91]
v_pk_fma_f32 v[12:13], v[74:75], v[106:107], v[12:13]
v_pk_fma_f32 v[14:15], v[58:59], v[106:107], v[14:15] neg_lo:[1,0,0] neg_hi:[1,0,0]
v_cvt_pk_bf16_f32 v163, v12, v13
v_cvt_pk_bf16_f32 v171, v14, v15
v_pk_mul_f32 v[8:9], v[60:61], v[92:93]
v_pk_mul_f32 v[10:11], v[76:77], v[92:93]
v_pk_fma_f32 v[8:9], v[76:77], v[108:109], v[8:9]
v_pk_fma_f32 v[10:11], v[60:61], v[108:109], v[10:11] neg_lo:[1,0,0] neg_hi:[1,0,0]
s_waitcnt lgkmcnt(0)
buffer_store_dwordx4 a[32:35], v143, s[8:11], s48 offen sc1
v_cvt_pk_bf16_f32 v164, v8, v9
s_add_u32 m0, s76, 57216
s_nop 0
buffer_load_dwordx4 v156, s[20:23], s74 offen offset:128 lds
v_cvt_pk_bf16_f32 v172, v10, v11
v_pk_mul_f32 v[12:13], v[62:63], v[94:95]
v_pk_mul_f32 v[14:15], v[78:79], v[94:95]
v_pk_fma_f32 v[12:13], v[78:79], v[110:111], v[12:13]
v_pk_fma_f32 v[14:15], v[62:63], v[110:111], v[14:15] neg_lo:[1,0,0] neg_hi:[1,0,0]
v_cvt_pk_bf16_f32 v165, v12, v13
v_cvt_pk_bf16_f32 v173, v14, v15
v_pk_mul_f32 v[8:9], v[64:65], v[96:97]
v_pk_mul_f32 v[10:11], v[80:81], v[96:97]
v_pk_fma_f32 v[8:9], v[80:81], v[112:113], v[8:9]
v_pk_fma_f32 v[10:11], v[64:65], v[112:113], v[10:11] neg_lo:[1,0,0] neg_hi:[1,0,0]
v_cvt_pk_bf16_f32 v166, v8, v9
v_cvt_pk_bf16_f32 v174, v10, v11
v_pk_mul_f32 v[12:13], v[66:67], v[98:99]
v_pk_mul_f32 v[14:15], v[82:83], v[98:99]
v_pk_fma_f32 v[12:13], v[82:83], v[114:115], v[12:13]
v_pk_fma_f32 v[14:15], v[66:67], v[114:115], v[14:15] neg_lo:[1,0,0] neg_hi:[1,0,0]
v_cvt_pk_bf16_f32 v167, v12, v13
s_add_u32 m0, s75, 34816
s_nop 0
buffer_load_dwordx4 v154, s[4:7], s73 offen lds
v_cvt_pk_bf16_f32 v175, v14, v15
v_mfma_f32_32x32x16_bf16 v[52:67], v[160:163], a[232:235], 0
v_mov_b32 v144, v138
v_mov_b32 v145, v139
v_mov_b32 v146, v140
v_mov_b32_e64 v147, v141
v_mfma_f32_32x32x16_bf16 v[68:83], v[160:163], a[240:243], 0
v_mov_b32 v148, v142
v_mov_b32 v149, v143
v_add_u32 v136, 0x10000, v128
v_add_u32 v137, 0x10000, v129
v_add_u32 v138, 0x10000, v130
v_mfma_f32_32x32x16_bf16 v[52:67], v[168:171], a[248:251], v[52:67]
v_add_u32 v139, 0x10000, v131
v_add_u32 v140, 0x10000, v132
v_add_u32 v141, 0x10000, v133
v_add_u32 v142, 0x10000, v134
v_add_u32 v143, 0x10000, v135
v_mfma_f32_32x32x16_bf16 v[68:83], v[168:171], a[232:235], v[68:83]
s_bitcmp1_b32 s53, 3
s_mov_b32 s94, 0x07060302
s_mov_b32 s95, 0x05040100
s_cselect_b32 s98, s94, s95
s_cselect_b32 s99, s95, s94
v_cmp_eq_u32 vcc, 63, v1
v_min_u32 v8, 161, v151
v_mov_b32 v9, 161
v_cndmask_b32_e64 v8, v8, v9, vcc
v_bfe_u32 v9, v8, 1, 3
v_lshlrev_b32_e64 v9, 4, v9
v_lshl_add_u32 v8, v8, 7, v9
v_add_u32 v8, 131072, v8
v_perm_b32 v20, v185, v184, s98
v_mfma_f32_32x32x16_bf16 v[52:67], v[164:167], a[236:239], v[52:67]
v_perm_b32 v21, v187, v186, s98
v_perm_b32 v22, v189, v188, s98
v_perm_b32 v23, v191, v190, s98
v_xor_b32_e64 v9, 32, v8
ds_write_b128 v9, v[20:23]
v_perm_b32 v24, v193, v192, s98
v_mfma_f32_32x32x16_bf16 v[68:83], v[164:167], a[244:247], v[68:83]
v_perm_b32 v25, v195, v194, s98
v_perm_b32 v26, v197, v196, s98
v_perm_b32 v27, v199, v198, s98
v_xor_b32_e64 v9, 48, v8
ds_write_b128 v9, v[24:27]
s_bitcmp0_b32 s53, 3
s_cbranch_scc1 L_wsh1
v_mov_b32_dpp v184, v184 wave_shl:1 row_mask:0xf bank_mask:0xf
v_mov_b32_dpp v185, v185 wave_shl:1 row_mask:0xf bank_mask:0xf
v_mov_b32_dpp v186, v186 wave_shl:1 row_mask:0xf bank_mask:0xf
v_mov_b32_dpp v187, v187 wave_shl:1 row_mask:0xf bank_mask:0xf
v_mov_b32_dpp v188, v188 wave_shl:1 row_mask:0xf bank_mask:0xf
v_mov_b32_dpp v189, v189 wave_shl:1 row_mask:0xf bank_mask:0xf
v_mov_b32_dpp v190, v190 wave_shl:1 row_mask:0xf bank_mask:0xf
v_mov_b32_dpp v191, v191 wave_shl:1 row_mask:0xf bank_mask:0xf
v_mov_b32_dpp v192, v192 wave_shl:1 row_mask:0xf bank_mask:0xf
v_mov_b32_dpp v193, v193 wave_shl:1 row_mask:0xf bank_mask:0xf
v_mov_b32_dpp v194, v194 wave_shl:1 row_mask:0xf bank_mask:0xf
v_mov_b32_dpp v195, v195 wave_shl:1 row_mask:0xf bank_mask:0xf
v_mov_b32_dpp v196, v196 wave_shl:1 row_mask:0xf bank_mask:0xf
v_mov_b32_dpp v197, v197 wave_shl:1 row_mask:0xf bank_mask:0xf
v_mov_b32_dpp v198, v198 wave_shl:1 row_mask:0xf bank_mask:0xf
v_mov_b32_dpp v199, v199 wave_shl:1 row_mask:0xf bank_mask:0xf
L_wsh1:
v_mfma_f32_32x32x16_bf16 v[52:67], v[172:175], a[252:255], v[52:67]
v_perm_b32 v28, v185, v184, s99
v_perm_b32 v29, v187, v186, s99
v_perm_b32 v30, v189, v188, s99
v_perm_b32 v31, v191, v190, s99
v_xor_b32 v9, 96, v8
ds_write_b128 v9, v[28:31]
v_mfma_f32_32x32x16_bf16 v[68:83], v[172:175], a[236:239], v[68:83]
v_perm_b32 v32, v193, v192, s99
v_perm_b32 v33, v195, v194, s99
v_perm_b32 v34, v197, v196, s99
v_perm_b32 v35, v199, v198, s99
v_xor_b32 v9, 112, v8
ds_write_b128 v9, v[32:35]
v_cvt_pk_bf16_f32 v8, v52, v53
s_nop 4
v_cvt_pk_bf16_f32 v9, v68, v69
v_xor_b32 v9, v220, v9
ds_write_b32 v208, v8
ds_write_b32 v214, v9
v_cvt_pk_bf16_f32 v10, v54, v55
v_cvt_pk_bf16_f32 v11, v70, v71
v_xor_b32_e64 v11, v220, v11
ds_write_b32 v209, v10
ds_write_b32 v215, v11
v_cvt_pk_bf16_f32 v8, v56, v57
v_cvt_pk_bf16_f32 v9, v72, v73
v_xor_b32_e64 v9, v220, v9
ds_write_b32 v210, v8
ds_write_b32 v216, v9
v_cvt_pk_bf16_f32 v10, v58, v59
v_cvt_pk_bf16_f32 v11, v74, v75
v_xor_b32_e64 v11, v220, v11
ds_write_b32 v211, v10
ds_write_b32 v217, v11
v_cvt_pk_bf16_f32 v8, v60, v61
v_cvt_pk_bf16_f32 v9, v76, v77
v_xor_b32_e64 v9, v220, v9
ds_write_b32 v212, v8
ds_write_b32 v218, v9
v_cvt_pk_bf16_f32 v10, v62, v63
v_cvt_pk_bf16_f32 v11, v78, v79
v_xor_b32_e64 v11, v220, v11
ds_write_b32 v213, v10
ds_write_b32 v219, v11
s_cmp_lg_u32 s38, 0
s_cbranch_scc1 L_narrow2
s_cmp_eq_u32 s53, 0
s_cbranch_scc1 L_widejob3
s_waitcnt vmcnt(8)
s_waitcnt lgkmcnt(0)
s_barrier
s_nop 0
ds_read_b128 a[0:3], v253 offset:0
ds_read_b128 a[4:7], v253 offset:4096
ds_read_b128 a[8:11], v253 offset:8192
ds_read_b128 a[12:15], v253 offset:12288
ds_read_b128 a[16:19], v253 offset:16384
ds_read_b128 a[20:23], v253 offset:20480
ds_read_b128 v[112:115], v128 offset:0
ds_read_b64_tr_b16 v[80:81], v132 offset:0
ds_read_b64_tr_b16 v[82:83], v132 offset:512
ds_read_b64_tr_b16 v[84:85], v133 offset:0
ds_read_b64_tr_b16 v[86:87], v133 offset:512
ds_read_b64_tr_b16 v[88:89], v134 offset:0
ds_read_b64_tr_b16 v[90:91], v134 offset:512
ds_read_b64_tr_b16 v[92:93], v135 offset:0
ds_read_b64_tr_b16 v[94:95], v135 offset:512
s_waitcnt lgkmcnt(6)
s_nop 0
v_mfma_f32_32x32x16_bf16 v[16:31], v[80:83], v[112:115], 0
s_add_u32 m0, s76, 50176
ds_read_b128 v[116:119], v129 offset:0
ds_read_b64_tr_b16 v[96:97], v132 offset:2048
ds_read_b64_tr_b16 v[98:99], v132 offset:2560
v_mfma_f32_16x16x32_bf16 v[120:123], v[80:83], v[124:127], 0
buffer_load_dwordx4 v157, s[20:23], s74 offen offset:0 lds
s_waitcnt lgkmcnt(7)
v_mfma_f32_32x32x16_bf16 v[32:47], v[84:87], v[112:115], 0
s_add_u32 m0, s75, 35840
ds_read_b64_tr_b16 v[100:101], v133 offset:2048
ds_read_b64_tr_b16 v[102:103], v133 offset:2560
buffer_load_dwordx4 v155, s[4:7], s73 offen lds
s_waitcnt lgkmcnt(7)
v_mfma_f32_32x32x16_bf16 v[48:63], v[88:91], v[112:115], 0
s_add_u32 m0, s76, 58240
ds_read_b64_tr_b16 v[104:105], v134 offset:2048
ds_read_b64_tr_b16 v[106:107], v134 offset:2560
buffer_load_dwordx4 v157, s[20:23], s74 offen offset:128 lds
s_waitcnt lgkmcnt(7)
v_mfma_f32_32x32x16_bf16 v[64:79], v[92:95], v[112:115], 0
s_add_u32 s72, s42, 2
s_cmp_ge_u32 s72, 10
s_cselect_b32 s73, 10, 0
s_sub_u32 s72, s72, s73
s_lshl_b32 s73, s72, 7
s_mul_i32 s74, s72, 221184
s_add_u32 s73, s73, s45
s_add_u32 s74, s74, s46
s_add_u32 m0, s75, 65536
ds_read_b64_tr_b16 v[108:109], v135 offset:2048
ds_read_b64_tr_b16 v[110:111], v135 offset:2560
buffer_load_dwordx4 v152, s[4:7], s73 offen lds
s_waitcnt lgkmcnt(6)
s_nop 0
v_mfma_f32_32x32x16_bf16 v[16:31], v[96:99], v[116:119], v[16:31]
s_add_u32 m0, s76, 81920
ds_read_b128 v[112:115], v130 offset:0
ds_read_b64_tr_b16 v[80:81], v132 offset:4096
ds_read_b64_tr_b16 v[82:83], v132 offset:4608
v_mfma_f32_16x16x32_bf16 v[120:123], v[96:99], v[124:127], v[120:123]
buffer_load_dwordx4 v156, s[20:23], s74 offen offset:0 lds
s_lshl_b32 s12, s43, 12
v_add_u32 v246, s44, v6
v_add_u32 v247, 4096, v246
s_waitcnt lgkmcnt(7)
v_mfma_f32_32x32x16_bf16 v[32:47], v[100:103], v[116:119], v[32:47]
s_add_u32 m0, s75, 66560
ds_read_b64_tr_b16 v[84:85], v133 offset:4096
ds_read_b64_tr_b16 v[86:87], v133 offset:4608
buffer_load_dwordx4 v153, s[4:7], s73 offen lds
s_waitcnt lgkmcnt(7)
v_mfma_f32_32x32x16_bf16 v[48:63], v[104:107], v[116:119], v[48:63]
s_add_u32 m0, s76, 89984
ds_read_b64_tr_b16 v[88:89], v134 offset:4096
ds_read_b64_tr_b16 v[90:91], v134 offset:4608
buffer_load_dwordx4 v156, s[20:23], s74 offen offset:128 lds
s_waitcnt lgkmcnt(7)
v_mfma_f32_32x32x16_bf16 v[64:79], v[108:111], v[116:119], v[64:79]
s_add_u32 m0, s75, 67584
ds_read_b64_tr_b16 v[92:93], v135 offset:4096
ds_read_b64_tr_b16 v[94:95], v135 offset:4608
buffer_load_dwordx4 v154, s[4:7], s73 offen lds
s_waitcnt lgkmcnt(6)
v_mfma_f32_32x32x16_bf16 v[16:31], v[80:83], v[112:115], v[16:31]
ds_read_b128 v[116:119], v131 offset:0
ds_read_b64_tr_b16 v[96:97], v132 offset:6144
ds_read_b64_tr_b16 v[98:99], v132 offset:6656
v_mfma_f32_16x16x32_bf16 v[120:123], v[80:83], v[124:127], v[120:123]
buffer_store_dwordx4 a[0:3], v252, s[8:11], s47 offen sc1
s_add_u32 m0, s76, 82944
s_nop 0
buffer_load_dwordx4 v157, s[20:23], s74 offen offset:0 lds
s_add_u32 s13, s12, 4096
s_cmp_eq_u32 s13, 53248
s_cselect_b32 s13, 0, s13
s_waitcnt lgkmcnt(7)
v_mfma_f32_32x32x16_bf16 v[32:47], v[84:87], v[112:115], v[32:47]
s_add_u32 m0, s75, 68608
ds_read_b64_tr_b16 v[100:101], v133 offset:6144
ds_read_b64_tr_b16 v[102:103], v133 offset:6656
buffer_load_dwordx4 v155, s[4:7], s73 offen lds
s_waitcnt lgkmcnt(7)
v_mfma_f32_32x32x16_bf16 v[48:63], v[88:91], v[112:115], v[48:63]
s_add_u32 m0, s76, 91008
ds_read_b64_tr_b16 v[104:105], v134 offset:6144
ds_read_b64_tr_b16 v[106:107], v134 offset:6656
buffer_load_dwordx4 v157, s[20:23], s74 offen offset:128 lds
s_waitcnt lgkmcnt(7)
v_mfma_f32_32x32x16_bf16 v[64:79], v[92:95], v[112:115], v[64:79]
s_add_u32 s72, s42, 3
s_cmp_ge_u32 s72, 10
s_cselect_b32 s73, 10, 0
s_sub_u32 s72, s72, s73
s_lshl_b32 s73, s72, 7
s_mul_i32 s74, s72, 221184
s_add_u32 s73, s73, s45
s_add_u32 s74, s74, s46
s_add_u32 m0, s75, 98304
ds_read_b64_tr_b16 v[108:109], v135 offset:6144
ds_read_b64_tr_b16 v[110:111], v135 offset:6656
buffer_load_dwordx4 v152, s[4:7], s73 offen lds
s_waitcnt vmcnt(10)
s_barrier
s_waitcnt lgkmcnt(6)
v_mfma_f32_32x32x16_bf16 v[16:31], v[96:99], v[116:119], v[16:31]
ds_read_b128 v[112:115], v128 offset:32768
ds_read_b64_tr_b16 v[80:81], v132 offset:32768
ds_read_b64_tr_b16 v[82:83], v132 offset:33280
v_mfma_f32_16x16x32_bf16 v[120:123], v[96:99], v[124:127], v[120:123]
s_waitcnt lgkmcnt(7)
v_mfma_f32_32x32x16_bf16 v[32:47], v[100:103], v[116:119], v[32:47]
s_add_u32 s47, s47, 4096
ds_read_b64_tr_b16 v[84:85], v133 offset:32768
ds_read_b64_tr_b16 v[86:87], v133 offset:33280
buffer_store_dwordx4 a[4:7], v252, s[8:11], s47 offen sc1
s_waitcnt lgkmcnt(7)
v_mfma_f32_32x32x16_bf16 v[48:63], v[104:107], v[116:119], v[48:63]
s_add_u32 m0, s76, 114688
ds_read_b64_tr_b16 v[88:89], v134 offset:32768
ds_read_b64_tr_b16 v[90:91], v134 offset:33280
buffer_load_dwordx4 v156, s[20:23], s74 offen offset:0 lds
s_waitcnt lgkmcnt(7)
v_mfma_f32_32x32x16_bf16 v[64:79], v[108:111], v[116:119], v[64:79]
s_add_u32 m0, s75, 99328
ds_read_b64_tr_b16 v[92:93], v135 offset:32768
ds_read_b64_tr_b16 v[94:95], v135 offset:33280
buffer_load_dwordx4 v153, s[4:7], s73 offen lds
s_waitcnt lgkmcnt(6)
s_nop 0
v_mfma_f32_32x32x16_bf16 v[16:31], v[80:83], v[112:115], v[16:31]
ds_read_b128 v[116:119], v129 offset:32768
ds_read_b64_tr_b16 v[96:97], v132 offset:34816
ds_read_b64_tr_b16 v[98:99], v132 offset:35328
v_mfma_f32_16x16x32_bf16 v[120:123], v[80:83], v[124:127], v[120:123]
s_add_u32 s14, s13, 4096
s_cmp_eq_u32 s14, 53248
s_cselect_b32 s14, 0, s14
s_waitcnt lgkmcnt(7)
v_mfma_f32_32x32x16_bf16 v[32:47], v[84:87], v[112:115], v[32:47]
s_add_u32 s47, s47, 4096
ds_read_b64_tr_b16 v[100:101], v133 offset:34816
ds_read_b64_tr_b16 v[102:103], v133 offset:35328
buffer_store_dwordx4 a[8:11], v252, s[8:11], s47 offen sc1
s_waitcnt lgkmcnt(7)
v_mfma_f32_32x32x16_bf16 v[48:63], v[88:91], v[112:115], v[48:63]
s_add_u32 m0, s76, 122752
ds_read_b64_tr_b16 v[104:105], v134 offset:34816
ds_read_b64_tr_b16 v[106:107], v134 offset:35328
buffer_load_dwordx4 v156, s[20:23], s74 offen offset:128 lds
s_waitcnt lgkmcnt(7)
v_mfma_f32_32x32x16_bf16 v[64:79], v[92:95], v[112:115], v[64:79]
s_add_u32 m0, s75, 100352
ds_read_b64_tr_b16 v[108:109], v135 offset:34816
ds_read_b64_tr_b16 v[110:111], v135 offset:35328
buffer_load_dwordx4 v154, s[4:7], s73 offen lds
s_waitcnt lgkmcnt(6)
s_nop 0
v_mfma_f32_32x32x16_bf16 v[16:31], v[96:99], v[116:119], v[16:31]
ds_read_b128 v[112:115], v130 offset:32768
ds_read_b64_tr_b16 v[80:81], v132 offset:36864
ds_read_b64_tr_b16 v[82:83], v132 offset:37376
v_mfma_f32_16x16x32_bf16 v[120:123], v[96:99], v[124:127], v[120:123]
s_add_u32 s15, s14, 4096
s_cmp_eq_u32 s15, 53248
s_cselect_b32 s15, 0, s15
s_waitcnt lgkmcnt(7)
v_mfma_f32_32x32x16_bf16 v[32:47], v[100:103], v[116:119], v[32:47]
s_add_u32 s47, s47, 4096
ds_read_b64_tr_b16 v[84:85], v133 offset:36864
ds_read_b64_tr_b16 v[86:87], v133 offset:37376
buffer_store_dwordx4 a[12:15], v252, s[8:11], s47 offen sc1
s_waitcnt lgkmcnt(7)
v_mfma_f32_32x32x16_bf16 v[48:63], v[104:107], v[116:119], v[48:63]
s_add_u32 m0, s76, 115712
ds_read_b64_tr_b16 v[88:89], v134 offset:36864
ds_read_b64_tr_b16 v[90:91], v134 offset:37376
buffer_load_dwordx4 v157, s[20:23], s74 offen offset:0 lds
s_waitcnt lgkmcnt(7)
v_mfma_f32_32x32x16_bf16 v[64:79], v[108:111], v[116:119], v[64:79]
s_add_u32 m0, s75, 101376
ds_read_b64_tr_b16 v[92:93], v135 offset:36864
ds_read_b64_tr_b16 v[94:95], v135 offset:37376
buffer_load_dwordx4 v155, s[4:7], s73 offen lds
s_waitcnt lgkmcnt(6)
v_mfma_f32_32x32x16_bf16 v[16:31], v[80:83], v[112:115], v[16:31]
ds_read_b128 v[116:119], v131 offset:32768
ds_read_b64_tr_b16 v[96:97], v132 offset:38912
ds_read_b64_tr_b16 v[98:99], v132 offset:39424
v_mfma_f32_16x16x32_bf16 v[120:123], v[80:83], v[124:127], v[120:123]
s_waitcnt lgkmcnt(7)
v_mfma_f32_32x32x16_bf16 v[32:47], v[84:87], v[112:115], v[32:47]
s_add_u32 s47, s47, 4096
ds_read_b64_tr_b16 v[100:101], v133 offset:38912
ds_read_b64_tr_b16 v[102:103], v133 offset:39424
buffer_store_dwordx4 a[16:19], v252, s[8:11], s47 offen sc1
s_waitcnt lgkmcnt(7)
v_mfma_f32_32x32x16_bf16 v[48:63], v[88:91], v[112:115], v[48:63]
ds_read_b64_tr_b16 v[104:105], v134 offset:38912
ds_read_b64_tr_b16 v[106:107], v134 offset:39424
s_waitcnt lgkmcnt(7)
v_mfma_f32_32x32x16_bf16 v[64:79], v[92:95], v[112:115], v[64:79]
s_add_u32 m0, s76, 123776
ds_read_b64_tr_b16 v[108:109], v135 offset:38912
ds_read_b64_tr_b16 v[110:111], v135 offset:39424
buffer_load_dwordx4 v157, s[20:23], s74 offen offset:128 lds
s_waitcnt vmcnt(12)
s_barrier
s_waitcnt lgkmcnt(6)
s_nop 0
v_mfma_f32_32x32x16_bf16 v[16:31], v[96:99], v[116:119], v[16:31]
ds_read_b128 v[112:115], v136 offset:0
ds_read_b64_tr_b16 v[80:81], v140 offset:0
ds_read_b64_tr_b16 v[82:83], v140 offset:512
v_mfma_f32_16x16x32_bf16 v[120:123], v[96:99], v[124:127], v[120:123]
s_add_u32 s16, s15, 4096
s_cmp_eq_u32 s16, 53248
s_cselect_b32 s16, 0, s16
s_waitcnt lgkmcnt(7)
v_mfma_f32_32x32x16_bf16 v[32:47], v[100:103], v[116:119], v[32:47]
ds_read_b64_tr_b16 v[84:85], v141 offset:0
ds_read_b64_tr_b16 v[86:87], v141 offset:512
s_cmp_lg_u32 s52, 0
s_cbranch_scc1 L_o65
s_mov_b64 exec, 0xff
s_add_u32 s47, s47, 4096
buffer_store_dwordx4 a[20:23], v252, s[8:11], s47 offen sc1
s_mov_b64 exec, -1
L_o65:
s_waitcnt lgkmcnt(7)
v_mfma_f32_32x32x16_bf16 v[48:63], v[104:107], v[116:119], v[48:63]
s_add_u32 s72, s42, 4
s_cmp_ge_u32 s72, 10
s_cselect_b32 s73, 10, 0
s_sub_u32 s72, s72, s73
s_lshl_b32 s73, s72, 7
s_mul_i32 s74, s72, 221184
s_add_u32 s73, s73, s45
s_add_u32 s74, s74, s46
s_add_u32 m0, s75, 0
ds_read_b64_tr_b16 v[88:89], v142 offset:0
ds_read_b64_tr_b16 v[90:91], v142 offset:512
buffer_load_dwordx4 v152, s[4:7], s73 offen lds
s_waitcnt lgkmcnt(7)
v_mfma_f32_32x32x16_bf16 v[64:79], v[108:111], v[116:119], v[64:79]
s_add_u32 m0, s76, 16384
ds_read_b64_tr_b16 v[92:93], v143 offset:0
ds_read_b64_tr_b16 v[94:95], v143 offset:512
buffer_load_dwordx4 v156, s[20:23], s74 offen offset:0 lds
s_waitcnt lgkmcnt(6)
v_mfma_f32_32x32x16_bf16 v[16:31], v[80:83], v[112:115], v[16:31]
ds_read_b128 v[116:119], v137 offset:0
ds_read_b64_tr_b16 v[96:97], v140 offset:2048
ds_read_b64_tr_b16 v[98:99], v140 offset:2560
v_mfma_f32_16x16x32_bf16 v[120:123], v[80:83], v[124:127], v[120:123]
s_add_u32 s17, s16, 4096
s_cmp_eq_u32 s17, 53248
s_cselect_b32 s17, 0, s17
s_waitcnt lgkmcnt(7)
v_mfma_f32_32x32x16_bf16 v[32:47], v[84:87], v[112:115], v[32:47]
s_add_u32 m0, s75, 1024
ds_read_b64_tr_b16 v[100:101], v141 offset:2048
ds_read_b64_tr_b16 v[102:103], v141 offset:2560
buffer_load_dwordx4 v153, s[4:7], s73 offen lds
s_waitcnt lgkmcnt(7)
v_mfma_f32_32x32x16_bf16 v[48:63], v[88:91], v[112:115], v[48:63]
ds_read_b64_tr_b16 v[104:105], v142 offset:2048
ds_read_b64_tr_b16 v[106:107], v142 offset:2560
s_waitcnt lgkmcnt(7)
v_mfma_f32_32x32x16_bf16 v[64:79], v[92:95], v[112:115], v[64:79]
s_add_u32 m0, s76, 24448
ds_read_b64_tr_b16 v[108:109], v143 offset:2048
ds_read_b64_tr_b16 v[110:111], v143 offset:2560
buffer_load_dwordx4 v156, s[20:23], s74 offen offset:128 lds
s_waitcnt lgkmcnt(6)
v_mfma_f32_32x32x16_bf16 v[16:31], v[96:99], v[116:119], v[16:31]
ds_read_b128 v[112:115], v138 offset:0
ds_read_b64_tr_b16 v[80:81], v140 offset:4096
ds_read_b64_tr_b16 v[82:83], v140 offset:4608
v_mfma_f32_16x16x32_bf16 v[120:123], v[96:99], v[124:127], v[120:123]
s_waitcnt lgkmcnt(7)
v_mfma_f32_32x32x16_bf16 v[32:47], v[100:103], v[116:119], v[32:47]
s_add_u32 m0, s75, 2048
ds_read_b64_tr_b16 v[84:85], v141 offset:4096
ds_read_b64_tr_b16 v[86:87], v141 offset:4608
buffer_load_dwordx4 v154, s[4:7], s73 offen lds
s_waitcnt lgkmcnt(7)
v_mfma_f32_32x32x16_bf16 v[48:63], v[104:107], v[116:119], v[48:63]
ds_read_b64_tr_b16 v[88:89], v142 offset:4096
ds_read_b64_tr_b16 v[90:91], v142 offset:4608
s_waitcnt lgkmcnt(7)
v_mfma_f32_32x32x16_bf16 v[64:79], v[108:111], v[116:119], v[64:79]
s_add_u32 m0, s76, 17408
ds_read_b64_tr_b16 v[92:93], v143 offset:4096
ds_read_b64_tr_b16 v[94:95], v143 offset:4608
buffer_load_dwordx4 v157, s[20:23], s74 offen offset:0 lds
s_waitcnt lgkmcnt(6)
s_nop 0
v_mfma_f32_32x32x16_bf16 v[16:31], v[80:83], v[112:115], v[16:31]
ds_read_b128 v[116:119], v139 offset:0
ds_read_b64_tr_b16 v[96:97], v140 offset:6144
ds_read_b64_tr_b16 v[98:99], v140 offset:6656
v_mfma_f32_16x16x32_bf16 v[120:123], v[80:83], v[124:127], v[120:123]
s_add_u32 s18, s17, 4096
s_cmp_eq_u32 s18, 53248
s_cselect_b32 s18, 0, s18
s_waitcnt lgkmcnt(7)
v_mfma_f32_32x32x16_bf16 v[32:47], v[84:87], v[112:115], v[32:47]
s_add_u32 m0, s75, 3072
ds_read_b64_tr_b16 v[100:101], v141 offset:6144
ds_read_b64_tr_b16 v[102:103], v141 offset:6656
buffer_load_dwordx4 v155, s[4:7], s73 offen lds
s_waitcnt lgkmcnt(7)
v_mfma_f32_32x32x16_bf16 v[48:63], v[88:91], v[112:115], v[48:63]
ds_read_b64_tr_b16 v[104:105], v142 offset:6144
ds_read_b64_tr_b16 v[106:107], v142 offset:6656
s_waitcnt lgkmcnt(7)
v_mfma_f32_32x32x16_bf16 v[64:79], v[92:95], v[112:115], v[64:79]
s_add_u32 m0, s76, 25472
ds_read_b64_tr_b16 v[108:109], v143 offset:6144
ds_read_b64_tr_b16 v[110:111], v143 offset:6656
buffer_load_dwordx4 v157, s[20:23], s74 offen offset:128 lds
s_waitcnt vmcnt(8)
s_waitcnt vmcnt(8)
s_barrier
s_waitcnt lgkmcnt(6)
v_mfma_f32_32x32x16_bf16 v[16:31], v[96:99], v[116:119], v[16:31]
ds_read_b128 v[112:115], v136 offset:32768
ds_read_b64_tr_b16 v[80:81], v140 offset:32768
ds_read_b64_tr_b16 v[82:83], v140 offset:33280
v_mfma_f32_16x16x32_bf16 v[120:123], v[96:99], v[124:127], v[120:123]
s_add_u32 s19, s18, 4096
s_cmp_eq_u32 s19, 53248
s_cselect_b32 s19, 0, s19
s_waitcnt lgkmcnt(7)
v_mfma_f32_32x32x16_bf16 v[32:47], v[100:103], v[116:119], v[32:47]
s_add_u32 s72, s42, 5
s_cmp_ge_u32 s72, 10
s_cselect_b32 s73, 10, 0
s_sub_u32 s72, s72, s73
s_lshl_b32 s73, s72, 7
s_mul_i32 s74, s72, 221184
s_add_u32 s73, s73, s45
s_add_u32 s74, s74, s46
s_add_u32 m0, s75, 32768
ds_read_b64_tr_b16 v[84:85], v141 offset:32768
ds_read_b64_tr_b16 v[86:87], v141 offset:33280
buffer_load_dwordx4 v152, s[4:7], s73 offen lds
s_waitcnt lgkmcnt(7)
v_mfma_f32_32x32x16_bf16 v[48:63], v[104:107], v[116:119], v[48:63]
ds_read_b64_tr_b16 v[88:89], v142 offset:32768
ds_read_b64_tr_b16 v[90:91], v142 offset:33280
s_waitcnt lgkmcnt(7)
v_mfma_f32_32x32x16_bf16 v[64:79], v[108:111], v[116:119], v[64:79]
s_cmp_lg_u32 s52, 0
s_cbranch_scc1 L_fs7
s_mul_i32 s72, s53, 16
s_add_u32 s72, s72, 131072
v_mov_b32_e64 v8, s56
v_mov_b32 v9, 0
s_mov_b64 exec, 1
buffer_store_dword v8, v9, s[8:11], s72 offen sc1
s_mov_b64 exec, -1
L_fs7:
s_add_u32 m0, s76, 49152
ds_read_b64_tr_b16 v[92:93], v143 offset:32768
ds_read_b64_tr_b16 v[94:95], v143 offset:33280
buffer_load_dwordx4 v156, s[20:23], s74 offen offset:0 lds
s_waitcnt lgkmcnt(6)
v_mfma_f32_32x32x16_bf16 v[16:31], v[80:83], v[112:115], v[16:31]
ds_read_b128 v[116:119], v137 offset:32768
ds_read_b64_tr_b16 v[96:97], v140 offset:34816
ds_read_b64_tr_b16 v[98:99], v140 offset:35328
v_mfma_f32_16x16x32_bf16 v[120:123], v[80:83], v[124:127], v[120:123]
s_waitcnt lgkmcnt(7)
v_mfma_f32_32x32x16_bf16 v[32:47], v[84:87], v[112:115], v[32:47]
s_add_u32 m0, s75, 33792
ds_read_b64_tr_b16 v[100:101], v141 offset:34816
ds_read_b64_tr_b16 v[102:103], v141 offset:35328
buffer_load_dwordx4 v153, s[4:7], s73 offen lds
s_waitcnt lgkmcnt(7)
v_mfma_f32_32x32x16_bf16 v[48:63], v[88:91], v[112:115], v[48:63]
ds_read_b64_tr_b16 v[104:105], v142 offset:34816
ds_read_b64_tr_b16 v[106:107], v142 offset:35328
s_waitcnt lgkmcnt(7)
v_mfma_f32_32x32x16_bf16 v[64:79], v[92:95], v[112:115], v[64:79]
s_add_u32 m0, s76, 57216
ds_read_b64_tr_b16 v[108:109], v143 offset:34816
ds_read_b64_tr_b16 v[110:111], v143 offset:35328
buffer_load_dwordx4 v156, s[20:23], s74 offen offset:128 lds
s_waitcnt lgkmcnt(6)
v_mfma_f32_32x32x16_bf16 v[16:31], v[96:99], v[116:119], v[16:31]
ds_read_b128 v[112:115], v138 offset:32768
ds_read_b64_tr_b16 v[80:81], v140 offset:36864
ds_read_b64_tr_b16 v[82:83], v140 offset:37376
v_mfma_f32_16x16x32_bf16 v[120:123], v[96:99], v[124:127], v[120:123]
s_add_u32 s24, s19, 4096
s_cmp_eq_u32 s24, 53248
s_cselect_b32 s24, 0, s24
s_waitcnt lgkmcnt(7)
v_mfma_f32_32x32x16_bf16 v[32:47], v[100:103], v[116:119], v[32:47]
s_add_u32 m0, s75, 34816
ds_read_b64_tr_b16 v[84:85], v141 offset:36864
ds_read_b64_tr_b16 v[86:87], v141 offset:37376
buffer_load_dwordx4 v154, s[4:7], s73 offen lds
s_waitcnt lgkmcnt(7)
v_mfma_f32_32x32x16_bf16 v[48:63], v[104:107], v[116:119], v[48:63]
ds_read_b64_tr_b16 v[88:89], v142 offset:36864
ds_read_b64_tr_b16 v[90:91], v142 offset:37376
s_waitcnt lgkmcnt(7)
v_mfma_f32_32x32x16_bf16 v[64:79], v[108:111], v[116:119], v[64:79]
s_add_u32 m0, s76, 50176
ds_read_b64_tr_b16 v[92:93], v143 offset:36864
ds_read_b64_tr_b16 v[94:95], v143 offset:37376
buffer_load_dwordx4 v157, s[20:23], s74 offen offset:0 lds
s_waitcnt lgkmcnt(6)
s_nop 0
v_mfma_f32_32x32x16_bf16 v[16:31], v[80:83], v[112:115], v[16:31]
ds_read_b128 v[116:119], v139 offset:32768
ds_read_b64_tr_b16 v[96:97], v140 offset:38912
ds_read_b64_tr_b16 v[98:99], v140 offset:39424
v_mfma_f32_16x16x32_bf16 v[120:123], v[80:83], v[124:127], v[120:123]
s_add_u32 s25, s24, 4096
s_cmp_eq_u32 s25, 53248
s_cselect_b32 s25, 0, s25
s_waitcnt lgkmcnt(7)
v_mfma_f32_32x32x16_bf16 v[32:47], v[84:87], v[112:115], v[32:47]
s_add_u32 m0, s75, 35840
ds_read_b64_tr_b16 v[100:101], v141 offset:38912
ds_read_b64_tr_b16 v[102:103], v141 offset:39424
buffer_load_dwordx4 v155, s[4:7], s73 offen lds
s_waitcnt lgkmcnt(7)
v_mfma_f32_32x32x16_bf16 v[48:63], v[88:91], v[112:115], v[48:63]
ds_read_b64_tr_b16 v[104:105], v142 offset:38912
ds_read_b64_tr_b16 v[106:107], v142 offset:39424
s_waitcnt lgkmcnt(7)
v_mfma_f32_32x32x16_bf16 v[64:79], v[92:95], v[112:115], v[64:79]
s_add_u32 m0, s76, 58240
ds_read_b64_tr_b16 v[108:109], v143 offset:38912
ds_read_b64_tr_b16 v[110:111], v143 offset:39424
buffer_load_dwordx4 v157, s[20:23], s74 offen offset:128 lds
s_waitcnt vmcnt(8)
s_barrier
s_waitcnt lgkmcnt(6)
v_mfma_f32_32x32x16_bf16 v[16:31], v[96:99], v[116:119], v[16:31]
ds_read_b128 v[112:115], v128 offset:0
ds_read_b64_tr_b16 v[80:81], v132 offset:0
ds_read_b64_tr_b16 v[82:83], v132 offset:512
v_mfma_f32_16x16x32_bf16 v[120:123], v[96:99], v[124:127], v[120:123]
s_waitcnt lgkmcnt(7)
v_mfma_f32_32x32x16_bf16 v[32:47], v[100:103], v[116:119], v[32:47]
s_add_u32 s72, s42, 6
s_cmp_ge_u32 s72, 10
s_cselect_b32 s73, 10, 0
s_sub_u32 s72, s72, s73
s_lshl_b32 s73, s72, 7
s_mul_i32 s74, s72, 221184
s_add_u32 s73, s73, s45
s_add_u32 s74, s74, s46
s_add_u32 m0, s75, 65536
ds_read_b64_tr_b16 v[84:85], v133 offset:0
ds_read_b64_tr_b16 v[86:87], v133 offset:512
buffer_load_dwordx4 v152, s[4:7], s73 offen lds
s_waitcnt lgkmcnt(7)
v_mfma_f32_32x32x16_bf16 v[48:63], v[104:107], v[116:119], v[48:63]
ds_read_b64_tr_b16 v[88:89], v134 offset:0
ds_read_b64_tr_b16 v[90:91], v134 offset:512
s_waitcnt lgkmcnt(7)
v_mfma_f32_32x32x16_bf16 v[64:79], v[108:111], v[116:119], v[64:79]
s_add_u32 m0, s76, 81920
ds_read_b64_tr_b16 v[92:93], v135 offset:0
ds_read_b64_tr_b16 v[94:95], v135 offset:512
buffer_load_dwordx4 v156, s[20:23], s74 offen offset:0 lds
s_waitcnt lgkmcnt(6)
v_mfma_f32_32x32x16_bf16 v[16:31], v[80:83], v[112:115], v[16:31]
ds_read_b128 v[116:119], v129 offset:0
ds_read_b64_tr_b16 v[96:97], v132 offset:2048
ds_read_b64_tr_b16 v[98:99], v132 offset:2560
v_mfma_f32_16x16x32_bf16 v[120:123], v[80:83], v[124:127], v[120:123]
s_add_u32 s26, s25, 4096
s_cmp_eq_u32 s26, 53248
s_cselect_b32 s26, 0, s26
s_waitcnt lgkmcnt(7)
v_mfma_f32_32x32x16_bf16 v[32:47], v[84:87], v[112:115], v[32:47]
s_add_u32 m0, s75, 66560
ds_read_b64_tr_b16 v[100:101], v133 offset:2048
ds_read_b64_tr_b16 v[102:103], v133 offset:2560
buffer_load_dwordx4 v153, s[4:7], s73 offen lds
s_waitcnt lgkmcnt(7)
v_mfma_f32_32x32x16_bf16 v[48:63], v[88:91], v[112:115], v[48:63]
ds_read_b64_tr_b16 v[104:105], v134 offset:2048
ds_read_b64_tr_b16 v[106:107], v134 offset:2560
s_waitcnt lgkmcnt(7)
v_mfma_f32_32x32x16_bf16 v[64:79], v[92:95], v[112:115], v[64:79]
s_add_u32 m0, s76, 89984
ds_read_b64_tr_b16 v[108:109], v135 offset:2048
ds_read_b64_tr_b16 v[110:111], v135 offset:2560
buffer_load_dwordx4 v156, s[20:23], s74 offen offset:128 lds
s_waitcnt lgkmcnt(6)
s_nop 0
v_mfma_f32_32x32x16_bf16 v[16:31], v[96:99], v[116:119], v[16:31]
ds_read_b128 v[112:115], v130 offset:0
ds_read_b64_tr_b16 v[80:81], v132 offset:4096
ds_read_b64_tr_b16 v[82:83], v132 offset:4608
v_mfma_f32_16x16x32_bf16 v[120:123], v[96:99], v[124:127], v[120:123]
s_add_u32 s27, s26, 4096
s_cmp_eq_u32 s27, 53248
s_cselect_b32 s27, 0, s27
s_waitcnt lgkmcnt(7)
v_mfma_f32_32x32x16_bf16 v[32:47], v[100:103], v[116:119], v[32:47]
s_add_u32 m0, s75, 67584
ds_read_b64_tr_b16 v[84:85], v133 offset:4096
ds_read_b64_tr_b16 v[86:87], v133 offset:4608
buffer_load_dwordx4 v154, s[4:7], s73 offen lds
s_waitcnt lgkmcnt(7)
v_mfma_f32_32x32x16_bf16 v[48:63], v[104:107], v[116:119], v[48:63]
ds_read_b64_tr_b16 v[88:89], v134 offset:4096
ds_read_b64_tr_b16 v[90:91], v134 offset:4608
s_waitcnt lgkmcnt(7)
v_mfma_f32_32x32x16_bf16 v[64:79], v[108:111], v[116:119], v[64:79]
s_add_u32 m0, s76, 82944
ds_read_b64_tr_b16 v[92:93], v135 offset:4096
ds_read_b64_tr_b16 v[94:95], v135 offset:4608
buffer_load_dwordx4 v157, s[20:23], s74 offen offset:0 lds
s_waitcnt lgkmcnt(6)
v_mfma_f32_32x32x16_bf16 v[16:31], v[80:83], v[112:115], v[16:31]
ds_read_b128 v[116:119], v131 offset:0
ds_read_b64_tr_b16 v[96:97], v132 offset:6144
ds_read_b64_tr_b16 v[98:99], v132 offset:6656
v_mfma_f32_16x16x32_bf16 v[120:123], v[80:83], v[124:127], v[120:123]
s_waitcnt lgkmcnt(7)
v_mfma_f32_32x32x16_bf16 v[32:47], v[84:87], v[112:115], v[32:47]
s_add_u32 m0, s75, 68608
ds_read_b64_tr_b16 v[100:101], v133 offset:6144
ds_read_b64_tr_b16 v[102:103], v133 offset:6656
buffer_load_dwordx4 v155, s[4:7], s73 offen lds
s_waitcnt lgkmcnt(7)
v_mfma_f32_32x32x16_bf16 v[48:63], v[88:91], v[112:115], v[48:63]
ds_read_b64_tr_b16 v[104:105], v134 offset:6144
ds_read_b64_tr_b16 v[106:107], v134 offset:6656
s_waitcnt lgkmcnt(7)
v_mfma_f32_32x32x16_bf16 v[64:79], v[92:95], v[112:115], v[64:79]
s_add_u32 m0, s76, 91008
ds_read_b64_tr_b16 v[108:109], v135 offset:6144
ds_read_b64_tr_b16 v[110:111], v135 offset:6656
buffer_load_dwordx4 v157, s[20:23], s74 offen offset:128 lds
s_waitcnt vmcnt(8)
s_barrier
s_waitcnt lgkmcnt(6)
s_nop 0
v_mfma_f32_32x32x16_bf16 v[16:31], v[96:99], v[116:119], v[16:31]
ds_read_b128 v[112:115], v128 offset:32768
ds_read_b64_tr_b16 v[80:81], v132 offset:32768
ds_read_b64_tr_b16 v[82:83], v132 offset:33280
v_mfma_f32_16x16x32_bf16 v[120:123], v[96:99], v[124:127], v[120:123]
s_add_u32 s57, s27, 4096
s_cmp_eq_u32 s57, 53248
s_cselect_b32 s57, 0, s57
s_waitcnt lgkmcnt(7)
v_mfma_f32_32x32x16_bf16 v[32:47], v[100:103], v[116:119], v[32:47]
s_add_u32 s72, s42, 7
s_cmp_ge_u32 s72, 10
s_cselect_b32 s73, 10, 0
s_sub_u32 s72, s72, s73
s_lshl_b32 s73, s72, 7
s_mul_i32 s74, s72, 221184
s_add_u32 s73, s73, s45
s_add_u32 s74, s74, s46
s_add_u32 m0, s75, 98304
ds_read_b64_tr_b16 v[84:85], v133 offset:32768
ds_read_b64_tr_b16 v[86:87], v133 offset:33280
buffer_load_dwordx4 v152, s[4:7], s73 offen lds
s_waitcnt lgkmcnt(7)
v_mfma_f32_32x32x16_bf16 v[48:63], v[104:107], v[116:119], v[48:63]
ds_read_b64_tr_b16 v[88:89], v134 offset:32768
ds_read_b64_tr_b16 v[90:91], v134 offset:33280
s_waitcnt lgkmcnt(7)
v_mfma_f32_32x32x16_bf16 v[64:79], v[108:111], v[116:119], v[64:79]
s_add_u32 m0, s76, 114688
ds_read_b64_tr_b16 v[92:93], v135 offset:32768
ds_read_b64_tr_b16 v[94:95], v135 offset:33280
buffer_load_dwordx4 v156, s[20:23], s74 offen offset:0 lds
s_waitcnt lgkmcnt(6)
v_mfma_f32_32x32x16_bf16 v[16:31], v[80:83], v[112:115], v[16:31]
ds_read_b128 v[116:119], v129 offset:32768
ds_read_b64_tr_b16 v[96:97], v132 offset:34816
ds_read_b64_tr_b16 v[98:99], v132 offset:35328
v_mfma_f32_16x16x32_bf16 v[120:123], v[80:83], v[124:127], v[120:123]
s_lshl_b32 s92, s52, 7
s_add_u32 s92, s92, 65536
s_waitcnt lgkmcnt(7)
v_mfma_f32_32x32x16_bf16 v[32:47], v[84:87], v[112:115], v[32:47]
s_add_u32 m0, s75, 99328
ds_read_b64_tr_b16 v[100:101], v133 offset:34816
ds_read_b64_tr_b16 v[102:103], v133 offset:35328
buffer_load_dwordx4 v153, s[4:7], s73 offen lds
s_waitcnt lgkmcnt(7)
v_mfma_f32_32x32x16_bf16 v[48:63], v[88:91], v[112:115], v[48:63]
ds_read_b64_tr_b16 v[104:105], v134 offset:34816
ds_read_b64_tr_b16 v[106:107], v134 offset:35328
s_waitcnt lgkmcnt(7)
v_mfma_f32_32x32x16_bf16 v[64:79], v[92:95], v[112:115], v[64:79]
s_add_u32 m0, s76, 122752
ds_read_b64_tr_b16 v[108:109], v135 offset:34816
ds_read_b64_tr_b16 v[110:111], v135 offset:35328
buffer_load_dwordx4 v156, s[20:23], s74 offen offset:128 lds
s_waitcnt lgkmcnt(6)
v_mfma_f32_32x32x16_bf16 v[16:31], v[96:99], v[116:119], v[16:31]
ds_read_b128 v[112:115], v130 offset:32768
ds_read_b64_tr_b16 v[80:81], v132 offset:36864
ds_read_b64_tr_b16 v[82:83], v132 offset:37376
v_mfma_f32_16x16x32_bf16 v[120:123], v[96:99], v[124:127], v[120:123]
s_waitcnt lgkmcnt(7)
v_mfma_f32_32x32x16_bf16 v[32:47], v[100:103], v[116:119], v[32:47]
s_add_u32 m0, s75, 100352
ds_read_b64_tr_b16 v[84:85], v133 offset:36864
ds_read_b64_tr_b16 v[86:87], v133 offset:37376
buffer_load_dwordx4 v154, s[4:7], s73 offen lds
s_waitcnt lgkmcnt(7)
v_mfma_f32_32x32x16_bf16 v[48:63], v[104:107], v[116:119], v[48:63]
ds_read_b64_tr_b16 v[88:89], v134 offset:36864
ds_read_b64_tr_b16 v[90:91], v134 offset:37376
s_waitcnt lgkmcnt(7)
v_mfma_f32_32x32x16_bf16 v[64:79], v[108:111], v[116:119], v[64:79]
s_add_u32 m0, s76, 115712
ds_read_b64_tr_b16 v[92:93], v135 offset:36864
ds_read_b64_tr_b16 v[94:95], v135 offset:37376
buffer_load_dwordx4 v157, s[20:23], s74 offen offset:0 lds
s_waitcnt lgkmcnt(6)
v_mfma_f32_32x32x16_bf16 v[16:31], v[80:83], v[112:115], v[16:31]
ds_read_b128 v[116:119], v131 offset:32768
ds_read_b64_tr_b16 v[96:97], v132 offset:38912
ds_read_b64_tr_b16 v[98:99], v132 offset:39424
v_mfma_f32_16x16x32_bf16 v[120:123], v[80:83], v[124:127], v[120:123]
v_lshrrev_b32 v2, 4, v1
v_lshlrev_b32 v2, 4, v2
v_and_b32 v5, 1, v1
v_lshl_or_b32 v2, v5, 6, v2
v_add_u32 v2, s92, v2
s_waitcnt lgkmcnt(7)
v_mfma_f32_32x32x16_bf16 v[32:47], v[84:87], v[112:115], v[32:47]
s_add_u32 m0, s75, 101376
ds_read_b64_tr_b16 v[100:101], v133 offset:38912
ds_read_b64_tr_b16 v[102:103], v133 offset:39424
buffer_load_dwordx4 v155, s[4:7], s73 offen lds
s_waitcnt lgkmcnt(7)
v_mfma_f32_32x32x16_bf16 v[48:63], v[88:91], v[112:115], v[48:63]
ds_read_b64_tr_b16 v[104:105], v134 offset:38912
ds_read_b64_tr_b16 v[106:107], v134 offset:39424
s_waitcnt lgkmcnt(7)
v_mfma_f32_32x32x16_bf16 v[64:79], v[92:95], v[112:115], v[64:79]
s_add_u32 m0, s76, 123776
ds_read_b64_tr_b16 v[108:109], v135 offset:38912
ds_read_b64_tr_b16 v[110:111], v135 offset:39424
buffer_load_dwordx4 v157, s[20:23], s74 offen offset:128 lds
s_waitcnt vmcnt(8)
s_barrier
s_waitcnt lgkmcnt(6)
s_nop 0
v_mfma_f32_32x32x16_bf16 v[16:31], v[96:99], v[116:119], v[16:31]
ds_read_b128 v[112:115], v136 offset:0
ds_read_b64_tr_b16 v[80:81], v140 offset:0
ds_read_b64_tr_b16 v[82:83], v140 offset:512
v_mfma_f32_16x16x32_bf16 v[120:123], v[96:99], v[124:127], v[120:123]
s_mul_i32 s92, s52, 110592
s_add_u32 s92, s92, s50
s_waitcnt lgkmcnt(7)
v_mfma_f32_32x32x16_bf16 v[32:47], v[100:103], v[116:119], v[32:47]
s_add_u32 s72, s42, 8
s_cmp_ge_u32 s72, 10
s_cselect_b32 s73, 10, 0
s_sub_u32 s72, s72, s73
s_lshl_b32 s73, s72, 7
s_mul_i32 s74, s72, 221184
s_add_u32 s73, s73, s45
s_add_u32 s74, s74, s46
s_add_u32 m0, s75, 0
ds_read_b64_tr_b16 v[84:85], v141 offset:0
ds_read_b64_tr_b16 v[86:87], v141 offset:512
buffer_load_dwordx4 v152, s[4:7], s73 offen lds
s_waitcnt lgkmcnt(7)
v_mfma_f32_32x32x16_bf16 v[48:63], v[104:107], v[116:119], v[48:63]
ds_read_b64_tr_b16 v[88:89], v142 offset:0
ds_read_b64_tr_b16 v[90:91], v142 offset:512
s_waitcnt lgkmcnt(7)
v_mfma_f32_32x32x16_bf16 v[64:79], v[108:111], v[116:119], v[64:79]
s_add_u32 m0, s76, 16384
ds_read_b64_tr_b16 v[92:93], v143 offset:0
ds_read_b64_tr_b16 v[94:95], v143 offset:512
buffer_load_dwordx4 v156, s[20:23], s74 offen offset:0 lds
s_waitcnt lgkmcnt(6)
v_mfma_f32_32x32x16_bf16 v[16:31], v[80:83], v[112:115], v[16:31]
ds_read_b128 v[116:119], v137 offset:0
ds_read_b64_tr_b16 v[96:97], v140 offset:2048
ds_read_b64_tr_b16 v[98:99], v140 offset:2560
v_mfma_f32_16x16x32_bf16 v[120:123], v[80:83], v[124:127], v[120:123]
s_waitcnt lgkmcnt(7)
v_mfma_f32_32x32x16_bf16 v[32:47], v[84:87], v[112:115], v[32:47]
s_add_u32 m0, s75, 1024
ds_read_b64_tr_b16 v[100:101], v141 offset:2048
ds_read_b64_tr_b16 v[102:103], v141 offset:2560
buffer_load_dwordx4 v153, s[4:7], s73 offen lds
s_waitcnt lgkmcnt(7)
v_mfma_f32_32x32x16_bf16 v[48:63], v[88:91], v[112:115], v[48:63]
ds_read_b64_tr_b16 v[104:105], v142 offset:2048
ds_read_b64_tr_b16 v[106:107], v142 offset:2560
s_waitcnt lgkmcnt(7)
v_mfma_f32_32x32x16_bf16 v[64:79], v[92:95], v[112:115], v[64:79]
s_add_u32 m0, s76, 24448
ds_read_b64_tr_b16 v[108:109], v143 offset:2048
ds_read_b64_tr_b16 v[110:111], v143 offset:2560
buffer_load_dwordx4 v156, s[20:23], s74 offen offset:128 lds
s_waitcnt lgkmcnt(6)
s_nop 0
v_mfma_f32_32x32x16_bf16 v[16:31], v[96:99], v[116:119], v[16:31]
ds_read_b128 v[112:115], v138 offset:0
ds_read_b64_tr_b16 v[80:81], v140 offset:4096
ds_read_b64_tr_b16 v[82:83], v140 offset:4608
v_mfma_f32_16x16x32_bf16 v[120:123], v[96:99], v[124:127], v[120:123]
v_bfe_u32 v7, v1, 4, 1
v_mul_u32_u24 v7, 55296, v7
v_and_b32_e64 v5, 15, v1
v_lshl_add_u32 v7, v5, 4, v7
v_lshl_add_u32 v7, v3, 8, v7
s_waitcnt lgkmcnt(7)
v_mfma_f32_32x32x16_bf16 v[32:47], v[100:103], v[116:119], v[32:47]
s_add_u32 m0, s75, 2048
ds_read_b64_tr_b16 v[84:85], v141 offset:4096
ds_read_b64_tr_b16 v[86:87], v141 offset:4608
buffer_load_dwordx4 v154, s[4:7], s73 offen lds
s_waitcnt lgkmcnt(7)
v_mfma_f32_32x32x16_bf16 v[48:63], v[104:107], v[116:119], v[48:63]
ds_read_b64_tr_b16 v[88:89], v142 offset:4096
ds_read_b64_tr_b16 v[90:91], v142 offset:4608
s_waitcnt lgkmcnt(7)
v_mfma_f32_32x32x16_bf16 v[64:79], v[108:111], v[116:119], v[64:79]
s_add_u32 m0, s76, 17408
ds_read_b64_tr_b16 v[92:93], v143 offset:4096
ds_read_b64_tr_b16 v[94:95], v143 offset:4608
buffer_load_dwordx4 v157, s[20:23], s74 offen offset:0 lds
s_waitcnt lgkmcnt(6)
v_mfma_f32_32x32x16_bf16 v[16:31], v[80:83], v[112:115], v[16:31]
ds_read_b128 v[116:119], v139 offset:0
ds_read_b64_tr_b16 v[96:97], v140 offset:6144
ds_read_b64_tr_b16 v[98:99], v140 offset:6656
v_mfma_f32_16x16x32_bf16 v[120:123], v[80:83], v[124:127], v[120:123]
v_lshlrev_b32_e64 v5, 4, v3
v_add_u32 v5, 65536, v5
s_waitcnt lgkmcnt(7)
v_mfma_f32_32x32x16_bf16 v[32:47], v[84:87], v[112:115], v[32:47]
s_add_u32 m0, s75, 3072
ds_read_b64_tr_b16 v[100:101], v141 offset:6144
ds_read_b64_tr_b16 v[102:103], v141 offset:6656
buffer_load_dwordx4 v155, s[4:7], s73 offen lds
s_waitcnt lgkmcnt(7)
v_mfma_f32_32x32x16_bf16 v[48:63], v[88:91], v[112:115], v[48:63]
ds_read_b64_tr_b16 v[104:105], v142 offset:6144
ds_read_b64_tr_b16 v[106:107], v142 offset:6656
s_waitcnt lgkmcnt(7)
v_mfma_f32_32x32x16_bf16 v[64:79], v[92:95], v[112:115], v[64:79]
s_add_u32 m0, s76, 25472
ds_read_b64_tr_b16 v[108:109], v143 offset:6144
ds_read_b64_tr_b16 v[110:111], v143 offset:6656
buffer_load_dwordx4 v157, s[20:23], s74 offen offset:128 lds
s_waitcnt vmcnt(8)
s_barrier
s_waitcnt lgkmcnt(6)
v_mfma_f32_32x32x16_bf16 v[16:31], v[96:99], v[116:119], v[16:31]
ds_read_b128 v[112:115], v136 offset:32768
ds_read_b64_tr_b16 v[80:81], v140 offset:32768
ds_read_b64_tr_b16 v[82:83], v140 offset:33280
v_mfma_f32_16x16x32_bf16 v[120:123], v[96:99], v[124:127], v[120:123]
s_waitcnt lgkmcnt(7)
v_mfma_f32_32x32x16_bf16 v[32:47], v[100:103], v[116:119], v[32:47]
s_add_u32 s72, s42, 9
s_cmp_ge_u32 s72, 10
s_cselect_b32 s73, 10, 0
s_sub_u32 s72, s72, s73
s_lshl_b32 s73, s72, 7
s_mul_i32 s74, s72, 221184
s_add_u32 s73, s73, s45
s_add_u32 s74, s74, s46
s_add_u32 m0, s75, 32768
ds_read_b64_tr_b16 v[84:85], v141 offset:32768
ds_read_b64_tr_b16 v[86:87], v141 offset:33280
buffer_load_dwordx4 v152, s[4:7], s73 offen lds
s_waitcnt lgkmcnt(7)
v_mfma_f32_32x32x16_bf16 v[48:63], v[104:107], v[116:119], v[48:63]
s_add_u32 m0, s76, 49152
ds_read_b64_tr_b16 v[88:89], v142 offset:32768
ds_read_b64_tr_b16 v[90:91], v142 offset:33280
buffer_load_dwordx4 v156, s[20:23], s74 offen offset:0 lds
s_waitcnt lgkmcnt(7)
v_mfma_f32_32x32x16_bf16 v[64:79], v[108:111], v[116:119], v[64:79]
s_add_u32 m0, s75, 33792
ds_read_b64_tr_b16 v[92:93], v143 offset:32768
ds_read_b64_tr_b16 v[94:95], v143 offset:33280
buffer_load_dwordx4 v153, s[4:7], s73 offen lds
s_waitcnt lgkmcnt(6)
v_mfma_f32_32x32x16_bf16 v[16:31], v[80:83], v[112:115], v[16:31]
ds_read_b128 v[116:119], v137 offset:32768
ds_read_b64_tr_b16 v[96:97], v140 offset:34816
ds_read_b64_tr_b16 v[98:99], v140 offset:35328
v_mfma_f32_16x16x32_bf16 v[120:123], v[80:83], v[124:127], v[120:123]
s_add_u32 s94, s52, 0
s_cmp_ge_u32 s94, 4
s_cselect_b32 s95, 4, 0
s_sub_u32 s94, s94, s95
s_waitcnt lgkmcnt(7)
v_mfma_f32_32x32x16_bf16 v[32:47], v[84:87], v[112:115], v[32:47]
s_add_u32 m0, s76, 57216
ds_read_b64_tr_b16 v[100:101], v141 offset:34816
ds_read_b64_tr_b16 v[102:103], v141 offset:35328
buffer_load_dwordx4 v156, s[20:23], s74 offen offset:128 lds
s_waitcnt lgkmcnt(7)
v_mfma_f32_32x32x16_bf16 v[48:63], v[88:91], v[112:115], v[48:63]
ds_read_b64_tr_b16 v[104:105], v142 offset:34816
ds_read_b64_tr_b16 v[106:107], v142 offset:35328
s_waitcnt lgkmcnt(7)
v_mfma_f32_32x32x16_bf16 v[64:79], v[92:95], v[112:115], v[64:79]
s_add_u32 m0, s75, 34816
ds_read_b64_tr_b16 v[108:109], v143 offset:34816
ds_read_b64_tr_b16 v[110:111], v143 offset:35328
buffer_load_dwordx4 v154, s[4:7], s73 offen lds
s_waitcnt lgkmcnt(6)
v_mfma_f32_32x32x16_bf16 v[16:31], v[96:99], v[116:119], v[16:31]
ds_read_b128 v[112:115], v138 offset:32768
ds_read_b64_tr_b16 v[80:81], v140 offset:36864
ds_read_b64_tr_b16 v[82:83], v140 offset:37376
v_mfma_f32_16x16x32_bf16 v[120:123], v[96:99], v[124:127], v[120:123]
s_lshl_b32 s64, s94, 7
s_lshl_b32 s94, s94, 10
s_add_u32 s68, s94, s92
s_waitcnt lgkmcnt(7)
v_mfma_f32_32x32x16_bf16 v[32:47], v[100:103], v[116:119], v[32:47]
ds_read_b64_tr_b16 v[84:85], v141 offset:36864
ds_read_b64_tr_b16 v[86:87], v141 offset:37376
s_cmp_lg_u32 s52, 0
s_cbranch_scc1 L_f1i6
v_mul_u32_u24 v8, 16, v1
v_add_u32 v8, 131072, v8
v_add_u32 v9, 1024, v8
v_add_u32 v10, 2048, v8
v_add_u32 v11, 3072, v8
buffer_load_dword v12, v8, s[8:11], 0 offen sc1
buffer_load_dword v13, v9, s[8:11], 0 offen sc1
buffer_load_dword v14, v10, s[8:11], 0 offen sc1
buffer_load_dword v15, v11, s[8:11], 0 offen sc1
L_f1i6:
s_waitcnt lgkmcnt(7)
v_mfma_f32_32x32x16_bf16 v[48:63], v[104:107], v[116:119], v[48:63]
s_add_u32 m0, s76, 50176
ds_read_b64_tr_b16 v[88:89], v142 offset:36864
ds_read_b64_tr_b16 v[90:91], v142 offset:37376
buffer_load_dwordx4 v157, s[20:23], s74 offen offset:0 lds
s_waitcnt lgkmcnt(7)
v_mfma_f32_32x32x16_bf16 v[64:79], v[108:111], v[116:119], v[64:79]
s_add_u32 m0, s75, 35840
ds_read_b64_tr_b16 v[92:93], v143 offset:36864
ds_read_b64_tr_b16 v[94:95], v143 offset:37376
buffer_load_dwordx4 v155, s[4:7], s73 offen lds
s_waitcnt lgkmcnt(6)
v_mfma_f32_32x32x16_bf16 v[16:31], v[80:83], v[112:115], v[16:31]
ds_read_b128 v[116:119], v139 offset:32768
ds_read_b64_tr_b16 v[96:97], v140 offset:38912
ds_read_b64_tr_b16 v[98:99], v140 offset:39424
v_mfma_f32_16x16x32_bf16 v[120:123], v[80:83], v[124:127], v[120:123]
s_waitcnt lgkmcnt(7)
v_mfma_f32_32x32x16_bf16 v[32:47], v[84:87], v[112:115], v[32:47]
s_add_u32 m0, s76, 58240
ds_read_b64_tr_b16 v[100:101], v141 offset:38912
ds_read_b64_tr_b16 v[102:103], v141 offset:39424
buffer_load_dwordx4 v157, s[20:23], s74 offen offset:128 lds
s_waitcnt lgkmcnt(7)
v_mfma_f32_32x32x16_bf16 v[48:63], v[88:91], v[112:115], v[48:63]
ds_read_b64_tr_b16 v[104:105], v142 offset:38912
ds_read_b64_tr_b16 v[106:107], v142 offset:39424
s_waitcnt lgkmcnt(7)
v_mfma_f32_32x32x16_bf16 v[64:79], v[92:95], v[112:115], v[64:79]
ds_read_b64_tr_b16 v[108:109], v143 offset:38912
ds_read_b64_tr_b16 v[110:111], v143 offset:39424
s_lshl_b32 s72, s36, 7
s_lshl_b32 s77, s52, 5
s_add_u32 s72, s72, s77
s_lshl_b32 s72, s72, 3
s_add_u32 s72, s72, 65536
v_lshlrev_b32 v231, 3, v4
v_add_u32 v231, s72, v231
buffer_load_dwordx2 v[158:159], v231, s[8:11], 0 offen sc1
s_waitcnt vmcnt(9)
s_cmp_lg_u32 s52, 0
s_cbranch_scc1 L_polld9
s_waitcnt vmcnt(4)
s_mov_b32 s79, 0
L_poll8:
v_cmp_ne_u32 vcc, s56, v12
v_cmp_ne_u32 s[62:63], s56, v13
s_nop 0
s_or_b64 vcc, vcc, s[62:63]
v_cmp_ne_u32 s[62:63], s56, v14
s_nop 0
s_or_b64 vcc, vcc, s[62:63]
v_cmp_ne_u32 s[62:63], s56, v15
s_nop 0
s_or_b64 vcc, vcc, s[62:63]
s_add_u32 s79, s79, 1
s_cmp_eq_u64 vcc, 0
s_cbranch_scc1 L_polld9
buffer_load_dword v12, v8, s[8:11], 0 offen sc1
buffer_load_dword v13, v9, s[8:11], 0 offen sc1
buffer_load_dword v14, v10, s[8:11], 0 offen sc1
buffer_load_dword v15, v11, s[8:11], 0 offen sc1
s_waitcnt vmcnt(0)
s_cmp_lt_u32 s79, 200000
s_cbranch_scc1 L_poll8
L_polld9:
s_barrier
s_waitcnt lgkmcnt(6)
v_mfma_f32_32x32x16_bf16 v[16:31], v[96:99], v[116:119], v[16:31]
ds_read_b128 v[112:115], v128 offset:0
ds_read_b64_tr_b16 v[80:81], v132 offset:0
ds_read_b64_tr_b16 v[82:83], v132 offset:512
v_mfma_f32_16x16x32_bf16 v[120:123], v[96:99], v[124:127], v[120:123]
s_add_u32 s94, s52, 1
s_cmp_ge_u32 s94, 4
s_cselect_b32 s95, 4, 0
s_sub_u32 s94, s94, s95
s_waitcnt lgkmcnt(7)
v_mfma_f32_32x32x16_bf16 v[32:47], v[100:103], v[116:119], v[32:47]
s_mul_i32 s77, s12, 5
ds_read_b64_tr_b16 v[84:85], v133 offset:0
ds_read_b64_tr_b16 v[86:87], v133 offset:512
buffer_load_dwordx4 a[0:3], v246, s[8:11], s77 offen offset:0 sc1
s_waitcnt lgkmcnt(7)
v_mfma_f32_32x32x16_bf16 v[48:63], v[104:107], v[116:119], v[48:63]
ds_read_b64_tr_b16 v[88:89], v134 offset:0
ds_read_b64_tr_b16 v[90:91], v134 offset:512
s_waitcnt lgkmcnt(7)
v_mfma_f32_32x32x16_bf16 v[64:79], v[108:111], v[116:119], v[64:79]
ds_read_b64_tr_b16 v[92:93], v135 offset:0
ds_read_b64_tr_b16 v[94:95], v135 offset:512
buffer_load_dwordx4 a[4:7], v246, s[8:11], s77 offen offset:1024 sc1
s_waitcnt lgkmcnt(6)
v_mfma_f32_32x32x16_bf16 v[16:31], v[80:83], v[112:115], v[16:31]
ds_read_b128 v[116:119], v129 offset:0
ds_read_b64_tr_b16 v[96:97], v132 offset:2048
ds_read_b64_tr_b16 v[98:99], v132 offset:2560
v_mfma_f32_16x16x32_bf16 v[120:123], v[80:83], v[124:127], v[120:123]
s_lshl_b32 s65, s94, 7
s_lshl_b32 s94, s94, 10
s_add_u32 s69, s94, s92
s_waitcnt lgkmcnt(7)
v_mfma_f32_32x32x16_bf16 v[32:47], v[84:87], v[112:115], v[32:47]
ds_read_b64_tr_b16 v[100:101], v133 offset:2048
ds_read_b64_tr_b16 v[102:103], v133 offset:2560
buffer_load_dwordx4 a[8:11], v246, s[8:11], s77 offen offset:2048 sc1
s_waitcnt lgkmcnt(7)
v_mfma_f32_32x32x16_bf16 v[48:63], v[88:91], v[112:115], v[48:63]
ds_read_b64_tr_b16 v[104:105], v134 offset:2048
ds_read_b64_tr_b16 v[106:107], v134 offset:2560
s_waitcnt lgkmcnt(7)
v_mfma_f32_32x32x16_bf16 v[64:79], v[92:95], v[112:115], v[64:79]
ds_read_b64_tr_b16 v[108:109], v135 offset:2048
ds_read_b64_tr_b16 v[110:111], v135 offset:2560
buffer_load_dwordx4 a[12:15], v246, s[8:11], s77 offen offset:3072 sc1
s_waitcnt lgkmcnt(6)
v_mfma_f32_32x32x16_bf16 v[16:31], v[96:99], v[116:119], v[16:31]
ds_read_b128 v[112:115], v130 offset:0
ds_read_b64_tr_b16 v[80:81], v132 offset:4096
ds_read_b64_tr_b16 v[82:83], v132 offset:4608
v_mfma_f32_16x16x32_bf16 v[120:123], v[96:99], v[124:127], v[120:123]
s_waitcnt lgkmcnt(7)
v_mfma_f32_32x32x16_bf16 v[32:47], v[100:103], v[116:119], v[32:47]
ds_read_b64_tr_b16 v[84:85], v133 offset:4096
ds_read_b64_tr_b16 v[86:87], v133 offset:4608
buffer_load_dwordx4 a[16:19], v247, s[8:11], s77 offen offset:0 sc1
s_waitcnt lgkmcnt(7)
v_mfma_f32_32x32x16_bf16 v[48:63], v[104:107], v[116:119], v[48:63]
ds_read_b64_tr_b16 v[88:89], v134 offset:4096
ds_read_b64_tr_b16 v[90:91], v134 offset:4608
s_waitcnt lgkmcnt(7)
v_mfma_f32_32x32x16_bf16 v[64:79], v[108:111], v[116:119], v[64:79]
s_mul_i32 s77, s13, 5
ds_read_b64_tr_b16 v[92:93], v135 offset:4096
ds_read_b64_tr_b16 v[94:95], v135 offset:4608
buffer_load_dwordx4 a[20:23], v246, s[8:11], s77 offen offset:0 sc1
s_waitcnt lgkmcnt(6)
v_mfma_f32_32x32x16_bf16 v[16:31], v[80:83], v[112:115], v[16:31]
ds_read_b128 v[116:119], v131 offset:0
ds_read_b64_tr_b16 v[96:97], v132 offset:6144
ds_read_b64_tr_b16 v[98:99], v132 offset:6656
v_mfma_f32_16x16x32_bf16 v[120:123], v[80:83], v[124:127], v[120:123]
s_add_u32 s94, s52, 2
s_cmp_ge_u32 s94, 4
s_cselect_b32 s95, 4, 0
s_sub_u32 s94, s94, s95
s_waitcnt lgkmcnt(7)
v_mfma_f32_32x32x16_bf16 v[32:47], v[84:87], v[112:115], v[32:47]
ds_read_b64_tr_b16 v[100:101], v133 offset:6144
ds_read_b64_tr_b16 v[102:103], v133 offset:6656
buffer_load_dwordx4 a[24:27], v246, s[8:11], s77 offen offset:1024 sc1
s_waitcnt lgkmcnt(7)
v_mfma_f32_32x32x16_bf16 v[48:63], v[88:91], v[112:115], v[48:63]
ds_read_b64_tr_b16 v[104:105], v134 offset:6144
ds_read_b64_tr_b16 v[106:107], v134 offset:6656
s_waitcnt lgkmcnt(7)
v_mfma_f32_32x32x16_bf16 v[64:79], v[92:95], v[112:115], v[64:79]
ds_read_b64_tr_b16 v[108:109], v135 offset:6144
ds_read_b64_tr_b16 v[110:111], v135 offset:6656
buffer_load_dwordx4 a[28:31], v246, s[8:11], s77 offen offset:2048 sc1
s_waitcnt vmcnt(9)
s_barrier
s_waitcnt lgkmcnt(6)
v_mfma_f32_32x32x16_bf16 v[16:31], v[96:99], v[116:119], v[16:31]
ds_read_b128 v[112:115], v128 offset:32768
ds_read_b64_tr_b16 v[80:81], v132 offset:32768
ds_read_b64_tr_b16 v[82:83], v132 offset:33280
v_mfma_f32_16x16x32_bf16 v[120:123], v[96:99], v[124:127], v[120:123]
s_lshl_b32 s66, s94, 7
s_lshl_b32 s94, s94, 10
s_add_u32 s70, s94, s92
s_waitcnt lgkmcnt(7)
v_mfma_f32_32x32x16_bf16 v[32:47], v[100:103], v[116:119], v[32:47]
ds_read_b64_tr_b16 v[84:85], v133 offset:32768
ds_read_b64_tr_b16 v[86:87], v133 offset:33280
buffer_load_dwordx4 a[32:35], v246, s[8:11], s77 offen offset:3072 sc1
s_waitcnt lgkmcnt(7)
v_mfma_f32_32x32x16_bf16 v[48:63], v[104:107], v[116:119], v[48:63]
ds_read_b64_tr_b16 v[88:89], v134 offset:32768
ds_read_b64_tr_b16 v[90:91], v134 offset:33280
s_waitcnt lgkmcnt(7)
v_mfma_f32_32x32x16_bf16 v[64:79], v[108:111], v[116:119], v[64:79]
ds_read_b64_tr_b16 v[92:93], v135 offset:32768
ds_read_b64_tr_b16 v[94:95], v135 offset:33280
buffer_load_dwordx4 a[36:39], v247, s[8:11], s77 offen offset:0 sc1
s_waitcnt lgkmcnt(6)
v_mfma_f32_32x32x16_bf16 v[16:31], v[80:83], v[112:115], v[16:31]
ds_read_b128 v[116:119], v129 offset:32768
ds_read_b64_tr_b16 v[96:97], v132 offset:34816
ds_read_b64_tr_b16 v[98:99], v132 offset:35328
v_mfma_f32_16x16x32_bf16 v[120:123], v[80:83], v[124:127], v[120:123]
s_waitcnt lgkmcnt(7)
v_mfma_f32_32x32x16_bf16 v[32:47], v[84:87], v[112:115], v[32:47]
s_mul_i32 s77, s14, 5
ds_read_b64_tr_b16 v[100:101], v133 offset:34816
ds_read_b64_tr_b16 v[102:103], v133 offset:35328
buffer_load_dwordx4 a[40:43], v246, s[8:11], s77 offen offset:0 sc1
s_waitcnt lgkmcnt(7)
v_mfma_f32_32x32x16_bf16 v[48:63], v[88:91], v[112:115], v[48:63]
ds_read_b64_tr_b16 v[104:105], v134 offset:34816
ds_read_b64_tr_b16 v[106:107], v134 offset:35328
s_waitcnt lgkmcnt(7)
v_mfma_f32_32x32x16_bf16 v[64:79], v[92:95], v[112:115], v[64:79]
ds_read_b64_tr_b16 v[108:109], v135 offset:34816
ds_read_b64_tr_b16 v[110:111], v135 offset:35328
buffer_load_dwordx4 a[44:47], v246, s[8:11], s77 offen offset:1024 sc1
s_waitcnt lgkmcnt(6)
v_mfma_f32_32x32x16_bf16 v[16:31], v[96:99], v[116:119], v[16:31]
ds_read_b128 v[112:115], v130 offset:32768
ds_read_b64_tr_b16 v[80:81], v132 offset:36864
ds_read_b64_tr_b16 v[82:83], v132 offset:37376
v_mfma_f32_16x16x32_bf16 v[120:123], v[96:99], v[124:127], v[120:123]
s_add_u32 s94, s52, 3
s_cmp_ge_u32 s94, 4
s_cselect_b32 s95, 4, 0
s_sub_u32 s94, s94, s95
s_waitcnt lgkmcnt(7)
v_mfma_f32_32x32x16_bf16 v[32:47], v[100:103], v[116:119], v[32:47]
ds_read_b64_tr_b16 v[84:85], v133 offset:36864
ds_read_b64_tr_b16 v[86:87], v133 offset:37376
buffer_load_dwordx4 a[48:51], v246, s[8:11], s77 offen offset:2048 sc1
s_waitcnt lgkmcnt(7)
v_mfma_f32_32x32x16_bf16 v[48:63], v[104:107], v[116:119], v[48:63]
ds_read_b64_tr_b16 v[88:89], v134 offset:36864
ds_read_b64_tr_b16 v[90:91], v134 offset:37376
s_waitcnt lgkmcnt(7)
v_mfma_f32_32x32x16_bf16 v[64:79], v[108:111], v[116:119], v[64:79]
ds_read_b64_tr_b16 v[92:93], v135 offset:36864
ds_read_b64_tr_b16 v[94:95], v135 offset:37376
buffer_load_dwordx4 a[52:55], v246, s[8:11], s77 offen offset:3072 sc1
s_waitcnt lgkmcnt(6)
v_mfma_f32_32x32x16_bf16 v[16:31], v[80:83], v[112:115], v[16:31]
ds_read_b128 v[116:119], v131 offset:32768
ds_read_b64_tr_b16 v[96:97], v132 offset:38912
ds_read_b64_tr_b16 v[98:99], v132 offset:39424
v_mfma_f32_16x16x32_bf16 v[120:123], v[80:83], v[124:127], v[120:123]
s_lshl_b32 s67, s94, 7
s_lshl_b32 s94, s94, 10
s_add_u32 s71, s94, s92
s_waitcnt lgkmcnt(7)
v_mfma_f32_32x32x16_bf16 v[32:47], v[84:87], v[112:115], v[32:47]
ds_read_b64_tr_b16 v[100:101], v133 offset:38912
ds_read_b64_tr_b16 v[102:103], v133 offset:39424
buffer_load_dwordx4 a[56:59], v247, s[8:11], s77 offen offset:0 sc1
s_waitcnt lgkmcnt(7)
v_mfma_f32_32x32x16_bf16 v[48:63], v[88:91], v[112:115], v[48:63]
ds_read_b64_tr_b16 v[104:105], v134 offset:38912
ds_read_b64_tr_b16 v[106:107], v134 offset:39424
s_waitcnt lgkmcnt(7)
v_mfma_f32_32x32x16_bf16 v[64:79], v[92:95], v[112:115], v[64:79]
s_mul_i32 s77, s15, 5
ds_read_b64_tr_b16 v[108:109], v135 offset:38912
ds_read_b64_tr_b16 v[110:111], v135 offset:39424
buffer_load_dwordx4 a[60:63], v246, s[8:11], s77 offen offset:0 sc1
s_waitcnt lgkmcnt(6)
v_mfma_f32_32x32x16_bf16 v[16:31], v[96:99], v[116:119], v[16:31]
v_mfma_f32_16x16x32_bf16 v[120:123], v[96:99], v[124:127], v[120:123]
s_waitcnt lgkmcnt(4)
v_mfma_f32_32x32x16_bf16 v[32:47], v[100:103], v[116:119], v[32:47]
buffer_load_dwordx4 a[64:67], v246, s[8:11], s77 offen offset:1024 sc1
s_waitcnt lgkmcnt(2)
v_mfma_f32_32x32x16_bf16 v[48:63], v[104:107], v[116:119], v[48:63]
s_waitcnt lgkmcnt(0)
v_mfma_f32_32x32x16_bf16 v[64:79], v[108:111], v[116:119], v[64:79]
buffer_load_dwordx4 a[68:71], v246, s[8:11], s77 offen offset:2048 sc1
s_mov_b32 exec_lo, 0x00030003
s_mov_b32 exec_hi, 0x00030003
ds_write_b128 v2, v[120:123]
s_mov_b64 exec, -1
v_add_u32 v9, s64, v5
v_add_u32 v10, s65, v5
v_add_u32 v11, s66, v5
v_add_u32 v12, s67, v5
s_waitcnt vmcnt(18)
s_mov_b32 s79, 0
L_st10:
v_cmp_ne_u32 vcc, s56, v159
s_add_u32 s79, s79, 1
s_cmp_eq_u64 vcc, 0
s_cbranch_scc1 L_std11
buffer_load_dwordx2 v[158:159], v231, s[8:11], 0 offen sc1
s_waitcnt vmcnt(0)
s_cmp_lt_u32 s79, 200000
s_cbranch_scc1 L_st10
L_std11:
v_lshlrev_b32_e64 v158, 16, v158
s_waitcnt lgkmcnt(0)
s_barrier
ds_read_b128 v[112:115], v9 offset:0
ds_read_b128 v[116:119], v9 offset:32
ds_read_b128 v[120:123], v9 offset:64
ds_read_b128 v[124:127], v9 offset:96
ds_read_b128 v[128:131], v10 offset:0
ds_read_b128 v[132:135], v10 offset:32
ds_read_b128 v[136:139], v10 offset:64
ds_read_b128 v[140:143], v10 offset:96
s_waitcnt lgkmcnt(6)
s_nop 0
v_pk_fma_f32 v[16:17], v[158:159], v[112:113], v[16:17] op_sel_hi:[0,1,1] neg_lo:[1,0,0] neg_hi:[1,0,0]
v_pk_fma_f32 v[18:19], v[158:159], v[114:115], v[18:19] op_sel_hi:[0,1,1] neg_lo:[1,0,0] neg_hi:[1,0,0]
v_pk_fma_f32 v[20:21], v[158:159], v[116:117], v[20:21] op_sel_hi:[0,1,1] neg_lo:[1,0,0] neg_hi:[1,0,0]
v_pk_fma_f32 v[22:23], v[158:159], v[118:119], v[22:23] op_sel_hi:[0,1,1] neg_lo:[1,0,0] neg_hi:[1,0,0]
v_cvt_pk_bf16_f32 v80, v16, v17
v_cvt_pk_bf16_f32 v81, v18, v19
v_cvt_pk_bf16_f32 v82, v20, v21
v_cvt_pk_bf16_f32 v83, v22, v23
v_pk_max_i16 v80, v80, 0
v_pk_max_i16 v81, v81, 0
v_pk_max_i16 v82, v82, 0
v_pk_max_i16 v83, v83, 0
buffer_store_dwordx4 v[80:83], v7, s[8:11], s68 offen offset:0 sc1
s_waitcnt lgkmcnt(4)
s_nop 0
v_pk_fma_f32 v[24:25], v[158:159], v[120:121], v[24:25] op_sel_hi:[0,1,1] neg_lo:[1,0,0] neg_hi:[1,0,0]
v_pk_fma_f32 v[26:27], v[158:159], v[122:123], v[26:27] op_sel_hi:[0,1,1] neg_lo:[1,0,0] neg_hi:[1,0,0]
v_pk_fma_f32 v[28:29], v[158:159], v[124:125], v[28:29] op_sel_hi:[0,1,1] neg_lo:[1,0,0] neg_hi:[1,0,0]
v_pk_fma_f32 v[30:31], v[158:159], v[126:127], v[30:31] op_sel_hi:[0,1,1] neg_lo:[1,0,0] neg_hi:[1,0,0]
v_cvt_pk_bf16_f32 v84, v24, v25
v_cvt_pk_bf16_f32 v85, v26, v27
v_cvt_pk_bf16_f32 v86, v28, v29
v_cvt_pk_bf16_f32 v87, v30, v31
v_pk_max_i16 v84, v84, 0
v_pk_max_i16 v85, v85, 0
v_pk_max_i16 v86, v86, 0
v_pk_max_i16 v87, v87, 0
buffer_store_dwordx4 v[84:87], v7, s[8:11], s68 offen offset:512 sc1
ds_read_b128 v[112:115], v11 offset:0
ds_read_b128 v[116:119], v11 offset:32
ds_read_b128 v[120:123], v11 offset:64
ds_read_b128 v[124:127], v11 offset:96
s_waitcnt lgkmcnt(6)
s_nop 0
v_pk_fma_f32 v[32:33], v[158:159], v[128:129], v[32:33] op_sel_hi:[0,1,1] neg_lo:[1,0,0] neg_hi:[1,0,0]
v_pk_fma_f32 v[34:35], v[158:159], v[130:131], v[34:35] op_sel_hi:[0,1,1] neg_lo:[1,0,0] neg_hi:[1,0,0]
v_pk_fma_f32 v[36:37], v[158:159], v[132:133], v[36:37] op_sel_hi:[0,1,1] neg_lo:[1,0,0] neg_hi:[1,0,0]
v_pk_fma_f32 v[38:39], v[158:159], v[134:135], v[38:39] op_sel_hi:[0,1,1] neg_lo:[1,0,0] neg_hi:[1,0,0]
v_cvt_pk_bf16_f32 v88, v32, v33
v_cvt_pk_bf16_f32 v89, v34, v35
v_cvt_pk_bf16_f32 v90, v36, v37
v_cvt_pk_bf16_f32 v91, v38, v39
v_pk_max_i16 v88, v88, 0
v_pk_max_i16 v89, v89, 0
v_pk_max_i16 v90, v90, 0
v_pk_max_i16 v91, v91, 0
buffer_store_dwordx4 v[88:91], v7, s[8:11], s69 offen offset:0 sc1
s_waitcnt lgkmcnt(4)
s_nop 0
v_pk_fma_f32 v[40:41], v[158:159], v[136:137], v[40:41] op_sel_hi:[0,1,1] neg_lo:[1,0,0] neg_hi:[1,0,0]
v_pk_fma_f32 v[42:43], v[158:159], v[138:139], v[42:43] op_sel_hi:[0,1,1] neg_lo:[1,0,0] neg_hi:[1,0,0]
v_pk_fma_f32 v[44:45], v[158:159], v[140:141], v[44:45] op_sel_hi:[0,1,1] neg_lo:[1,0,0] neg_hi:[1,0,0]
v_pk_fma_f32 v[46:47], v[158:159], v[142:143], v[46:47] op_sel_hi:[0,1,1] neg_lo:[1,0,0] neg_hi:[1,0,0]
v_cvt_pk_bf16_f32 v92, v40, v41
v_cvt_pk_bf16_f32 v93, v42, v43
v_cvt_pk_bf16_f32 v94, v44, v45
v_cvt_pk_bf16_f32 v95, v46, v47
v_pk_max_i16 v92, v92, 0
v_pk_max_i16 v93, v93, 0
v_pk_max_i16 v94, v94, 0
v_pk_max_i16 v95, v95, 0
buffer_store_dwordx4 v[92:95], v7, s[8:11], s69 offen offset:512 sc1
ds_read_b128 v[128:131], v12 offset:0
ds_read_b128 v[132:135], v12 offset:32
ds_read_b128 v[136:139], v12 offset:64
ds_read_b128 v[140:143], v12 offset:96
s_waitcnt lgkmcnt(6)
s_nop 0
v_pk_fma_f32 v[48:49], v[158:159], v[112:113], v[48:49] op_sel_hi:[0,1,1] neg_lo:[1,0,0] neg_hi:[1,0,0]
v_pk_fma_f32 v[50:51], v[158:159], v[114:115], v[50:51] op_sel_hi:[0,1,1] neg_lo:[1,0,0] neg_hi:[1,0,0]
v_pk_fma_f32 v[52:53], v[158:159], v[116:117], v[52:53] op_sel_hi:[0,1,1] neg_lo:[1,0,0] neg_hi:[1,0,0]
v_pk_fma_f32 v[54:55], v[158:159], v[118:119], v[54:55] op_sel_hi:[0,1,1] neg_lo:[1,0,0] neg_hi:[1,0,0]
v_cvt_pk_bf16_f32 v96, v48, v49
v_cvt_pk_bf16_f32 v97, v50, v51
v_cvt_pk_bf16_f32 v98, v52, v53
v_cvt_pk_bf16_f32 v99, v54, v55
v_pk_max_i16 v96, v96, 0
v_pk_max_i16 v97, v97, 0
v_pk_max_i16 v98, v98, 0
v_pk_max_i16 v99, v99, 0
buffer_store_dwordx4 v[96:99], v7, s[8:11], s70 offen offset:0 sc1
s_waitcnt lgkmcnt(4)
s_nop 0
v_pk_fma_f32 v[56:57], v[158:159], v[120:121], v[56:57] op_sel_hi:[0,1,1] neg_lo:[1,0,0] neg_hi:[1,0,0]
v_pk_fma_f32 v[58:59], v[158:159], v[122:123], v[58:59] op_sel_hi:[0,1,1] neg_lo:[1,0,0] neg_hi:[1,0,0]
v_pk_fma_f32 v[60:61], v[158:159], v[124:125], v[60:61] op_sel_hi:[0,1,1] neg_lo:[1,0,0] neg_hi:[1,0,0]
v_pk_fma_f32 v[62:63], v[158:159], v[126:127], v[62:63] op_sel_hi:[0,1,1] neg_lo:[1,0,0] neg_hi:[1,0,0]
v_cvt_pk_bf16_f32 v100, v56, v57
v_cvt_pk_bf16_f32 v101, v58, v59
v_cvt_pk_bf16_f32 v102, v60, v61
v_cvt_pk_bf16_f32 v103, v62, v63
v_pk_max_i16 v100, v100, 0
v_pk_max_i16 v101, v101, 0
v_pk_max_i16 v102, v102, 0
v_pk_max_i16 v103, v103, 0
buffer_store_dwordx4 v[100:103], v7, s[8:11], s70 offen offset:512 sc1
s_waitcnt lgkmcnt(2)
s_nop 0
v_pk_fma_f32 v[64:65], v[158:159], v[128:129], v[64:65] op_sel_hi:[0,1,1] neg_lo:[1,0,0] neg_hi:[1,0,0]
v_pk_fma_f32 v[66:67], v[158:159], v[130:131], v[66:67] op_sel_hi:[0,1,1] neg_lo:[1,0,0] neg_hi:[1,0,0]
v_pk_fma_f32 v[68:69], v[158:159], v[132:133], v[68:69] op_sel_hi:[0,1,1] neg_lo:[1,0,0] neg_hi:[1,0,0]
v_pk_fma_f32 v[70:71], v[158:159], v[134:135], v[70:71] op_sel_hi:[0,1,1] neg_lo:[1,0,0] neg_hi:[1,0,0]
v_cvt_pk_bf16_f32 v104, v64, v65
v_cvt_pk_bf16_f32 v105, v66, v67
v_cvt_pk_bf16_f32 v106, v68, v69
v_cvt_pk_bf16_f32 v107, v70, v71
v_pk_max_i16 v104, v104, 0
v_pk_max_i16 v105, v105, 0
v_pk_max_i16 v106, v106, 0
v_pk_max_i16 v107, v107, 0
buffer_store_dwordx4 v[104:107], v7, s[8:11], s71 offen offset:0 sc1
s_waitcnt lgkmcnt(0)
s_nop 0
v_pk_fma_f32 v[72:73], v[158:159], v[136:137], v[72:73] op_sel_hi:[0,1,1] neg_lo:[1,0,0] neg_hi:[1,0,0]
v_pk_fma_f32 v[74:75], v[158:159], v[138:139], v[74:75] op_sel_hi:[0,1,1] neg_lo:[1,0,0] neg_hi:[1,0,0]
v_pk_fma_f32 v[76:77], v[158:159], v[140:141], v[76:77] op_sel_hi:[0,1,1] neg_lo:[1,0,0] neg_hi:[1,0,0]
v_pk_fma_f32 v[78:79], v[158:159], v[142:143], v[78:79] op_sel_hi:[0,1,1] neg_lo:[1,0,0] neg_hi:[1,0,0]
v_cvt_pk_bf16_f32 v108, v72, v73
v_cvt_pk_bf16_f32 v109, v74, v75
v_cvt_pk_bf16_f32 v110, v76, v77
v_cvt_pk_bf16_f32 v111, v78, v79
v_pk_max_i16 v108, v108, 0
v_pk_max_i16 v109, v109, 0
v_pk_max_i16 v110, v110, 0
v_pk_max_i16 v111, v111, 0
buffer_store_dwordx4 v[108:111], v7, s[8:11], s71 offen offset:512 sc1
buffer_load_dwordx4 a[72:75], v246, s[8:11], s77 offen offset:3072 sc1
s_mul_i32 s92, s41, 40
v_and_b32 v158, 15, v1
v_add_u32 v159, s92, v158
v_cvt_f32_u32 v112, v159
v_add_f32 v113, 0x41800000, v112
v_and_b32 v159, 7, v158
v_lshrrev_b32 v158, 3, v158
v_mul_u32_u24 v158, 320, v158
v_add3_u32 v159, v159, v158, s92
v_add_u32_e64 v159, 32, v159
v_cvt_f32_u32 v114, v159
s_and_b32 s92, s52, 1
s_mul_i32 s92, s92, 160
s_lshr_b32 s93, s52, 1
s_add_u32 s92, s92, s93
v_lshrrev_b32_e64 v158, 4, v1
v_lshl_add_u32 v158, v158, 3, s92
v_cvt_f32_u32_e64 v115, v158
s_mul_i32 s92, s52, 15360
s_add_u32 s92, s92, 0
v_add_u32 v134, s92, v6
buffer_load_dwordx4 a[76:79], v247, s[8:11], s77 offen offset:0 sc1
v_mul_f32 v158, 0.5, v112
v_fract_f32 v158, v158
v_mul_f32 v112, 0x3acccccd, v112
v_cos_f32 v158, v158
v_mul_f32 v159, v115, v112
v_cvt_pk_bf16_f32 v160, 1.0, v158
v_fract_f32 v159, v159
v_add_f32 v158, v112, v112
v_mul_f32 v135, 0x41d00000, v112
v_cos_f32_e64 v116, v159
v_sin_f32 v117, -v159
v_cos_f32_e64 v122, v158
v_sin_f32 v123, -v158
s_mul_i32 s77, s16, 5
buffer_load_dwordx4 a[80:83], v246, s[8:11], s77 offen offset:0 sc1
v_cos_f32 v128, v135
v_sin_f32 v129, -v135
v_mul_f32 v158, 0.5, v113
v_fract_f32 v158, v158
v_mul_f32 v113, 0x3acccccd, v113
v_cos_f32 v158, v158
v_mul_f32 v159, v115, v113
v_cvt_pk_bf16_f32 v161, 1.0, v158
v_fract_f32 v159, v159
v_add_f32 v158, v113, v113
v_mul_f32 v135, 0x41d00000, v113
v_cos_f32_e64 v118, v159
v_sin_f32 v119, -v159
buffer_load_dwordx4 a[84:87], v246, s[8:11], s77 offen offset:1024 sc1
v_cos_f32_e64 v124, v158
v_sin_f32 v125, -v158
v_cos_f32_e64 v130, v135
v_sin_f32 v131, -v135
v_mul_f32 v158, 0.5, v114
v_fract_f32 v158, v158
v_mul_f32 v114, 0x3acccccd, v114
v_cos_f32 v158, v158
v_mul_f32 v159, v115, v114
v_cvt_pk_bf16_f32 v162, 1.0, v158
v_fract_f32 v159, v159
v_add_f32 v158, v114, v114
v_mul_f32 v135, 0x41d00000, v114
buffer_load_dwordx4 a[88:91], v246, s[8:11], s77 offen offset:2048 sc1
v_cos_f32_e64 v120, v159
v_sin_f32 v121, -v159
v_cos_f32_e64 v126, v158
v_sin_f32 v127, -v158
v_cos_f32_e64 v132, v135
v_sin_f32 v133, -v135
v_cvt_pk_bf16_f32 v136, v116, v117
v_pk_mul_f32 v[164:165], v[116:117], v[122:123] op_sel_hi:[1,0]
v_pk_fma_f32 v[116:117], v[116:117], v[122:123], v[164:165] op_sel:[1,1,0] op_sel_hi:[0,1,1] neg_lo:[1,0,0]
v_cvt_pk_bf16_f32 v140, v118, v119
v_pk_mul_f32 v[166:167], v[118:119], v[124:125] op_sel_hi:[1,0]
v_pk_fma_f32 v[118:119], v[118:119], v[124:125], v[166:167] op_sel:[1,1,0] op_sel_hi:[0,1,1] neg_lo:[1,0,0]
v_cvt_pk_bf16_f32 v144, v120, v121
buffer_load_dwordx4 a[92:95], v246, s[8:11], s77 offen offset:3072 sc1
v_pk_mul_f32 v[168:169], v[120:121], v[126:127] op_sel_hi:[1,0]
v_pk_fma_f32 v[120:121], v[120:121], v[126:127], v[168:169] op_sel:[1,1,0] op_sel_hi:[0,1,1] neg_lo:[1,0,0]
v_cvt_pk_bf16_f32 v137, v116, v117
v_pk_mul_f32 v[164:165], v[116:117], v[122:123] op_sel_hi:[1,0]
v_pk_fma_f32 v[116:117], v[116:117], v[122:123], v[164:165] op_sel:[1,1,0] op_sel_hi:[0,1,1] neg_lo:[1,0,0]
v_cvt_pk_bf16_f32 v141, v118, v119
v_pk_mul_f32 v[166:167], v[118:119], v[124:125] op_sel_hi:[1,0]
v_pk_fma_f32 v[118:119], v[118:119], v[124:125], v[166:167] op_sel:[1,1,0] op_sel_hi:[0,1,1] neg_lo:[1,0,0]
v_cvt_pk_bf16_f32 v145, v120, v121
v_pk_mul_f32 v[168:169], v[120:121], v[126:127] op_sel_hi:[1,0]
v_pk_fma_f32 v[120:121], v[120:121], v[126:127], v[168:169] op_sel:[1,1,0] op_sel_hi:[0,1,1] neg_lo:[1,0,0]
v_cvt_pk_bf16_f32 v138, v116, v117
v_pk_mul_f32 v[164:165], v[116:117], v[122:123] op_sel_hi:[1,0]
v_pk_fma_f32 v[116:117], v[116:117], v[122:123], v[164:165] op_sel:[1,1,0] op_sel_hi:[0,1,1] neg_lo:[1,0,0]
v_cvt_pk_bf16_f32 v142, v118, v119
v_pk_mul_f32 v[166:167], v[118:119], v[124:125] op_sel_hi:[1,0]
v_pk_fma_f32 v[118:119], v[118:119], v[124:125], v[166:167] op_sel:[1,1,0] op_sel_hi:[0,1,1] neg_lo:[1,0,0]
v_cvt_pk_bf16_f32 v146, v120, v121
v_pk_mul_f32 v[168:169], v[120:121], v[126:127] op_sel_hi:[1,0]
buffer_load_dwordx4 a[96:99], v247, s[8:11], s77 offen offset:0 sc1
v_pk_fma_f32 v[120:121], v[120:121], v[126:127], v[168:169] op_sel:[1,1,0] op_sel_hi:[0,1,1] neg_lo:[1,0,0]
v_cvt_pk_bf16_f32 v139, v116, v117
v_pk_mul_f32 v[164:165], v[116:117], v[128:129] op_sel_hi:[1,0]
v_pk_fma_f32 v[116:117], v[116:117], v[128:129], v[164:165] op_sel:[1,1,0] op_sel_hi:[0,1,1] neg_lo:[1,0,0]
v_cmp_eq_f32 vcc, 0, v115
s_nop 1
v_cndmask_b32_e64 v136, v136, v160, vcc
ds_write_b128 v134, v[136:139] offset:0
v_cvt_pk_bf16_f32 v143, v118, v119
v_pk_mul_f32 v[166:167], v[118:119], v[130:131] op_sel_hi:[1,0]
v_pk_fma_f32 v[118:119], v[118:119], v[130:131], v[166:167] op_sel:[1,1,0] op_sel_hi:[0,1,1] neg_lo:[1,0,0]
v_cmp_eq_f32 vcc, 0, v115
s_nop 1
v_cndmask_b32_e64 v140, v140, v161, vcc
ds_write_b128 v134, v[140:143] offset:1024
v_cvt_pk_bf16_f32 v147, v120, v121
v_pk_mul_f32 v[168:169], v[120:121], v[132:133] op_sel_hi:[1,0]
v_pk_fma_f32 v[120:121], v[120:121], v[132:133], v[168:169] op_sel:[1,1,0] op_sel_hi:[0,1,1] neg_lo:[1,0,0]
v_cmp_eq_f32 vcc, 0, v115
s_nop 1
v_cndmask_b32 v144, v144, v162, vcc
s_mul_i32 s77, s17, 5
buffer_load_dwordx4 a[100:103], v246, s[8:11], s77 offen offset:0 sc1
ds_write_b128 v134, v[144:147] offset:2048
v_cvt_pk_bf16_f32 v172, v116, v117
v_pk_mul_f32 v[164:165], v[116:117], v[122:123] op_sel_hi:[1,0]
v_pk_fma_f32 v[116:117], v[116:117], v[122:123], v[164:165] op_sel:[1,1,0] op_sel_hi:[0,1,1] neg_lo:[1,0,0]
v_cvt_pk_bf16_f32 v176, v118, v119
v_pk_mul_f32 v[166:167], v[118:119], v[124:125] op_sel_hi:[1,0]
v_pk_fma_f32 v[118:119], v[118:119], v[124:125], v[166:167] op_sel:[1,1,0] op_sel_hi:[0,1,1] neg_lo:[1,0,0]
v_cvt_pk_bf16_f32 v180, v120, v121
v_pk_mul_f32 v[168:169], v[120:121], v[126:127] op_sel_hi:[1,0]
v_pk_fma_f32 v[120:121], v[120:121], v[126:127], v[168:169] op_sel:[1,1,0] op_sel_hi:[0,1,1] neg_lo:[1,0,0]
v_cvt_pk_bf16_f32 v173, v116, v117
v_pk_mul_f32 v[164:165], v[116:117], v[122:123] op_sel_hi:[1,0]
v_pk_fma_f32 v[116:117], v[116:117], v[122:123], v[164:165] op_sel:[1,1,0] op_sel_hi:[0,1,1] neg_lo:[1,0,0]
v_cvt_pk_bf16_f32 v177, v118, v119
v_pk_mul_f32 v[166:167], v[118:119], v[124:125] op_sel_hi:[1,0]
v_pk_fma_f32 v[118:119], v[118:119], v[124:125], v[166:167] op_sel:[1,1,0] op_sel_hi:[0,1,1] neg_lo:[1,0,0]
buffer_load_dwordx4 a[104:107], v246, s[8:11], s77 offen offset:1024 sc1
v_cvt_pk_bf16_f32 v181, v120, v121
v_pk_mul_f32 v[168:169], v[120:121], v[126:127] op_sel_hi:[1,0]
v_pk_fma_f32 v[120:121], v[120:121], v[126:127], v[168:169] op_sel:[1,1,0] op_sel_hi:[0,1,1] neg_lo:[1,0,0]
v_cvt_pk_bf16_f32 v174, v116, v117
v_pk_mul_f32 v[164:165], v[116:117], v[122:123] op_sel_hi:[1,0]
v_pk_fma_f32 v[116:117], v[116:117], v[122:123], v[164:165] op_sel:[1,1,0] op_sel_hi:[0,1,1] neg_lo:[1,0,0]
v_cvt_pk_bf16_f32 v178, v118, v119
v_pk_mul_f32 v[166:167], v[118:119], v[124:125] op_sel_hi:[1,0]
v_pk_fma_f32 v[118:119], v[118:119], v[124:125], v[166:167] op_sel:[1,1,0] op_sel_hi:[0,1,1] neg_lo:[1,0,0]
v_cvt_pk_bf16_f32 v182, v120, v121
v_pk_mul_f32 v[168:169], v[120:121], v[126:127] op_sel_hi:[1,0]
v_pk_fma_f32 v[120:121], v[120:121], v[126:127], v[168:169] op_sel:[1,1,0] op_sel_hi:[0,1,1] neg_lo:[1,0,0]
v_cvt_pk_bf16_f32 v175, v116, v117
v_pk_mul_f32 v[164:165], v[116:117], v[128:129] op_sel_hi:[1,0]
v_pk_fma_f32 v[116:117], v[116:117], v[128:129], v[164:165] op_sel:[1,1,0] op_sel_hi:[0,1,1] neg_lo:[1,0,0]
ds_write_b128 v134, v[172:175] offset:3072
v_cvt_pk_bf16_f32 v179, v118, v119
v_pk_mul_f32 v[166:167], v[118:119], v[130:131] op_sel_hi:[1,0]
v_pk_fma_f32 v[118:119], v[118:119], v[130:131], v[166:167] op_sel:[1,1,0] op_sel_hi:[0,1,1] neg_lo:[1,0,0]
buffer_load_dwordx4 a[108:111], v246, s[8:11], s77 offen offset:2048 sc1
ds_write_b128 v134, v[176:179] offset:4096
v_cvt_pk_bf16_f32 v183, v120, v121
v_pk_mul_f32 v[168:169], v[120:121], v[132:133] op_sel_hi:[1,0]
v_pk_fma_f32 v[120:121], v[120:121], v[132:133], v[168:169] op_sel:[1,1,0] op_sel_hi:[0,1,1] neg_lo:[1,0,0]
ds_write_b128 v134, v[180:183] offset:5120
v_cvt_pk_bf16_f32 v136, v116, v117
v_pk_mul_f32 v[164:165], v[116:117], v[122:123] op_sel_hi:[1,0]
v_pk_fma_f32 v[116:117], v[116:117], v[122:123], v[164:165] op_sel:[1,1,0] op_sel_hi:[0,1,1] neg_lo:[1,0,0]
v_cvt_pk_bf16_f32 v140, v118, v119
v_pk_mul_f32 v[166:167], v[118:119], v[124:125] op_sel_hi:[1,0]
v_pk_fma_f32 v[118:119], v[118:119], v[124:125], v[166:167] op_sel:[1,1,0] op_sel_hi:[0,1,1] neg_lo:[1,0,0]
v_cvt_pk_bf16_f32 v144, v120, v121
v_pk_mul_f32 v[168:169], v[120:121], v[126:127] op_sel_hi:[1,0]
v_pk_fma_f32 v[120:121], v[120:121], v[126:127], v[168:169] op_sel:[1,1,0] op_sel_hi:[0,1,1] neg_lo:[1,0,0]
v_cvt_pk_bf16_f32 v137, v116, v117
v_pk_mul_f32 v[164:165], v[116:117], v[122:123] op_sel_hi:[1,0]
v_pk_fma_f32 v[116:117], v[116:117], v[122:123], v[164:165] op_sel:[1,1,0] op_sel_hi:[0,1,1] neg_lo:[1,0,0]
v_cvt_pk_bf16_f32 v141, v118, v119
v_pk_mul_f32 v[166:167], v[118:119], v[124:125] op_sel_hi:[1,0]
buffer_load_dwordx4 a[112:115], v246, s[8:11], s77 offen offset:3072 sc1
v_pk_fma_f32 v[118:119], v[118:119], v[124:125], v[166:167] op_sel:[1,1,0] op_sel_hi:[0,1,1] neg_lo:[1,0,0]
v_cvt_pk_bf16_f32 v145, v120, v121
v_pk_mul_f32 v[168:169], v[120:121], v[126:127] op_sel_hi:[1,0]
v_pk_fma_f32 v[120:121], v[120:121], v[126:127], v[168:169] op_sel:[1,1,0] op_sel_hi:[0,1,1] neg_lo:[1,0,0]
v_cvt_pk_bf16_f32 v138, v116, v117
v_pk_mul_f32 v[164:165], v[116:117], v[122:123] op_sel_hi:[1,0]
v_pk_fma_f32 v[116:117], v[116:117], v[122:123], v[164:165] op_sel:[1,1,0] op_sel_hi:[0,1,1] neg_lo:[1,0,0]
v_cvt_pk_bf16_f32 v142, v118, v119
v_pk_mul_f32 v[166:167], v[118:119], v[124:125] op_sel_hi:[1,0]
v_pk_fma_f32 v[118:119], v[118:119], v[124:125], v[166:167] op_sel:[1,1,0] op_sel_hi:[0,1,1] neg_lo:[1,0,0]
v_cvt_pk_bf16_f32 v146, v120, v121
v_pk_mul_f32 v[168:169], v[120:121], v[126:127] op_sel_hi:[1,0]
v_pk_fma_f32 v[120:121], v[120:121], v[126:127], v[168:169] op_sel:[1,1,0] op_sel_hi:[0,1,1] neg_lo:[1,0,0]
v_cvt_pk_bf16_f32 v139, v116, v117
v_pk_mul_f32 v[164:165], v[116:117], v[128:129] op_sel_hi:[1,0]
v_pk_fma_f32 v[116:117], v[116:117], v[128:129], v[164:165] op_sel:[1,1,0] op_sel_hi:[0,1,1] neg_lo:[1,0,0]
ds_write_b128 v134, v[136:139] offset:6144
v_cvt_pk_bf16_f32 v143, v118, v119
v_pk_mul_f32 v[166:167], v[118:119], v[130:131] op_sel_hi:[1,0]
buffer_load_dwordx4 a[116:119], v247, s[8:11], s77 offen offset:0 sc1
v_pk_fma_f32 v[118:119], v[118:119], v[130:131], v[166:167] op_sel:[1,1,0] op_sel_hi:[0,1,1] neg_lo:[1,0,0]
ds_write_b128 v134, v[140:143] offset:7168
v_cvt_pk_bf16_f32 v147, v120, v121
v_pk_mul_f32 v[168:169], v[120:121], v[132:133] op_sel_hi:[1,0]
v_pk_fma_f32 v[120:121], v[120:121], v[132:133], v[168:169] op_sel:[1,1,0] op_sel_hi:[0,1,1] neg_lo:[1,0,0]
ds_write_b128 v134, v[144:147] offset:8192
v_cvt_pk_bf16_f32 v172, v116, v117
v_pk_mul_f32 v[164:165], v[116:117], v[122:123] op_sel_hi:[1,0]
v_pk_fma_f32 v[116:117], v[116:117], v[122:123], v[164:165] op_sel:[1,1,0] op_sel_hi:[0,1,1] neg_lo:[1,0,0]
v_cvt_pk_bf16_f32 v176, v118, v119
v_pk_mul_f32 v[166:167], v[118:119], v[124:125] op_sel_hi:[1,0]
v_pk_fma_f32 v[118:119], v[118:119], v[124:125], v[166:167] op_sel:[1,1,0] op_sel_hi:[0,1,1] neg_lo:[1,0,0]
v_cvt_pk_bf16_f32 v180, v120, v121
v_pk_mul_f32 v[168:169], v[120:121], v[126:127] op_sel_hi:[1,0]
v_pk_fma_f32 v[120:121], v[120:121], v[126:127], v[168:169] op_sel:[1,1,0] op_sel_hi:[0,1,1] neg_lo:[1,0,0]
v_cvt_pk_bf16_f32 v173, v116, v117
v_pk_mul_f32 v[164:165], v[116:117], v[122:123] op_sel_hi:[1,0]
v_pk_fma_f32 v[116:117], v[116:117], v[122:123], v[164:165] op_sel:[1,1,0] op_sel_hi:[0,1,1] neg_lo:[1,0,0]
v_cvt_pk_bf16_f32 v177, v118, v119
s_mul_i32 s77, s18, 5
s_nop 0
buffer_load_dwordx4 a[120:123], v246, s[8:11], s77 offen offset:0 sc1
v_pk_mul_f32 v[166:167], v[118:119], v[124:125] op_sel_hi:[1,0]
v_pk_fma_f32 v[118:119], v[118:119], v[124:125], v[166:167] op_sel:[1,1,0] op_sel_hi:[0,1,1] neg_lo:[1,0,0]
v_cvt_pk_bf16_f32 v181, v120, v121
v_pk_mul_f32 v[168:169], v[120:121], v[126:127] op_sel_hi:[1,0]
v_pk_fma_f32 v[120:121], v[120:121], v[126:127], v[168:169] op_sel:[1,1,0] op_sel_hi:[0,1,1] neg_lo:[1,0,0]
v_cvt_pk_bf16_f32 v174, v116, v117
v_pk_mul_f32 v[164:165], v[116:117], v[122:123] op_sel_hi:[1,0]
v_pk_fma_f32 v[116:117], v[116:117], v[122:123], v[164:165] op_sel:[1,1,0] op_sel_hi:[0,1,1] neg_lo:[1,0,0]
v_cvt_pk_bf16_f32 v178, v118, v119
v_pk_mul_f32 v[166:167], v[118:119], v[124:125] op_sel_hi:[1,0]
v_pk_fma_f32 v[118:119], v[118:119], v[124:125], v[166:167] op_sel:[1,1,0] op_sel_hi:[0,1,1] neg_lo:[1,0,0]
v_cvt_pk_bf16_f32 v182, v120, v121
v_pk_mul_f32 v[168:169], v[120:121], v[126:127] op_sel_hi:[1,0]
v_pk_fma_f32 v[120:121], v[120:121], v[126:127], v[168:169] op_sel:[1,1,0] op_sel_hi:[0,1,1] neg_lo:[1,0,0]
v_cvt_pk_bf16_f32 v175, v116, v117
v_pk_mul_f32 v[164:165], v[116:117], v[128:129] op_sel_hi:[1,0]
v_pk_fma_f32 v[116:117], v[116:117], v[128:129], v[164:165] op_sel:[1,1,0] op_sel_hi:[0,1,1] neg_lo:[1,0,0]
ds_write_b128 v134, v[172:175] offset:9216
buffer_load_dwordx4 a[124:127], v246, s[8:11], s77 offen offset:1024 sc1
v_cvt_pk_bf16_f32 v179, v118, v119
v_pk_mul_f32 v[166:167], v[118:119], v[130:131] op_sel_hi:[1,0]
v_pk_fma_f32 v[118:119], v[118:119], v[130:131], v[166:167] op_sel:[1,1,0] op_sel_hi:[0,1,1] neg_lo:[1,0,0]
ds_write_b128 v134, v[176:179] offset:10240
v_cvt_pk_bf16_f32 v183, v120, v121
v_pk_mul_f32 v[168:169], v[120:121], v[132:133] op_sel_hi:[1,0]
v_pk_fma_f32 v[120:121], v[120:121], v[132:133], v[168:169] op_sel:[1,1,0] op_sel_hi:[0,1,1] neg_lo:[1,0,0]
ds_write_b128 v134, v[180:183] offset:11264
v_cvt_pk_bf16_f32 v136, v116, v117
v_pk_mul_f32 v[164:165], v[116:117], v[122:123] op_sel_hi:[1,0]
v_pk_fma_f32 v[116:117], v[116:117], v[122:123], v[164:165] op_sel:[1,1,0] op_sel_hi:[0,1,1] neg_lo:[1,0,0]
v_cvt_pk_bf16_f32 v140, v118, v119
v_pk_mul_f32 v[166:167], v[118:119], v[124:125] op_sel_hi:[1,0]
v_pk_fma_f32 v[118:119], v[118:119], v[124:125], v[166:167] op_sel:[1,1,0] op_sel_hi:[0,1,1] neg_lo:[1,0,0]
v_cvt_pk_bf16_f32 v144, v120, v121
v_pk_mul_f32 v[168:169], v[120:121], v[126:127] op_sel_hi:[1,0]
v_pk_fma_f32 v[120:121], v[120:121], v[126:127], v[168:169] op_sel:[1,1,0] op_sel_hi:[0,1,1] neg_lo:[1,0,0]
v_cvt_pk_bf16_f32 v137, v116, v117
v_pk_mul_f32 v[164:165], v[116:117], v[122:123] op_sel_hi:[1,0]
buffer_load_dwordx4 a[128:131], v246, s[8:11], s77 offen offset:2048 sc1
v_pk_fma_f32 v[116:117], v[116:117], v[122:123], v[164:165] op_sel:[1,1,0] op_sel_hi:[0,1,1] neg_lo:[1,0,0]
v_cvt_pk_bf16_f32 v141, v118, v119
v_pk_mul_f32 v[166:167], v[118:119], v[124:125] op_sel_hi:[1,0]
v_pk_fma_f32 v[118:119], v[118:119], v[124:125], v[166:167] op_sel:[1,1,0] op_sel_hi:[0,1,1] neg_lo:[1,0,0]
v_cvt_pk_bf16_f32 v145, v120, v121
v_pk_mul_f32 v[168:169], v[120:121], v[126:127] op_sel_hi:[1,0]
v_pk_fma_f32 v[120:121], v[120:121], v[126:127], v[168:169] op_sel:[1,1,0] op_sel_hi:[0,1,1] neg_lo:[1,0,0]
v_cvt_pk_bf16_f32 v138, v116, v117
v_pk_mul_f32 v[164:165], v[116:117], v[122:123] op_sel_hi:[1,0]
v_pk_fma_f32 v[116:117], v[116:117], v[122:123], v[164:165] op_sel:[1,1,0] op_sel_hi:[0,1,1] neg_lo:[1,0,0]
v_cvt_pk_bf16_f32 v142, v118, v119
v_pk_mul_f32 v[166:167], v[118:119], v[124:125] op_sel_hi:[1,0]
v_pk_fma_f32 v[118:119], v[118:119], v[124:125], v[166:167] op_sel:[1,1,0] op_sel_hi:[0,1,1] neg_lo:[1,0,0]
v_cvt_pk_bf16_f32 v146, v120, v121
v_pk_mul_f32 v[168:169], v[120:121], v[126:127] op_sel_hi:[1,0]
v_pk_fma_f32 v[120:121], v[120:121], v[126:127], v[168:169] op_sel:[1,1,0] op_sel_hi:[0,1,1] neg_lo:[1,0,0]
v_cvt_pk_bf16_f32 v139, v116, v117
ds_write_b128 v134, v[136:139] offset:12288
v_cvt_pk_bf16_f32 v143, v118, v119
buffer_load_dwordx4 a[132:135], v246, s[8:11], s77 offen offset:3072 sc1
ds_write_b128 v134, v[140:143] offset:13312
v_cvt_pk_bf16_f32 v147, v120, v121
ds_write_b128 v134, v[144:147] offset:14336
buffer_load_dwordx4 a[136:139], v247, s[8:11], s77 offen offset:0 sc1
s_mul_i32 s77, s19, 5
buffer_load_dwordx4 a[140:143], v246, s[8:11], s77 offen offset:0 sc1
buffer_load_dwordx4 a[144:147], v246, s[8:11], s77 offen offset:1024 sc1
buffer_load_dwordx4 a[148:151], v246, s[8:11], s77 offen offset:2048 sc1
s_waitcnt vmcnt(20)
s_lshr_b32 s92, s52, 1
s_lshl_b32 s92, s92, 5
s_and_b32 s93, s52, 1
s_add_u32 s92, s92, s93
s_mul_i32 s92, s92, 16
s_add_u32 s92, s92, s51
v_mov_b32_e64 v8, s56
v_mov_b32 v9, 0
s_mov_b64 exec, 1
buffer_store_dword v8, v9, s[8:11], s92 offen sc1
s_mov_b64 exec, -1
s_waitcnt lgkmcnt(0)
s_barrier
buffer_load_dwordx4 a[152:155], v246, s[8:11], s77 offen offset:3072 sc1
v_and_b32 v5, 15, v1
v_lshrrev_b32_e64 v2, 4, v1
s_add_u32 s92, s52, 0
s_and_b32 s92, s92, 3
s_lshl_b32 s97, s40, 2
s_add_u32 s92, s92, s97
s_mul_i32 s92, s92, 55296
s_lshl_b32 s97, s52, 10
s_add_u32 s92, s92, s97
s_add_u32 s92, s92, 10485760
v_add_u32_e64 v10, s92, v6
s_add_u32 s92, s52, 1
s_and_b32 s92, s92, 3
s_lshl_b32 s97, s40, 2
s_add_u32 s92, s92, s97
s_mul_i32 s92, s92, 55296
s_lshl_b32 s97, s52, 10
s_add_u32 s92, s92, s97
s_add_u32 s92, s92, 10485760
buffer_load_dwordx4 a[156:159], v247, s[8:11], s77 offen offset:0 sc1
v_add_u32_e64 v11, s92, v6
s_add_u32 s92, s52, 2
s_and_b32 s92, s92, 3
s_lshl_b32 s97, s40, 2
s_add_u32 s92, s92, s97
s_mul_i32 s92, s92, 55296
s_lshl_b32 s97, s52, 10
s_add_u32 s92, s92, s97
s_add_u32 s92, s92, 10485760
v_add_u32_e64 v12, s92, v6
s_add_u32 s92, s52, 3
s_and_b32 s92, s92, 3
s_lshl_b32 s97, s40, 2
s_add_u32 s92, s92, s97
s_mul_i32 s92, s92, 55296
s_lshl_b32 s97, s52, 10
s_add_u32 s92, s92, s97
s_add_u32 s92, s92, 10485760
v_add_u32 v13, s92, v6
s_mul_i32 s77, s24, 5
buffer_load_dwordx4 a[160:163], v246, s[8:11], s77 offen offset:0 sc1
s_cmp_eq_u32 s52, 0
s_cselect_b32 s92, 40, 39
s_mul_i32 s93, s52, 656
s_add_u32 s93, s93, 524288
v_min_u32 v196, s92, v1
v_mul_u32_u24 v196, 16, v196
v_add_u32 v196, s93, v196
s_lshl_b32 s92, s40, 8
s_lshl_b32 s93, s52, 15
s_add_u32 s92, s92, s93
s_add_u32 s92, s92, 18874368
v_lshlrev_b32_e64 v199, 13, v2
v_lshl_add_u32 v199, v5, 4, v199
v_add_u32_e64 v199, s92, v199
v_bfe_u32 v200, v1, 2, 2
v_lshlrev_b32_e64 v201, 10, v2
v_lshl_add_u32 v201, v200, 7, v201
v_lshrrev_b32 v200, 1, v200
v_and_b32 v7, 1, v2
v_lshl_or_b32 v200, v7, 1, v200
v_xor_b32_e64 v200, s52, v200
v_lshl_add_u32 v201, v200, 5, v201
buffer_load_dwordx4 a[164:167], v246, s[8:11], s77 offen offset:1024 sc1
v_and_b32_e64 v200, 3, v1
v_lshl_add_u32 v201, v200, 3, v201
v_add_u32 v200, 65536, v201
v_add_u32 v201, 106496, v201
v_add_u32_e64 v202, 0, v6
s_mul_i32 s92, s52, 2560
s_add_u32 s76, s92, 147456
v_mul_u32_u24 v243, 160, v5
v_add_u32_e64 v243, s76, v243
v_lshl_add_u32 v244, v7, 3, v243
v_lshrrev_b32_e64 v7, 1, v2
v_mul_u32_u24 v7, 80, v7
v_add3_u32 v244, v244, v7, 64
v_lshl_add_u32 v243, v2, 3, v243
v_add_u32_e64 v197, s76, v6
s_mul_i32 s92, s52, 655360
s_add_u32 s92, s92, s49
buffer_load_dwordx4 a[168:171], v246, s[8:11], s77 offen offset:2048 sc1
v_add_u32 v7, 0, v1
v_mul_u32_u24 v2, 6554, v7
v_lshrrev_b32 v2, 16, v2
v_mul_u32_u24 v198, 10, v2
v_sub_u32_e64 v7, v7, v198
v_mul_u32_u24 v2, 40960, v2
v_cmp_lt_u32_e64 vcc, 4, v7
v_lshl_add_u32 v2, v7, 4, v2
v_add_u32 v7, 560, v2
v_cndmask_b32 v2, v2, v7, vcc
v_add_u32 v240, s92, v2
v_add_u32_e64 v7, 64, v1
v_mul_u32_u24 v2, 6554, v7
v_lshrrev_b32 v2, 16, v2
v_mul_u32_u24 v198, 10, v2
v_sub_u32_e64 v7, v7, v198
v_mul_u32_u24 v2, 40960, v2
v_cmp_lt_u32_e64 vcc, 4, v7
v_lshl_add_u32 v2, v7, 4, v2
v_add_u32 v7, 560, v2
v_cndmask_b32_e64 v2, v2, v7, vcc
buffer_load_dwordx4 a[172:175], v246, s[8:11], s77 offen offset:3072 sc1
v_add_u32_e64 v241, s92, v2
v_add_u32 v7, 128, v1
v_mul_u32_u24 v2, 6554, v7
v_lshrrev_b32 v2, 16, v2
v_mul_u32_u24 v198, 10, v2
v_sub_u32_e64 v7, v7, v198
v_mul_u32_u24 v2, 40960, v2
v_cmp_lt_u32_e64 vcc, 4, v7
v_lshl_add_u32 v2, v7, 4, v2
v_add_u32 v7, 560, v2
v_cndmask_b32 v2, v2, v7, vcc
v_add_u32 v242, s92, v2
v_lshlrev_b32 v5, 3, v5
s_lshl_b32 s75, s52, 10
buffer_load_dwordx4 a[176:179], v247, s[8:11], s77 offen offset:0 sc1
s_mul_i32 s77, s25, 5
buffer_load_dwordx4 a[180:183], v246, s[8:11], s77 offen offset:0 sc1
buffer_load_dwordx4 a[184:187], v246, s[8:11], s77 offen offset:1024 sc1
buffer_load_dwordx4 a[188:191], v246, s[8:11], s77 offen offset:2048 sc1
buffer_load_dwordx4 a[192:195], v246, s[8:11], s77 offen offset:3072 sc1
buffer_load_dwordx4 a[196:199], v247, s[8:11], s77 offen offset:0 sc1
s_mul_i32 s77, s26, 5
buffer_load_dwordx4 a[200:203], v246, s[8:11], s77 offen offset:0 sc1
buffer_load_dwordx4 a[204:207], v246, s[8:11], s77 offen offset:1024 sc1
buffer_load_dwordx4 a[208:211], v246, s[8:11], s77 offen offset:2048 sc1
buffer_load_dwordx4 a[212:215], v246, s[8:11], s77 offen offset:3072 sc1
buffer_load_dwordx4 a[216:219], v247, s[8:11], s77 offen offset:0 sc1
s_mul_i32 s77, s27, 5
buffer_load_dwordx4 a[220:223], v246, s[8:11], s77 offen offset:0 sc1
buffer_load_dwordx4 a[224:227], v246, s[8:11], s77 offen offset:1024 sc1
buffer_load_dwordx4 a[228:231], v246, s[8:11], s77 offen offset:2048 sc1
s_lshl_b32 s92, s40, 5
v_add_u32 v7, s92, v4
v_mul_u32_u24 v7, 16, v7
v_add_u32 v7, 262144, v7
buffer_load_dword v14, v7, s[8:11], 0 offen sc1
buffer_load_dwordx4 a[232:235], v246, s[8:11], s77 offen offset:3072 sc1
buffer_load_dwordx4 a[236:239], v247, s[8:11], s77 offen offset:0 sc1
s_mul_i32 s77, s57, 5
buffer_load_dwordx4 a[240:243], v246, s[8:11], s77 offen offset:0 sc1
buffer_load_dwordx4 a[244:247], v246, s[8:11], s77 offen offset:1024 sc1
buffer_load_dwordx4 a[248:251], v246, s[8:11], s77 offen offset:2048 sc1
buffer_load_dwordx4 a[252:255], v246, s[8:11], s77 offen offset:3072 sc1
buffer_load_dwordx4 v[208:211], v247, s[8:11], s77 offen offset:0 sc1
s_cmp_ge_u32 s52, 2
s_cbranch_scc1 L_w1312
s_nop 0
s_mov_b32 s77, 266240
buffer_load_dwordx4 v[212:215], v246, s[8:11], s77 offen offset:0 sc1
buffer_load_dwordx4 v[216:219], v246, s[8:11], s77 offen offset:1024 sc1
buffer_load_dwordx4 v[220:223], v246, s[8:11], s77 offen offset:2048 sc1
buffer_load_dwordx4 v[224:227], v246, s[8:11], s77 offen offset:3072 sc1
buffer_load_dwordx4 v[228:231], v247, s[8:11], s77 offen offset:0 sc1
L_w1312:
s_waitcnt vmcnt(7)
s_mov_b32 s79, 0
L_poll13:
v_cmp_ne_u32 vcc, s56, v14
s_add_u32 s79, s79, 1
s_cmp_eq_u64 vcc, 0
s_cbranch_scc1 L_polld14
buffer_load_dword v14, v7, s[8:11], 0 offen sc1
s_waitcnt vmcnt(0)
s_cmp_lt_u32 s79, 200000
s_cbranch_scc1 L_poll13
L_polld14:
s_branch L_join4
L_widejob3:
s_waitcnt vmcnt(8)
s_waitcnt lgkmcnt(0)
s_barrier
ds_read_b128 a[0:3], v253 offset:0
ds_read_b128 a[4:7], v253 offset:4096
ds_read_b128 a[8:11], v253 offset:8192
ds_read_b128 a[12:15], v253 offset:12288
ds_read_b128 a[16:19], v253 offset:16384
ds_read_b128 a[20:23], v253 offset:20480
ds_read_b128 v[112:115], v128 offset:0
ds_read_b64_tr_b16 v[80:81], v132 offset:0
ds_read_b64_tr_b16 v[82:83], v132 offset:512
ds_read_b64_tr_b16 v[84:85], v133 offset:0
ds_read_b64_tr_b16 v[86:87], v133 offset:512
ds_read_b64_tr_b16 v[88:89], v134 offset:0
ds_read_b64_tr_b16 v[90:91], v134 offset:512
ds_read_b64_tr_b16 v[92:93], v135 offset:0
ds_read_b64_tr_b16 v[94:95], v135 offset:512
s_waitcnt lgkmcnt(6)
s_nop 0
v_mfma_f32_32x32x16_bf16 v[16:31], v[80:83], v[112:115], 0
s_add_u32 m0, s76, 50176
ds_read_b128 v[116:119], v129 offset:0
ds_read_b64_tr_b16 v[96:97], v132 offset:2048
ds_read_b64_tr_b16 v[98:99], v132 offset:2560
v_mfma_f32_16x16x32_bf16 v[120:123], v[80:83], v[124:127], 0
buffer_load_dwordx4 v157, s[20:23], s74 offen offset:0 lds
s_lshl_b32 s12, s43, 12
v_add_u32 v246, s44, v6
v_add_u32 v247, 4096, v246
s_waitcnt lgkmcnt(7)
s_nop 0
v_mfma_f32_32x32x16_bf16 v[32:47], v[84:87], v[112:115], 0
s_add_u32 m0, s75, 35840
ds_read_b64_tr_b16 v[100:101], v133 offset:2048
ds_read_b64_tr_b16 v[102:103], v133 offset:2560
buffer_load_dwordx4 v155, s[4:7], s73 offen lds
s_add_u32 s13, s12, 4096
s_cmp_eq_u32 s13, 53248
s_cselect_b32 s13, 0, s13
s_waitcnt lgkmcnt(7)
v_mfma_f32_32x32x16_bf16 v[48:63], v[88:91], v[112:115], 0
s_add_u32 m0, s76, 58240
ds_read_b64_tr_b16 v[104:105], v134 offset:2048
ds_read_b64_tr_b16 v[106:107], v134 offset:2560
buffer_load_dwordx4 v157, s[20:23], s74 offen offset:128 lds
s_add_u32 s14, s13, 4096
s_cmp_eq_u32 s14, 53248
s_cselect_b32 s14, 0, s14
s_add_u32 s15, s14, 4096
s_cmp_eq_u32 s15, 53248
s_cselect_b32 s15, 0, s15
s_add_u32 s16, s15, 4096
s_cmp_eq_u32 s16, 53248
s_cselect_b32 s16, 0, s16
s_waitcnt lgkmcnt(7)
v_mfma_f32_32x32x16_bf16 v[64:79], v[92:95], v[112:115], 0
s_add_u32 s72, s42, 2
s_cmp_ge_u32 s72, 10
s_cselect_b32 s73, 10, 0
s_sub_u32 s72, s72, s73
s_lshl_b32 s73, s72, 7
s_mul_i32 s74, s72, 221184
s_add_u32 s73, s73, s45
s_add_u32 s74, s74, s46
s_nop 0
s_add_u32 m0, s75, 65536
ds_read_b64_tr_b16 v[108:109], v135 offset:2048
ds_read_b64_tr_b16 v[110:111], v135 offset:2560
buffer_load_dwordx4 v152, s[4:7], s73 offen lds
s_add_u32 s17, s16, 4096
s_cmp_eq_u32 s17, 53248
s_cselect_b32 s17, 0, s17
s_add_u32 s18, s17, 4096
s_cmp_eq_u32 s18, 53248
s_cselect_b32 s18, 0, s18
s_add_u32 s19, s18, 4096
s_cmp_eq_u32 s19, 53248
s_cselect_b32 s19, 0, s19
s_waitcnt lgkmcnt(6)
v_mfma_f32_32x32x16_bf16 v[16:31], v[96:99], v[116:119], v[16:31]
s_add_u32 m0, s76, 81920
ds_read_b128 v[112:115], v130 offset:0
ds_read_b64_tr_b16 v[80:81], v132 offset:4096
ds_read_b64_tr_b16 v[82:83], v132 offset:4608
v_mfma_f32_16x16x32_bf16 v[120:123], v[96:99], v[124:127], v[120:123]
buffer_load_dwordx4 v156, s[20:23], s74 offen offset:0 lds
s_add_u32 s24, s19, 4096
s_cmp_eq_u32 s24, 53248
s_cselect_b32 s24, 0, s24
s_waitcnt lgkmcnt(7)
v_mfma_f32_32x32x16_bf16 v[32:47], v[100:103], v[116:119], v[32:47]
s_add_u32 m0, s75, 66560
ds_read_b64_tr_b16 v[84:85], v133 offset:4096
ds_read_b64_tr_b16 v[86:87], v133 offset:4608
buffer_load_dwordx4 v153, s[4:7], s73 offen lds
s_add_u32 s25, s24, 4096
s_cmp_eq_u32 s25, 53248
s_cselect_b32 s25, 0, s25
s_waitcnt lgkmcnt(7)
v_mfma_f32_32x32x16_bf16 v[48:63], v[104:107], v[116:119], v[48:63]
s_add_u32 m0, s76, 89984
ds_read_b64_tr_b16 v[88:89], v134 offset:4096
ds_read_b64_tr_b16 v[90:91], v134 offset:4608
buffer_load_dwordx4 v156, s[20:23], s74 offen offset:128 lds
s_add_u32 s26, s25, 4096
s_cmp_eq_u32 s26, 53248
s_cselect_b32 s26, 0, s26
s_waitcnt lgkmcnt(7)
v_mfma_f32_32x32x16_bf16 v[64:79], v[108:111], v[116:119], v[64:79]
s_add_u32 m0, s75, 67584
ds_read_b64_tr_b16 v[92:93], v135 offset:4096
ds_read_b64_tr_b16 v[94:95], v135 offset:4608
buffer_load_dwordx4 v154, s[4:7], s73 offen lds
s_add_u32 s27, s26, 4096
s_cmp_eq_u32 s27, 53248
s_cselect_b32 s27, 0, s27
s_add_u32 s57, s27, 4096
s_cmp_eq_u32 s57, 53248
s_cselect_b32 s57, 0, s57
v_lshrrev_b32 v2, 3, v1
v_and_b32 v5, 3, v2
v_lshrrev_b32_e64 v7, 2, v2
v_lshl_add_u32 v5, v7, 3, v5
s_mov_b32 s95, 164864
v_mul_lo_u32 v5, v5, s95
s_bfe_u32 s95, s39, 0x30001
v_lshrrev_b32 v7, 1, v2
v_and_b32 v2, 7, v1
v_xor_b32_e64 v7, v7, v2
v_xor_b32 v7, s95, v7
s_lshl_b32 s95, s39, 7
s_mul_i32 s96, s52, 41216
s_add_u32 s95, s95, s96
s_add_u32 s95, s95, 1048576
s_waitcnt lgkmcnt(6)
v_mfma_f32_32x32x16_bf16 v[16:31], v[80:83], v[112:115], v[16:31]
ds_read_b128 v[116:119], v131 offset:0
ds_read_b64_tr_b16 v[96:97], v132 offset:6144
ds_read_b64_tr_b16 v[98:99], v132 offset:6656
v_mfma_f32_16x16x32_bf16 v[120:123], v[80:83], v[124:127], v[120:123]
buffer_store_dwordx4 a[0:3], v252, s[8:11], s47 offen sc1
s_add_u32 m0, s76, 82944
s_nop 0
buffer_load_dwordx4 v157, s[20:23], s74 offen offset:0 lds
v_add_u32 v5, s95, v5
v_lshl_add_u32 v224, v7, 4, v5
v_xor_b32_e64 v7, 4, v7
v_lshl_add_u32 v225, v7, 4, v5
s_waitcnt lgkmcnt(7)
v_mfma_f32_32x32x16_bf16 v[32:47], v[84:87], v[112:115], v[32:47]
s_add_u32 m0, s75, 68608
ds_read_b64_tr_b16 v[100:101], v133 offset:6144
ds_read_b64_tr_b16 v[102:103], v133 offset:6656
buffer_load_dwordx4 v155, s[4:7], s73 offen lds
v_and_b32_e64 v2, 0x13, v4
s_waitcnt lgkmcnt(7)
v_mfma_f32_32x32x16_bf16 v[48:63], v[88:91], v[112:115], v[48:63]
s_add_u32 m0, s76, 91008
ds_read_b64_tr_b16 v[104:105], v134 offset:6144
ds_read_b64_tr_b16 v[106:107], v134 offset:6656
buffer_load_dwordx4 v157, s[20:23], s74 offen offset:128 lds
v_bfe_u32 v5, v4, 2, 1
v_lshl_or_b32 v2, v5, 3, v2
v_bfe_u32 v5, v4, 3, 1
v_lshl_or_b32 v2, v5, 2, v2
s_and_b32 s92, s52, 1
s_lshl_b32 s92, s92, 5
v_add_u32 v5, s92, v2
v_cvt_f32_u32 v5, v5
v_mul_f32 v5, 0x3a000000, v5
s_waitcnt lgkmcnt(7)
v_mfma_f32_32x32x16_bf16 v[64:79], v[92:95], v[112:115], v[64:79]
s_add_u32 s72, s42, 3
s_cmp_ge_u32 s72, 10
s_cselect_b32 s73, 10, 0
s_sub_u32 s72, s72, s73
s_lshl_b32 s73, s72, 7
s_mul_i32 s74, s72, 221184
s_add_u32 s73, s73, s45
s_add_u32 s74, s74, s46
s_add_u32 m0, s75, 98304
ds_read_b64_tr_b16 v[108:109], v135 offset:6144
ds_read_b64_tr_b16 v[110:111], v135 offset:6656
buffer_load_dwordx4 v152, s[4:7], s73 offen lds
v_cvt_f32_u32_e64 v2, v2
v_mul_f32 v2, 0x3a000000, v2
s_waitcnt vmcnt(10)
s_barrier
s_waitcnt lgkmcnt(6)
v_mfma_f32_32x32x16_bf16 v[16:31], v[96:99], v[116:119], v[16:31]
ds_read_b128 v[112:115], v128 offset:32768
ds_read_b64_tr_b16 v[80:81], v132 offset:32768
ds_read_b64_tr_b16 v[82:83], v132 offset:33280
v_mfma_f32_16x16x32_bf16 v[120:123], v[96:99], v[124:127], v[120:123]
v_lshlrev_b32 v7, 3, v3
v_cvt_f32_u32 v232, v7
v_mul_f32 v232, v232, v5
v_add_u32 v7, s92, v7
v_cvt_f32_u32 v233, v7
v_mul_f32 v233, v233, v2
s_waitcnt lgkmcnt(7)
v_mfma_f32_32x32x16_bf16 v[32:47], v[100:103], v[116:119], v[32:47]
s_add_u32 s47, s47, 4096
ds_read_b64_tr_b16 v[84:85], v133 offset:32768
ds_read_b64_tr_b16 v[86:87], v133 offset:33280
buffer_store_dwordx4 a[4:7], v252, s[8:11], s47 offen sc1
s_lshr_b32 s93, s52, 1
s_lshl_b32 s93, s93, 8
s_or_b32 s93, s93, s39
s_cmp_eq_u32 s93, 0
s_cselect_b32 s94, 0.5, 1.0
s_cmp_eq_u32 s93, 160
s_cselect_b32 s94, 0.5, s94
s_waitcnt lgkmcnt(7)
s_nop 0
v_mfma_f32_32x32x16_bf16 v[48:63], v[104:107], v[116:119], v[48:63]
s_add_u32 m0, s76, 114688
ds_read_b64_tr_b16 v[88:89], v134 offset:32768
ds_read_b64_tr_b16 v[90:91], v134 offset:33280
buffer_load_dwordx4 v156, s[20:23], s74 offen offset:0 lds
v_fmamk_f32 v7, v5, 0x00000000, v232
s_waitcnt lgkmcnt(7)
s_nop 0
v_mfma_f32_32x32x16_bf16 v[64:79], v[108:111], v[116:119], v[64:79]
s_add_u32 m0, s75, 99328
ds_read_b64_tr_b16 v[92:93], v135 offset:32768
ds_read_b64_tr_b16 v[94:95], v135 offset:33280
buffer_load_dwordx4 v153, s[4:7], s73 offen lds
v_fmamk_f32 v234, v2, 0x00000000, v233
v_cos_f32 v160, v7
v_sin_f32 v176, v7
v_cos_f32_e64 v192, v234
v_sin_f32 v208, v234
s_waitcnt lgkmcnt(6)
v_mfma_f32_32x32x16_bf16 v[16:31], v[80:83], v[112:115], v[16:31]
ds_read_b128 v[116:119], v129 offset:32768
ds_read_b64_tr_b16 v[96:97], v132 offset:34816
ds_read_b64_tr_b16 v[98:99], v132 offset:35328
v_mfma_f32_16x16x32_bf16 v[120:123], v[80:83], v[124:127], v[120:123]
v_fmamk_f32 v7, v5, 0x3f800000, v232
v_fmamk_f32 v234, v2, 0x3f800000, v233
v_cos_f32 v161, v7
s_waitcnt lgkmcnt(7)
v_mfma_f32_32x32x16_bf16 v[32:47], v[84:87], v[112:115], v[32:47]
s_add_u32 s47, s47, 4096
ds_read_b64_tr_b16 v[100:101], v133 offset:34816
ds_read_b64_tr_b16 v[102:103], v133 offset:35328
buffer_store_dwordx4 a[8:11], v252, s[8:11], s47 offen sc1
v_sin_f32 v177, v7
s_waitcnt lgkmcnt(7)
v_mfma_f32_32x32x16_bf16 v[48:63], v[88:91], v[112:115], v[48:63]
s_add_u32 m0, s76, 122752
ds_read_b64_tr_b16 v[104:105], v134 offset:34816
ds_read_b64_tr_b16 v[106:107], v134 offset:35328
buffer_load_dwordx4 v156, s[20:23], s74 offen offset:128 lds
v_cos_f32 v193, v234
s_waitcnt lgkmcnt(7)
v_mfma_f32_32x32x16_bf16 v[64:79], v[92:95], v[112:115], v[64:79]
s_add_u32 m0, s75, 100352
ds_read_b64_tr_b16 v[108:109], v135 offset:34816
ds_read_b64_tr_b16 v[110:111], v135 offset:35328
buffer_load_dwordx4 v154, s[4:7], s73 offen lds
v_sin_f32_e64 v209, v234
v_fmamk_f32 v7, v5, 0x40000000, v232
v_fmamk_f32 v234, v2, 0x40000000, v233
v_cos_f32 v162, v7
s_waitcnt lgkmcnt(6)
v_mfma_f32_32x32x16_bf16 v[16:31], v[96:99], v[116:119], v[16:31]
ds_read_b128 v[112:115], v130 offset:32768
ds_read_b64_tr_b16 v[80:81], v132 offset:36864
ds_read_b64_tr_b16 v[82:83], v132 offset:37376
v_mfma_f32_16x16x32_bf16 v[120:123], v[96:99], v[124:127], v[120:123]
v_sin_f32_e64 v178, v7
v_cos_f32 v194, v234
s_waitcnt lgkmcnt(7)
v_mfma_f32_32x32x16_bf16 v[32:47], v[100:103], v[116:119], v[32:47]
s_add_u32 s47, s47, 4096
ds_read_b64_tr_b16 v[84:85], v133 offset:36864
ds_read_b64_tr_b16 v[86:87], v133 offset:37376
buffer_store_dwordx4 a[12:15], v252, s[8:11], s47 offen sc1
v_sin_f32 v210, v234
s_waitcnt lgkmcnt(7)
v_mfma_f32_32x32x16_bf16 v[48:63], v[104:107], v[116:119], v[48:63]
s_add_u32 m0, s76, 115712
ds_read_b64_tr_b16 v[88:89], v134 offset:36864
ds_read_b64_tr_b16 v[90:91], v134 offset:37376
buffer_load_dwordx4 v157, s[20:23], s74 offen offset:0 lds
v_fmamk_f32 v7, v5, 0x40400000, v232
s_waitcnt lgkmcnt(7)
s_nop 0
v_mfma_f32_32x32x16_bf16 v[64:79], v[108:111], v[116:119], v[64:79]
s_add_u32 m0, s75, 101376
ds_read_b64_tr_b16 v[92:93], v135 offset:36864
ds_read_b64_tr_b16 v[94:95], v135 offset:37376
buffer_load_dwordx4 v155, s[4:7], s73 offen lds
v_fmamk_f32 v234, v2, 0x40400000, v233
v_cos_f32 v163, v7
v_sin_f32 v179, v7
v_cos_f32 v195, v234
s_waitcnt lgkmcnt(6)
v_mfma_f32_32x32x16_bf16 v[16:31], v[80:83], v[112:115], v[16:31]
ds_read_b128 v[116:119], v131 offset:32768
ds_read_b64_tr_b16 v[96:97], v132 offset:38912
ds_read_b64_tr_b16 v[98:99], v132 offset:39424
v_mfma_f32_16x16x32_bf16 v[120:123], v[80:83], v[124:127], v[120:123]
v_sin_f32 v211, v234
s_waitcnt lgkmcnt(7)
v_mfma_f32_32x32x16_bf16 v[32:47], v[84:87], v[112:115], v[32:47]
s_add_u32 s47, s47, 4096
ds_read_b64_tr_b16 v[100:101], v133 offset:38912
ds_read_b64_tr_b16 v[102:103], v133 offset:39424
buffer_store_dwordx4 a[16:19], v252, s[8:11], s47 offen sc1
s_waitcnt lgkmcnt(7)
v_mfma_f32_32x32x16_bf16 v[48:63], v[88:91], v[112:115], v[48:63]
ds_read_b64_tr_b16 v[104:105], v134 offset:38912
ds_read_b64_tr_b16 v[106:107], v134 offset:39424
v_fmamk_f32 v7, v5, 0x40800000, v232
v_fmamk_f32 v234, v2, 0x40800000, v233
v_cos_f32_e64 v164, v7
s_waitcnt lgkmcnt(7)
v_mfma_f32_32x32x16_bf16 v[64:79], v[92:95], v[112:115], v[64:79]
s_add_u32 m0, s76, 123776
ds_read_b64_tr_b16 v[108:109], v135 offset:38912
ds_read_b64_tr_b16 v[110:111], v135 offset:39424
buffer_load_dwordx4 v157, s[20:23], s74 offen offset:128 lds
v_sin_f32 v180, v7
v_cos_f32 v196, v234
v_sin_f32_e64 v212, v234
v_fmamk_f32 v7, v5, 0x40a00000, v232
v_fmamk_f32 v234, v2, 0x40a00000, v233
s_waitcnt vmcnt(12)
s_barrier
s_waitcnt lgkmcnt(6)
v_mfma_f32_32x32x16_bf16 v[16:31], v[96:99], v[116:119], v[16:31]
ds_read_b128 v[112:115], v136 offset:0
ds_read_b64_tr_b16 v[80:81], v140 offset:0
ds_read_b64_tr_b16 v[82:83], v140 offset:512
v_mfma_f32_16x16x32_bf16 v[120:123], v[96:99], v[124:127], v[120:123]
v_cos_f32 v165, v7
v_sin_f32 v181, v7
s_waitcnt lgkmcnt(7)
v_mfma_f32_32x32x16_bf16 v[32:47], v[100:103], v[116:119], v[32:47]
ds_read_b64_tr_b16 v[84:85], v141 offset:0
ds_read_b64_tr_b16 v[86:87], v141 offset:512
s_cmp_lg_u32 s52, 0
s_cbranch_scc1 L_o615
s_mov_b64 exec, 0xff
s_add_u32 s47, s47, 4096
buffer_store_dwordx4 a[20:23], v252, s[8:11], s47 offen sc1
s_mov_b64 exec, -1
L_o615:
s_waitcnt lgkmcnt(7)
v_mfma_f32_32x32x16_bf16 v[48:63], v[104:107], v[116:119], v[48:63]
s_add_u32 s72, s42, 4
s_cmp_ge_u32 s72, 10
s_cselect_b32 s73, 10, 0
s_sub_u32 s72, s72, s73
s_lshl_b32 s73, s72, 7
s_mul_i32 s74, s72, 221184
s_add_u32 s73, s73, s45
s_add_u32 s74, s74, s46
s_add_u32 m0, s75, 0
ds_read_b64_tr_b16 v[88:89], v142 offset:0
ds_read_b64_tr_b16 v[90:91], v142 offset:512
buffer_load_dwordx4 v152, s[4:7], s73 offen lds
s_waitcnt lgkmcnt(7)
v_mfma_f32_32x32x16_bf16 v[64:79], v[108:111], v[116:119], v[64:79]
s_add_u32 m0, s76, 16384
ds_read_b64_tr_b16 v[92:93], v143 offset:0
ds_read_b64_tr_b16 v[94:95], v143 offset:512
buffer_load_dwordx4 v156, s[20:23], s74 offen offset:0 lds
v_cos_f32 v197, v234
v_sin_f32_e64 v213, v234
v_fmamk_f32 v7, v5, 0x40c00000, v232
v_fmamk_f32 v234, v2, 0x40c00000, v233
v_cos_f32 v166, v7
v_sin_f32 v182, v7
v_cos_f32 v198, v234
s_waitcnt lgkmcnt(6)
v_mfma_f32_32x32x16_bf16 v[16:31], v[80:83], v[112:115], v[16:31]
ds_read_b128 v[116:119], v137 offset:0
ds_read_b64_tr_b16 v[96:97], v140 offset:2048
ds_read_b64_tr_b16 v[98:99], v140 offset:2560
v_mfma_f32_16x16x32_bf16 v[120:123], v[80:83], v[124:127], v[120:123]
v_sin_f32 v214, v234
s_waitcnt lgkmcnt(7)
v_mfma_f32_32x32x16_bf16 v[32:47], v[84:87], v[112:115], v[32:47]
s_add_u32 m0, s75, 1024
ds_read_b64_tr_b16 v[100:101], v141 offset:2048
ds_read_b64_tr_b16 v[102:103], v141 offset:2560
buffer_load_dwordx4 v153, s[4:7], s73 offen lds
s_waitcnt lgkmcnt(7)
v_mfma_f32_32x32x16_bf16 v[48:63], v[88:91], v[112:115], v[48:63]
ds_read_b64_tr_b16 v[104:105], v142 offset:2048
ds_read_b64_tr_b16 v[106:107], v142 offset:2560
v_fmamk_f32 v7, v5, 0x40e00000, v232
v_fmamk_f32 v234, v2, 0x40e00000, v233
v_cos_f32_e64 v167, v7
s_waitcnt lgkmcnt(7)
v_mfma_f32_32x32x16_bf16 v[64:79], v[92:95], v[112:115], v[64:79]
s_add_u32 m0, s76, 24448
ds_read_b64_tr_b16 v[108:109], v143 offset:2048
ds_read_b64_tr_b16 v[110:111], v143 offset:2560
buffer_load_dwordx4 v156, s[20:23], s74 offen offset:128 lds
v_sin_f32 v183, v7
v_cos_f32 v199, v234
v_sin_f32_e64 v215, v234
v_fmamk_f32 v7, v5, 0x41800000, v232
v_fmamk_f32 v234, v2, 0x41800000, v233
s_waitcnt lgkmcnt(6)
v_mfma_f32_32x32x16_bf16 v[16:31], v[96:99], v[116:119], v[16:31]
ds_read_b128 v[112:115], v138 offset:0
ds_read_b64_tr_b16 v[80:81], v140 offset:4096
ds_read_b64_tr_b16 v[82:83], v140 offset:4608
v_mfma_f32_16x16x32_bf16 v[120:123], v[96:99], v[124:127], v[120:123]
v_cos_f32_e64 v168, v7
s_waitcnt lgkmcnt(7)
v_mfma_f32_32x32x16_bf16 v[32:47], v[100:103], v[116:119], v[32:47]
s_add_u32 m0, s75, 2048
ds_read_b64_tr_b16 v[84:85], v141 offset:4096
ds_read_b64_tr_b16 v[86:87], v141 offset:4608
buffer_load_dwordx4 v154, s[4:7], s73 offen lds
s_waitcnt lgkmcnt(7)
v_mfma_f32_32x32x16_bf16 v[48:63], v[104:107], v[116:119], v[48:63]
ds_read_b64_tr_b16 v[88:89], v142 offset:4096
ds_read_b64_tr_b16 v[90:91], v142 offset:4608
v_sin_f32 v184, v7
v_cos_f32 v200, v234
s_waitcnt lgkmcnt(7)
v_mfma_f32_32x32x16_bf16 v[64:79], v[108:111], v[116:119], v[64:79]
s_add_u32 m0, s76, 17408
ds_read_b64_tr_b16 v[92:93], v143 offset:4096
ds_read_b64_tr_b16 v[94:95], v143 offset:4608
buffer_load_dwordx4 v157, s[20:23], s74 offen offset:0 lds
v_sin_f32_e64 v216, v234
v_fmamk_f32 v7, v5, 0x41880000, v232
v_fmamk_f32 v234, v2, 0x41880000, v233
v_cos_f32 v169, v7
v_sin_f32 v185, v7
v_cos_f32 v201, v234
s_waitcnt lgkmcnt(6)
v_mfma_f32_32x32x16_bf16 v[16:31], v[80:83], v[112:115], v[16:31]
ds_read_b128 v[116:119], v139 offset:0
ds_read_b64_tr_b16 v[96:97], v140 offset:6144
ds_read_b64_tr_b16 v[98:99], v140 offset:6656
v_mfma_f32_16x16x32_bf16 v[120:123], v[80:83], v[124:127], v[120:123]
v_sin_f32 v217, v234
s_waitcnt lgkmcnt(7)
v_mfma_f32_32x32x16_bf16 v[32:47], v[84:87], v[112:115], v[32:47]
s_add_u32 m0, s75, 3072
ds_read_b64_tr_b16 v[100:101], v141 offset:6144
ds_read_b64_tr_b16 v[102:103], v141 offset:6656
buffer_load_dwordx4 v155, s[4:7], s73 offen lds
s_waitcnt lgkmcnt(7)
v_mfma_f32_32x32x16_bf16 v[48:63], v[88:91], v[112:115], v[48:63]
ds_read_b64_tr_b16 v[104:105], v142 offset:6144
ds_read_b64_tr_b16 v[106:107], v142 offset:6656
v_fmamk_f32 v7, v5, 0x41900000, v232
v_fmamk_f32 v234, v2, 0x41900000, v233
v_cos_f32_e64 v170, v7
s_waitcnt lgkmcnt(7)
v_mfma_f32_32x32x16_bf16 v[64:79], v[92:95], v[112:115], v[64:79]
s_add_u32 m0, s76, 25472
ds_read_b64_tr_b16 v[108:109], v143 offset:6144
ds_read_b64_tr_b16 v[110:111], v143 offset:6656
buffer_load_dwordx4 v157, s[20:23], s74 offen offset:128 lds
v_sin_f32 v186, v7
v_cos_f32 v202, v234
v_sin_f32_e64 v218, v234
v_fmamk_f32 v7, v5, 0x41980000, v232
v_fmamk_f32 v234, v2, 0x41980000, v233
s_waitcnt vmcnt(8)
s_waitcnt vmcnt(8)
s_barrier
s_waitcnt lgkmcnt(6)
v_mfma_f32_32x32x16_bf16 v[16:31], v[96:99], v[116:119], v[16:31]
ds_read_b128 v[112:115], v136 offset:32768
ds_read_b64_tr_b16 v[80:81], v140 offset:32768
ds_read_b64_tr_b16 v[82:83], v140 offset:33280
v_mfma_f32_16x16x32_bf16 v[120:123], v[96:99], v[124:127], v[120:123]
v_cos_f32 v171, v7
s_waitcnt lgkmcnt(7)
v_mfma_f32_32x32x16_bf16 v[32:47], v[100:103], v[116:119], v[32:47]
s_add_u32 s72, s42, 5
s_cmp_ge_u32 s72, 10
s_cselect_b32 s73, 10, 0
s_sub_u32 s72, s72, s73
s_lshl_b32 s73, s72, 7
s_mul_i32 s74, s72, 221184
s_add_u32 s73, s73, s45
s_add_u32 s74, s74, s46
s_add_u32 m0, s75, 32768
ds_read_b64_tr_b16 v[84:85], v141 offset:32768
ds_read_b64_tr_b16 v[86:87], v141 offset:33280
buffer_load_dwordx4 v152, s[4:7], s73 offen lds
s_waitcnt lgkmcnt(7)
v_mfma_f32_32x32x16_bf16 v[48:63], v[104:107], v[116:119], v[48:63]
ds_read_b64_tr_b16 v[88:89], v142 offset:32768
ds_read_b64_tr_b16 v[90:91], v142 offset:33280
v_sin_f32 v187, v7
v_cos_f32 v203, v234
v_sin_f32_e64 v219, v234
v_fmamk_f32 v7, v5, 0x41a00000, v232
v_fmamk_f32 v234, v2, 0x41a00000, v233
v_cos_f32_e64 v172, v7
v_sin_f32 v188, v7
s_waitcnt lgkmcnt(7)
v_mfma_f32_32x32x16_bf16 v[64:79], v[108:111], v[116:119], v[64:79]
s_cmp_lg_u32 s52, 0
s_cbranch_scc1 L_fs18
s_mul_i32 s72, s53, 16
s_add_u32 s72, s72, 131072
v_mov_b32 v8, s56
v_mov_b32 v9, 0
s_mov_b64 exec, 1
buffer_store_dword v8, v9, s[8:11], s72 offen sc1
s_mov_b64 exec, -1
L_fs18:
s_add_u32 m0, s76, 49152
ds_read_b64_tr_b16 v[92:93], v143 offset:32768
ds_read_b64_tr_b16 v[94:95], v143 offset:33280
buffer_load_dwordx4 v156, s[20:23], s74 offen offset:0 lds
s_waitcnt lgkmcnt(6)
v_mfma_f32_32x32x16_bf16 v[16:31], v[80:83], v[112:115], v[16:31]
ds_read_b128 v[116:119], v137 offset:32768
ds_read_b64_tr_b16 v[96:97], v140 offset:34816
ds_read_b64_tr_b16 v[98:99], v140 offset:35328
v_mfma_f32_16x16x32_bf16 v[120:123], v[80:83], v[124:127], v[120:123]
v_cos_f32 v204, v234
s_waitcnt lgkmcnt(7)
v_mfma_f32_32x32x16_bf16 v[32:47], v[84:87], v[112:115], v[32:47]
s_add_u32 m0, s75, 33792
ds_read_b64_tr_b16 v[100:101], v141 offset:34816
ds_read_b64_tr_b16 v[102:103], v141 offset:35328
buffer_load_dwordx4 v153, s[4:7], s73 offen lds
s_waitcnt lgkmcnt(7)
v_mfma_f32_32x32x16_bf16 v[48:63], v[88:91], v[112:115], v[48:63]
ds_read_b64_tr_b16 v[104:105], v142 offset:34816
ds_read_b64_tr_b16 v[106:107], v142 offset:35328
v_sin_f32 v220, v234
v_fmamk_f32 v7, v5, 0x41a80000, v232
s_waitcnt lgkmcnt(7)
s_nop 0
v_mfma_f32_32x32x16_bf16 v[64:79], v[92:95], v[112:115], v[64:79]
s_add_u32 m0, s76, 57216
ds_read_b64_tr_b16 v[108:109], v143 offset:34816
ds_read_b64_tr_b16 v[110:111], v143 offset:35328
buffer_load_dwordx4 v156, s[20:23], s74 offen offset:128 lds
v_fmamk_f32 v234, v2, 0x41a80000, v233
v_cos_f32 v173, v7
v_sin_f32 v189, v7
v_cos_f32 v205, v234
v_sin_f32 v221, v234
v_fmamk_f32 v7, v5, 0x41b00000, v232
s_waitcnt lgkmcnt(6)
s_nop 0
v_mfma_f32_32x32x16_bf16 v[16:31], v[96:99], v[116:119], v[16:31]
ds_read_b128 v[112:115], v138 offset:32768
ds_read_b64_tr_b16 v[80:81], v140 offset:36864
ds_read_b64_tr_b16 v[82:83], v140 offset:37376
v_mfma_f32_16x16x32_bf16 v[120:123], v[96:99], v[124:127], v[120:123]
v_fmamk_f32 v234, v2, 0x41b00000, v233
v_cos_f32 v174, v7
s_waitcnt lgkmcnt(7)
v_mfma_f32_32x32x16_bf16 v[32:47], v[100:103], v[116:119], v[32:47]
s_add_u32 m0, s75, 34816
ds_read_b64_tr_b16 v[84:85], v141 offset:36864
ds_read_b64_tr_b16 v[86:87], v141 offset:37376
buffer_load_dwordx4 v154, s[4:7], s73 offen lds
s_waitcnt lgkmcnt(7)
v_mfma_f32_32x32x16_bf16 v[48:63], v[104:107], v[116:119], v[48:63]
ds_read_b64_tr_b16 v[88:89], v142 offset:36864
ds_read_b64_tr_b16 v[90:91], v142 offset:37376
v_sin_f32 v190, v7
v_cos_f32 v206, v234
s_waitcnt lgkmcnt(7)
v_mfma_f32_32x32x16_bf16 v[64:79], v[108:111], v[116:119], v[64:79]
s_add_u32 m0, s76, 50176
ds_read_b64_tr_b16 v[92:93], v143 offset:36864
ds_read_b64_tr_b16 v[94:95], v143 offset:37376
buffer_load_dwordx4 v157, s[20:23], s74 offen offset:0 lds
v_sin_f32_e64 v222, v234
v_fmamk_f32 v7, v5, 0x41b80000, v232
v_fmamk_f32 v234, v2, 0x41b80000, v233
v_cos_f32_e64 v175, v7
v_sin_f32 v191, v7
s_waitcnt lgkmcnt(6)
v_mfma_f32_32x32x16_bf16 v[16:31], v[80:83], v[112:115], v[16:31]
ds_read_b128 v[116:119], v139 offset:32768
ds_read_b64_tr_b16 v[96:97], v140 offset:38912
ds_read_b64_tr_b16 v[98:99], v140 offset:39424
v_mfma_f32_16x16x32_bf16 v[120:123], v[80:83], v[124:127], v[120:123]
v_cos_f32 v207, v234
s_waitcnt lgkmcnt(7)
v_mfma_f32_32x32x16_bf16 v[32:47], v[84:87], v[112:115], v[32:47]
s_add_u32 m0, s75, 35840
ds_read_b64_tr_b16 v[100:101], v141 offset:38912
ds_read_b64_tr_b16 v[102:103], v141 offset:39424
buffer_load_dwordx4 v155, s[4:7], s73 offen lds
s_waitcnt lgkmcnt(7)
v_mfma_f32_32x32x16_bf16 v[48:63], v[88:91], v[112:115], v[48:63]
ds_read_b64_tr_b16 v[104:105], v142 offset:38912
ds_read_b64_tr_b16 v[106:107], v142 offset:39424
v_sin_f32 v223, v234
s_cmp_eq_u32 s94, 1.0
s_cbranch_scc1 L_tw217
v_mul_f32 v192, 0.5, v192
v_mul_f32 v193, 0.5, v193
v_mul_f32 v194, 0.5, v194
v_mul_f32 v195, 0.5, v195
v_mul_f32 v196, 0.5, v196
v_mul_f32 v197, 0.5, v197
v_mul_f32 v198, 0.5, v198
v_mul_f32 v199, 0.5, v199
v_mul_f32 v200, 0.5, v200
v_mul_f32 v201, 0.5, v201
v_mul_f32 v202, 0.5, v202
v_mul_f32 v203, 0.5, v203
v_mul_f32 v204, 0.5, v204
v_mul_f32 v205, 0.5, v205
v_mul_f32 v206, 0.5, v206
v_mul_f32 v207, 0.5, v207
v_mul_f32 v208, 0.5, v208
v_mul_f32 v209, 0.5, v209
v_mul_f32 v210, 0.5, v210
v_mul_f32 v211, 0.5, v211
v_mul_f32 v212, 0.5, v212
v_mul_f32 v213, 0.5, v213
v_mul_f32 v214, 0.5, v214
v_mul_f32 v215, 0.5, v215
v_mul_f32 v216, 0.5, v216
v_mul_f32 v217, 0.5, v217
v_mul_f32 v218, 0.5, v218
v_mul_f32 v219, 0.5, v219
v_mul_f32 v220, 0.5, v220
v_mul_f32 v221, 0.5, v221
v_mul_f32_e64 v222, 0.5, v222
v_mul_f32 v223, 0.5, v223
L_tw217:
s_waitcnt lgkmcnt(7)
v_mfma_f32_32x32x16_bf16 v[64:79], v[92:95], v[112:115], v[64:79]
s_add_u32 m0, s76, 58240
ds_read_b64_tr_b16 v[108:109], v143 offset:38912
ds_read_b64_tr_b16 v[110:111], v143 offset:39424
buffer_load_dwordx4 v157, s[20:23], s74 offen offset:128 lds
s_lshr_b32 s95, s52, 1
s_lshl_b32 s95, s95, 2
s_and_b32 s96, s52, 1
v_bfe_u32 v2, v1, 1, 3
v_xor_b32 v2, s95, v2
v_lshlrev_b32_e64 v5, 7, v4
v_add_u32 v5, 131072, v5
v_lshl_add_u32 v7, v2, 4, v5
v_lshl_add_u32 v7, v3, 12, v7
s_lshl_b32 s95, s96, 14
v_add_u32 v226, s95, v7
v_xor_b32_e64 v227, 16, v226
s_xor_b32 s95, s95, 16384
v_add_u32 v228, s95, v7
v_xor_b32 v229, 16, v228
v_xor_b32 v2, 2, v2
v_xor_b32 v2, v3, v2
v_lshl_add_u32 v230, v2, 4, v5
s_lshl_b32 s95, s96, 12
v_add_u32_e64 v230, s95, v230
s_waitcnt vmcnt(8)
s_barrier
s_waitcnt lgkmcnt(6)
v_mfma_f32_32x32x16_bf16 v[16:31], v[96:99], v[116:119], v[16:31]
ds_read_b128 v[112:115], v128 offset:0
ds_read_b64_tr_b16 v[80:81], v132 offset:0
ds_read_b64_tr_b16 v[82:83], v132 offset:512
v_mfma_f32_16x16x32_bf16 v[120:123], v[96:99], v[124:127], v[120:123]
v_and_b32_e64 v2, 0x13, v4
v_bfe_u32 v5, v4, 2, 1
s_waitcnt lgkmcnt(7)
v_mfma_f32_32x32x16_bf16 v[32:47], v[100:103], v[116:119], v[32:47]
s_add_u32 s72, s42, 6
s_cmp_ge_u32 s72, 10
s_cselect_b32 s73, 10, 0
s_sub_u32 s72, s72, s73
s_lshl_b32 s73, s72, 7
s_mul_i32 s74, s72, 221184
s_add_u32 s73, s73, s45
s_add_u32 s74, s74, s46
s_add_u32 m0, s75, 65536
ds_read_b64_tr_b16 v[84:85], v133 offset:0
ds_read_b64_tr_b16 v[86:87], v133 offset:512
buffer_load_dwordx4 v152, s[4:7], s73 offen lds
s_waitcnt lgkmcnt(7)
s_nop 0
v_mfma_f32_32x32x16_bf16 v[48:63], v[104:107], v[116:119], v[48:63]
ds_read_b64_tr_b16 v[88:89], v134 offset:0
ds_read_b64_tr_b16 v[90:91], v134 offset:512
v_lshl_or_b32 v2, v5, 3, v2
v_bfe_u32 v5, v4, 3, 1
v_lshl_or_b32 v2, v5, 2, v2
s_waitcnt lgkmcnt(7)
v_mfma_f32_32x32x16_bf16 v[64:79], v[108:111], v[116:119], v[64:79]
s_add_u32 m0, s76, 81920
ds_read_b64_tr_b16 v[92:93], v135 offset:0
ds_read_b64_tr_b16 v[94:95], v135 offset:512
buffer_load_dwordx4 v156, s[20:23], s74 offen offset:0 lds
s_and_b32 s92, s52, 1
s_lshl_b32 s92, s92, 5
v_add_u32 v2, s92, v2
v_cvt_f32_u32_e64 v2, v2
v_mul_f32 v2, 0x3c800000, v2
v_lshl_add_u32 v5, v3, 3, s92
v_xor_b32 v7, 32, v5
v_cvt_f32_u32 v5, v5
v_cvt_f32_u32 v7, v7
v_mul_f32 v5, v5, v2
v_mul_f32_e64 v7, v7, v2
v_fmamk_f32 v232, v2, 0x00000000, v5
v_add_f32 v233, v232, v2
s_waitcnt lgkmcnt(6)
v_mfma_f32_32x32x16_bf16 v[16:31], v[80:83], v[112:115], v[16:31]
ds_read_b128 v[116:119], v129 offset:0
ds_read_b64_tr_b16 v[96:97], v132 offset:2048
ds_read_b64_tr_b16 v[98:99], v132 offset:2560
v_mfma_f32_16x16x32_bf16 v[120:123], v[80:83], v[124:127], v[120:123]
v_cos_f32 v234, v232
s_waitcnt lgkmcnt(7)
v_mfma_f32_32x32x16_bf16 v[32:47], v[84:87], v[112:115], v[32:47]
s_add_u32 m0, s75, 66560
ds_read_b64_tr_b16 v[100:101], v133 offset:2048
ds_read_b64_tr_b16 v[102:103], v133 offset:2560
buffer_load_dwordx4 v153, s[4:7], s73 offen lds
s_waitcnt lgkmcnt(7)
v_mfma_f32_32x32x16_bf16 v[48:63], v[88:91], v[112:115], v[48:63]
ds_read_b64_tr_b16 v[104:105], v134 offset:2048
ds_read_b64_tr_b16 v[106:107], v134 offset:2560
v_cos_f32 v235, v233
v_sin_f32 v236, v232
s_waitcnt lgkmcnt(7)
v_mfma_f32_32x32x16_bf16 v[64:79], v[92:95], v[112:115], v[64:79]
s_add_u32 m0, s76, 89984
ds_read_b64_tr_b16 v[108:109], v135 offset:2048
ds_read_b64_tr_b16 v[110:111], v135 offset:2560
buffer_load_dwordx4 v156, s[20:23], s74 offen offset:128 lds
v_sin_f32_e64 v237, v233
v_cvt_pk_bf16_f32 v234, v234, v235
v_cvt_pk_bf16_f32 v238, -v236, -v237
v_cvt_pk_bf16_f32 v239, v236, v237
v_accvgpr_write_b32 a184, v234
s_waitcnt lgkmcnt(6)
s_nop 0
v_mfma_f32_32x32x16_bf16 v[16:31], v[96:99], v[116:119], v[16:31]
ds_read_b128 v[112:115], v130 offset:0
ds_read_b64_tr_b16 v[80:81], v132 offset:4096
ds_read_b64_tr_b16 v[82:83], v132 offset:4608
v_mfma_f32_16x16x32_bf16 v[120:123], v[96:99], v[124:127], v[120:123]
v_accvgpr_write_b32 a200, v238
v_accvgpr_write_b32 a216, v239
s_waitcnt lgkmcnt(7)
v_mfma_f32_32x32x16_bf16 v[32:47], v[100:103], v[116:119], v[32:47]
s_add_u32 m0, s75, 67584
ds_read_b64_tr_b16 v[84:85], v133 offset:4096
ds_read_b64_tr_b16 v[86:87], v133 offset:4608
buffer_load_dwordx4 v154, s[4:7], s73 offen lds
s_waitcnt lgkmcnt(7)
v_mfma_f32_32x32x16_bf16 v[48:63], v[104:107], v[116:119], v[48:63]
ds_read_b64_tr_b16 v[88:89], v134 offset:4096
ds_read_b64_tr_b16 v[90:91], v134 offset:4608
v_fmamk_f32 v232, v2, 0x40000000, v5
v_add_f32_e64 v233, v232, v2
v_cos_f32 v234, v232
s_waitcnt lgkmcnt(7)
v_mfma_f32_32x32x16_bf16 v[64:79], v[108:111], v[116:119], v[64:79]
s_add_u32 m0, s76, 82944
ds_read_b64_tr_b16 v[92:93], v135 offset:4096
ds_read_b64_tr_b16 v[94:95], v135 offset:4608
buffer_load_dwordx4 v157, s[20:23], s74 offen offset:0 lds
v_cos_f32 v235, v233
v_sin_f32 v236, v232
v_sin_f32_e64 v237, v233
v_cvt_pk_bf16_f32 v234, v234, v235
s_waitcnt lgkmcnt(6)
s_nop 0
v_mfma_f32_32x32x16_bf16 v[16:31], v[80:83], v[112:115], v[16:31]
ds_read_b128 v[116:119], v131 offset:0
ds_read_b64_tr_b16 v[96:97], v132 offset:6144
ds_read_b64_tr_b16 v[98:99], v132 offset:6656
v_mfma_f32_16x16x32_bf16 v[120:123], v[80:83], v[124:127], v[120:123]
v_cvt_pk_bf16_f32 v238, -v236, -v237
v_cvt_pk_bf16_f32 v239, v236, v237
s_waitcnt lgkmcnt(7)
v_mfma_f32_32x32x16_bf16 v[32:47], v[84:87], v[112:115], v[32:47]
s_add_u32 m0, s75, 68608
ds_read_b64_tr_b16 v[100:101], v133 offset:6144
ds_read_b64_tr_b16 v[102:103], v133 offset:6656
buffer_load_dwordx4 v155, s[4:7], s73 offen lds
s_waitcnt lgkmcnt(7)
v_mfma_f32_32x32x16_bf16 v[48:63], v[88:91], v[112:115], v[48:63]
ds_read_b64_tr_b16 v[104:105], v134 offset:6144
ds_read_b64_tr_b16 v[106:107], v134 offset:6656
v_accvgpr_write_b32 a185, v234
v_accvgpr_write_b32 a201, v238
v_accvgpr_write_b32 a217, v239
s_waitcnt lgkmcnt(7)
s_nop 0
v_mfma_f32_32x32x16_bf16 v[64:79], v[92:95], v[112:115], v[64:79]
s_add_u32 m0, s76, 91008
ds_read_b64_tr_b16 v[108:109], v135 offset:6144
ds_read_b64_tr_b16 v[110:111], v135 offset:6656
buffer_load_dwordx4 v157, s[20:23], s74 offen offset:128 lds
v_fmamk_f32 v232, v2, 0x40800000, v5
v_add_f32 v233, v232, v2
v_cos_f32 v234, v232
v_cos_f32 v235, v233
s_waitcnt vmcnt(8)
s_barrier
s_waitcnt lgkmcnt(6)
v_mfma_f32_32x32x16_bf16 v[16:31], v[96:99], v[116:119], v[16:31]
ds_read_b128 v[112:115], v128 offset:32768
ds_read_b64_tr_b16 v[80:81], v132 offset:32768
ds_read_b64_tr_b16 v[82:83], v132 offset:33280
v_mfma_f32_16x16x32_bf16 v[120:123], v[96:99], v[124:127], v[120:123]
v_sin_f32 v236, v232
s_waitcnt lgkmcnt(7)
v_mfma_f32_32x32x16_bf16 v[32:47], v[100:103], v[116:119], v[32:47]
s_add_u32 s72, s42, 7
s_cmp_ge_u32 s72, 10
s_cselect_b32 s73, 10, 0
s_sub_u32 s72, s72, s73
s_lshl_b32 s73, s72, 7
s_mul_i32 s74, s72, 221184
s_add_u32 s73, s73, s45
s_add_u32 s74, s74, s46
s_add_u32 m0, s75, 98304
ds_read_b64_tr_b16 v[84:85], v133 offset:32768
ds_read_b64_tr_b16 v[86:87], v133 offset:33280
buffer_load_dwordx4 v152, s[4:7], s73 offen lds
s_waitcnt lgkmcnt(7)
v_mfma_f32_32x32x16_bf16 v[48:63], v[104:107], v[116:119], v[48:63]
ds_read_b64_tr_b16 v[88:89], v134 offset:32768
ds_read_b64_tr_b16 v[90:91], v134 offset:33280
v_sin_f32_e64 v237, v233
v_cvt_pk_bf16_f32 v234, v234, v235
s_waitcnt lgkmcnt(7)
s_nop 0
v_mfma_f32_32x32x16_bf16 v[64:79], v[108:111], v[116:119], v[64:79]
s_add_u32 m0, s76, 114688
ds_read_b64_tr_b16 v[92:93], v135 offset:32768
ds_read_b64_tr_b16 v[94:95], v135 offset:33280
buffer_load_dwordx4 v156, s[20:23], s74 offen offset:0 lds
v_cvt_pk_bf16_f32 v238, -v236, -v237
v_cvt_pk_bf16_f32 v239, v236, v237
v_accvgpr_write_b32 a186, v234
v_accvgpr_write_b32 a202, v238
v_accvgpr_write_b32 a218, v239
v_fmamk_f32 v232, v2, 0x40c00000, v5
s_waitcnt lgkmcnt(6)
v_mfma_f32_32x32x16_bf16 v[16:31], v[80:83], v[112:115], v[16:31]
ds_read_b128 v[116:119], v129 offset:32768
ds_read_b64_tr_b16 v[96:97], v132 offset:34816
ds_read_b64_tr_b16 v[98:99], v132 offset:35328
v_mfma_f32_16x16x32_bf16 v[120:123], v[80:83], v[124:127], v[120:123]
v_add_f32 v233, v232, v2
v_cos_f32 v234, v232
s_waitcnt lgkmcnt(7)
v_mfma_f32_32x32x16_bf16 v[32:47], v[84:87], v[112:115], v[32:47]
s_add_u32 m0, s75, 99328
ds_read_b64_tr_b16 v[100:101], v133 offset:34816
ds_read_b64_tr_b16 v[102:103], v133 offset:35328
buffer_load_dwordx4 v153, s[4:7], s73 offen lds
s_waitcnt lgkmcnt(7)
v_mfma_f32_32x32x16_bf16 v[48:63], v[88:91], v[112:115], v[48:63]
ds_read_b64_tr_b16 v[104:105], v134 offset:34816
ds_read_b64_tr_b16 v[106:107], v134 offset:35328
v_cos_f32 v235, v233
v_sin_f32 v236, v232
s_waitcnt lgkmcnt(7)
v_mfma_f32_32x32x16_bf16 v[64:79], v[92:95], v[112:115], v[64:79]
s_add_u32 m0, s76, 122752
ds_read_b64_tr_b16 v[108:109], v135 offset:34816
ds_read_b64_tr_b16 v[110:111], v135 offset:35328
buffer_load_dwordx4 v156, s[20:23], s74 offen offset:128 lds
v_sin_f32_e64 v237, v233
v_cvt_pk_bf16_f32 v234, v234, v235
v_cvt_pk_bf16_f32 v238, -v236, -v237
v_cvt_pk_bf16_f32 v239, v236, v237
v_accvgpr_write_b32 a187, v234
s_waitcnt lgkmcnt(6)
s_nop 0
v_mfma_f32_32x32x16_bf16 v[16:31], v[96:99], v[116:119], v[16:31]
ds_read_b128 v[112:115], v130 offset:32768
ds_read_b64_tr_b16 v[80:81], v132 offset:36864
ds_read_b64_tr_b16 v[82:83], v132 offset:37376
v_mfma_f32_16x16x32_bf16 v[120:123], v[96:99], v[124:127], v[120:123]
v_accvgpr_write_b32 a203, v238
v_accvgpr_write_b32 a219, v239
s_waitcnt lgkmcnt(7)
v_mfma_f32_32x32x16_bf16 v[32:47], v[100:103], v[116:119], v[32:47]
s_add_u32 m0, s75, 100352
ds_read_b64_tr_b16 v[84:85], v133 offset:36864
ds_read_b64_tr_b16 v[86:87], v133 offset:37376
buffer_load_dwordx4 v154, s[4:7], s73 offen lds
s_waitcnt lgkmcnt(7)
v_mfma_f32_32x32x16_bf16 v[48:63], v[104:107], v[116:119], v[48:63]
ds_read_b64_tr_b16 v[88:89], v134 offset:36864
ds_read_b64_tr_b16 v[90:91], v134 offset:37376
v_fmamk_f32 v232, v2, 0x41800000, v5
v_add_f32_e64 v233, v232, v2
v_cos_f32 v234, v232
s_waitcnt lgkmcnt(7)
v_mfma_f32_32x32x16_bf16 v[64:79], v[108:111], v[116:119], v[64:79]
s_add_u32 m0, s76, 115712
ds_read_b64_tr_b16 v[92:93], v135 offset:36864
ds_read_b64_tr_b16 v[94:95], v135 offset:37376
buffer_load_dwordx4 v157, s[20:23], s74 offen offset:0 lds
v_cos_f32 v235, v233
v_sin_f32 v236, v232
v_sin_f32_e64 v237, v233
v_cvt_pk_bf16_f32 v234, v234, v235
s_waitcnt lgkmcnt(6)
s_nop 0
v_mfma_f32_32x32x16_bf16 v[16:31], v[80:83], v[112:115], v[16:31]
ds_read_b128 v[116:119], v131 offset:32768
ds_read_b64_tr_b16 v[96:97], v132 offset:38912
ds_read_b64_tr_b16 v[98:99], v132 offset:39424
v_mfma_f32_16x16x32_bf16 v[120:123], v[80:83], v[124:127], v[120:123]
v_cvt_pk_bf16_f32 v238, -v236, -v237
v_cvt_pk_bf16_f32 v239, v236, v237
s_waitcnt lgkmcnt(7)
v_mfma_f32_32x32x16_bf16 v[32:47], v[84:87], v[112:115], v[32:47]
s_add_u32 m0, s75, 101376
ds_read_b64_tr_b16 v[100:101], v133 offset:38912
ds_read_b64_tr_b16 v[102:103], v133 offset:39424
buffer_load_dwordx4 v155, s[4:7], s73 offen lds
s_waitcnt lgkmcnt(7)
v_mfma_f32_32x32x16_bf16 v[48:63], v[88:91], v[112:115], v[48:63]
ds_read_b64_tr_b16 v[104:105], v134 offset:38912
ds_read_b64_tr_b16 v[106:107], v134 offset:39424
v_accvgpr_write_b32 a188, v234
v_accvgpr_write_b32 a204, v238
v_accvgpr_write_b32 a220, v239
s_waitcnt lgkmcnt(7)
s_nop 0
v_mfma_f32_32x32x16_bf16 v[64:79], v[92:95], v[112:115], v[64:79]
s_add_u32 m0, s76, 123776
ds_read_b64_tr_b16 v[108:109], v135 offset:38912
ds_read_b64_tr_b16 v[110:111], v135 offset:39424
buffer_load_dwordx4 v157, s[20:23], s74 offen offset:128 lds
v_fmamk_f32 v232, v2, 0x41900000, v5
v_add_f32_e64 v233, v232, v2
v_cos_f32 v234, v232
s_waitcnt vmcnt(8)
s_barrier
s_waitcnt lgkmcnt(6)
v_mfma_f32_32x32x16_bf16 v[16:31], v[96:99], v[116:119], v[16:31]
ds_read_b128 v[112:115], v136 offset:0
ds_read_b64_tr_b16 v[80:81], v140 offset:0
ds_read_b64_tr_b16 v[82:83], v140 offset:512
v_mfma_f32_16x16x32_bf16 v[120:123], v[96:99], v[124:127], v[120:123]
v_cos_f32 v235, v233
s_waitcnt lgkmcnt(7)
v_mfma_f32_32x32x16_bf16 v[32:47], v[100:103], v[116:119], v[32:47]
s_add_u32 s72, s42, 8
s_cmp_ge_u32 s72, 10
s_cselect_b32 s73, 10, 0
s_sub_u32 s72, s72, s73
s_lshl_b32 s73, s72, 7
s_mul_i32 s74, s72, 221184
s_add_u32 s73, s73, s45
s_add_u32 s74, s74, s46
s_add_u32 m0, s75, 0
ds_read_b64_tr_b16 v[84:85], v141 offset:0
ds_read_b64_tr_b16 v[86:87], v141 offset:512
buffer_load_dwordx4 v152, s[4:7], s73 offen lds
s_waitcnt lgkmcnt(7)
v_mfma_f32_32x32x16_bf16 v[48:63], v[104:107], v[116:119], v[48:63]
ds_read_b64_tr_b16 v[88:89], v142 offset:0
ds_read_b64_tr_b16 v[90:91], v142 offset:512
v_sin_f32 v236, v232
v_sin_f32 v237, v233
s_waitcnt lgkmcnt(7)
v_mfma_f32_32x32x16_bf16 v[64:79], v[108:111], v[116:119], v[64:79]
s_add_u32 m0, s76, 16384
ds_read_b64_tr_b16 v[92:93], v143 offset:0
ds_read_b64_tr_b16 v[94:95], v143 offset:512
buffer_load_dwordx4 v156, s[20:23], s74 offen offset:0 lds
v_cvt_pk_bf16_f32 v234, v234, v235
v_cvt_pk_bf16_f32 v238, -v236, -v237
v_cvt_pk_bf16_f32 v239, v236, v237
v_accvgpr_write_b32 a189, v234
v_accvgpr_write_b32 a205, v238
v_accvgpr_write_b32 a221, v239
s_waitcnt lgkmcnt(6)
s_nop 0
v_mfma_f32_32x32x16_bf16 v[16:31], v[80:83], v[112:115], v[16:31]
ds_read_b128 v[116:119], v137 offset:0
ds_read_b64_tr_b16 v[96:97], v140 offset:2048
ds_read_b64_tr_b16 v[98:99], v140 offset:2560
v_mfma_f32_16x16x32_bf16 v[120:123], v[80:83], v[124:127], v[120:123]
v_fmamk_f32 v232, v2, 0x41a00000, v5
v_add_f32 v233, v232, v2
s_waitcnt lgkmcnt(7)
v_mfma_f32_32x32x16_bf16 v[32:47], v[84:87], v[112:115], v[32:47]
s_add_u32 m0, s75, 1024
ds_read_b64_tr_b16 v[100:101], v141 offset:2048
ds_read_b64_tr_b16 v[102:103], v141 offset:2560
buffer_load_dwordx4 v153, s[4:7], s73 offen lds
s_waitcnt lgkmcnt(7)
v_mfma_f32_32x32x16_bf16 v[48:63], v[88:91], v[112:115], v[48:63]
ds_read_b64_tr_b16 v[104:105], v142 offset:2048
ds_read_b64_tr_b16 v[106:107], v142 offset:2560
v_cos_f32 v234, v232
v_cos_f32 v235, v233
s_waitcnt lgkmcnt(7)
v_mfma_f32_32x32x16_bf16 v[64:79], v[92:95], v[112:115], v[64:79]
s_add_u32 m0, s76, 24448
ds_read_b64_tr_b16 v[108:109], v143 offset:2048
ds_read_b64_tr_b16 v[110:111], v143 offset:2560
buffer_load_dwordx4 v156, s[20:23], s74 offen offset:128 lds
v_sin_f32 v236, v232
v_sin_f32 v237, v233
v_cvt_pk_bf16_f32 v234, v234, v235
v_cvt_pk_bf16_f32 v238, -v236, -v237
v_cvt_pk_bf16_f32 v239, v236, v237
s_waitcnt lgkmcnt(6)
s_nop 0
v_mfma_f32_32x32x16_bf16 v[16:31], v[96:99], v[116:119], v[16:31]
ds_read_b128 v[112:115], v138 offset:0
ds_read_b64_tr_b16 v[80:81], v140 offset:4096
ds_read_b64_tr_b16 v[82:83], v140 offset:4608
v_mfma_f32_16x16x32_bf16 v[120:123], v[96:99], v[124:127], v[120:123]
v_accvgpr_write_b32 a190, v234
v_accvgpr_write_b32 a206, v238
s_waitcnt lgkmcnt(7)
v_mfma_f32_32x32x16_bf16 v[32:47], v[100:103], v[116:119], v[32:47]
s_add_u32 m0, s75, 2048
ds_read_b64_tr_b16 v[84:85], v141 offset:4096
ds_read_b64_tr_b16 v[86:87], v141 offset:4608
buffer_load_dwordx4 v154, s[4:7], s73 offen lds
s_waitcnt lgkmcnt(7)
v_mfma_f32_32x32x16_bf16 v[48:63], v[104:107], v[116:119], v[48:63]
ds_read_b64_tr_b16 v[88:89], v142 offset:4096
ds_read_b64_tr_b16 v[90:91], v142 offset:4608
v_accvgpr_write_b32 a222, v239
v_fmamk_f32 v232, v2, 0x41b00000, v5
v_add_f32 v233, v232, v2
s_waitcnt lgkmcnt(7)
v_mfma_f32_32x32x16_bf16 v[64:79], v[108:111], v[116:119], v[64:79]
s_add_u32 m0, s76, 17408
ds_read_b64_tr_b16 v[92:93], v143 offset:4096
ds_read_b64_tr_b16 v[94:95], v143 offset:4608
buffer_load_dwordx4 v157, s[20:23], s74 offen offset:0 lds
v_cos_f32 v234, v232
v_cos_f32 v235, v233
v_sin_f32_e64 v236, v232
v_sin_f32 v237, v233
s_waitcnt lgkmcnt(6)
v_mfma_f32_32x32x16_bf16 v[16:31], v[80:83], v[112:115], v[16:31]
ds_read_b128 v[116:119], v139 offset:0
ds_read_b64_tr_b16 v[96:97], v140 offset:6144
ds_read_b64_tr_b16 v[98:99], v140 offset:6656
v_mfma_f32_16x16x32_bf16 v[120:123], v[80:83], v[124:127], v[120:123]
v_cvt_pk_bf16_f32 v234, v234, v235
v_cvt_pk_bf16_f32 v238, -v236, -v237
s_waitcnt lgkmcnt(7)
v_mfma_f32_32x32x16_bf16 v[32:47], v[84:87], v[112:115], v[32:47]
s_add_u32 m0, s75, 3072
ds_read_b64_tr_b16 v[100:101], v141 offset:6144
ds_read_b64_tr_b16 v[102:103], v141 offset:6656
buffer_load_dwordx4 v155, s[4:7], s73 offen lds
s_waitcnt lgkmcnt(7)
v_mfma_f32_32x32x16_bf16 v[48:63], v[88:91], v[112:115], v[48:63]
ds_read_b64_tr_b16 v[104:105], v142 offset:6144
ds_read_b64_tr_b16 v[106:107], v142 offset:6656
v_cvt_pk_bf16_f32 v239, v236, v237
v_accvgpr_write_b32 a191, v234
v_accvgpr_write_b32 a207, v238
s_waitcnt lgkmcnt(7)
s_nop 0
v_mfma_f32_32x32x16_bf16 v[64:79], v[92:95], v[112:115], v[64:79]
s_add_u32 m0, s76, 25472
ds_read_b64_tr_b16 v[108:109], v143 offset:6144
ds_read_b64_tr_b16 v[110:111], v143 offset:6656
buffer_load_dwordx4 v157, s[20:23], s74 offen offset:128 lds
v_accvgpr_write_b32 a223, v239
v_fmamk_f32 v232, v2, 0x00000000, v7
v_add_f32_e64 v233, v232, v2
v_cos_f32 v234, v232
s_waitcnt vmcnt(8)
s_barrier
s_waitcnt lgkmcnt(6)
v_mfma_f32_32x32x16_bf16 v[16:31], v[96:99], v[116:119], v[16:31]
ds_read_b128 v[112:115], v136 offset:32768
ds_read_b64_tr_b16 v[80:81], v140 offset:32768
ds_read_b64_tr_b16 v[82:83], v140 offset:33280
v_mfma_f32_16x16x32_bf16 v[120:123], v[96:99], v[124:127], v[120:123]
v_cos_f32_e64 v235, v233
v_sin_f32 v236, v232
s_waitcnt lgkmcnt(7)
v_mfma_f32_32x32x16_bf16 v[32:47], v[100:103], v[116:119], v[32:47]
s_add_u32 s72, s42, 9
s_cmp_ge_u32 s72, 10
s_cselect_b32 s73, 10, 0
s_sub_u32 s72, s72, s73
s_lshl_b32 s73, s72, 7
s_mul_i32 s74, s72, 221184
s_add_u32 s73, s73, s45
s_add_u32 s74, s74, s46
s_add_u32 m0, s75, 32768
ds_read_b64_tr_b16 v[84:85], v141 offset:32768
ds_read_b64_tr_b16 v[86:87], v141 offset:33280
buffer_load_dwordx4 v152, s[4:7], s73 offen lds
s_waitcnt lgkmcnt(7)
v_mfma_f32_32x32x16_bf16 v[48:63], v[104:107], v[116:119], v[48:63]
s_add_u32 m0, s76, 49152
ds_read_b64_tr_b16 v[88:89], v142 offset:32768
ds_read_b64_tr_b16 v[90:91], v142 offset:33280
buffer_load_dwordx4 v156, s[20:23], s74 offen offset:0 lds
v_sin_f32 v237, v233
s_waitcnt lgkmcnt(7)
v_mfma_f32_32x32x16_bf16 v[64:79], v[108:111], v[116:119], v[64:79]
s_add_u32 m0, s75, 33792
ds_read_b64_tr_b16 v[92:93], v143 offset:32768
ds_read_b64_tr_b16 v[94:95], v143 offset:33280
buffer_load_dwordx4 v153, s[4:7], s73 offen lds
v_cvt_pk_bf16_f32 v234, v234, v235
v_cvt_pk_bf16_f32 v238, -v236, -v237
v_cvt_pk_bf16_f32 v239, v236, v237
v_accvgpr_write_b32 a192, v234
v_accvgpr_write_b32 a208, v238
s_waitcnt lgkmcnt(6)
s_nop 0
v_mfma_f32_32x32x16_bf16 v[16:31], v[80:83], v[112:115], v[16:31]
ds_read_b128 v[116:119], v137 offset:32768
ds_read_b64_tr_b16 v[96:97], v140 offset:34816
ds_read_b64_tr_b16 v[98:99], v140 offset:35328
v_mfma_f32_16x16x32_bf16 v[120:123], v[80:83], v[124:127], v[120:123]
v_accvgpr_write_b32 a224, v239
v_fmamk_f32 v232, v2, 0x40000000, v7
s_waitcnt lgkmcnt(7)
v_mfma_f32_32x32x16_bf16 v[32:47], v[84:87], v[112:115], v[32:47]
s_add_u32 m0, s76, 57216
ds_read_b64_tr_b16 v[100:101], v141 offset:34816
ds_read_b64_tr_b16 v[102:103], v141 offset:35328
buffer_load_dwordx4 v156, s[20:23], s74 offen offset:128 lds
s_waitcnt lgkmcnt(7)
v_mfma_f32_32x32x16_bf16 v[48:63], v[88:91], v[112:115], v[48:63]
ds_read_b64_tr_b16 v[104:105], v142 offset:34816
ds_read_b64_tr_b16 v[106:107], v142 offset:35328
v_add_f32_e64 v233, v232, v2
v_cos_f32 v234, v232
s_waitcnt lgkmcnt(7)
v_mfma_f32_32x32x16_bf16 v[64:79], v[92:95], v[112:115], v[64:79]
s_add_u32 m0, s75, 34816
ds_read_b64_tr_b16 v[108:109], v143 offset:34816
ds_read_b64_tr_b16 v[110:111], v143 offset:35328
buffer_load_dwordx4 v154, s[4:7], s73 offen lds
v_cos_f32 v235, v233
v_sin_f32 v236, v232
v_sin_f32_e64 v237, v233
v_cvt_pk_bf16_f32 v234, v234, v235
v_cvt_pk_bf16_f32 v238, -v236, -v237
s_waitcnt lgkmcnt(6)
s_nop 0
v_mfma_f32_32x32x16_bf16 v[16:31], v[96:99], v[116:119], v[16:31]
ds_read_b128 v[112:115], v138 offset:32768
ds_read_b64_tr_b16 v[80:81], v140 offset:36864
ds_read_b64_tr_b16 v[82:83], v140 offset:37376
v_mfma_f32_16x16x32_bf16 v[120:123], v[96:99], v[124:127], v[120:123]
v_cvt_pk_bf16_f32 v239, v236, v237
v_accvgpr_write_b32 a193, v234
v_accvgpr_write_b32 a209, v238
v_accvgpr_write_b32 a225, v239
s_waitcnt lgkmcnt(7)
v_mfma_f32_32x32x16_bf16 v[32:47], v[100:103], v[116:119], v[32:47]
ds_read_b64_tr_b16 v[84:85], v141 offset:36864
ds_read_b64_tr_b16 v[86:87], v141 offset:37376
s_cmp_lg_u32 s52, 0
s_cbranch_scc1 L_f1i16
v_mul_u32_u24 v8, 16, v1
v_add_u32 v8, 131072, v8
v_add_u32 v9, 1024, v8
v_add_u32 v10, 2048, v8
v_add_u32 v11, 3072, v8
buffer_load_dword v12, v8, s[8:11], 0 offen sc1
buffer_load_dword v13, v9, s[8:11], 0 offen sc1
buffer_load_dword v14, v10, s[8:11], 0 offen sc1
buffer_load_dword v15, v11, s[8:11], 0 offen sc1
L_f1i16:
s_waitcnt lgkmcnt(7)
s_nop 0
v_mfma_f32_32x32x16_bf16 v[48:63], v[104:107], v[116:119], v[48:63]
s_add_u32 m0, s76, 50176
ds_read_b64_tr_b16 v[88:89], v142 offset:36864
ds_read_b64_tr_b16 v[90:91], v142 offset:37376
buffer_load_dwordx4 v157, s[20:23], s74 offen offset:0 lds
v_fmamk_f32 v232, v2, 0x40800000, v7
s_waitcnt lgkmcnt(7)
v_mfma_f32_32x32x16_bf16 v[64:79], v[108:111], v[116:119], v[64:79]
s_add_u32 m0, s75, 35840
ds_read_b64_tr_b16 v[92:93], v143 offset:36864
ds_read_b64_tr_b16 v[94:95], v143 offset:37376
buffer_load_dwordx4 v155, s[4:7], s73 offen lds
v_add_f32 v233, v232, v2
v_cos_f32 v234, v232
v_cos_f32 v235, v233
v_sin_f32 v236, v232
s_waitcnt lgkmcnt(6)
v_mfma_f32_32x32x16_bf16 v[16:31], v[80:83], v[112:115], v[16:31]
ds_read_b128 v[116:119], v139 offset:32768
ds_read_b64_tr_b16 v[96:97], v140 offset:38912
ds_read_b64_tr_b16 v[98:99], v140 offset:39424
v_mfma_f32_16x16x32_bf16 v[120:123], v[80:83], v[124:127], v[120:123]
v_sin_f32 v237, v233
s_waitcnt lgkmcnt(7)
v_mfma_f32_32x32x16_bf16 v[32:47], v[84:87], v[112:115], v[32:47]
s_add_u32 m0, s76, 58240
ds_read_b64_tr_b16 v[100:101], v141 offset:38912
ds_read_b64_tr_b16 v[102:103], v141 offset:39424
buffer_load_dwordx4 v157, s[20:23], s74 offen offset:128 lds
s_waitcnt lgkmcnt(7)
s_nop 0
v_mfma_f32_32x32x16_bf16 v[48:63], v[88:91], v[112:115], v[48:63]
ds_read_b64_tr_b16 v[104:105], v142 offset:38912
ds_read_b64_tr_b16 v[106:107], v142 offset:39424
v_cvt_pk_bf16_f32 v234, v234, v235
v_cvt_pk_bf16_f32 v238, -v236, -v237
v_cvt_pk_bf16_f32 v239, v236, v237
v_accvgpr_write_b32 a194, v234
v_accvgpr_write_b32 a210, v238
v_accvgpr_write_b32 a226, v239
v_fmamk_f32 v232, v2, 0x40c00000, v7
v_add_f32 v233, v232, v2
s_waitcnt lgkmcnt(7)
v_mfma_f32_32x32x16_bf16 v[64:79], v[92:95], v[112:115], v[64:79]
ds_read_b64_tr_b16 v[108:109], v143 offset:38912
ds_read_b64_tr_b16 v[110:111], v143 offset:39424
s_lshl_b32 s72, s36, 7
s_lshl_b32 s77, s52, 5
s_add_u32 s72, s72, s77
s_lshl_b32 s72, s72, 3
s_add_u32 s72, s72, 65536
v_lshlrev_b32 v231, 3, v4
v_add_u32 v231, s72, v231
buffer_load_dwordx2 v[158:159], v231, s[8:11], 0 offen sc1
s_waitcnt vmcnt(9)
s_cmp_lg_u32 s52, 0
s_cbranch_scc1 L_polld20
s_waitcnt vmcnt(4)
s_mov_b32 s79, 0
L_poll19:
v_cmp_ne_u32 vcc, s56, v12
v_cmp_ne_u32 s[62:63], s56, v13
s_nop 0
s_or_b64 vcc, vcc, s[62:63]
v_cmp_ne_u32 s[62:63], s56, v14
s_nop 0
s_or_b64 vcc, vcc, s[62:63]
v_cmp_ne_u32 s[62:63], s56, v15
s_nop 0
s_or_b64 vcc, vcc, s[62:63]
s_add_u32 s79, s79, 1
s_cmp_eq_u64 vcc, 0
s_cbranch_scc1 L_polld20
buffer_load_dword v12, v8, s[8:11], 0 offen sc1
buffer_load_dword v13, v9, s[8:11], 0 offen sc1
buffer_load_dword v14, v10, s[8:11], 0 offen sc1
buffer_load_dword v15, v11, s[8:11], 0 offen sc1
s_waitcnt vmcnt(0)
s_cmp_lt_u32 s79, 200000
s_cbranch_scc1 L_poll19
L_polld20:
s_barrier
s_waitcnt lgkmcnt(6)
v_mfma_f32_32x32x16_bf16 v[16:31], v[96:99], v[116:119], v[16:31]
ds_read_b128 v[112:115], v128 offset:0
ds_read_b64_tr_b16 v[80:81], v132 offset:0
ds_read_b64_tr_b16 v[82:83], v132 offset:512
v_mfma_f32_16x16x32_bf16 v[120:123], v[96:99], v[124:127], v[120:123]
v_cos_f32_e64 v234, v232
s_waitcnt lgkmcnt(7)
v_mfma_f32_32x32x16_bf16 v[32:47], v[100:103], v[116:119], v[32:47]
s_lshl_b32 s3, s52, 13
s_add_u32 m0, s3, 131072
s_mov_b32 s72, 0
ds_read_b64_tr_b16 v[84:85], v133 offset:0
ds_read_b64_tr_b16 v[86:87], v133 offset:512
buffer_load_dwordx4 v224, s[8:11], s72 offen sc1 lds
s_waitcnt lgkmcnt(7)
v_mfma_f32_32x32x16_bf16 v[48:63], v[104:107], v[116:119], v[48:63]
ds_read_b64_tr_b16 v[88:89], v134 offset:0
ds_read_b64_tr_b16 v[90:91], v134 offset:512
v_cos_f32 v235, v233
v_sin_f32 v236, v232
s_waitcnt lgkmcnt(7)
v_mfma_f32_32x32x16_bf16 v[64:79], v[108:111], v[116:119], v[64:79]
s_add_u32 m0, s3, 132096
s_mov_b32 s72, 659456
ds_read_b64_tr_b16 v[92:93], v135 offset:0
ds_read_b64_tr_b16 v[94:95], v135 offset:512
buffer_load_dwordx4 v225, s[8:11], s72 offen sc1 lds
v_sin_f32_e64 v237, v233
v_cvt_pk_bf16_f32 v234, v234, v235
v_cvt_pk_bf16_f32 v238, -v236, -v237
v_cvt_pk_bf16_f32 v239, v236, v237
v_accvgpr_write_b32 a195, v234
v_accvgpr_write_b32 a211, v238
s_waitcnt lgkmcnt(6)
s_nop 0
v_mfma_f32_32x32x16_bf16 v[16:31], v[80:83], v[112:115], v[16:31]
ds_read_b128 v[116:119], v129 offset:0
ds_read_b64_tr_b16 v[96:97], v132 offset:2048
ds_read_b64_tr_b16 v[98:99], v132 offset:2560
v_mfma_f32_16x16x32_bf16 v[120:123], v[80:83], v[124:127], v[120:123]
v_accvgpr_write_b32 a227, v239
v_fmamk_f32 v232, v2, 0x41800000, v7
s_waitcnt lgkmcnt(7)
s_nop 0
v_mfma_f32_32x32x16_bf16 v[32:47], v[84:87], v[112:115], v[32:47]
s_add_u32 m0, s3, 133120
s_mov_b32 s72, 2637824
ds_read_b64_tr_b16 v[100:101], v133 offset:2048
ds_read_b64_tr_b16 v[102:103], v133 offset:2560
buffer_load_dwordx4 v224, s[8:11], s72 offen sc1 lds
s_waitcnt lgkmcnt(7)
v_mfma_f32_32x32x16_bf16 v[48:63], v[88:91], v[112:115], v[48:63]
ds_read_b64_tr_b16 v[104:105], v134 offset:2048
ds_read_b64_tr_b16 v[106:107], v134 offset:2560
v_add_f32 v233, v232, v2
v_cos_f32_e64 v234, v232
v_cos_f32 v235, v233
s_waitcnt lgkmcnt(7)
v_mfma_f32_32x32x16_bf16 v[64:79], v[92:95], v[112:115], v[64:79]
s_add_u32 m0, s3, 134144
s_mov_b32 s72, 3297280
ds_read_b64_tr_b16 v[108:109], v135 offset:2048
ds_read_b64_tr_b16 v[110:111], v135 offset:2560
buffer_load_dwordx4 v225, s[8:11], s72 offen sc1 lds
v_sin_f32 v236, v232
v_sin_f32 v237, v233
v_cvt_pk_bf16_f32 v234, v234, v235
v_cvt_pk_bf16_f32 v238, -v236, -v237
s_waitcnt lgkmcnt(6)
s_nop 0
v_mfma_f32_32x32x16_bf16 v[16:31], v[96:99], v[116:119], v[16:31]
ds_read_b128 v[112:115], v130 offset:0
ds_read_b64_tr_b16 v[80:81], v132 offset:4096
ds_read_b64_tr_b16 v[82:83], v132 offset:4608
v_mfma_f32_16x16x32_bf16 v[120:123], v[96:99], v[124:127], v[120:123]
v_cvt_pk_bf16_f32 v239, v236, v237
v_accvgpr_write_b32 a196, v234
s_waitcnt lgkmcnt(7)
s_nop 0
v_mfma_f32_32x32x16_bf16 v[32:47], v[100:103], v[116:119], v[32:47]
s_add_u32 m0, s3, 135168
s_mov_b32 s72, 20608
ds_read_b64_tr_b16 v[84:85], v133 offset:4096
ds_read_b64_tr_b16 v[86:87], v133 offset:4608
buffer_load_dwordx4 v224, s[8:11], s72 offen sc1 lds
s_waitcnt lgkmcnt(7)
s_nop 0
v_mfma_f32_32x32x16_bf16 v[48:63], v[104:107], v[116:119], v[48:63]
ds_read_b64_tr_b16 v[88:89], v134 offset:4096
ds_read_b64_tr_b16 v[90:91], v134 offset:4608
v_accvgpr_write_b32 a212, v238
v_accvgpr_write_b32 a228, v239
v_fmamk_f32 v232, v2, 0x41900000, v7
v_add_f32 v233, v232, v2
s_waitcnt lgkmcnt(7)
v_mfma_f32_32x32x16_bf16 v[64:79], v[108:111], v[116:119], v[64:79]
s_add_u32 m0, s3, 136192
s_mov_b32 s72, 680064
ds_read_b64_tr_b16 v[92:93], v135 offset:4096
ds_read_b64_tr_b16 v[94:95], v135 offset:4608
buffer_load_dwordx4 v225, s[8:11], s72 offen sc1 lds
v_cos_f32_e64 v234, v232
v_cos_f32 v235, v233
s_waitcnt lgkmcnt(6)
v_mfma_f32_32x32x16_bf16 v[16:31], v[80:83], v[112:115], v[16:31]
ds_read_b128 v[116:119], v131 offset:0
ds_read_b64_tr_b16 v[96:97], v132 offset:6144
ds_read_b64_tr_b16 v[98:99], v132 offset:6656
v_mfma_f32_16x16x32_bf16 v[120:123], v[80:83], v[124:127], v[120:123]
v_sin_f32 v236, v232
s_waitcnt lgkmcnt(7)
v_mfma_f32_32x32x16_bf16 v[32:47], v[84:87], v[112:115], v[32:47]
s_add_u32 m0, s3, 137216
s_mov_b32 s72, 2658432
ds_read_b64_tr_b16 v[100:101], v133 offset:6144
ds_read_b64_tr_b16 v[102:103], v133 offset:6656
buffer_load_dwordx4 v224, s[8:11], s72 offen sc1 lds
s_waitcnt lgkmcnt(7)
v_mfma_f32_32x32x16_bf16 v[48:63], v[88:91], v[112:115], v[48:63]
ds_read_b64_tr_b16 v[104:105], v134 offset:6144
ds_read_b64_tr_b16 v[106:107], v134 offset:6656
v_sin_f32 v237, v233
v_cvt_pk_bf16_f32 v234, v234, v235
v_cvt_pk_bf16_f32 v238, -v236, -v237
s_waitcnt lgkmcnt(7)
s_nop 0
v_mfma_f32_32x32x16_bf16 v[64:79], v[92:95], v[112:115], v[64:79]
s_add_u32 m0, s3, 138240
s_mov_b32 s72, 3317888
ds_read_b64_tr_b16 v[108:109], v135 offset:6144
ds_read_b64_tr_b16 v[110:111], v135 offset:6656
buffer_load_dwordx4 v225, s[8:11], s72 offen sc1 lds
v_cvt_pk_bf16_f32 v239, v236, v237
v_accvgpr_write_b32 a197, v234
v_accvgpr_write_b32 a213, v238
v_accvgpr_write_b32 a229, v239
v_fmamk_f32 v232, v2, 0x41a00000, v7
s_waitcnt vmcnt(9)
s_barrier
s_waitcnt lgkmcnt(6)
v_mfma_f32_32x32x16_bf16 v[16:31], v[96:99], v[116:119], v[16:31]
ds_read_b128 v[112:115], v128 offset:32768
ds_read_b64_tr_b16 v[80:81], v132 offset:32768
ds_read_b64_tr_b16 v[82:83], v132 offset:33280
v_mfma_f32_16x16x32_bf16 v[120:123], v[96:99], v[124:127], v[120:123]
v_add_f32 v233, v232, v2
v_cos_f32 v234, v232
s_waitcnt lgkmcnt(7)
v_mfma_f32_32x32x16_bf16 v[32:47], v[100:103], v[116:119], v[32:47]
s_mul_i32 s77, s12, 5
ds_read_b64_tr_b16 v[84:85], v133 offset:32768
ds_read_b64_tr_b16 v[86:87], v133 offset:33280
buffer_load_dwordx4 a[0:3], v246, s[8:11], s77 offen offset:0 sc1
s_waitcnt lgkmcnt(7)
v_mfma_f32_32x32x16_bf16 v[48:63], v[104:107], v[116:119], v[48:63]
ds_read_b64_tr_b16 v[88:89], v134 offset:32768
ds_read_b64_tr_b16 v[90:91], v134 offset:33280
v_cos_f32 v235, v233
s_waitcnt lgkmcnt(7)
v_mfma_f32_32x32x16_bf16 v[64:79], v[108:111], v[116:119], v[64:79]
ds_read_b64_tr_b16 v[92:93], v135 offset:32768
ds_read_b64_tr_b16 v[94:95], v135 offset:33280
buffer_load_dwordx4 a[4:7], v246, s[8:11], s77 offen offset:1024 sc1
v_sin_f32 v236, v232
v_sin_f32 v237, v233
v_cvt_pk_bf16_f32 v234, v234, v235
v_cvt_pk_bf16_f32 v238, -v236, -v237
v_cvt_pk_bf16_f32 v239, v236, v237
v_accvgpr_write_b32 a198, v234
s_waitcnt lgkmcnt(6)
s_nop 0
v_mfma_f32_32x32x16_bf16 v[16:31], v[80:83], v[112:115], v[16:31]
ds_read_b128 v[116:119], v129 offset:32768
ds_read_b64_tr_b16 v[96:97], v132 offset:34816
ds_read_b64_tr_b16 v[98:99], v132 offset:35328
v_mfma_f32_16x16x32_bf16 v[120:123], v[80:83], v[124:127], v[120:123]
v_accvgpr_write_b32 a214, v238
v_accvgpr_write_b32 a230, v239
s_waitcnt lgkmcnt(7)
v_mfma_f32_32x32x16_bf16 v[32:47], v[84:87], v[112:115], v[32:47]
ds_read_b64_tr_b16 v[100:101], v133 offset:34816
ds_read_b64_tr_b16 v[102:103], v133 offset:35328
buffer_load_dwordx4 a[8:11], v246, s[8:11], s77 offen offset:2048 sc1
s_waitcnt lgkmcnt(7)
v_mfma_f32_32x32x16_bf16 v[48:63], v[88:91], v[112:115], v[48:63]
ds_read_b64_tr_b16 v[104:105], v134 offset:34816
ds_read_b64_tr_b16 v[106:107], v134 offset:35328
v_fmamk_f32 v232, v2, 0x41b00000, v7
v_add_f32 v233, v232, v2
s_waitcnt lgkmcnt(7)
v_mfma_f32_32x32x16_bf16 v[64:79], v[92:95], v[112:115], v[64:79]
ds_read_b64_tr_b16 v[108:109], v135 offset:34816
ds_read_b64_tr_b16 v[110:111], v135 offset:35328
buffer_load_dwordx4 a[12:15], v246, s[8:11], s77 offen offset:3072 sc1
v_cos_f32 v234, v232
v_cos_f32 v235, v233
v_sin_f32 v236, v232
v_sin_f32 v237, v233
v_cvt_pk_bf16_f32 v234, v234, v235
s_waitcnt lgkmcnt(6)
s_nop 0
v_mfma_f32_32x32x16_bf16 v[16:31], v[96:99], v[116:119], v[16:31]
ds_read_b128 v[112:115], v130 offset:32768
ds_read_b64_tr_b16 v[80:81], v132 offset:36864
ds_read_b64_tr_b16 v[82:83], v132 offset:37376
v_mfma_f32_16x16x32_bf16 v[120:123], v[96:99], v[124:127], v[120:123]
v_cvt_pk_bf16_f32 v238, -v236, -v237
v_cvt_pk_bf16_f32 v239, v236, v237
s_waitcnt lgkmcnt(7)
v_mfma_f32_32x32x16_bf16 v[32:47], v[100:103], v[116:119], v[32:47]
ds_read_b64_tr_b16 v[84:85], v133 offset:36864
ds_read_b64_tr_b16 v[86:87], v133 offset:37376
buffer_load_dwordx4 a[16:19], v247, s[8:11], s77 offen offset:0 sc1
s_waitcnt lgkmcnt(7)
v_mfma_f32_32x32x16_bf16 v[48:63], v[104:107], v[116:119], v[48:63]
ds_read_b64_tr_b16 v[88:89], v134 offset:36864
ds_read_b64_tr_b16 v[90:91], v134 offset:37376
v_accvgpr_write_b32 a199, v234
v_accvgpr_write_b32 a215, v238
v_accvgpr_write_b32 a231, v239
s_waitcnt lgkmcnt(7)
v_mfma_f32_32x32x16_bf16 v[64:79], v[108:111], v[116:119], v[64:79]
s_mul_i32 s77, s13, 5
ds_read_b64_tr_b16 v[92:93], v135 offset:36864
ds_read_b64_tr_b16 v[94:95], v135 offset:37376
buffer_load_dwordx4 a[20:23], v246, s[8:11], s77 offen offset:0 sc1
s_lshl_b32 s92, s52, 7
s_add_u32 s92, s92, 65536
v_lshrrev_b32 v2, 4, v1
v_lshlrev_b32 v2, 4, v2
v_and_b32 v5, 1, v1
v_lshl_or_b32 v2, v5, 6, v2
v_add_u32_e64 v2, s92, v2
s_mul_i32 s92, s52, 110592
s_add_u32 s92, s92, s50
v_bfe_u32 v7, v1, 4, 1
v_mul_u32_u24 v7, 55296, v7
v_and_b32 v5, 15, v1
v_lshl_add_u32 v7, v5, 4, v7
v_lshl_add_u32 v7, v3, 8, v7
s_waitcnt lgkmcnt(6)
v_mfma_f32_32x32x16_bf16 v[16:31], v[80:83], v[112:115], v[16:31]
ds_read_b128 v[116:119], v131 offset:32768
ds_read_b64_tr_b16 v[96:97], v132 offset:38912
ds_read_b64_tr_b16 v[98:99], v132 offset:39424
v_mfma_f32_16x16x32_bf16 v[120:123], v[80:83], v[124:127], v[120:123]
v_lshlrev_b32 v5, 4, v3
v_add_u32 v5, 65536, v5
s_waitcnt lgkmcnt(7)
v_mfma_f32_32x32x16_bf16 v[32:47], v[84:87], v[112:115], v[32:47]
ds_read_b64_tr_b16 v[100:101], v133 offset:38912
ds_read_b64_tr_b16 v[102:103], v133 offset:39424
buffer_load_dwordx4 a[24:27], v246, s[8:11], s77 offen offset:1024 sc1
s_waitcnt lgkmcnt(7)
v_mfma_f32_32x32x16_bf16 v[48:63], v[88:91], v[112:115], v[48:63]
ds_read_b64_tr_b16 v[104:105], v134 offset:38912
ds_read_b64_tr_b16 v[106:107], v134 offset:39424
s_add_u32 s94, s52, 0
s_cmp_ge_u32 s94, 4
s_cselect_b32 s95, 4, 0
s_sub_u32 s94, s94, s95
s_waitcnt lgkmcnt(7)
v_mfma_f32_32x32x16_bf16 v[64:79], v[92:95], v[112:115], v[64:79]
ds_read_b64_tr_b16 v[108:109], v135 offset:38912
ds_read_b64_tr_b16 v[110:111], v135 offset:39424
buffer_load_dwordx4 a[28:31], v246, s[8:11], s77 offen offset:2048 sc1
s_lshl_b32 s64, s94, 7
s_lshl_b32 s94, s94, 10
s_add_u32 s68, s94, s92
s_add_u32 s94, s52, 1
s_cmp_ge_u32 s94, 4
s_cselect_b32 s95, 4, 0
s_sub_u32 s94, s94, s95
s_lshl_b32 s65, s94, 7
s_lshl_b32 s94, s94, 10
s_add_u32 s69, s94, s92
s_add_u32 s94, s52, 2
s_cmp_ge_u32 s94, 4
s_cselect_b32 s95, 4, 0
s_sub_u32 s94, s94, s95
s_lshl_b32 s66, s94, 7
s_lshl_b32 s94, s94, 10
s_add_u32 s70, s94, s92
s_add_u32 s94, s52, 3
s_cmp_ge_u32 s94, 4
s_cselect_b32 s95, 4, 0
s_sub_u32 s94, s94, s95
s_lshl_b32 s67, s94, 7
s_lshl_b32 s94, s94, 10
s_add_u32 s71, s94, s92
s_waitcnt lgkmcnt(6)
v_mfma_f32_32x32x16_bf16 v[16:31], v[96:99], v[116:119], v[16:31]
v_mfma_f32_16x16x32_bf16 v[120:123], v[96:99], v[124:127], v[120:123]
s_waitcnt lgkmcnt(4)
v_mfma_f32_32x32x16_bf16 v[32:47], v[100:103], v[116:119], v[32:47]
buffer_load_dwordx4 a[32:35], v246, s[8:11], s77 offen offset:3072 sc1
s_waitcnt lgkmcnt(2)
v_mfma_f32_32x32x16_bf16 v[48:63], v[104:107], v[116:119], v[48:63]
s_waitcnt lgkmcnt(0)
v_mfma_f32_32x32x16_bf16 v[64:79], v[108:111], v[116:119], v[64:79]
buffer_load_dwordx4 a[36:39], v247, s[8:11], s77 offen offset:0 sc1
s_mov_b32 exec_lo, 0x00030003
s_mov_b32 exec_hi, 0x00030003
ds_write_b128 v2, v[120:123]
s_mov_b64 exec, -1
v_add_u32 v9, s64, v5
v_add_u32 v10, s65, v5
v_add_u32 v11, s66, v5
v_add_u32 v12, s67, v5
s_waitcnt vmcnt(18)
s_mov_b32 s79, 0
L_st21:
v_cmp_ne_u32 vcc, s56, v159
s_add_u32 s79, s79, 1
s_cmp_eq_u64 vcc, 0
s_cbranch_scc1 L_std22
buffer_load_dwordx2 v[158:159], v231, s[8:11], 0 offen sc1
s_waitcnt vmcnt(0)
s_cmp_lt_u32 s79, 200000
s_cbranch_scc1 L_st21
L_std22:
v_lshlrev_b32_e64 v158, 16, v158
s_waitcnt lgkmcnt(0)
s_barrier
ds_read_b128 v[112:115], v9 offset:0
ds_read_b128 v[116:119], v9 offset:32
ds_read_b128 v[120:123], v9 offset:64
ds_read_b128 v[124:127], v9 offset:96
ds_read_b128 v[128:131], v10 offset:0
ds_read_b128 v[132:135], v10 offset:32
ds_read_b128 v[136:139], v10 offset:64
ds_read_b128 v[140:143], v10 offset:96
s_waitcnt lgkmcnt(6)
s_nop 0
v_pk_fma_f32 v[16:17], v[158:159], v[112:113], v[16:17] op_sel_hi:[0,1,1] neg_lo:[1,0,0] neg_hi:[1,0,0]
v_pk_fma_f32 v[18:19], v[158:159], v[114:115], v[18:19] op_sel_hi:[0,1,1] neg_lo:[1,0,0] neg_hi:[1,0,0]
v_pk_fma_f32 v[20:21], v[158:159], v[116:117], v[20:21] op_sel_hi:[0,1,1] neg_lo:[1,0,0] neg_hi:[1,0,0]
v_pk_fma_f32 v[22:23], v[158:159], v[118:119], v[22:23] op_sel_hi:[0,1,1] neg_lo:[1,0,0] neg_hi:[1,0,0]
v_cvt_pk_bf16_f32 v80, v16, v17
v_cvt_pk_bf16_f32 v81, v18, v19
v_cvt_pk_bf16_f32 v82, v20, v21
v_cvt_pk_bf16_f32 v83, v22, v23
v_pk_max_i16 v80, v80, 0
v_pk_max_i16 v81, v81, 0
v_pk_max_i16 v82, v82, 0
v_pk_max_i16 v83, v83, 0
buffer_store_dwordx4 v[80:83], v7, s[8:11], s68 offen offset:0 sc1
s_waitcnt lgkmcnt(4)
s_nop 0
v_pk_fma_f32 v[24:25], v[158:159], v[120:121], v[24:25] op_sel_hi:[0,1,1] neg_lo:[1,0,0] neg_hi:[1,0,0]
v_pk_fma_f32 v[26:27], v[158:159], v[122:123], v[26:27] op_sel_hi:[0,1,1] neg_lo:[1,0,0] neg_hi:[1,0,0]
v_pk_fma_f32 v[28:29], v[158:159], v[124:125], v[28:29] op_sel_hi:[0,1,1] neg_lo:[1,0,0] neg_hi:[1,0,0]
v_pk_fma_f32 v[30:31], v[158:159], v[126:127], v[30:31] op_sel_hi:[0,1,1] neg_lo:[1,0,0] neg_hi:[1,0,0]
v_cvt_pk_bf16_f32 v84, v24, v25
v_cvt_pk_bf16_f32 v85, v26, v27
v_cvt_pk_bf16_f32 v86, v28, v29
v_cvt_pk_bf16_f32 v87, v30, v31
v_pk_max_i16 v84, v84, 0
v_pk_max_i16 v85, v85, 0
v_pk_max_i16 v86, v86, 0
v_pk_max_i16 v87, v87, 0
buffer_store_dwordx4 v[84:87], v7, s[8:11], s68 offen offset:512 sc1
ds_read_b128 v[112:115], v11 offset:0
ds_read_b128 v[116:119], v11 offset:32
ds_read_b128 v[120:123], v11 offset:64
ds_read_b128 v[124:127], v11 offset:96
s_waitcnt lgkmcnt(6)
s_nop 0
v_pk_fma_f32 v[32:33], v[158:159], v[128:129], v[32:33] op_sel_hi:[0,1,1] neg_lo:[1,0,0] neg_hi:[1,0,0]
v_pk_fma_f32 v[34:35], v[158:159], v[130:131], v[34:35] op_sel_hi:[0,1,1] neg_lo:[1,0,0] neg_hi:[1,0,0]
v_pk_fma_f32 v[36:37], v[158:159], v[132:133], v[36:37] op_sel_hi:[0,1,1] neg_lo:[1,0,0] neg_hi:[1,0,0]
v_pk_fma_f32 v[38:39], v[158:159], v[134:135], v[38:39] op_sel_hi:[0,1,1] neg_lo:[1,0,0] neg_hi:[1,0,0]
v_cvt_pk_bf16_f32 v88, v32, v33
v_cvt_pk_bf16_f32 v89, v34, v35
v_cvt_pk_bf16_f32 v90, v36, v37
v_cvt_pk_bf16_f32 v91, v38, v39
v_pk_max_i16 v88, v88, 0
v_pk_max_i16 v89, v89, 0
v_pk_max_i16 v90, v90, 0
v_pk_max_i16 v91, v91, 0
buffer_store_dwordx4 v[88:91], v7, s[8:11], s69 offen offset:0 sc1
s_waitcnt lgkmcnt(4)
s_nop 0
v_pk_fma_f32 v[40:41], v[158:159], v[136:137], v[40:41] op_sel_hi:[0,1,1] neg_lo:[1,0,0] neg_hi:[1,0,0]
v_pk_fma_f32 v[42:43], v[158:159], v[138:139], v[42:43] op_sel_hi:[0,1,1] neg_lo:[1,0,0] neg_hi:[1,0,0]
v_pk_fma_f32 v[44:45], v[158:159], v[140:141], v[44:45] op_sel_hi:[0,1,1] neg_lo:[1,0,0] neg_hi:[1,0,0]
v_pk_fma_f32 v[46:47], v[158:159], v[142:143], v[46:47] op_sel_hi:[0,1,1] neg_lo:[1,0,0] neg_hi:[1,0,0]
v_cvt_pk_bf16_f32 v92, v40, v41
v_cvt_pk_bf16_f32 v93, v42, v43
v_cvt_pk_bf16_f32 v94, v44, v45
v_cvt_pk_bf16_f32 v95, v46, v47
v_pk_max_i16 v92, v92, 0
v_pk_max_i16 v93, v93, 0
v_pk_max_i16 v94, v94, 0
v_pk_max_i16 v95, v95, 0
buffer_store_dwordx4 v[92:95], v7, s[8:11], s69 offen offset:512 sc1
ds_read_b128 v[128:131], v12 offset:0
ds_read_b128 v[132:135], v12 offset:32
ds_read_b128 v[136:139], v12 offset:64
ds_read_b128 v[140:143], v12 offset:96
s_waitcnt lgkmcnt(6)
s_nop 0
v_pk_fma_f32 v[48:49], v[158:159], v[112:113], v[48:49] op_sel_hi:[0,1,1] neg_lo:[1,0,0] neg_hi:[1,0,0]
v_pk_fma_f32 v[50:51], v[158:159], v[114:115], v[50:51] op_sel_hi:[0,1,1] neg_lo:[1,0,0] neg_hi:[1,0,0]
v_pk_fma_f32 v[52:53], v[158:159], v[116:117], v[52:53] op_sel_hi:[0,1,1] neg_lo:[1,0,0] neg_hi:[1,0,0]
v_pk_fma_f32 v[54:55], v[158:159], v[118:119], v[54:55] op_sel_hi:[0,1,1] neg_lo:[1,0,0] neg_hi:[1,0,0]
v_cvt_pk_bf16_f32 v96, v48, v49
v_cvt_pk_bf16_f32 v97, v50, v51
v_cvt_pk_bf16_f32 v98, v52, v53
v_cvt_pk_bf16_f32 v99, v54, v55
v_pk_max_i16 v96, v96, 0
v_pk_max_i16 v97, v97, 0
v_pk_max_i16 v98, v98, 0
v_pk_max_i16 v99, v99, 0
buffer_store_dwordx4 v[96:99], v7, s[8:11], s70 offen offset:0 sc1
s_waitcnt lgkmcnt(4)
s_nop 0
v_pk_fma_f32 v[56:57], v[158:159], v[120:121], v[56:57] op_sel_hi:[0,1,1] neg_lo:[1,0,0] neg_hi:[1,0,0]
v_pk_fma_f32 v[58:59], v[158:159], v[122:123], v[58:59] op_sel_hi:[0,1,1] neg_lo:[1,0,0] neg_hi:[1,0,0]
v_pk_fma_f32 v[60:61], v[158:159], v[124:125], v[60:61] op_sel_hi:[0,1,1] neg_lo:[1,0,0] neg_hi:[1,0,0]
v_pk_fma_f32 v[62:63], v[158:159], v[126:127], v[62:63] op_sel_hi:[0,1,1] neg_lo:[1,0,0] neg_hi:[1,0,0]
v_cvt_pk_bf16_f32 v100, v56, v57
v_cvt_pk_bf16_f32 v101, v58, v59
v_cvt_pk_bf16_f32 v102, v60, v61
v_cvt_pk_bf16_f32 v103, v62, v63
v_pk_max_i16 v100, v100, 0
v_pk_max_i16 v101, v101, 0
v_pk_max_i16 v102, v102, 0
v_pk_max_i16 v103, v103, 0
buffer_store_dwordx4 v[100:103], v7, s[8:11], s70 offen offset:512 sc1
s_waitcnt lgkmcnt(2)
s_nop 0
v_pk_fma_f32 v[64:65], v[158:159], v[128:129], v[64:65] op_sel_hi:[0,1,1] neg_lo:[1,0,0] neg_hi:[1,0,0]
v_pk_fma_f32 v[66:67], v[158:159], v[130:131], v[66:67] op_sel_hi:[0,1,1] neg_lo:[1,0,0] neg_hi:[1,0,0]
v_pk_fma_f32 v[68:69], v[158:159], v[132:133], v[68:69] op_sel_hi:[0,1,1] neg_lo:[1,0,0] neg_hi:[1,0,0]
v_pk_fma_f32 v[70:71], v[158:159], v[134:135], v[70:71] op_sel_hi:[0,1,1] neg_lo:[1,0,0] neg_hi:[1,0,0]
v_cvt_pk_bf16_f32 v104, v64, v65
v_cvt_pk_bf16_f32 v105, v66, v67
v_cvt_pk_bf16_f32 v106, v68, v69
v_cvt_pk_bf16_f32 v107, v70, v71
v_pk_max_i16 v104, v104, 0
v_pk_max_i16 v105, v105, 0
v_pk_max_i16 v106, v106, 0
v_pk_max_i16 v107, v107, 0
buffer_store_dwordx4 v[104:107], v7, s[8:11], s71 offen offset:0 sc1
s_waitcnt lgkmcnt(0)
s_nop 0
v_pk_fma_f32 v[72:73], v[158:159], v[136:137], v[72:73] op_sel_hi:[0,1,1] neg_lo:[1,0,0] neg_hi:[1,0,0]
v_pk_fma_f32 v[74:75], v[158:159], v[138:139], v[74:75] op_sel_hi:[0,1,1] neg_lo:[1,0,0] neg_hi:[1,0,0]
v_pk_fma_f32 v[76:77], v[158:159], v[140:141], v[76:77] op_sel_hi:[0,1,1] neg_lo:[1,0,0] neg_hi:[1,0,0]
v_pk_fma_f32 v[78:79], v[158:159], v[142:143], v[78:79] op_sel_hi:[0,1,1] neg_lo:[1,0,0] neg_hi:[1,0,0]
v_cvt_pk_bf16_f32 v108, v72, v73
v_cvt_pk_bf16_f32 v109, v74, v75
v_cvt_pk_bf16_f32 v110, v76, v77
v_cvt_pk_bf16_f32 v111, v78, v79
v_pk_max_i16 v108, v108, 0
v_pk_max_i16 v109, v109, 0
v_pk_max_i16 v110, v110, 0
v_pk_max_i16 v111, v111, 0
buffer_store_dwordx4 v[108:111], v7, s[8:11], s71 offen offset:512 sc1
s_waitcnt vmcnt(18)
s_barrier
ds_read_b128 v[16:19], v226 offset:0
ds_read_b128 v[32:35], v227 offset:0
ds_read_b128 v[20:23], v226 offset:8192
ds_read_b128 v[36:39], v227 offset:8192
ds_read_b128 v[24:27], v228 offset:0
ds_read_b128 v[40:43], v229 offset:0
ds_read_b128 v[28:31], v228 offset:8192
ds_read_b128 v[44:47], v229 offset:8192
s_waitcnt lgkmcnt(7)
v_mfma_f32_32x32x16_bf16 v[48:63], v[16:19], a[184:187], 0
s_mul_i32 s77, s14, 5
buffer_load_dwordx4 a[40:43], v246, s[8:11], s77 offen offset:0 sc1
v_mfma_f32_32x32x16_bf16 v[64:79], v[16:19], a[200:203], 0
s_waitcnt lgkmcnt(6)
v_mfma_f32_32x32x16_bf16 v[48:63], v[32:35], a[216:219], v[48:63]
v_mfma_f32_32x32x16_bf16 v[64:79], v[32:35], a[184:187], v[64:79]
s_waitcnt lgkmcnt(5)
v_mfma_f32_32x32x16_bf16 v[48:63], v[20:23], a[188:191], v[48:63]
buffer_load_dwordx4 a[44:47], v246, s[8:11], s77 offen offset:1024 sc1
v_mfma_f32_32x32x16_bf16 v[64:79], v[20:23], a[204:207], v[64:79]
s_waitcnt lgkmcnt(4)
v_mfma_f32_32x32x16_bf16 v[48:63], v[36:39], a[220:223], v[48:63]
v_mfma_f32_32x32x16_bf16 v[64:79], v[36:39], a[188:191], v[64:79]
buffer_load_dwordx4 a[48:51], v246, s[8:11], s77 offen offset:2048 sc1
s_waitcnt lgkmcnt(3)
v_mfma_f32_32x32x16_bf16 v[48:63], v[24:27], a[192:195], v[48:63]
v_mfma_f32_32x32x16_bf16 v[64:79], v[24:27], a[208:211], v[64:79]
s_waitcnt lgkmcnt(2)
v_mfma_f32_32x32x16_bf16 v[48:63], v[40:43], a[224:227], v[48:63]
v_mfma_f32_32x32x16_bf16 v[64:79], v[40:43], a[192:195], v[64:79]
buffer_load_dwordx4 a[52:55], v246, s[8:11], s77 offen offset:3072 sc1
s_waitcnt lgkmcnt(1)
v_mfma_f32_32x32x16_bf16 v[48:63], v[28:31], a[196:199], v[48:63]
v_mfma_f32_32x32x16_bf16 v[64:79], v[28:31], a[212:215], v[64:79]
s_waitcnt lgkmcnt(0)
s_nop 0
v_mfma_f32_32x32x16_bf16 v[48:63], v[44:47], a[228:231], v[48:63]
buffer_load_dwordx4 a[56:59], v247, s[8:11], s77 offen offset:0 sc1
v_mfma_f32_32x32x16_bf16 v[64:79], v[44:47], a[196:199], v[64:79]
ds_read_b128 v[32:35], v230 offset:0
ds_read_b128 v[36:39], v230 offset:8192
ds_read_b128 v[40:43], v230 offset:16384
ds_read_b128 v[44:47], v230 offset:24576
s_lshl_b32 s95, s52, 12
s_add_u32 s95, s95, 98304
v_add_u32 v120, s95, v6
v_xor_b32 v121, 4096, v120
s_nop 1
v_pk_mul_f32 v[112:113], v[48:49], v[160:161]
s_nop 0
v_pk_mul_f32 v[114:115], v[64:65], v[160:161]
v_pk_fma_f32 v[112:113], v[64:65], v[176:177], v[112:113]
v_pk_fma_f32 v[114:115], v[48:49], v[176:177], v[114:115] neg_lo:[1,0,0] neg_hi:[1,0,0]
v_cvt_pk_bf16_f32 v16, v112, v113
v_cvt_pk_bf16_f32 v24, v114, v115
v_pk_mul_f32 v[116:117], v[50:51], v[162:163]
v_pk_mul_f32 v[118:119], v[66:67], v[162:163]
v_pk_fma_f32 v[116:117], v[66:67], v[178:179], v[116:117]
s_mul_i32 s77, s15, 5
s_nop 0
buffer_load_dwordx4 a[60:63], v246, s[8:11], s77 offen offset:0 sc1
v_pk_fma_f32 v[118:119], v[50:51], v[178:179], v[118:119] neg_lo:[1,0,0] neg_hi:[1,0,0]
v_cvt_pk_bf16_f32 v17, v116, v117
v_cvt_pk_bf16_f32 v25, v118, v119
v_pk_mul_f32 v[112:113], v[52:53], v[164:165]
v_pk_mul_f32 v[114:115], v[68:69], v[164:165]
v_pk_fma_f32 v[112:113], v[68:69], v[180:181], v[112:113]
v_pk_fma_f32 v[114:115], v[52:53], v[180:181], v[114:115] neg_lo:[1,0,0] neg_hi:[1,0,0]
v_cvt_pk_bf16_f32 v18, v112, v113
v_cvt_pk_bf16_f32 v26, v114, v115
v_pk_mul_f32 v[116:117], v[54:55], v[166:167]
v_pk_mul_f32 v[118:119], v[70:71], v[166:167]
v_pk_fma_f32 v[116:117], v[70:71], v[182:183], v[116:117]
v_pk_fma_f32 v[118:119], v[54:55], v[182:183], v[118:119] neg_lo:[1,0,0] neg_hi:[1,0,0]
v_cvt_pk_bf16_f32 v19, v116, v117
v_cvt_pk_bf16_f32 v27, v118, v119
v_pk_mul_f32 v[112:113], v[56:57], v[168:169]
v_pk_mul_f32 v[114:115], v[72:73], v[168:169]
v_pk_fma_f32 v[112:113], v[72:73], v[184:185], v[112:113]
v_pk_fma_f32 v[114:115], v[56:57], v[184:185], v[114:115] neg_lo:[1,0,0] neg_hi:[1,0,0]
v_cvt_pk_bf16_f32 v20, v112, v113
v_cvt_pk_bf16_f32 v28, v114, v115
v_pk_mul_f32 v[116:117], v[58:59], v[170:171]
v_pk_mul_f32 v[118:119], v[74:75], v[170:171]
v_pk_fma_f32 v[116:117], v[74:75], v[186:187], v[116:117]
v_pk_fma_f32 v[118:119], v[58:59], v[186:187], v[118:119] neg_lo:[1,0,0] neg_hi:[1,0,0]
buffer_load_dwordx4 a[64:67], v246, s[8:11], s77 offen offset:1024 sc1
v_cvt_pk_bf16_f32 v21, v116, v117
v_cvt_pk_bf16_f32 v29, v118, v119
v_pk_mul_f32 v[112:113], v[60:61], v[172:173]
v_pk_mul_f32 v[114:115], v[76:77], v[172:173]
v_pk_fma_f32 v[112:113], v[76:77], v[188:189], v[112:113]
v_pk_fma_f32 v[114:115], v[60:61], v[188:189], v[114:115] neg_lo:[1,0,0] neg_hi:[1,0,0]
v_cvt_pk_bf16_f32 v22, v112, v113
v_cvt_pk_bf16_f32 v30, v114, v115
v_pk_mul_f32 v[116:117], v[62:63], v[174:175]
v_pk_mul_f32 v[118:119], v[78:79], v[174:175]
v_pk_fma_f32 v[116:117], v[78:79], v[190:191], v[116:117]
v_pk_fma_f32 v[118:119], v[62:63], v[190:191], v[118:119] neg_lo:[1,0,0] neg_hi:[1,0,0]
v_cvt_pk_bf16_f32 v23, v116, v117
v_cvt_pk_bf16_f32 v31, v118, v119
s_waitcnt lgkmcnt(0)
v_mfma_f32_32x32x16_bf16 v[80:95], a[232:235], v[16:19], 0
v_lshlrev_b32 v48, 16, v32
v_and_b32 v64, 0xffff0000, v32
v_lshlrev_b32_e64 v49, 16, v33
v_and_b32 v65, 0xffff0000, v33
v_mfma_f32_32x32x16_bf16 v[96:111], a[240:243], v[16:19], 0
v_lshlrev_b32_e64 v50, 16, v34
v_and_b32 v66, 0xffff0000, v34
buffer_load_dwordx4 a[68:71], v246, s[8:11], s77 offen offset:2048 sc1
v_lshlrev_b32_e64 v51, 16, v35
v_and_b32 v67, 0xffff0000, v35
v_mfma_f32_32x32x16_bf16 v[80:95], a[248:251], v[24:27], v[80:95]
v_lshlrev_b32_e64 v52, 16, v36
v_and_b32 v68, 0xffff0000, v36
v_lshlrev_b32_e64 v53, 16, v37
v_and_b32 v69, 0xffff0000, v37
v_mfma_f32_32x32x16_bf16 v[96:111], a[232:235], v[24:27], v[96:111]
v_lshlrev_b32_e64 v54, 16, v38
v_and_b32 v70, 0xffff0000, v38
v_lshlrev_b32_e64 v55, 16, v39
v_and_b32 v71, 0xffff0000, v39
v_mfma_f32_32x32x16_bf16 v[80:95], a[236:239], v[20:23], v[80:95]
v_lshlrev_b32_e64 v56, 16, v40
v_and_b32 v72, 0xffff0000, v40
v_lshlrev_b32_e64 v57, 16, v41
v_and_b32 v73, 0xffff0000, v41
v_mfma_f32_32x32x16_bf16 v[96:111], a[244:247], v[20:23], v[96:111]
buffer_load_dwordx4 a[72:75], v246, s[8:11], s77 offen offset:3072 sc1
v_lshlrev_b32_e64 v58, 16, v42
v_and_b32 v74, 0xffff0000, v42
v_lshlrev_b32_e64 v59, 16, v43
v_and_b32 v75, 0xffff0000, v43
v_mfma_f32_32x32x16_bf16 v[80:95], a[252:255], v[28:31], v[80:95]
v_lshlrev_b32_e64 v60, 16, v44
v_and_b32 v76, 0xffff0000, v44
v_lshlrev_b32_e64 v61, 16, v45
v_and_b32 v77, 0xffff0000, v45
v_mfma_f32_32x32x16_bf16 v[96:111], a[236:239], v[28:31], v[96:111]
v_lshlrev_b32_e64 v62, 16, v46
v_and_b32 v78, 0xffff0000, v46
v_lshlrev_b32_e64 v63, 16, v47
v_and_b32 v79, 0xffff0000, v47
s_nop 2
v_pk_mul_f32 v[112:113], v[80:81], v[48:49]
s_nop 3
v_pk_mul_f32 v[114:115], v[96:97], v[48:49]
v_pk_fma_f32 v[112:113], v[96:97], v[64:65], v[112:113] neg_lo:[1,0,0] neg_hi:[1,0,0]
v_pk_fma_f32 v[114:115], v[80:81], v[64:65], v[114:115]
v_cvt_pk_bf16_f32 v16, v112, v113
buffer_load_dwordx4 a[76:79], v247, s[8:11], s77 offen offset:0 sc1
v_cvt_pk_bf16_f32 v24, v114, v115
v_pk_mul_f32 v[116:117], v[82:83], v[50:51]
v_pk_mul_f32 v[118:119], v[98:99], v[50:51]
v_pk_fma_f32 v[116:117], v[98:99], v[66:67], v[116:117] neg_lo:[1,0,0] neg_hi:[1,0,0]
v_pk_fma_f32 v[118:119], v[82:83], v[66:67], v[118:119]
v_cvt_pk_bf16_f32 v17, v116, v117
v_cvt_pk_bf16_f32 v25, v118, v119
v_pk_mul_f32 v[112:113], v[84:85], v[52:53]
v_pk_mul_f32 v[114:115], v[100:101], v[52:53]
v_pk_fma_f32 v[112:113], v[100:101], v[68:69], v[112:113] neg_lo:[1,0,0] neg_hi:[1,0,0]
v_pk_fma_f32 v[114:115], v[84:85], v[68:69], v[114:115]
v_cvt_pk_bf16_f32 v18, v112, v113
v_cvt_pk_bf16_f32 v26, v114, v115
v_pk_mul_f32 v[116:117], v[86:87], v[54:55]
v_pk_mul_f32 v[118:119], v[102:103], v[54:55]
v_pk_fma_f32 v[116:117], v[102:103], v[70:71], v[116:117] neg_lo:[1,0,0] neg_hi:[1,0,0]
v_pk_fma_f32 v[118:119], v[86:87], v[70:71], v[118:119]
v_cvt_pk_bf16_f32 v19, v116, v117
v_cvt_pk_bf16_f32 v27, v118, v119
v_pk_mul_f32 v[112:113], v[88:89], v[56:57]
v_pk_mul_f32 v[114:115], v[104:105], v[56:57]
v_pk_fma_f32 v[112:113], v[104:105], v[72:73], v[112:113] neg_lo:[1,0,0] neg_hi:[1,0,0]
v_pk_fma_f32 v[114:115], v[88:89], v[72:73], v[114:115]
v_cvt_pk_bf16_f32 v20, v112, v113
v_cvt_pk_bf16_f32 v28, v114, v115
v_pk_mul_f32 v[116:117], v[90:91], v[58:59]
s_mul_i32 s77, s16, 5
s_nop 0
buffer_load_dwordx4 a[80:83], v246, s[8:11], s77 offen offset:0 sc1
v_pk_mul_f32 v[118:119], v[106:107], v[58:59]
v_pk_fma_f32 v[116:117], v[106:107], v[74:75], v[116:117] neg_lo:[1,0,0] neg_hi:[1,0,0]
v_pk_fma_f32 v[118:119], v[90:91], v[74:75], v[118:119]
v_cvt_pk_bf16_f32 v21, v116, v117
v_cvt_pk_bf16_f32 v29, v118, v119
v_pk_mul_f32 v[112:113], v[92:93], v[60:61]
v_pk_mul_f32 v[114:115], v[108:109], v[60:61]
v_pk_fma_f32 v[112:113], v[108:109], v[76:77], v[112:113] neg_lo:[1,0,0] neg_hi:[1,0,0]
v_pk_fma_f32 v[114:115], v[92:93], v[76:77], v[114:115]
v_cvt_pk_bf16_f32 v22, v112, v113
v_cvt_pk_bf16_f32 v30, v114, v115
v_pk_mul_f32 v[116:117], v[94:95], v[62:63]
v_pk_mul_f32 v[118:119], v[110:111], v[62:63]
v_pk_fma_f32 v[116:117], v[110:111], v[78:79], v[116:117] neg_lo:[1,0,0] neg_hi:[1,0,0]
v_pk_fma_f32 v[118:119], v[94:95], v[78:79], v[118:119]
v_cvt_pk_bf16_f32 v23, v116, v117
v_cvt_pk_bf16_f32 v31, v118, v119
s_waitcnt vmcnt(11)
s_lshr_b32 s92, s52, 1
s_lshl_b32 s92, s92, 5
s_and_b32 s93, s52, 1
s_add_u32 s92, s92, s93
s_mul_i32 s92, s92, 16
s_add_u32 s92, s92, s51
v_mov_b32 v8, s56
v_mov_b32 v9, 0
s_mov_b64 exec, 1
buffer_store_dword v8, v9, s[8:11], s92 offen sc1
s_mov_b64 exec, -1
buffer_load_dwordx4 a[84:87], v246, s[8:11], s77 offen offset:1024 sc1
v_mfma_f32_32x32x16_bf16 v[48:63], v[16:19], a[232:235], 0
v_and_b32 v122, 0x13, v4
v_bfe_u32 v123, v4, 2, 1
v_mfma_f32_32x32x16_bf16 v[64:79], v[16:19], a[248:251], 0
v_lshl_or_b32 v122, v123, 3, v122
v_mfma_f32_32x32x16_bf16 v[48:63], v[24:27], a[240:243], v[48:63]
v_bfe_u32 v123, v4, 3, 1
v_lshl_or_b32 v122, v123, 2, v122
v_mfma_f32_32x32x16_bf16 v[64:79], v[24:27], a[232:235], v[64:79]
buffer_load_dwordx4 a[88:91], v246, s[8:11], s77 offen offset:2048 sc1
s_and_b32 s95, s39, 1
s_bfe_u32 s96, s39, 0x10002
s_lshl_b32 s96, s96, 1
s_or_b32 s95, s95, s96
v_mfma_f32_32x32x16_bf16 v[48:63], v[20:23], a[236:239], v[48:63]
s_and_b32 s96, s52, 1
s_lshl_b32 s96, s96, 1
s_xor_b32 s95, s95, s96
s_lshl_b32 s95, s95, 5
s_lshr_b32 s96, s52, 1
s_mul_i32 s96, s96, 8704
s_add_u32 s96, s96, 114688
v_mfma_f32_32x32x16_bf16 v[64:79], v[20:23], a[252:255], v[64:79]
v_mul_u32_u24 v122, 272, v122
v_lshl_add_u32 v122, v3, 4, v122
v_add_u32_e64 v122, s96, v122
v_mfma_f32_32x32x16_bf16 v[48:63], v[28:31], a[244:247], v[48:63]
buffer_load_dwordx4 a[92:95], v246, s[8:11], s77 offen offset:3072 sc1
s_xor_b32 s98, s95, 32
v_add_u32 v123, s98, v122
v_add_u32 v122, s95, v122
s_and_b32 s95, s52, 1
s_mul_i32 s98, s95, 4352
s_add_u32 s96, s96, s98
v_mfma_f32_32x32x16_bf16 v[64:79], v[28:31], a[236:239], v[64:79]
v_lshrrev_b32 v124, 4, v1
v_mul_u32_u24 v124, 272, v124
v_and_b32_e64 v125, 15, v1
v_lshl_add_u32 v124, v125, 4, v124
v_add_u32 v124, s96, v124
s_lshr_b32 s96, s52, 1
s_mul_i32 s96, s96, 160
s_add_u32 s96, s96, s39
s_lshl_b32 s96, s96, 13
s_cmp_eq_u32 s39, 160
s_cselect_b32 s96, 128, s96
s_lshl_b32 s95, s95, 12
s_add_u32 s96, s96, s95
s_add_u32 s96, s96, 18874368
s_mul_i32 s93, s39, 2
s_lshr_b32 s94, s52, 1
s_add_u32 s93, s93, s94
s_cmp_eq_u32 s93, 0
s_cselect_b32 s58, 0x00ff00ff, -1
s_cmp_eq_u32 s93, 320
s_cselect_b32 s58, 0x00ff00ff, s58
s_mov_b32 s59, s58
s_nop 0
buffer_load_dwordx4 a[96:99], v247, s[8:11], s77 offen offset:0 sc1
s_cmp_eq_u32 s93, 321
s_cselect_b32 s96, 268435456, s96
v_pk_mul_f32 v[112:113], v[48:49], v[192:193]
v_pk_mul_f32 v[114:115], v[64:65], v[192:193]
v_pk_fma_f32 v[112:113], v[64:65], v[208:209], v[112:113] neg_lo:[1,0,0] neg_hi:[1,0,0]
v_pk_fma_f32 v[114:115], v[48:49], v[208:209], v[114:115]
v_cvt_pk_bf16_f32 v16, v112, v113
v_cvt_pk_bf16_f32 v24, v114, v115
v_pk_mul_f32 v[116:117], v[50:51], v[194:195]
v_pk_mul_f32 v[118:119], v[66:67], v[194:195]
v_pk_fma_f32 v[116:117], v[66:67], v[210:211], v[116:117] neg_lo:[1,0,0] neg_hi:[1,0,0]
v_pk_fma_f32 v[118:119], v[50:51], v[210:211], v[118:119]
v_cvt_pk_bf16_f32 v17, v116, v117
v_cvt_pk_bf16_f32 v25, v118, v119
v_pk_mul_f32 v[112:113], v[52:53], v[196:197]
v_pk_mul_f32 v[114:115], v[68:69], v[196:197]
v_pk_fma_f32 v[112:113], v[68:69], v[212:213], v[112:113] neg_lo:[1,0,0] neg_hi:[1,0,0]
v_pk_fma_f32 v[114:115], v[52:53], v[212:213], v[114:115]
v_cvt_pk_bf16_f32 v18, v112, v113
v_cvt_pk_bf16_f32 v26, v114, v115
v_pk_mul_f32 v[116:117], v[54:55], v[198:199]
v_pk_mul_f32 v[118:119], v[70:71], v[198:199]
v_pk_fma_f32 v[116:117], v[70:71], v[214:215], v[116:117] neg_lo:[1,0,0] neg_hi:[1,0,0]
s_mul_i32 s77, s17, 5
s_nop 0
buffer_load_dwordx4 a[100:103], v246, s[8:11], s77 offen offset:0 sc1
v_pk_fma_f32 v[118:119], v[54:55], v[214:215], v[118:119]
v_cvt_pk_bf16_f32 v19, v116, v117
v_cvt_pk_bf16_f32 v27, v118, v119
v_pk_mul_f32 v[112:113], v[56:57], v[200:201]
v_pk_mul_f32 v[114:115], v[72:73], v[200:201]
v_pk_fma_f32 v[112:113], v[72:73], v[216:217], v[112:113] neg_lo:[1,0,0] neg_hi:[1,0,0]
v_pk_fma_f32 v[114:115], v[56:57], v[216:217], v[114:115]
v_cvt_pk_bf16_f32 v20, v112, v113
v_cvt_pk_bf16_f32 v28, v114, v115
v_pk_mul_f32 v[116:117], v[58:59], v[202:203]
v_pk_mul_f32 v[118:119], v[74:75], v[202:203]
v_pk_fma_f32 v[116:117], v[74:75], v[218:219], v[116:117] neg_lo:[1,0,0] neg_hi:[1,0,0]
v_pk_fma_f32 v[118:119], v[58:59], v[218:219], v[118:119]
v_cvt_pk_bf16_f32 v21, v116, v117
v_cvt_pk_bf16_f32 v29, v118, v119
v_pk_mul_f32 v[112:113], v[60:61], v[204:205]
v_pk_mul_f32 v[114:115], v[76:77], v[204:205]
v_pk_fma_f32 v[112:113], v[76:77], v[220:221], v[112:113] neg_lo:[1,0,0] neg_hi:[1,0,0]
v_pk_fma_f32 v[114:115], v[60:61], v[220:221], v[114:115]
v_cvt_pk_bf16_f32 v22, v112, v113
v_cvt_pk_bf16_f32 v30, v114, v115
v_pk_mul_f32 v[116:117], v[62:63], v[206:207]
v_pk_mul_f32 v[118:119], v[78:79], v[206:207]
v_pk_fma_f32 v[116:117], v[78:79], v[222:223], v[116:117] neg_lo:[1,0,0] neg_hi:[1,0,0]
v_pk_fma_f32 v[118:119], v[62:63], v[222:223], v[118:119]
buffer_load_dwordx4 a[104:107], v246, s[8:11], s77 offen offset:1024 sc1
v_cvt_pk_bf16_f32 v23, v116, v117
v_cvt_pk_bf16_f32 v31, v118, v119
ds_write_b128 v120, v[16:19] offset:0
ds_write_b128 v120, v[20:23] offset:1024
ds_write_b128 v120, v[24:27] offset:2048
ds_write_b128 v120, v[28:31] offset:3072
v_mfma_f32_32x32x16_bf16 v[80:95], a[184:187], v[16:19], 0
v_mfma_f32_32x32x16_bf16 v[96:111], a[216:219], v[16:19], 0
v_mfma_f32_32x32x16_bf16 v[80:95], a[200:203], v[24:27], v[80:95]
v_mfma_f32_32x32x16_bf16 v[96:111], a[184:187], v[24:27], v[96:111]
buffer_load_dwordx4 a[108:111], v246, s[8:11], s77 offen offset:2048 sc1
s_waitcnt lgkmcnt(0)
s_barrier
ds_read_b128 v[32:35], v121 offset:0
ds_read_b128 v[36:39], v121 offset:1024
ds_read_b128 v[40:43], v121 offset:2048
ds_read_b128 v[44:47], v121 offset:3072
v_mfma_f32_32x32x16_bf16 v[80:95], a[188:191], v[20:23], v[80:95]
v_mfma_f32_32x32x16_bf16 v[96:111], a[220:223], v[20:23], v[96:111]
buffer_load_dwordx4 a[112:115], v246, s[8:11], s77 offen offset:3072 sc1
v_mfma_f32_32x32x16_bf16 v[80:95], a[204:207], v[28:31], v[80:95]
v_mfma_f32_32x32x16_bf16 v[96:111], a[188:191], v[28:31], v[96:111]
s_waitcnt lgkmcnt(0)
s_nop 0
v_mfma_f32_32x32x16_bf16 v[80:95], a[192:195], v[32:35], v[80:95]
v_mfma_f32_32x32x16_bf16 v[96:111], a[224:227], v[32:35], v[96:111]
buffer_load_dwordx4 a[116:119], v247, s[8:11], s77 offen offset:0 sc1
v_mfma_f32_32x32x16_bf16 v[80:95], a[208:211], v[40:43], v[80:95]
v_mfma_f32_32x32x16_bf16 v[96:111], a[192:195], v[40:43], v[96:111]
v_mfma_f32_32x32x16_bf16 v[80:95], a[196:199], v[36:39], v[80:95]
s_mul_i32 s77, s18, 5
buffer_load_dwordx4 a[120:123], v246, s[8:11], s77 offen offset:0 sc1
v_mfma_f32_32x32x16_bf16 v[96:111], a[228:231], v[36:39], v[96:111]
v_mfma_f32_32x32x16_bf16 v[80:95], a[212:215], v[44:47], v[80:95]
v_mfma_f32_32x32x16_bf16 v[96:111], a[196:199], v[44:47], v[96:111]
s_nop 10
v_cvt_pk_bf16_f32 v16, v80, v81
v_cvt_pk_bf16_f32 v17, v82, v83
v_cvt_pk_bf16_f32 v18, v84, v85
v_cvt_pk_bf16_f32 v19, v86, v87
ds_write_b128 v122, v[16:19] offset:0
v_cvt_pk_bf16_f32 v20, v88, v89
v_cvt_pk_bf16_f32 v21, v90, v91
v_cvt_pk_bf16_f32 v22, v92, v93
v_cvt_pk_bf16_f32 v23, v94, v95
ds_write_b128 v123, v[20:23] offset:0
v_cvt_pk_bf16_f32 v24, v96, v97
v_cvt_pk_bf16_f32 v25, v98, v99
v_cvt_pk_bf16_f32 v26, v100, v101
v_cvt_pk_bf16_f32 v27, v102, v103
ds_write_b128 v122, v[24:27] offset:128
v_cvt_pk_bf16_f32 v28, v104, v105
v_cvt_pk_bf16_f32 v29, v106, v107
v_cvt_pk_bf16_f32 v30, v108, v109
v_cvt_pk_bf16_f32 v31, v110, v111
ds_write_b128 v123, v[28:31] offset:128
s_waitcnt lgkmcnt(0)
s_barrier
ds_read_b128 v[32:35], v124 offset:0
ds_read_b128 v[36:39], v124 offset:1088
ds_read_b128 v[40:43], v124 offset:2176
ds_read_b128 v[44:47], v124 offset:3264
s_waitcnt lgkmcnt(3)
s_mov_b64 exec, s[58:59]
buffer_store_dwordx4 v[32:35], v6, s[8:11], s96 offen offset:0 sc1
s_mov_b64 exec, -1
s_waitcnt lgkmcnt(2)
s_mov_b64 exec, s[58:59]
buffer_store_dwordx4 v[36:39], v6, s[8:11], s96 offen offset:1024 sc1
s_mov_b64 exec, -1
s_waitcnt lgkmcnt(1)
s_mov_b64 exec, s[58:59]
buffer_store_dwordx4 v[40:43], v6, s[8:11], s96 offen offset:2048 sc1
s_mov_b64 exec, -1
s_waitcnt lgkmcnt(0)
s_mov_b64 exec, s[58:59]
buffer_store_dwordx4 v[44:47], v6, s[8:11], s96 offen offset:3072 sc1
s_mov_b64 exec, -1
buffer_load_dwordx4 a[124:127], v246, s[8:11], s77 offen offset:1024 sc1
s_mul_i32 s92, s41, 40
v_and_b32 v158, 15, v1
v_add_u32 v159, s92, v158
v_cvt_f32_u32 v112, v159
v_add_f32 v113, 0x41800000, v112
v_and_b32 v159, 7, v158
v_lshrrev_b32 v158, 3, v158
v_mul_u32_u24 v158, 320, v158
v_add3_u32 v159, v159, v158, s92
v_add_u32_e64 v159, 32, v159
v_cvt_f32_u32 v114, v159
s_and_b32 s92, s52, 1
s_mul_i32 s92, s92, 160
s_lshr_b32 s93, s52, 1
s_add_u32 s92, s92, s93
v_lshrrev_b32_e64 v158, 4, v1
v_lshl_add_u32 v158, v158, 3, s92
v_cvt_f32_u32_e64 v115, v158
s_mul_i32 s92, s52, 15360
s_add_u32 s92, s92, 0
v_add_u32 v134, s92, v6
buffer_load_dwordx4 a[128:131], v246, s[8:11], s77 offen offset:2048 sc1
v_mul_f32 v158, 0.5, v112
v_fract_f32 v158, v158
v_mul_f32 v112, 0x3acccccd, v112
v_cos_f32 v158, v158
v_mul_f32 v159, v115, v112
v_cvt_pk_bf16_f32 v160, 1.0, v158
v_fract_f32 v159, v159
v_add_f32 v158, v112, v112
v_mul_f32 v135, 0x41d00000, v112
v_cos_f32_e64 v116, v159
v_sin_f32 v117, -v159
v_cos_f32_e64 v122, v158
v_sin_f32 v123, -v158
buffer_load_dwordx4 a[132:135], v246, s[8:11], s77 offen offset:3072 sc1
v_cos_f32_e64 v128, v135
v_sin_f32 v129, -v135
v_mul_f32 v158, 0.5, v113
v_fract_f32 v158, v158
v_mul_f32 v113, 0x3acccccd, v113
v_cos_f32 v158, v158
v_mul_f32 v159, v115, v113
v_cvt_pk_bf16_f32 v161, 1.0, v158
v_fract_f32 v159, v159
v_add_f32 v158, v113, v113
v_mul_f32 v135, 0x41d00000, v113
v_cos_f32_e64 v118, v159
v_sin_f32 v119, -v159
buffer_load_dwordx4 a[136:139], v247, s[8:11], s77 offen offset:0 sc1
v_cos_f32_e64 v124, v158
v_sin_f32 v125, -v158
v_cos_f32_e64 v130, v135
v_sin_f32 v131, -v135
v_mul_f32 v158, 0.5, v114
v_fract_f32 v158, v158
v_mul_f32 v114, 0x3acccccd, v114
v_cos_f32 v158, v158
v_mul_f32 v159, v115, v114
v_cvt_pk_bf16_f32 v162, 1.0, v158
v_fract_f32 v159, v159
v_add_f32 v158, v114, v114
v_mul_f32 v135, 0x41d00000, v114
v_cos_f32 v120, v159
s_mul_i32 s77, s19, 5
buffer_load_dwordx4 a[140:143], v246, s[8:11], s77 offen offset:0 sc1
v_sin_f32 v121, -v159
v_cos_f32_e64 v126, v158
v_sin_f32 v127, -v158
v_cos_f32_e64 v132, v135
v_sin_f32 v133, -v135
v_cvt_pk_bf16_f32 v136, v116, v117
v_pk_mul_f32 v[164:165], v[116:117], v[122:123] op_sel_hi:[1,0]
v_pk_fma_f32 v[116:117], v[116:117], v[122:123], v[164:165] op_sel:[1,1,0] op_sel_hi:[0,1,1] neg_lo:[1,0,0]
v_cvt_pk_bf16_f32 v140, v118, v119
v_pk_mul_f32 v[166:167], v[118:119], v[124:125] op_sel_hi:[1,0]
v_pk_fma_f32 v[118:119], v[118:119], v[124:125], v[166:167] op_sel:[1,1,0] op_sel_hi:[0,1,1] neg_lo:[1,0,0]
v_cvt_pk_bf16_f32 v144, v120, v121
buffer_load_dwordx4 a[144:147], v246, s[8:11], s77 offen offset:1024 sc1
v_pk_mul_f32 v[168:169], v[120:121], v[126:127] op_sel_hi:[1,0]
v_pk_fma_f32 v[120:121], v[120:121], v[126:127], v[168:169] op_sel:[1,1,0] op_sel_hi:[0,1,1] neg_lo:[1,0,0]
v_cvt_pk_bf16_f32 v137, v116, v117
v_pk_mul_f32 v[164:165], v[116:117], v[122:123] op_sel_hi:[1,0]
v_pk_fma_f32 v[116:117], v[116:117], v[122:123], v[164:165] op_sel:[1,1,0] op_sel_hi:[0,1,1] neg_lo:[1,0,0]
v_cvt_pk_bf16_f32 v141, v118, v119
v_pk_mul_f32 v[166:167], v[118:119], v[124:125] op_sel_hi:[1,0]
v_pk_fma_f32 v[118:119], v[118:119], v[124:125], v[166:167] op_sel:[1,1,0] op_sel_hi:[0,1,1] neg_lo:[1,0,0]
v_cvt_pk_bf16_f32 v145, v120, v121
v_pk_mul_f32 v[168:169], v[120:121], v[126:127] op_sel_hi:[1,0]
v_pk_fma_f32 v[120:121], v[120:121], v[126:127], v[168:169] op_sel:[1,1,0] op_sel_hi:[0,1,1] neg_lo:[1,0,0]
v_cvt_pk_bf16_f32 v138, v116, v117
v_pk_mul_f32 v[164:165], v[116:117], v[122:123] op_sel_hi:[1,0]
v_pk_fma_f32 v[116:117], v[116:117], v[122:123], v[164:165] op_sel:[1,1,0] op_sel_hi:[0,1,1] neg_lo:[1,0,0]
v_cvt_pk_bf16_f32 v142, v118, v119
v_pk_mul_f32 v[166:167], v[118:119], v[124:125] op_sel_hi:[1,0]
v_pk_fma_f32 v[118:119], v[118:119], v[124:125], v[166:167] op_sel:[1,1,0] op_sel_hi:[0,1,1] neg_lo:[1,0,0]
v_cvt_pk_bf16_f32 v146, v120, v121
v_pk_mul_f32 v[168:169], v[120:121], v[126:127] op_sel_hi:[1,0]
buffer_load_dwordx4 a[148:151], v246, s[8:11], s77 offen offset:2048 sc1
v_pk_fma_f32 v[120:121], v[120:121], v[126:127], v[168:169] op_sel:[1,1,0] op_sel_hi:[0,1,1] neg_lo:[1,0,0]
v_cvt_pk_bf16_f32 v139, v116, v117
v_pk_mul_f32 v[164:165], v[116:117], v[128:129] op_sel_hi:[1,0]
v_pk_fma_f32 v[116:117], v[116:117], v[128:129], v[164:165] op_sel:[1,1,0] op_sel_hi:[0,1,1] neg_lo:[1,0,0]
v_cmp_eq_f32 vcc, 0, v115
s_nop 1
v_cndmask_b32_e64 v136, v136, v160, vcc
ds_write_b128 v134, v[136:139] offset:0
v_cvt_pk_bf16_f32 v143, v118, v119
v_pk_mul_f32 v[166:167], v[118:119], v[130:131] op_sel_hi:[1,0]
v_pk_fma_f32 v[118:119], v[118:119], v[130:131], v[166:167] op_sel:[1,1,0] op_sel_hi:[0,1,1] neg_lo:[1,0,0]
v_cmp_eq_f32 vcc, 0, v115
s_nop 1
v_cndmask_b32_e64 v140, v140, v161, vcc
ds_write_b128 v134, v[140:143] offset:1024
v_cvt_pk_bf16_f32 v147, v120, v121
v_pk_mul_f32 v[168:169], v[120:121], v[132:133] op_sel_hi:[1,0]
v_pk_fma_f32 v[120:121], v[120:121], v[132:133], v[168:169] op_sel:[1,1,0] op_sel_hi:[0,1,1] neg_lo:[1,0,0]
v_cmp_eq_f32 vcc, 0, v115
s_nop 1
v_cndmask_b32_e64 v144, v144, v162, vcc
buffer_load_dwordx4 a[152:155], v246, s[8:11], s77 offen offset:3072 sc1
ds_write_b128 v134, v[144:147] offset:2048
v_cvt_pk_bf16_f32 v172, v116, v117
v_pk_mul_f32 v[164:165], v[116:117], v[122:123] op_sel_hi:[1,0]
v_pk_fma_f32 v[116:117], v[116:117], v[122:123], v[164:165] op_sel:[1,1,0] op_sel_hi:[0,1,1] neg_lo:[1,0,0]
v_cvt_pk_bf16_f32 v176, v118, v119
v_pk_mul_f32 v[166:167], v[118:119], v[124:125] op_sel_hi:[1,0]
v_pk_fma_f32 v[118:119], v[118:119], v[124:125], v[166:167] op_sel:[1,1,0] op_sel_hi:[0,1,1] neg_lo:[1,0,0]
v_cvt_pk_bf16_f32 v180, v120, v121
v_pk_mul_f32 v[168:169], v[120:121], v[126:127] op_sel_hi:[1,0]
v_pk_fma_f32 v[120:121], v[120:121], v[126:127], v[168:169] op_sel:[1,1,0] op_sel_hi:[0,1,1] neg_lo:[1,0,0]
v_cvt_pk_bf16_f32 v173, v116, v117
v_pk_mul_f32 v[164:165], v[116:117], v[122:123] op_sel_hi:[1,0]
v_pk_fma_f32 v[116:117], v[116:117], v[122:123], v[164:165] op_sel:[1,1,0] op_sel_hi:[0,1,1] neg_lo:[1,0,0]
v_cvt_pk_bf16_f32 v177, v118, v119
v_pk_mul_f32 v[166:167], v[118:119], v[124:125] op_sel_hi:[1,0]
v_pk_fma_f32 v[118:119], v[118:119], v[124:125], v[166:167] op_sel:[1,1,0] op_sel_hi:[0,1,1] neg_lo:[1,0,0]
v_cvt_pk_bf16_f32 v181, v120, v121
buffer_load_dwordx4 a[156:159], v247, s[8:11], s77 offen offset:0 sc1
v_pk_mul_f32 v[168:169], v[120:121], v[126:127] op_sel_hi:[1,0]
v_pk_fma_f32 v[120:121], v[120:121], v[126:127], v[168:169] op_sel:[1,1,0] op_sel_hi:[0,1,1] neg_lo:[1,0,0]
v_cvt_pk_bf16_f32 v174, v116, v117
v_pk_mul_f32 v[164:165], v[116:117], v[122:123] op_sel_hi:[1,0]
v_pk_fma_f32 v[116:117], v[116:117], v[122:123], v[164:165] op_sel:[1,1,0] op_sel_hi:[0,1,1] neg_lo:[1,0,0]
v_cvt_pk_bf16_f32 v178, v118, v119
v_pk_mul_f32 v[166:167], v[118:119], v[124:125] op_sel_hi:[1,0]
v_pk_fma_f32 v[118:119], v[118:119], v[124:125], v[166:167] op_sel:[1,1,0] op_sel_hi:[0,1,1] neg_lo:[1,0,0]
v_cvt_pk_bf16_f32 v182, v120, v121
v_pk_mul_f32 v[168:169], v[120:121], v[126:127] op_sel_hi:[1,0]
v_pk_fma_f32 v[120:121], v[120:121], v[126:127], v[168:169] op_sel:[1,1,0] op_sel_hi:[0,1,1] neg_lo:[1,0,0]
v_cvt_pk_bf16_f32 v175, v116, v117
v_pk_mul_f32 v[164:165], v[116:117], v[128:129] op_sel_hi:[1,0]
v_pk_fma_f32 v[116:117], v[116:117], v[128:129], v[164:165] op_sel:[1,1,0] op_sel_hi:[0,1,1] neg_lo:[1,0,0]
ds_write_b128 v134, v[172:175] offset:3072
v_cvt_pk_bf16_f32 v179, v118, v119
v_pk_mul_f32 v[166:167], v[118:119], v[130:131] op_sel_hi:[1,0]
v_pk_fma_f32 v[118:119], v[118:119], v[130:131], v[166:167] op_sel:[1,1,0] op_sel_hi:[0,1,1] neg_lo:[1,0,0]
ds_write_b128 v134, v[176:179] offset:4096
s_mul_i32 s77, s24, 5
s_nop 0
buffer_load_dwordx4 a[160:163], v246, s[8:11], s77 offen offset:0 sc1
v_cvt_pk_bf16_f32 v183, v120, v121
v_pk_mul_f32 v[168:169], v[120:121], v[132:133] op_sel_hi:[1,0]
v_pk_fma_f32 v[120:121], v[120:121], v[132:133], v[168:169] op_sel:[1,1,0] op_sel_hi:[0,1,1] neg_lo:[1,0,0]
ds_write_b128 v134, v[180:183] offset:5120
v_cvt_pk_bf16_f32 v136, v116, v117
v_pk_mul_f32 v[164:165], v[116:117], v[122:123] op_sel_hi:[1,0]
v_pk_fma_f32 v[116:117], v[116:117], v[122:123], v[164:165] op_sel:[1,1,0] op_sel_hi:[0,1,1] neg_lo:[1,0,0]
v_cvt_pk_bf16_f32 v140, v118, v119
v_pk_mul_f32 v[166:167], v[118:119], v[124:125] op_sel_hi:[1,0]
v_pk_fma_f32 v[118:119], v[118:119], v[124:125], v[166:167] op_sel:[1,1,0] op_sel_hi:[0,1,1] neg_lo:[1,0,0]
v_cvt_pk_bf16_f32 v144, v120, v121
v_pk_mul_f32 v[168:169], v[120:121], v[126:127] op_sel_hi:[1,0]
v_pk_fma_f32 v[120:121], v[120:121], v[126:127], v[168:169] op_sel:[1,1,0] op_sel_hi:[0,1,1] neg_lo:[1,0,0]
v_cvt_pk_bf16_f32 v137, v116, v117
v_pk_mul_f32 v[164:165], v[116:117], v[122:123] op_sel_hi:[1,0]
v_pk_fma_f32 v[116:117], v[116:117], v[122:123], v[164:165] op_sel:[1,1,0] op_sel_hi:[0,1,1] neg_lo:[1,0,0]
v_cvt_pk_bf16_f32 v141, v118, v119
v_pk_mul_f32 v[166:167], v[118:119], v[124:125] op_sel_hi:[1,0]
buffer_load_dwordx4 a[164:167], v246, s[8:11], s77 offen offset:1024 sc1
v_pk_fma_f32 v[118:119], v[118:119], v[124:125], v[166:167] op_sel:[1,1,0] op_sel_hi:[0,1,1] neg_lo:[1,0,0]
v_cvt_pk_bf16_f32 v145, v120, v121
v_pk_mul_f32 v[168:169], v[120:121], v[126:127] op_sel_hi:[1,0]
v_pk_fma_f32 v[120:121], v[120:121], v[126:127], v[168:169] op_sel:[1,1,0] op_sel_hi:[0,1,1] neg_lo:[1,0,0]
v_cvt_pk_bf16_f32 v138, v116, v117
v_pk_mul_f32 v[164:165], v[116:117], v[122:123] op_sel_hi:[1,0]
v_pk_fma_f32 v[116:117], v[116:117], v[122:123], v[164:165] op_sel:[1,1,0] op_sel_hi:[0,1,1] neg_lo:[1,0,0]
v_cvt_pk_bf16_f32 v142, v118, v119
v_pk_mul_f32 v[166:167], v[118:119], v[124:125] op_sel_hi:[1,0]
v_pk_fma_f32 v[118:119], v[118:119], v[124:125], v[166:167] op_sel:[1,1,0] op_sel_hi:[0,1,1] neg_lo:[1,0,0]
v_cvt_pk_bf16_f32 v146, v120, v121
v_pk_mul_f32 v[168:169], v[120:121], v[126:127] op_sel_hi:[1,0]
v_pk_fma_f32 v[120:121], v[120:121], v[126:127], v[168:169] op_sel:[1,1,0] op_sel_hi:[0,1,1] neg_lo:[1,0,0]
v_cvt_pk_bf16_f32 v139, v116, v117
v_pk_mul_f32 v[164:165], v[116:117], v[128:129] op_sel_hi:[1,0]
v_pk_fma_f32 v[116:117], v[116:117], v[128:129], v[164:165] op_sel:[1,1,0] op_sel_hi:[0,1,1] neg_lo:[1,0,0]
ds_write_b128 v134, v[136:139] offset:6144
v_cvt_pk_bf16_f32 v143, v118, v119
v_pk_mul_f32 v[166:167], v[118:119], v[130:131] op_sel_hi:[1,0]
buffer_load_dwordx4 a[168:171], v246, s[8:11], s77 offen offset:2048 sc1
v_pk_fma_f32 v[118:119], v[118:119], v[130:131], v[166:167] op_sel:[1,1,0] op_sel_hi:[0,1,1] neg_lo:[1,0,0]
ds_write_b128 v134, v[140:143] offset:7168
v_cvt_pk_bf16_f32 v147, v120, v121
v_pk_mul_f32 v[168:169], v[120:121], v[132:133] op_sel_hi:[1,0]
v_pk_fma_f32 v[120:121], v[120:121], v[132:133], v[168:169] op_sel:[1,1,0] op_sel_hi:[0,1,1] neg_lo:[1,0,0]
ds_write_b128 v134, v[144:147] offset:8192
v_cvt_pk_bf16_f32 v172, v116, v117
v_pk_mul_f32 v[164:165], v[116:117], v[122:123] op_sel_hi:[1,0]
v_pk_fma_f32 v[116:117], v[116:117], v[122:123], v[164:165] op_sel:[1,1,0] op_sel_hi:[0,1,1] neg_lo:[1,0,0]
v_cvt_pk_bf16_f32 v176, v118, v119
v_pk_mul_f32 v[166:167], v[118:119], v[124:125] op_sel_hi:[1,0]
v_pk_fma_f32 v[118:119], v[118:119], v[124:125], v[166:167] op_sel:[1,1,0] op_sel_hi:[0,1,1] neg_lo:[1,0,0]
v_cvt_pk_bf16_f32 v180, v120, v121
v_pk_mul_f32 v[168:169], v[120:121], v[126:127] op_sel_hi:[1,0]
v_pk_fma_f32 v[120:121], v[120:121], v[126:127], v[168:169] op_sel:[1,1,0] op_sel_hi:[0,1,1] neg_lo:[1,0,0]
v_cvt_pk_bf16_f32 v173, v116, v117
v_pk_mul_f32 v[164:165], v[116:117], v[122:123] op_sel_hi:[1,0]
v_pk_fma_f32 v[116:117], v[116:117], v[122:123], v[164:165] op_sel:[1,1,0] op_sel_hi:[0,1,1] neg_lo:[1,0,0]
v_cvt_pk_bf16_f32 v177, v118, v119
buffer_load_dwordx4 a[172:175], v246, s[8:11], s77 offen offset:3072 sc1
v_pk_mul_f32 v[166:167], v[118:119], v[124:125] op_sel_hi:[1,0]
v_pk_fma_f32 v[118:119], v[118:119], v[124:125], v[166:167] op_sel:[1,1,0] op_sel_hi:[0,1,1] neg_lo:[1,0,0]
v_cvt_pk_bf16_f32 v181, v120, v121
v_pk_mul_f32 v[168:169], v[120:121], v[126:127] op_sel_hi:[1,0]
v_pk_fma_f32 v[120:121], v[120:121], v[126:127], v[168:169] op_sel:[1,1,0] op_sel_hi:[0,1,1] neg_lo:[1,0,0]
v_cvt_pk_bf16_f32 v174, v116, v117
v_pk_mul_f32 v[164:165], v[116:117], v[122:123] op_sel_hi:[1,0]
v_pk_fma_f32 v[116:117], v[116:117], v[122:123], v[164:165] op_sel:[1,1,0] op_sel_hi:[0,1,1] neg_lo:[1,0,0]
v_cvt_pk_bf16_f32 v178, v118, v119
v_pk_mul_f32 v[166:167], v[118:119], v[124:125] op_sel_hi:[1,0]
v_pk_fma_f32 v[118:119], v[118:119], v[124:125], v[166:167] op_sel:[1,1,0] op_sel_hi:[0,1,1] neg_lo:[1,0,0]
v_cvt_pk_bf16_f32 v182, v120, v121
v_pk_mul_f32 v[168:169], v[120:121], v[126:127] op_sel_hi:[1,0]
v_pk_fma_f32 v[120:121], v[120:121], v[126:127], v[168:169] op_sel:[1,1,0] op_sel_hi:[0,1,1] neg_lo:[1,0,0]
v_cvt_pk_bf16_f32 v175, v116, v117
v_pk_mul_f32 v[164:165], v[116:117], v[128:129] op_sel_hi:[1,0]
v_pk_fma_f32 v[116:117], v[116:117], v[128:129], v[164:165] op_sel:[1,1,0] op_sel_hi:[0,1,1] neg_lo:[1,0,0]
ds_write_b128 v134, v[172:175] offset:9216
v_cvt_pk_bf16_f32 v179, v118, v119
buffer_load_dwordx4 a[176:179], v247, s[8:11], s77 offen offset:0 sc1
v_pk_mul_f32 v[166:167], v[118:119], v[130:131] op_sel_hi:[1,0]
v_pk_fma_f32 v[118:119], v[118:119], v[130:131], v[166:167] op_sel:[1,1,0] op_sel_hi:[0,1,1] neg_lo:[1,0,0]
ds_write_b128 v134, v[176:179] offset:10240
v_cvt_pk_bf16_f32 v183, v120, v121
v_pk_mul_f32 v[168:169], v[120:121], v[132:133] op_sel_hi:[1,0]
v_pk_fma_f32 v[120:121], v[120:121], v[132:133], v[168:169] op_sel:[1,1,0] op_sel_hi:[0,1,1] neg_lo:[1,0,0]
ds_write_b128 v134, v[180:183] offset:11264
v_cvt_pk_bf16_f32 v136, v116, v117
v_pk_mul_f32 v[164:165], v[116:117], v[122:123] op_sel_hi:[1,0]
v_pk_fma_f32 v[116:117], v[116:117], v[122:123], v[164:165] op_sel:[1,1,0] op_sel_hi:[0,1,1] neg_lo:[1,0,0]
v_cvt_pk_bf16_f32 v140, v118, v119
v_pk_mul_f32 v[166:167], v[118:119], v[124:125] op_sel_hi:[1,0]
v_pk_fma_f32 v[118:119], v[118:119], v[124:125], v[166:167] op_sel:[1,1,0] op_sel_hi:[0,1,1] neg_lo:[1,0,0]
v_cvt_pk_bf16_f32 v144, v120, v121
v_pk_mul_f32 v[168:169], v[120:121], v[126:127] op_sel_hi:[1,0]
v_pk_fma_f32 v[120:121], v[120:121], v[126:127], v[168:169] op_sel:[1,1,0] op_sel_hi:[0,1,1] neg_lo:[1,0,0]
v_cvt_pk_bf16_f32 v137, v116, v117
v_pk_mul_f32 v[164:165], v[116:117], v[122:123] op_sel_hi:[1,0]
v_pk_fma_f32 v[116:117], v[116:117], v[122:123], v[164:165] op_sel:[1,1,0] op_sel_hi:[0,1,1] neg_lo:[1,0,0]
s_mul_i32 s77, s25, 5
s_nop 0
buffer_load_dwordx4 a[180:183], v246, s[8:11], s77 offen offset:0 sc1
v_cvt_pk_bf16_f32 v141, v118, v119
v_pk_mul_f32 v[166:167], v[118:119], v[124:125] op_sel_hi:[1,0]
v_pk_fma_f32 v[118:119], v[118:119], v[124:125], v[166:167] op_sel:[1,1,0] op_sel_hi:[0,1,1] neg_lo:[1,0,0]
v_cvt_pk_bf16_f32 v145, v120, v121
v_pk_mul_f32 v[168:169], v[120:121], v[126:127] op_sel_hi:[1,0]
v_pk_fma_f32 v[120:121], v[120:121], v[126:127], v[168:169] op_sel:[1,1,0] op_sel_hi:[0,1,1] neg_lo:[1,0,0]
v_cvt_pk_bf16_f32 v138, v116, v117
v_pk_mul_f32 v[164:165], v[116:117], v[122:123] op_sel_hi:[1,0]
v_pk_fma_f32 v[116:117], v[116:117], v[122:123], v[164:165] op_sel:[1,1,0] op_sel_hi:[0,1,1] neg_lo:[1,0,0]
v_cvt_pk_bf16_f32 v142, v118, v119
v_pk_mul_f32 v[166:167], v[118:119], v[124:125] op_sel_hi:[1,0]
v_pk_fma_f32 v[118:119], v[118:119], v[124:125], v[166:167] op_sel:[1,1,0] op_sel_hi:[0,1,1] neg_lo:[1,0,0]
v_cvt_pk_bf16_f32 v146, v120, v121
v_pk_mul_f32 v[168:169], v[120:121], v[126:127] op_sel_hi:[1,0]
v_pk_fma_f32 v[120:121], v[120:121], v[126:127], v[168:169] op_sel:[1,1,0] op_sel_hi:[0,1,1] neg_lo:[1,0,0]
v_cvt_pk_bf16_f32 v139, v116, v117
ds_write_b128 v134, v[136:139] offset:12288
v_cvt_pk_bf16_f32 v143, v118, v119
buffer_load_dwordx4 a[184:187], v246, s[8:11], s77 offen offset:1024 sc1
ds_write_b128 v134, v[140:143] offset:13312
v_cvt_pk_bf16_f32 v147, v120, v121
ds_write_b128 v134, v[144:147] offset:14336
buffer_load_dwordx4 a[188:191], v246, s[8:11], s77 offen offset:2048 sc1
buffer_load_dwordx4 a[192:195], v246, s[8:11], s77 offen offset:3072 sc1
buffer_load_dwordx4 a[196:199], v247, s[8:11], s77 offen offset:0 sc1
s_mul_i32 s77, s26, 5
buffer_load_dwordx4 a[200:203], v246, s[8:11], s77 offen offset:0 sc1
s_waitcnt vmcnt(20)
s_waitcnt lgkmcnt(0)
s_barrier
s_cmp_lg_u32 s52, 0
s_cbranch_scc1 L_fs24
s_bfe_u32 s92, s39, 0x20002
s_mul_i32 s92, s92, 41
s_lshr_b32 s93, s39, 4
s_lshl_b32 s93, s93, 2
s_add_u32 s92, s92, s93
s_and_b32 s93, s39, 3
s_add_u32 s92, s92, s93
s_mul_i32 s92, s92, 16
s_add_u32 s92, s92, 524288
v_mov_b32 v8, s56
v_mov_b32 v9, 0
s_mov_b64 exec, 1
buffer_store_dword v8, v9, s[8:11], s92 offen sc1
s_mov_b64 exec, -1
L_fs24:
buffer_load_dwordx4 a[204:207], v246, s[8:11], s77 offen offset:1024 sc1
v_and_b32 v5, 15, v1
v_lshrrev_b32_e64 v2, 4, v1
s_add_u32 s92, s52, 0
s_and_b32 s92, s92, 3
s_lshl_b32 s97, s40, 2
s_add_u32 s92, s92, s97
s_mul_i32 s92, s92, 55296
s_lshl_b32 s97, s52, 10
s_add_u32 s92, s92, s97
s_add_u32 s92, s92, 10485760
v_add_u32_e64 v10, s92, v6
s_add_u32 s92, s52, 1
s_and_b32 s92, s92, 3
s_lshl_b32 s97, s40, 2
s_add_u32 s92, s92, s97
s_mul_i32 s92, s92, 55296
s_lshl_b32 s97, s52, 10
s_add_u32 s92, s92, s97
s_add_u32 s92, s92, 10485760
buffer_load_dwordx4 a[208:211], v246, s[8:11], s77 offen offset:2048 sc1
v_add_u32_e64 v11, s92, v6
s_add_u32 s92, s52, 2
s_and_b32 s92, s92, 3
s_lshl_b32 s97, s40, 2
s_add_u32 s92, s92, s97
s_mul_i32 s92, s92, 55296
s_lshl_b32 s97, s52, 10
s_add_u32 s92, s92, s97
s_add_u32 s92, s92, 10485760
v_add_u32_e64 v12, s92, v6
s_add_u32 s92, s52, 3
s_and_b32 s92, s92, 3
s_lshl_b32 s97, s40, 2
s_add_u32 s92, s92, s97
s_mul_i32 s92, s92, 55296
s_lshl_b32 s97, s52, 10
s_add_u32 s92, s92, s97
s_add_u32 s92, s92, 10485760
v_add_u32_e64 v13, s92, v6
buffer_load_dwordx4 a[212:215], v246, s[8:11], s77 offen offset:3072 sc1
s_cmp_eq_u32 s52, 0
s_cselect_b32 s92, 40, 39
s_mul_i32 s93, s52, 656
s_add_u32 s93, s93, 524288
v_min_u32 v196, s92, v1
v_mul_u32_u24 v196, 16, v196
v_add_u32 v196, s93, v196
s_lshl_b32 s92, s40, 8
s_lshl_b32 s93, s52, 15
s_add_u32 s92, s92, s93
s_add_u32 s92, s92, 18874368
v_lshlrev_b32_e64 v199, 13, v2
v_lshl_add_u32 v199, v5, 4, v199
v_add_u32_e64 v199, s92, v199
v_bfe_u32 v200, v1, 2, 2
v_lshlrev_b32_e64 v201, 10, v2
v_lshl_add_u32 v201, v200, 7, v201
v_lshrrev_b32 v200, 1, v200
v_and_b32 v7, 1, v2
v_lshl_or_b32 v200, v7, 1, v200
v_xor_b32_e64 v200, s52, v200
v_lshl_add_u32 v201, v200, 5, v201
buffer_load_dwordx4 a[216:219], v247, s[8:11], s77 offen offset:0 sc1
v_and_b32_e64 v200, 3, v1
v_lshl_add_u32 v201, v200, 3, v201
v_add_u32 v200, 65536, v201
v_add_u32 v201, 106496, v201
v_add_u32_e64 v202, 0, v6
s_mul_i32 s92, s52, 2560
s_add_u32 s76, s92, 147456
v_mul_u32_u24 v243, 160, v5
v_add_u32_e64 v243, s76, v243
v_lshl_add_u32 v244, v7, 3, v243
v_lshrrev_b32_e64 v7, 1, v2
v_mul_u32_u24 v7, 80, v7
v_add3_u32 v244, v244, v7, 64
v_lshl_add_u32 v243, v2, 3, v243
v_add_u32_e64 v197, s76, v6
s_mul_i32 s92, s52, 655360
s_add_u32 s92, s92, s49
s_mul_i32 s77, s27, 5
buffer_load_dwordx4 a[220:223], v246, s[8:11], s77 offen offset:0 sc1
v_add_u32_e64 v7, 0, v1
v_mul_u32_u24 v2, 6554, v7
v_lshrrev_b32 v2, 16, v2
v_mul_u32_u24 v198, 10, v2
v_sub_u32_e64 v7, v7, v198
v_mul_u32_u24 v2, 40960, v2
v_cmp_lt_u32_e64 vcc, 4, v7
v_lshl_add_u32 v2, v7, 4, v2
v_add_u32 v7, 560, v2
v_cndmask_b32 v2, v2, v7, vcc
v_add_u32 v240, s92, v2
v_add_u32_e64 v7, 64, v1
v_mul_u32_u24 v2, 6554, v7
v_lshrrev_b32 v2, 16, v2
v_mul_u32_u24 v198, 10, v2
v_sub_u32_e64 v7, v7, v198
v_mul_u32_u24 v2, 40960, v2
v_cmp_lt_u32_e64 vcc, 4, v7
v_lshl_add_u32 v2, v7, 4, v2
v_add_u32 v7, 560, v2
v_cndmask_b32_e64 v2, v2, v7, vcc
buffer_load_dwordx4 a[224:227], v246, s[8:11], s77 offen offset:1024 sc1
v_add_u32_e64 v241, s92, v2
v_add_u32 v7, 128, v1
v_mul_u32_u24 v2, 6554, v7
v_lshrrev_b32 v2, 16, v2
v_mul_u32_u24 v198, 10, v2
v_sub_u32_e64 v7, v7, v198
v_mul_u32_u24 v2, 40960, v2
v_cmp_lt_u32_e64 vcc, 4, v7
v_lshl_add_u32 v2, v7, 4, v2
v_add_u32 v7, 560, v2
v_cndmask_b32 v2, v2, v7, vcc
v_add_u32 v242, s92, v2
v_lshlrev_b32 v5, 3, v5
s_lshl_b32 s75, s52, 10
buffer_load_dwordx4 a[228:231], v246, s[8:11], s77 offen offset:2048 sc1
s_lshl_b32 s92, s40, 5
v_add_u32 v7, s92, v4
v_mul_u32_u24_e64 v7, 16, v7
v_add_u32 v7, 262144, v7
buffer_load_dword v14, v7, s[8:11], 0 offen sc1
buffer_load_dwordx4 a[232:235], v246, s[8:11], s77 offen offset:3072 sc1
buffer_load_dwordx4 a[236:239], v247, s[8:11], s77 offen offset:0 sc1
s_mul_i32 s77, s57, 5
buffer_load_dwordx4 a[240:243], v246, s[8:11], s77 offen offset:0 sc1
buffer_load_dwordx4 a[244:247], v246, s[8:11], s77 offen offset:1024 sc1
buffer_load_dwordx4 a[248:251], v246, s[8:11], s77 offen offset:2048 sc1
buffer_load_dwordx4 a[252:255], v246, s[8:11], s77 offen offset:3072 sc1
buffer_load_dwordx4 v[208:211], v247, s[8:11], s77 offen offset:0 sc1
s_cmp_ge_u32 s52, 2
s_cbranch_scc1 L_w1323
s_nop 0
s_mov_b32 s77, 266240
buffer_load_dwordx4 v[212:215], v246, s[8:11], s77 offen offset:0 sc1
buffer_load_dwordx4 v[216:219], v246, s[8:11], s77 offen offset:1024 sc1
buffer_load_dwordx4 v[220:223], v246, s[8:11], s77 offen offset:2048 sc1
buffer_load_dwordx4 v[224:227], v246, s[8:11], s77 offen offset:3072 sc1
buffer_load_dwordx4 v[228:231], v247, s[8:11], s77 offen offset:0 sc1
L_w1323:
s_waitcnt vmcnt(7)
s_mov_b32 s79, 0
L_poll25:
v_cmp_ne_u32 vcc, s56, v14
s_add_u32 s79, s79, 1
s_cmp_eq_u64 vcc, 0
s_cbranch_scc1 L_polld26
buffer_load_dword v14, v7, s[8:11], 0 offen sc1
s_waitcnt vmcnt(0)
s_cmp_lt_u32 s79, 200000
s_cbranch_scc1 L_poll25
L_polld26:
s_branch L_join4
L_narrow2:
s_waitcnt vmcnt(8)
s_waitcnt lgkmcnt(0)
s_barrier
ds_read_b128 a[0:3], v253 offset:0
ds_read_b128 a[4:7], v253 offset:4096
ds_read_b128 a[8:11], v253 offset:8192
ds_read_b128 a[12:15], v253 offset:12288
ds_read_b128 a[16:19], v253 offset:16384
ds_read_b128 a[20:23], v253 offset:20480
ds_read_b128 v[112:115], v128 offset:0
ds_read_b64_tr_b16 v[80:81], v132 offset:0
ds_read_b64_tr_b16 v[82:83], v132 offset:512
ds_read_b64_tr_b16 v[84:85], v133 offset:0
ds_read_b64_tr_b16 v[86:87], v133 offset:512
ds_read_b64_tr_b16 v[88:89], v134 offset:0
ds_read_b64_tr_b16 v[90:91], v134 offset:512
s_waitcnt lgkmcnt(4)
s_nop 0
v_mfma_f32_32x32x16_bf16 v[16:31], v[80:83], v[112:115], 0
s_add_u32 m0, s76, 50176
ds_read_b128 v[116:119], v129 offset:0
ds_read_b64_tr_b16 v[96:97], v132 offset:2048
ds_read_b64_tr_b16 v[98:99], v132 offset:2560
v_mfma_f32_16x16x32_bf16 v[120:123], v[80:83], v[124:127], 0
buffer_load_dwordx4 v157, s[20:23], s74 offen offset:0 lds
s_add_u32 m0, s75, 35840
s_nop 0
buffer_load_dwordx4 v155, s[4:7], s73 offen lds
s_waitcnt lgkmcnt(5)
v_mfma_f32_32x32x16_bf16 v[32:47], v[84:87], v[112:115], 0
s_add_u32 m0, s76, 58240
ds_read_b64_tr_b16 v[100:101], v133 offset:2048
ds_read_b64_tr_b16 v[102:103], v133 offset:2560
buffer_load_dwordx4 v157, s[20:23], s74 offen offset:128 lds
s_lshl_b32 s12, s43, 12
v_add_u32 v246, s44, v6
v_add_u32 v247, 4096, v246
s_add_u32 s13, s12, 4096
s_cmp_eq_u32 s13, 53248
s_cselect_b32 s13, 0, s13
s_add_u32 s14, s13, 4096
s_cmp_eq_u32 s14, 53248
s_cselect_b32 s14, 0, s14
s_waitcnt lgkmcnt(5)
v_mfma_f32_32x32x16_bf16 v[48:63], v[88:91], v[112:115], 0
s_add_u32 s72, s42, 2
s_cmp_ge_u32 s72, 10
s_cselect_b32 s73, 10, 0
s_sub_u32 s72, s72, s73
s_lshl_b32 s73, s72, 7
s_mul_i32 s74, s72, 221184
s_add_u32 s73, s73, s45
s_add_u32 s74, s74, s46
s_add_u32 m0, s75, 65536
ds_read_b64_tr_b16 v[104:105], v134 offset:2048
ds_read_b64_tr_b16 v[106:107], v134 offset:2560
buffer_load_dwordx4 v152, s[4:7], s73 offen lds
s_add_u32 s15, s14, 4096
s_cmp_eq_u32 s15, 53248
s_cselect_b32 s15, 0, s15
s_add_u32 s16, s15, 4096
s_cmp_eq_u32 s16, 53248
s_cselect_b32 s16, 0, s16
s_add_u32 s17, s16, 4096
s_cmp_eq_u32 s17, 53248
s_cselect_b32 s17, 0, s17
s_add_u32 s18, s17, 4096
s_cmp_eq_u32 s18, 53248
s_cselect_b32 s18, 0, s18
s_add_u32 s19, s18, 4096
s_cmp_eq_u32 s19, 53248
s_cselect_b32 s19, 0, s19
s_waitcnt lgkmcnt(4)
v_mfma_f32_32x32x16_bf16 v[16:31], v[96:99], v[116:119], v[16:31]
s_add_u32 m0, s76, 81920
ds_read_b128 v[112:115], v130 offset:0
ds_read_b64_tr_b16 v[80:81], v132 offset:4096
ds_read_b64_tr_b16 v[82:83], v132 offset:4608
v_mfma_f32_16x16x32_bf16 v[120:123], v[96:99], v[124:127], v[120:123]
buffer_load_dwordx4 v156, s[20:23], s74 offen offset:0 lds
s_add_u32 m0, s75, 66560
s_nop 0
buffer_load_dwordx4 v153, s[4:7], s73 offen lds
s_waitcnt lgkmcnt(5)
v_mfma_f32_32x32x16_bf16 v[32:47], v[100:103], v[116:119], v[32:47]
s_add_u32 m0, s76, 89984
ds_read_b64_tr_b16 v[84:85], v133 offset:4096
ds_read_b64_tr_b16 v[86:87], v133 offset:4608
buffer_load_dwordx4 v156, s[20:23], s74 offen offset:128 lds
s_add_u32 s24, s19, 4096
s_cmp_eq_u32 s24, 53248
s_cselect_b32 s24, 0, s24
s_waitcnt lgkmcnt(5)
v_mfma_f32_32x32x16_bf16 v[48:63], v[104:107], v[116:119], v[48:63]
s_add_u32 m0, s75, 67584
ds_read_b64_tr_b16 v[88:89], v134 offset:4096
ds_read_b64_tr_b16 v[90:91], v134 offset:4608
buffer_load_dwordx4 v154, s[4:7], s73 offen lds
s_add_u32 s25, s24, 4096
s_cmp_eq_u32 s25, 53248
s_cselect_b32 s25, 0, s25
s_add_u32 s26, s25, 4096
s_cmp_eq_u32 s26, 53248
s_cselect_b32 s26, 0, s26
s_add_u32 s27, s26, 4096
s_cmp_eq_u32 s27, 53248
s_cselect_b32 s27, 0, s27
s_add_u32 s57, s27, 4096
s_cmp_eq_u32 s57, 53248
s_cselect_b32 s57, 0, s57
v_lshrrev_b32 v2, 3, v1
v_and_b32 v5, 3, v2
v_lshrrev_b32_e64 v7, 2, v2
v_lshl_add_u32 v5, v7, 3, v5
s_mov_b32 s95, 164864
v_mul_lo_u32 v5, v5, s95
s_bfe_u32 s95, s39, 0x30001
v_lshrrev_b32 v7, 1, v2
v_and_b32 v2, 7, v1
v_xor_b32_e64 v7, v7, v2
v_xor_b32 v7, s95, v7
s_lshl_b32 s95, s39, 7
s_mul_i32 s96, s52, 41216
s_add_u32 s95, s95, s96
s_add_u32 s95, s95, 1048576
s_waitcnt lgkmcnt(4)
v_mfma_f32_32x32x16_bf16 v[16:31], v[80:83], v[112:115], v[16:31]
ds_read_b128 v[116:119], v131 offset:0
ds_read_b64_tr_b16 v[96:97], v132 offset:6144
ds_read_b64_tr_b16 v[98:99], v132 offset:6656
v_mfma_f32_16x16x32_bf16 v[120:123], v[80:83], v[124:127], v[120:123]
buffer_store_dwordx4 a[0:3], v252, s[8:11], s47 offen sc1
s_add_u32 m0, s76, 82944
s_nop 0
buffer_load_dwordx4 v157, s[20:23], s74 offen offset:0 lds
v_add_u32 v5, s95, v5
v_lshl_add_u32 v224, v7, 4, v5
v_xor_b32_e64 v7, 4, v7
v_lshl_add_u32 v225, v7, 4, v5
s_waitcnt lgkmcnt(5)
s_nop 0
v_mfma_f32_32x32x16_bf16 v[32:47], v[84:87], v[112:115], v[32:47]
s_add_u32 m0, s75, 68608
ds_read_b64_tr_b16 v[100:101], v133 offset:6144
ds_read_b64_tr_b16 v[102:103], v133 offset:6656
buffer_load_dwordx4 v155, s[4:7], s73 offen lds
s_add_u32 m0, s76, 91008
s_nop 0
buffer_load_dwordx4 v157, s[20:23], s74 offen offset:128 lds
v_and_b32 v2, 0x13, v4
v_bfe_u32 v5, v4, 2, 1
v_lshl_or_b32 v2, v5, 3, v2
v_bfe_u32 v5, v4, 3, 1
v_lshl_or_b32 v2, v5, 2, v2
s_and_b32 s92, s52, 1
s_lshl_b32 s92, s92, 5
s_waitcnt lgkmcnt(5)
v_mfma_f32_32x32x16_bf16 v[48:63], v[88:91], v[112:115], v[48:63]
s_add_u32 s72, s42, 3
s_cmp_ge_u32 s72, 10
s_cselect_b32 s73, 10, 0
s_sub_u32 s72, s72, s73
s_lshl_b32 s73, s72, 7
s_mul_i32 s74, s72, 221184
s_add_u32 s73, s73, s45
s_add_u32 s74, s74, s46
s_add_u32 m0, s75, 98304
ds_read_b64_tr_b16 v[104:105], v134 offset:6144
ds_read_b64_tr_b16 v[106:107], v134 offset:6656
buffer_load_dwordx4 v152, s[4:7], s73 offen lds
v_add_u32 v5, s92, v2
v_cvt_f32_u32 v5, v5
v_mul_f32 v5, 0x3a000000, v5
v_cvt_f32_u32_e64 v2, v2
v_mul_f32 v2, 0x3a000000, v2
s_waitcnt vmcnt(10)
s_barrier
s_waitcnt lgkmcnt(4)
s_nop 0
v_mfma_f32_32x32x16_bf16 v[16:31], v[96:99], v[116:119], v[16:31]
s_add_u32 s47, s47, 4096
ds_read_b128 v[112:115], v128 offset:32768
ds_read_b64_tr_b16 v[80:81], v132 offset:32768
ds_read_b64_tr_b16 v[82:83], v132 offset:33280
v_mfma_f32_16x16x32_bf16 v[120:123], v[96:99], v[124:127], v[120:123]
buffer_store_dwordx4 a[4:7], v252, s[8:11], s47 offen sc1
v_lshlrev_b32 v7, 3, v3
v_cvt_f32_u32 v232, v7
v_mul_f32 v232, v232, v5
s_waitcnt lgkmcnt(5)
v_mfma_f32_32x32x16_bf16 v[32:47], v[100:103], v[116:119], v[32:47]
s_add_u32 m0, s76, 114688
ds_read_b64_tr_b16 v[84:85], v133 offset:32768
ds_read_b64_tr_b16 v[86:87], v133 offset:33280
buffer_load_dwordx4 v156, s[20:23], s74 offen offset:0 lds
v_add_u32 v7, s92, v7
v_cvt_f32_u32 v233, v7
v_mul_f32 v233, v233, v2
s_waitcnt lgkmcnt(5)
v_mfma_f32_32x32x16_bf16 v[48:63], v[104:107], v[116:119], v[48:63]
s_add_u32 m0, s75, 99328
ds_read_b64_tr_b16 v[88:89], v134 offset:32768
ds_read_b64_tr_b16 v[90:91], v134 offset:33280
buffer_load_dwordx4 v153, s[4:7], s73 offen lds
s_lshr_b32 s93, s52, 1
s_lshl_b32 s93, s93, 8
s_or_b32 s93, s93, s39
s_cmp_eq_u32 s93, 0
s_cselect_b32 s94, 0.5, 1.0
s_cmp_eq_u32 s93, 160
s_cselect_b32 s94, 0.5, s94
v_fmamk_f32 v7, v5, 0x00000000, v232
v_fmamk_f32 v234, v2, 0x00000000, v233
v_cos_f32 v160, v7
v_sin_f32 v176, v7
v_cos_f32_e64 v192, v234
v_sin_f32 v208, v234
s_waitcnt lgkmcnt(4)
v_mfma_f32_32x32x16_bf16 v[16:31], v[80:83], v[112:115], v[16:31]
s_add_u32 s47, s47, 4096
ds_read_b128 v[116:119], v129 offset:32768
ds_read_b64_tr_b16 v[96:97], v132 offset:34816
ds_read_b64_tr_b16 v[98:99], v132 offset:35328
v_mfma_f32_16x16x32_bf16 v[120:123], v[80:83], v[124:127], v[120:123]
buffer_store_dwordx4 a[8:11], v252, s[8:11], s47 offen sc1
v_fmamk_f32 v7, v5, 0x3f800000, v232
v_fmamk_f32 v234, v2, 0x3f800000, v233
s_waitcnt lgkmcnt(5)
v_mfma_f32_32x32x16_bf16 v[32:47], v[84:87], v[112:115], v[32:47]
s_add_u32 m0, s76, 122752
ds_read_b64_tr_b16 v[100:101], v133 offset:34816
ds_read_b64_tr_b16 v[102:103], v133 offset:35328
buffer_load_dwordx4 v156, s[20:23], s74 offen offset:128 lds
v_cos_f32_e64 v161, v7
s_waitcnt lgkmcnt(5)
v_mfma_f32_32x32x16_bf16 v[48:63], v[88:91], v[112:115], v[48:63]
s_add_u32 m0, s75, 100352
ds_read_b64_tr_b16 v[104:105], v134 offset:34816
ds_read_b64_tr_b16 v[106:107], v134 offset:35328
buffer_load_dwordx4 v154, s[4:7], s73 offen lds
v_sin_f32 v177, v7
v_cos_f32 v193, v234
v_sin_f32_e64 v209, v234
v_fmamk_f32 v7, v5, 0x40000000, v232
v_fmamk_f32 v234, v2, 0x40000000, v233
v_cos_f32 v162, v7
s_waitcnt lgkmcnt(4)
v_mfma_f32_32x32x16_bf16 v[16:31], v[96:99], v[116:119], v[16:31]
s_add_u32 s47, s47, 4096
ds_read_b128 v[112:115], v130 offset:32768
ds_read_b64_tr_b16 v[80:81], v132 offset:36864
ds_read_b64_tr_b16 v[82:83], v132 offset:37376
v_mfma_f32_16x16x32_bf16 v[120:123], v[96:99], v[124:127], v[120:123]
buffer_store_dwordx4 a[12:15], v252, s[8:11], s47 offen sc1
v_sin_f32 v178, v7
s_waitcnt lgkmcnt(5)
v_mfma_f32_32x32x16_bf16 v[32:47], v[100:103], v[116:119], v[32:47]
s_add_u32 m0, s76, 115712
ds_read_b64_tr_b16 v[84:85], v133 offset:36864
ds_read_b64_tr_b16 v[86:87], v133 offset:37376
buffer_load_dwordx4 v157, s[20:23], s74 offen offset:0 lds
v_cos_f32 v194, v234
s_waitcnt lgkmcnt(5)
v_mfma_f32_32x32x16_bf16 v[48:63], v[104:107], v[116:119], v[48:63]
s_add_u32 m0, s75, 101376
ds_read_b64_tr_b16 v[88:89], v134 offset:36864
ds_read_b64_tr_b16 v[90:91], v134 offset:37376
buffer_load_dwordx4 v155, s[4:7], s73 offen lds
v_sin_f32_e64 v210, v234
v_fmamk_f32 v7, v5, 0x40400000, v232
v_fmamk_f32 v234, v2, 0x40400000, v233
v_cos_f32 v163, v7
v_sin_f32 v179, v7
v_cos_f32_e64 v195, v234
v_sin_f32 v211, v234
s_waitcnt lgkmcnt(4)
v_mfma_f32_32x32x16_bf16 v[16:31], v[80:83], v[112:115], v[16:31]
ds_read_b128 v[116:119], v131 offset:32768
ds_read_b64_tr_b16 v[96:97], v132 offset:38912
ds_read_b64_tr_b16 v[98:99], v132 offset:39424
v_mfma_f32_16x16x32_bf16 v[120:123], v[80:83], v[124:127], v[120:123]
v_fmamk_f32 v7, v5, 0x40800000, v232
v_fmamk_f32 v234, v2, 0x40800000, v233
v_cos_f32 v164, v7
s_waitcnt lgkmcnt(5)
v_mfma_f32_32x32x16_bf16 v[32:47], v[84:87], v[112:115], v[32:47]
s_add_u32 s47, s47, 4096
ds_read_b64_tr_b16 v[100:101], v133 offset:38912
ds_read_b64_tr_b16 v[102:103], v133 offset:39424
buffer_store_dwordx4 a[16:19], v252, s[8:11], s47 offen sc1
v_sin_f32 v180, v7
s_waitcnt lgkmcnt(5)
v_mfma_f32_32x32x16_bf16 v[48:63], v[88:91], v[112:115], v[48:63]
s_add_u32 m0, s76, 123776
ds_read_b64_tr_b16 v[104:105], v134 offset:38912
ds_read_b64_tr_b16 v[106:107], v134 offset:39424
buffer_load_dwordx4 v157, s[20:23], s74 offen offset:128 lds
v_cos_f32 v196, v234
v_sin_f32 v212, v234
v_fmamk_f32 v7, v5, 0x40a00000, v232
v_fmamk_f32 v234, v2, 0x40a00000, v233
s_waitcnt vmcnt(12)
s_barrier
s_waitcnt lgkmcnt(4)
v_mfma_f32_32x32x16_bf16 v[16:31], v[96:99], v[116:119], v[16:31]
ds_read_b128 v[112:115], v136 offset:0
ds_read_b64_tr_b16 v[80:81], v140 offset:0
ds_read_b64_tr_b16 v[82:83], v140 offset:512
v_mfma_f32_16x16x32_bf16 v[120:123], v[96:99], v[124:127], v[120:123]
s_cmp_lg_u32 s52, 0
s_cbranch_scc1 L_o627
s_mov_b64 exec, 0xff
s_add_u32 s47, s47, 4096
buffer_store_dwordx4 a[20:23], v252, s[8:11], s47 offen sc1
s_mov_b64 exec, -1
L_o627:
s_waitcnt lgkmcnt(5)
v_mfma_f32_32x32x16_bf16 v[32:47], v[100:103], v[116:119], v[32:47]
s_add_u32 s72, s42, 4
s_cmp_ge_u32 s72, 10
s_cselect_b32 s73, 10, 0
s_sub_u32 s72, s72, s73
s_lshl_b32 s73, s72, 7
s_mul_i32 s74, s72, 221184
s_add_u32 s73, s73, s45
s_add_u32 s74, s74, s46
s_add_u32 m0, s75, 0
ds_read_b64_tr_b16 v[84:85], v141 offset:0
ds_read_b64_tr_b16 v[86:87], v141 offset:512
buffer_load_dwordx4 v152, s[4:7], s73 offen lds
s_waitcnt lgkmcnt(5)
v_mfma_f32_32x32x16_bf16 v[48:63], v[104:107], v[116:119], v[48:63]
s_add_u32 m0, s76, 16384
ds_read_b64_tr_b16 v[88:89], v142 offset:0
ds_read_b64_tr_b16 v[90:91], v142 offset:512
buffer_load_dwordx4 v156, s[20:23], s74 offen offset:0 lds
v_cos_f32 v165, v7
v_sin_f32 v181, v7
v_cos_f32 v197, v234
v_sin_f32 v213, v234
v_fmamk_f32 v7, v5, 0x40c00000, v232
v_fmamk_f32 v234, v2, 0x40c00000, v233
v_cos_f32 v166, v7
v_sin_f32 v182, v7
v_cos_f32 v198, v234
s_waitcnt lgkmcnt(4)
v_mfma_f32_32x32x16_bf16 v[16:31], v[80:83], v[112:115], v[16:31]
ds_read_b128 v[116:119], v137 offset:0
ds_read_b64_tr_b16 v[96:97], v140 offset:2048
ds_read_b64_tr_b16 v[98:99], v140 offset:2560
v_mfma_f32_16x16x32_bf16 v[120:123], v[80:83], v[124:127], v[120:123]
v_sin_f32_e64 v214, v234
v_fmamk_f32 v7, v5, 0x40e00000, v232
v_fmamk_f32 v234, v2, 0x40e00000, v233
s_waitcnt lgkmcnt(5)
v_mfma_f32_32x32x16_bf16 v[32:47], v[84:87], v[112:115], v[32:47]
s_add_u32 m0, s75, 1024
ds_read_b64_tr_b16 v[100:101], v141 offset:2048
ds_read_b64_tr_b16 v[102:103], v141 offset:2560
buffer_load_dwordx4 v153, s[4:7], s73 offen lds
v_cos_f32_e64 v167, v7
s_waitcnt lgkmcnt(5)
v_mfma_f32_32x32x16_bf16 v[48:63], v[88:91], v[112:115], v[48:63]
s_add_u32 m0, s76, 24448
ds_read_b64_tr_b16 v[104:105], v142 offset:2048
ds_read_b64_tr_b16 v[106:107], v142 offset:2560
buffer_load_dwordx4 v156, s[20:23], s74 offen offset:128 lds
v_sin_f32 v183, v7
v_cos_f32 v199, v234
v_sin_f32_e64 v215, v234
v_fmamk_f32 v7, v5, 0x41800000, v232
v_fmamk_f32 v234, v2, 0x41800000, v233
s_waitcnt lgkmcnt(4)
v_mfma_f32_32x32x16_bf16 v[16:31], v[96:99], v[116:119], v[16:31]
ds_read_b128 v[112:115], v138 offset:0
ds_read_b64_tr_b16 v[80:81], v140 offset:4096
ds_read_b64_tr_b16 v[82:83], v140 offset:4608
v_mfma_f32_16x16x32_bf16 v[120:123], v[96:99], v[124:127], v[120:123]
v_cos_f32 v168, v7
v_sin_f32 v184, v7
s_waitcnt lgkmcnt(5)
v_mfma_f32_32x32x16_bf16 v[32:47], v[100:103], v[116:119], v[32:47]
s_add_u32 m0, s75, 2048
ds_read_b64_tr_b16 v[84:85], v141 offset:4096
ds_read_b64_tr_b16 v[86:87], v141 offset:4608
buffer_load_dwordx4 v154, s[4:7], s73 offen lds
v_cos_f32 v200, v234
s_waitcnt lgkmcnt(5)
v_mfma_f32_32x32x16_bf16 v[48:63], v[104:107], v[116:119], v[48:63]
s_add_u32 m0, s76, 17408
ds_read_b64_tr_b16 v[88:89], v142 offset:4096
ds_read_b64_tr_b16 v[90:91], v142 offset:4608
buffer_load_dwordx4 v157, s[20:23], s74 offen offset:0 lds
v_sin_f32_e64 v216, v234
v_fmamk_f32 v7, v5, 0x41880000, v232
v_fmamk_f32 v234, v2, 0x41880000, v233
v_cos_f32 v169, v7
v_sin_f32 v185, v7
v_cos_f32 v201, v234
s_waitcnt lgkmcnt(4)
v_mfma_f32_32x32x16_bf16 v[16:31], v[80:83], v[112:115], v[16:31]
ds_read_b128 v[116:119], v139 offset:0
ds_read_b64_tr_b16 v[96:97], v140 offset:6144
ds_read_b64_tr_b16 v[98:99], v140 offset:6656
v_mfma_f32_16x16x32_bf16 v[120:123], v[80:83], v[124:127], v[120:123]
v_sin_f32_e64 v217, v234
v_fmamk_f32 v7, v5, 0x41900000, v232
v_fmamk_f32 v234, v2, 0x41900000, v233
s_waitcnt lgkmcnt(5)
v_mfma_f32_32x32x16_bf16 v[32:47], v[84:87], v[112:115], v[32:47]
s_add_u32 m0, s75, 3072
ds_read_b64_tr_b16 v[100:101], v141 offset:6144
ds_read_b64_tr_b16 v[102:103], v141 offset:6656
buffer_load_dwordx4 v155, s[4:7], s73 offen lds
v_cos_f32_e64 v170, v7
s_waitcnt lgkmcnt(5)
v_mfma_f32_32x32x16_bf16 v[48:63], v[88:91], v[112:115], v[48:63]
s_add_u32 m0, s76, 25472
ds_read_b64_tr_b16 v[104:105], v142 offset:6144
ds_read_b64_tr_b16 v[106:107], v142 offset:6656
buffer_load_dwordx4 v157, s[20:23], s74 offen offset:128 lds
v_sin_f32 v186, v7
v_cos_f32 v202, v234
v_sin_f32_e64 v218, v234
v_fmamk_f32 v7, v5, 0x41980000, v232
v_fmamk_f32 v234, v2, 0x41980000, v233
s_waitcnt vmcnt(8)
s_waitcnt vmcnt(8)
s_barrier
s_waitcnt lgkmcnt(4)
v_mfma_f32_32x32x16_bf16 v[16:31], v[96:99], v[116:119], v[16:31]
ds_read_b128 v[112:115], v136 offset:32768
ds_read_b64_tr_b16 v[80:81], v140 offset:32768
ds_read_b64_tr_b16 v[82:83], v140 offset:33280
v_mfma_f32_16x16x32_bf16 v[120:123], v[96:99], v[124:127], v[120:123]
v_cos_f32 v171, v7
v_sin_f32 v187, v7
v_cos_f32 v203, v234
v_sin_f32 v219, v234
v_fmamk_f32 v7, v5, 0x41a00000, v232
v_fmamk_f32 v234, v2, 0x41a00000, v233
v_cos_f32 v172, v7
s_waitcnt lgkmcnt(5)
v_mfma_f32_32x32x16_bf16 v[32:47], v[100:103], v[116:119], v[32:47]
s_add_u32 s72, s42, 5
s_cmp_ge_u32 s72, 10
s_cselect_b32 s73, 10, 0
s_sub_u32 s72, s72, s73
s_lshl_b32 s73, s72, 7
s_mul_i32 s74, s72, 221184
s_add_u32 s73, s73, s45
s_add_u32 s74, s74, s46
s_add_u32 m0, s75, 32768
ds_read_b64_tr_b16 v[84:85], v141 offset:32768
ds_read_b64_tr_b16 v[86:87], v141 offset:33280
buffer_load_dwordx4 v152, s[4:7], s73 offen lds
v_sin_f32_e64 v188, v7
s_waitcnt lgkmcnt(5)
v_mfma_f32_32x32x16_bf16 v[48:63], v[104:107], v[116:119], v[48:63]
s_cmp_lg_u32 s52, 0
s_cbranch_scc1 L_fs30
s_mul_i32 s72, s53, 16
s_add_u32 s72, s72, 131072
v_mov_b32 v8, s56
v_mov_b32 v9, 0
s_mov_b64 exec, 1
buffer_store_dword v8, v9, s[8:11], s72 offen sc1
s_mov_b64 exec, -1
L_fs30:
s_add_u32 m0, s76, 49152
ds_read_b64_tr_b16 v[88:89], v142 offset:32768
ds_read_b64_tr_b16 v[90:91], v142 offset:33280
buffer_load_dwordx4 v156, s[20:23], s74 offen offset:0 lds
v_cos_f32_e64 v204, v234
s_waitcnt lgkmcnt(4)
v_mfma_f32_32x32x16_bf16 v[16:31], v[80:83], v[112:115], v[16:31]
ds_read_b128 v[116:119], v137 offset:32768
ds_read_b64_tr_b16 v[96:97], v140 offset:34816
ds_read_b64_tr_b16 v[98:99], v140 offset:35328
v_mfma_f32_16x16x32_bf16 v[120:123], v[80:83], v[124:127], v[120:123]
v_sin_f32_e64 v220, v234
v_fmamk_f32 v7, v5, 0x41a80000, v232
v_fmamk_f32 v234, v2, 0x41a80000, v233
s_waitcnt lgkmcnt(5)
v_mfma_f32_32x32x16_bf16 v[32:47], v[84:87], v[112:115], v[32:47]
s_add_u32 m0, s75, 33792
ds_read_b64_tr_b16 v[100:101], v141 offset:34816
ds_read_b64_tr_b16 v[102:103], v141 offset:35328
buffer_load_dwordx4 v153, s[4:7], s73 offen lds
v_cos_f32_e64 v173, v7
s_waitcnt lgkmcnt(5)
v_mfma_f32_32x32x16_bf16 v[48:63], v[88:91], v[112:115], v[48:63]
s_add_u32 m0, s76, 57216
ds_read_b64_tr_b16 v[104:105], v142 offset:34816
ds_read_b64_tr_b16 v[106:107], v142 offset:35328
buffer_load_dwordx4 v156, s[20:23], s74 offen offset:128 lds
v_sin_f32 v189, v7
v_cos_f32 v205, v234
v_sin_f32_e64 v221, v234
v_fmamk_f32 v7, v5, 0x41b00000, v232
v_fmamk_f32 v234, v2, 0x41b00000, v233
s_waitcnt lgkmcnt(4)
v_mfma_f32_32x32x16_bf16 v[16:31], v[96:99], v[116:119], v[16:31]
ds_read_b128 v[112:115], v138 offset:32768
ds_read_b64_tr_b16 v[80:81], v140 offset:36864
ds_read_b64_tr_b16 v[82:83], v140 offset:37376
v_mfma_f32_16x16x32_bf16 v[120:123], v[96:99], v[124:127], v[120:123]
v_cos_f32 v174, v7
v_sin_f32 v190, v7
s_waitcnt lgkmcnt(5)
v_mfma_f32_32x32x16_bf16 v[32:47], v[100:103], v[116:119], v[32:47]
s_add_u32 m0, s75, 34816
ds_read_b64_tr_b16 v[84:85], v141 offset:36864
ds_read_b64_tr_b16 v[86:87], v141 offset:37376
buffer_load_dwordx4 v154, s[4:7], s73 offen lds
v_cos_f32 v206, v234
s_waitcnt lgkmcnt(5)
v_mfma_f32_32x32x16_bf16 v[48:63], v[104:107], v[116:119], v[48:63]
s_add_u32 m0, s76, 50176
ds_read_b64_tr_b16 v[88:89], v142 offset:36864
ds_read_b64_tr_b16 v[90:91], v142 offset:37376
buffer_load_dwordx4 v157, s[20:23], s74 offen offset:0 lds
v_sin_f32_e64 v222, v234
v_fmamk_f32 v7, v5, 0x41b80000, v232
v_fmamk_f32 v234, v2, 0x41b80000, v233
v_cos_f32_e64 v175, v7
v_sin_f32 v191, v7
s_waitcnt lgkmcnt(4)
v_mfma_f32_32x32x16_bf16 v[16:31], v[80:83], v[112:115], v[16:31]
ds_read_b128 v[116:119], v139 offset:32768
ds_read_b64_tr_b16 v[96:97], v140 offset:38912
ds_read_b64_tr_b16 v[98:99], v140 offset:39424
v_mfma_f32_16x16x32_bf16 v[120:123], v[80:83], v[124:127], v[120:123]
v_cos_f32_e64 v207, v234
v_sin_f32 v223, v234
s_waitcnt lgkmcnt(5)
v_mfma_f32_32x32x16_bf16 v[32:47], v[84:87], v[112:115], v[32:47]
s_add_u32 m0, s75, 35840
ds_read_b64_tr_b16 v[100:101], v141 offset:38912
ds_read_b64_tr_b16 v[102:103], v141 offset:39424
buffer_load_dwordx4 v155, s[4:7], s73 offen lds
s_cmp_eq_u32 s94, 1.0
s_cbranch_scc1 L_tw229
v_mul_f32 v192, 0.5, v192
v_mul_f32 v193, 0.5, v193
v_mul_f32 v194, 0.5, v194
v_mul_f32 v195, 0.5, v195
v_mul_f32 v196, 0.5, v196
v_mul_f32 v197, 0.5, v197
v_mul_f32 v198, 0.5, v198
v_mul_f32 v199, 0.5, v199
v_mul_f32 v200, 0.5, v200
v_mul_f32 v201, 0.5, v201
v_mul_f32 v202, 0.5, v202
v_mul_f32 v203, 0.5, v203
v_mul_f32 v204, 0.5, v204
v_mul_f32 v205, 0.5, v205
v_mul_f32 v206, 0.5, v206
v_mul_f32 v207, 0.5, v207
v_mul_f32 v208, 0.5, v208
v_mul_f32 v209, 0.5, v209
v_mul_f32 v210, 0.5, v210
v_mul_f32 v211, 0.5, v211
v_mul_f32 v212, 0.5, v212
v_mul_f32 v213, 0.5, v213
v_mul_f32 v214, 0.5, v214
v_mul_f32 v215, 0.5, v215
v_mul_f32 v216, 0.5, v216
v_mul_f32 v217, 0.5, v217
v_mul_f32 v218, 0.5, v218
v_mul_f32 v219, 0.5, v219
v_mul_f32 v220, 0.5, v220
v_mul_f32 v221, 0.5, v221
v_mul_f32_e64 v222, 0.5, v222
v_mul_f32 v223, 0.5, v223
L_tw229:
s_waitcnt lgkmcnt(5)
v_mfma_f32_32x32x16_bf16 v[48:63], v[88:91], v[112:115], v[48:63]
s_add_u32 m0, s76, 58240
ds_read_b64_tr_b16 v[104:105], v142 offset:38912
ds_read_b64_tr_b16 v[106:107], v142 offset:39424
buffer_load_dwordx4 v157, s[20:23], s74 offen offset:128 lds
s_lshr_b32 s95, s52, 1
s_lshl_b32 s95, s95, 2
s_and_b32 s96, s52, 1
v_bfe_u32 v2, v1, 1, 3
v_xor_b32 v2, s95, v2
v_lshlrev_b32_e64 v5, 7, v4
v_add_u32 v5, 131072, v5
v_lshl_add_u32 v7, v2, 4, v5
v_lshl_add_u32 v7, v3, 12, v7
s_lshl_b32 s95, s96, 14
v_add_u32 v226, s95, v7
v_xor_b32_e64 v227, 16, v226
s_xor_b32 s95, s95, 16384
v_add_u32 v228, s95, v7
v_xor_b32 v229, 16, v228
v_xor_b32 v2, 2, v2
v_xor_b32 v2, v3, v2
v_lshl_add_u32 v230, v2, 4, v5
s_lshl_b32 s95, s96, 12
v_add_u32_e64 v230, s95, v230
s_waitcnt vmcnt(8)
s_barrier
s_waitcnt lgkmcnt(4)
v_mfma_f32_32x32x16_bf16 v[16:31], v[96:99], v[116:119], v[16:31]
ds_read_b128 v[112:115], v128 offset:0
ds_read_b64_tr_b16 v[80:81], v132 offset:0
ds_read_b64_tr_b16 v[82:83], v132 offset:512
v_mfma_f32_16x16x32_bf16 v[120:123], v[96:99], v[124:127], v[120:123]
v_and_b32_e64 v2, 0x13, v4
v_bfe_u32 v5, v4, 2, 1
v_lshl_or_b32 v2, v5, 3, v2
v_bfe_u32 v5, v4, 3, 1
s_waitcnt lgkmcnt(5)
v_mfma_f32_32x32x16_bf16 v[32:47], v[100:103], v[116:119], v[32:47]
s_add_u32 s72, s42, 6
s_cmp_ge_u32 s72, 10
s_cselect_b32 s73, 10, 0
s_sub_u32 s72, s72, s73
s_lshl_b32 s73, s72, 7
s_mul_i32 s74, s72, 221184
s_add_u32 s73, s73, s45
s_add_u32 s74, s74, s46
s_add_u32 m0, s75, 65536
ds_read_b64_tr_b16 v[84:85], v133 offset:0
ds_read_b64_tr_b16 v[86:87], v133 offset:512
buffer_load_dwordx4 v152, s[4:7], s73 offen lds
s_waitcnt lgkmcnt(5)
s_nop 0
v_mfma_f32_32x32x16_bf16 v[48:63], v[104:107], v[116:119], v[48:63]
s_add_u32 m0, s76, 81920
ds_read_b64_tr_b16 v[88:89], v134 offset:0
ds_read_b64_tr_b16 v[90:91], v134 offset:512
buffer_load_dwordx4 v156, s[20:23], s74 offen offset:0 lds
v_lshl_or_b32 v2, v5, 2, v2
s_and_b32 s92, s52, 1
s_lshl_b32 s92, s92, 5
v_add_u32 v2, s92, v2
v_cvt_f32_u32 v2, v2
v_mul_f32 v2, 0x3c800000, v2
v_lshl_add_u32 v5, v3, 3, s92
v_xor_b32 v7, 32, v5
v_cvt_f32_u32 v5, v5
v_cvt_f32_u32 v7, v7
v_mul_f32 v5, v5, v2
v_mul_f32_e64 v7, v7, v2
v_fmamk_f32 v232, v2, 0x00000000, v5
v_add_f32 v233, v232, v2
s_waitcnt lgkmcnt(4)
v_mfma_f32_32x32x16_bf16 v[16:31], v[80:83], v[112:115], v[16:31]
ds_read_b128 v[116:119], v129 offset:0
ds_read_b64_tr_b16 v[96:97], v132 offset:2048
ds_read_b64_tr_b16 v[98:99], v132 offset:2560
v_mfma_f32_16x16x32_bf16 v[120:123], v[80:83], v[124:127], v[120:123]
v_cos_f32_e64 v234, v232
v_cos_f32 v235, v233
s_waitcnt lgkmcnt(5)
v_mfma_f32_32x32x16_bf16 v[32:47], v[84:87], v[112:115], v[32:47]
s_add_u32 m0, s75, 66560
ds_read_b64_tr_b16 v[100:101], v133 offset:2048
ds_read_b64_tr_b16 v[102:103], v133 offset:2560
buffer_load_dwordx4 v153, s[4:7], s73 offen lds
v_sin_f32 v236, v232
s_waitcnt lgkmcnt(5)
v_mfma_f32_32x32x16_bf16 v[48:63], v[88:91], v[112:115], v[48:63]
s_add_u32 m0, s76, 89984
ds_read_b64_tr_b16 v[104:105], v134 offset:2048
ds_read_b64_tr_b16 v[106:107], v134 offset:2560
buffer_load_dwordx4 v156, s[20:23], s74 offen offset:128 lds
v_sin_f32_e64 v237, v233
v_cvt_pk_bf16_f32 v234, v234, v235
v_cvt_pk_bf16_f32 v238, -v236, -v237
v_cvt_pk_bf16_f32 v239, v236, v237
v_accvgpr_write_b32 a184, v234
v_accvgpr_write_b32 a200, v238
s_waitcnt lgkmcnt(4)
s_nop 0
v_mfma_f32_32x32x16_bf16 v[16:31], v[96:99], v[116:119], v[16:31]
ds_read_b128 v[112:115], v130 offset:0
ds_read_b64_tr_b16 v[80:81], v132 offset:4096
ds_read_b64_tr_b16 v[82:83], v132 offset:4608
v_mfma_f32_16x16x32_bf16 v[120:123], v[96:99], v[124:127], v[120:123]
v_accvgpr_write_b32 a216, v239
v_fmamk_f32 v232, v2, 0x40000000, v5
v_add_f32_e64 v233, v232, v2
v_cos_f32 v234, v232
s_waitcnt lgkmcnt(5)
v_mfma_f32_32x32x16_bf16 v[32:47], v[100:103], v[116:119], v[32:47]
s_add_u32 m0, s75, 67584
ds_read_b64_tr_b16 v[84:85], v133 offset:4096
ds_read_b64_tr_b16 v[86:87], v133 offset:4608
buffer_load_dwordx4 v154, s[4:7], s73 offen lds
v_cos_f32 v235, v233
s_waitcnt lgkmcnt(5)
v_mfma_f32_32x32x16_bf16 v[48:63], v[104:107], v[116:119], v[48:63]
s_add_u32 m0, s76, 82944
ds_read_b64_tr_b16 v[88:89], v134 offset:4096
ds_read_b64_tr_b16 v[90:91], v134 offset:4608
buffer_load_dwordx4 v157, s[20:23], s74 offen offset:0 lds
v_sin_f32 v236, v232
v_sin_f32 v237, v233
v_cvt_pk_bf16_f32 v234, v234, v235
v_cvt_pk_bf16_f32 v238, -v236, -v237
s_waitcnt lgkmcnt(4)
s_nop 0
v_mfma_f32_32x32x16_bf16 v[16:31], v[80:83], v[112:115], v[16:31]
ds_read_b128 v[116:119], v131 offset:0
ds_read_b64_tr_b16 v[96:97], v132 offset:6144
ds_read_b64_tr_b16 v[98:99], v132 offset:6656
v_mfma_f32_16x16x32_bf16 v[120:123], v[80:83], v[124:127], v[120:123]
v_cvt_pk_bf16_f32 v239, v236, v237
v_accvgpr_write_b32 a185, v234
v_accvgpr_write_b32 a201, v238
v_accvgpr_write_b32 a217, v239
s_waitcnt lgkmcnt(5)
s_nop 0
v_mfma_f32_32x32x16_bf16 v[32:47], v[84:87], v[112:115], v[32:47]
s_add_u32 m0, s75, 68608
ds_read_b64_tr_b16 v[100:101], v133 offset:6144
ds_read_b64_tr_b16 v[102:103], v133 offset:6656
buffer_load_dwordx4 v155, s[4:7], s73 offen lds
v_fmamk_f32 v232, v2, 0x40800000, v5
s_waitcnt lgkmcnt(5)
v_mfma_f32_32x32x16_bf16 v[48:63], v[88:91], v[112:115], v[48:63]
s_add_u32 m0, s76, 91008
ds_read_b64_tr_b16 v[104:105], v134 offset:6144
ds_read_b64_tr_b16 v[106:107], v134 offset:6656
buffer_load_dwordx4 v157, s[20:23], s74 offen offset:128 lds
v_add_f32 v233, v232, v2
v_cos_f32 v234, v232
v_cos_f32 v235, v233
v_sin_f32 v236, v232
s_waitcnt vmcnt(8)
s_barrier
s_waitcnt lgkmcnt(4)
v_mfma_f32_32x32x16_bf16 v[16:31], v[96:99], v[116:119], v[16:31]
ds_read_b128 v[112:115], v128 offset:32768
ds_read_b64_tr_b16 v[80:81], v132 offset:32768
ds_read_b64_tr_b16 v[82:83], v132 offset:33280
v_mfma_f32_16x16x32_bf16 v[120:123], v[96:99], v[124:127], v[120:123]
v_sin_f32_e64 v237, v233
v_cvt_pk_bf16_f32 v234, v234, v235
v_cvt_pk_bf16_f32 v238, -v236, -v237
s_waitcnt lgkmcnt(5)
v_mfma_f32_32x32x16_bf16 v[32:47], v[100:103], v[116:119], v[32:47]
s_add_u32 s72, s42, 7
s_cmp_ge_u32 s72, 10
s_cselect_b32 s73, 10, 0
s_sub_u32 s72, s72, s73
s_lshl_b32 s73, s72, 7
s_mul_i32 s74, s72, 221184
s_add_u32 s73, s73, s45
s_add_u32 s74, s74, s46
s_add_u32 m0, s75, 98304
ds_read_b64_tr_b16 v[84:85], v133 offset:32768
ds_read_b64_tr_b16 v[86:87], v133 offset:33280
buffer_load_dwordx4 v152, s[4:7], s73 offen lds
s_waitcnt lgkmcnt(5)
s_nop 0
v_mfma_f32_32x32x16_bf16 v[48:63], v[104:107], v[116:119], v[48:63]
s_add_u32 m0, s76, 114688
ds_read_b64_tr_b16 v[88:89], v134 offset:32768
ds_read_b64_tr_b16 v[90:91], v134 offset:33280
buffer_load_dwordx4 v156, s[20:23], s74 offen offset:0 lds
v_cvt_pk_bf16_f32 v239, v236, v237
v_accvgpr_write_b32 a186, v234
v_accvgpr_write_b32 a202, v238
v_accvgpr_write_b32 a218, v239
v_fmamk_f32 v232, v2, 0x40c00000, v5
s_waitcnt lgkmcnt(4)
v_mfma_f32_32x32x16_bf16 v[16:31], v[80:83], v[112:115], v[16:31]
ds_read_b128 v[116:119], v129 offset:32768
ds_read_b64_tr_b16 v[96:97], v132 offset:34816
ds_read_b64_tr_b16 v[98:99], v132 offset:35328
v_mfma_f32_16x16x32_bf16 v[120:123], v[80:83], v[124:127], v[120:123]
v_add_f32 v233, v232, v2
v_cos_f32_e64 v234, v232
v_cos_f32 v235, v233
s_waitcnt lgkmcnt(5)
v_mfma_f32_32x32x16_bf16 v[32:47], v[84:87], v[112:115], v[32:47]
s_add_u32 m0, s75, 99328
ds_read_b64_tr_b16 v[100:101], v133 offset:34816
ds_read_b64_tr_b16 v[102:103], v133 offset:35328
buffer_load_dwordx4 v153, s[4:7], s73 offen lds
v_sin_f32 v236, v232
s_waitcnt lgkmcnt(5)
v_mfma_f32_32x32x16_bf16 v[48:63], v[88:91], v[112:115], v[48:63]
s_add_u32 m0, s76, 122752
ds_read_b64_tr_b16 v[104:105], v134 offset:34816
ds_read_b64_tr_b16 v[106:107], v134 offset:35328
buffer_load_dwordx4 v156, s[20:23], s74 offen offset:128 lds
v_sin_f32_e64 v237, v233
v_cvt_pk_bf16_f32 v234, v234, v235
v_cvt_pk_bf16_f32 v238, -v236, -v237
v_cvt_pk_bf16_f32 v239, v236, v237
v_accvgpr_write_b32 a187, v234
s_waitcnt lgkmcnt(4)
s_nop 0
v_mfma_f32_32x32x16_bf16 v[16:31], v[96:99], v[116:119], v[16:31]
ds_read_b128 v[112:115], v130 offset:32768
ds_read_b64_tr_b16 v[80:81], v132 offset:36864
ds_read_b64_tr_b16 v[82:83], v132 offset:37376
v_mfma_f32_16x16x32_bf16 v[120:123], v[96:99], v[124:127], v[120:123]
v_accvgpr_write_b32 a203, v238
v_accvgpr_write_b32 a219, v239
v_fmamk_f32 v232, v2, 0x41800000, v5
v_add_f32 v233, v232, v2
s_waitcnt lgkmcnt(5)
v_mfma_f32_32x32x16_bf16 v[32:47], v[100:103], v[116:119], v[32:47]
s_add_u32 m0, s75, 100352
ds_read_b64_tr_b16 v[84:85], v133 offset:36864
ds_read_b64_tr_b16 v[86:87], v133 offset:37376
buffer_load_dwordx4 v154, s[4:7], s73 offen lds
v_cos_f32 v234, v232
s_waitcnt lgkmcnt(5)
v_mfma_f32_32x32x16_bf16 v[48:63], v[104:107], v[116:119], v[48:63]
s_add_u32 m0, s76, 115712
ds_read_b64_tr_b16 v[88:89], v134 offset:36864
ds_read_b64_tr_b16 v[90:91], v134 offset:37376
buffer_load_dwordx4 v157, s[20:23], s74 offen offset:0 lds
v_cos_f32 v235, v233
v_sin_f32 v236, v232
v_sin_f32_e64 v237, v233
v_cvt_pk_bf16_f32 v234, v234, v235
s_waitcnt lgkmcnt(4)
s_nop 0
v_mfma_f32_32x32x16_bf16 v[16:31], v[80:83], v[112:115], v[16:31]
ds_read_b128 v[116:119], v131 offset:32768
ds_read_b64_tr_b16 v[96:97], v132 offset:38912
ds_read_b64_tr_b16 v[98:99], v132 offset:39424
v_mfma_f32_16x16x32_bf16 v[120:123], v[80:83], v[124:127], v[120:123]
v_cvt_pk_bf16_f32 v238, -v236, -v237
v_cvt_pk_bf16_f32 v239, v236, v237
v_accvgpr_write_b32 a188, v234
v_accvgpr_write_b32 a204, v238
s_waitcnt lgkmcnt(5)
s_nop 0
v_mfma_f32_32x32x16_bf16 v[32:47], v[84:87], v[112:115], v[32:47]
s_add_u32 m0, s75, 101376
ds_read_b64_tr_b16 v[100:101], v133 offset:38912
ds_read_b64_tr_b16 v[102:103], v133 offset:39424
buffer_load_dwordx4 v155, s[4:7], s73 offen lds
v_accvgpr_write_b32 a220, v239
s_waitcnt lgkmcnt(5)
s_nop 0
v_mfma_f32_32x32x16_bf16 v[48:63], v[88:91], v[112:115], v[48:63]
s_add_u32 m0, s76, 123776
ds_read_b64_tr_b16 v[104:105], v134 offset:38912
ds_read_b64_tr_b16 v[106:107], v134 offset:39424
buffer_load_dwordx4 v157, s[20:23], s74 offen offset:128 lds
v_fmamk_f32 v232, v2, 0x41900000, v5
v_add_f32 v233, v232, v2
v_cos_f32 v234, v232
v_cos_f32 v235, v233
s_waitcnt vmcnt(8)
s_barrier
s_waitcnt lgkmcnt(4)
v_mfma_f32_32x32x16_bf16 v[16:31], v[96:99], v[116:119], v[16:31]
ds_read_b128 v[112:115], v136 offset:0
ds_read_b64_tr_b16 v[80:81], v140 offset:0
ds_read_b64_tr_b16 v[82:83], v140 offset:512
v_mfma_f32_16x16x32_bf16 v[120:123], v[96:99], v[124:127], v[120:123]
v_sin_f32_e64 v236, v232
v_sin_f32 v237, v233
s_waitcnt lgkmcnt(5)
v_mfma_f32_32x32x16_bf16 v[32:47], v[100:103], v[116:119], v[32:47]
s_add_u32 s72, s42, 8
s_cmp_ge_u32 s72, 10
s_cselect_b32 s73, 10, 0
s_sub_u32 s72, s72, s73
s_lshl_b32 s73, s72, 7
s_mul_i32 s74, s72, 221184
s_add_u32 s73, s73, s45
s_add_u32 s74, s74, s46
s_add_u32 m0, s75, 0
ds_read_b64_tr_b16 v[84:85], v141 offset:0
ds_read_b64_tr_b16 v[86:87], v141 offset:512
buffer_load_dwordx4 v152, s[4:7], s73 offen lds
s_waitcnt lgkmcnt(5)
s_nop 0
v_mfma_f32_32x32x16_bf16 v[48:63], v[104:107], v[116:119], v[48:63]
s_add_u32 m0, s76, 16384
ds_read_b64_tr_b16 v[88:89], v142 offset:0
ds_read_b64_tr_b16 v[90:91], v142 offset:512
buffer_load_dwordx4 v156, s[20:23], s74 offen offset:0 lds
v_cvt_pk_bf16_f32 v234, v234, v235
v_cvt_pk_bf16_f32 v238, -v236, -v237
v_cvt_pk_bf16_f32 v239, v236, v237
v_accvgpr_write_b32 a189, v234
v_accvgpr_write_b32 a205, v238
v_accvgpr_write_b32 a221, v239
v_fmamk_f32 v232, v2, 0x41a00000, v5
s_waitcnt lgkmcnt(4)
v_mfma_f32_32x32x16_bf16 v[16:31], v[80:83], v[112:115], v[16:31]
ds_read_b128 v[116:119], v137 offset:0
ds_read_b64_tr_b16 v[96:97], v140 offset:2048
ds_read_b64_tr_b16 v[98:99], v140 offset:2560
v_mfma_f32_16x16x32_bf16 v[120:123], v[80:83], v[124:127], v[120:123]
v_add_f32 v233, v232, v2
v_cos_f32_e64 v234, v232
v_cos_f32 v235, v233
s_waitcnt lgkmcnt(5)
v_mfma_f32_32x32x16_bf16 v[32:47], v[84:87], v[112:115], v[32:47]
s_add_u32 m0, s75, 1024
ds_read_b64_tr_b16 v[100:101], v141 offset:2048
ds_read_b64_tr_b16 v[102:103], v141 offset:2560
buffer_load_dwordx4 v153, s[4:7], s73 offen lds
v_sin_f32 v236, v232
s_waitcnt lgkmcnt(5)
v_mfma_f32_32x32x16_bf16 v[48:63], v[88:91], v[112:115], v[48:63]
s_add_u32 m0, s76, 24448
ds_read_b64_tr_b16 v[104:105], v142 offset:2048
ds_read_b64_tr_b16 v[106:107], v142 offset:2560
buffer_load_dwordx4 v156, s[20:23], s74 offen offset:128 lds
v_sin_f32_e64 v237, v233
v_cvt_pk_bf16_f32 v234, v234, v235
v_cvt_pk_bf16_f32 v238, -v236, -v237
v_cvt_pk_bf16_f32 v239, v236, v237
v_accvgpr_write_b32 a190, v234
s_waitcnt lgkmcnt(4)
s_nop 0
v_mfma_f32_32x32x16_bf16 v[16:31], v[96:99], v[116:119], v[16:31]
ds_read_b128 v[112:115], v138 offset:0
ds_read_b64_tr_b16 v[80:81], v140 offset:4096
ds_read_b64_tr_b16 v[82:83], v140 offset:4608
v_mfma_f32_16x16x32_bf16 v[120:123], v[96:99], v[124:127], v[120:123]
v_accvgpr_write_b32 a206, v238
v_accvgpr_write_b32 a222, v239
v_fmamk_f32 v232, v2, 0x41b00000, v5
v_add_f32 v233, v232, v2
s_waitcnt lgkmcnt(5)
v_mfma_f32_32x32x16_bf16 v[32:47], v[100:103], v[116:119], v[32:47]
s_add_u32 m0, s75, 2048
ds_read_b64_tr_b16 v[84:85], v141 offset:4096
ds_read_b64_tr_b16 v[86:87], v141 offset:4608
buffer_load_dwordx4 v154, s[4:7], s73 offen lds
v_cos_f32 v234, v232
s_waitcnt lgkmcnt(5)
v_mfma_f32_32x32x16_bf16 v[48:63], v[104:107], v[116:119], v[48:63]
s_add_u32 m0, s76, 17408
ds_read_b64_tr_b16 v[88:89], v142 offset:4096
ds_read_b64_tr_b16 v[90:91], v142 offset:4608
buffer_load_dwordx4 v157, s[20:23], s74 offen offset:0 lds
v_cos_f32 v235, v233
v_sin_f32 v236, v232
v_sin_f32_e64 v237, v233
v_cvt_pk_bf16_f32 v234, v234, v235
s_waitcnt lgkmcnt(4)
s_nop 0
v_mfma_f32_32x32x16_bf16 v[16:31], v[80:83], v[112:115], v[16:31]
ds_read_b128 v[116:119], v139 offset:0
ds_read_b64_tr_b16 v[96:97], v140 offset:6144
ds_read_b64_tr_b16 v[98:99], v140 offset:6656
v_mfma_f32_16x16x32_bf16 v[120:123], v[80:83], v[124:127], v[120:123]
v_cvt_pk_bf16_f32 v238, -v236, -v237
v_cvt_pk_bf16_f32 v239, v236, v237
v_accvgpr_write_b32 a191, v234
v_accvgpr_write_b32 a207, v238
s_waitcnt lgkmcnt(5)
s_nop 0
v_mfma_f32_32x32x16_bf16 v[32:47], v[84:87], v[112:115], v[32:47]
s_add_u32 m0, s75, 3072
ds_read_b64_tr_b16 v[100:101], v141 offset:6144
ds_read_b64_tr_b16 v[102:103], v141 offset:6656
buffer_load_dwordx4 v155, s[4:7], s73 offen lds
v_accvgpr_write_b32 a223, v239
s_waitcnt lgkmcnt(5)
s_nop 0
v_mfma_f32_32x32x16_bf16 v[48:63], v[88:91], v[112:115], v[48:63]
s_add_u32 m0, s76, 25472
ds_read_b64_tr_b16 v[104:105], v142 offset:6144
ds_read_b64_tr_b16 v[106:107], v142 offset:6656
buffer_load_dwordx4 v157, s[20:23], s74 offen offset:128 lds
v_fmamk_f32 v232, v2, 0x00000000, v7
v_add_f32_e64 v233, v232, v2
v_cos_f32 v234, v232
s_waitcnt vmcnt(8)
s_barrier
s_waitcnt lgkmcnt(4)
v_mfma_f32_32x32x16_bf16 v[16:31], v[96:99], v[116:119], v[16:31]
s_add_u32 s72, s42, 9
s_cmp_ge_u32 s72, 10
s_cselect_b32 s73, 10, 0
s_sub_u32 s72, s72, s73
s_lshl_b32 s73, s72, 7
s_mul_i32 s74, s72, 221184
s_add_u32 s73, s73, s45
s_add_u32 s74, s74, s46
s_nop 0
s_add_u32 m0, s75, 32768
ds_read_b128 v[112:115], v136 offset:32768
ds_read_b64_tr_b16 v[80:81], v140 offset:32768
ds_read_b64_tr_b16 v[82:83], v140 offset:33280
v_mfma_f32_16x16x32_bf16 v[120:123], v[96:99], v[124:127], v[120:123]
buffer_load_dwordx4 v152, s[4:7], s73 offen lds
s_waitcnt lgkmcnt(5)
v_mfma_f32_32x32x16_bf16 v[32:47], v[100:103], v[116:119], v[32:47]
s_add_u32 m0, s76, 49152
ds_read_b64_tr_b16 v[84:85], v141 offset:32768
ds_read_b64_tr_b16 v[86:87], v141 offset:33280
buffer_load_dwordx4 v156, s[20:23], s74 offen offset:0 lds
v_cos_f32_e64 v235, v233
s_waitcnt lgkmcnt(5)
v_mfma_f32_32x32x16_bf16 v[48:63], v[104:107], v[116:119], v[48:63]
s_add_u32 m0, s75, 33792
ds_read_b64_tr_b16 v[88:89], v142 offset:32768
ds_read_b64_tr_b16 v[90:91], v142 offset:33280
buffer_load_dwordx4 v153, s[4:7], s73 offen lds
v_sin_f32 v236, v232
v_sin_f32 v237, v233
v_cvt_pk_bf16_f32 v234, v234, v235
v_cvt_pk_bf16_f32 v238, -v236, -v237
v_cvt_pk_bf16_f32 v239, v236, v237
v_accvgpr_write_b32 a192, v234
v_accvgpr_write_b32 a208, v238
v_accvgpr_write_b32 a224, v239
s_waitcnt lgkmcnt(4)
s_nop 0
v_mfma_f32_32x32x16_bf16 v[16:31], v[80:83], v[112:115], v[16:31]
ds_read_b128 v[116:119], v137 offset:32768
ds_read_b64_tr_b16 v[96:97], v140 offset:34816
ds_read_b64_tr_b16 v[98:99], v140 offset:35328
v_mfma_f32_16x16x32_bf16 v[120:123], v[80:83], v[124:127], v[120:123]
v_fmamk_f32 v232, v2, 0x40000000, v7
v_add_f32_e64 v233, v232, v2
v_cos_f32 v234, v232
s_waitcnt lgkmcnt(5)
v_mfma_f32_32x32x16_bf16 v[32:47], v[84:87], v[112:115], v[32:47]
s_add_u32 m0, s76, 57216
ds_read_b64_tr_b16 v[100:101], v141 offset:34816
ds_read_b64_tr_b16 v[102:103], v141 offset:35328
buffer_load_dwordx4 v156, s[20:23], s74 offen offset:128 lds
v_cos_f32 v235, v233
s_waitcnt lgkmcnt(5)
v_mfma_f32_32x32x16_bf16 v[48:63], v[88:91], v[112:115], v[48:63]
s_add_u32 m0, s75, 34816
ds_read_b64_tr_b16 v[104:105], v142 offset:34816
ds_read_b64_tr_b16 v[106:107], v142 offset:35328
buffer_load_dwordx4 v154, s[4:7], s73 offen lds
v_sin_f32 v236, v232
v_sin_f32 v237, v233
v_cvt_pk_bf16_f32 v234, v234, v235
v_cvt_pk_bf16_f32 v238, -v236, -v237
v_cvt_pk_bf16_f32 v239, v236, v237
s_waitcnt lgkmcnt(4)
v_mfma_f32_32x32x16_bf16 v[16:31], v[96:99], v[116:119], v[16:31]
ds_read_b128 v[112:115], v138 offset:32768
ds_read_b64_tr_b16 v[80:81], v140 offset:36864
ds_read_b64_tr_b16 v[82:83], v140 offset:37376
v_mfma_f32_16x16x32_bf16 v[120:123], v[96:99], v[124:127], v[120:123]
s_cmp_lg_u32 s52, 0
s_cbranch_scc1 L_f1i28
v_mul_u32_u24 v8, 16, v1
v_add_u32 v8, 131072, v8
v_add_u32 v9, 1024, v8
v_add_u32 v10, 2048, v8
v_add_u32 v11, 3072, v8
buffer_load_dword v12, v8, s[8:11], 0 offen sc1
buffer_load_dword v13, v9, s[8:11], 0 offen sc1
buffer_load_dword v14, v10, s[8:11], 0 offen sc1
buffer_load_dword v15, v11, s[8:11], 0 offen sc1
L_f1i28:
s_waitcnt lgkmcnt(5)
s_nop 0
v_mfma_f32_32x32x16_bf16 v[32:47], v[100:103], v[116:119], v[32:47]
s_add_u32 m0, s76, 50176
ds_read_b64_tr_b16 v[84:85], v141 offset:36864
ds_read_b64_tr_b16 v[86:87], v141 offset:37376
buffer_load_dwordx4 v157, s[20:23], s74 offen offset:0 lds
v_accvgpr_write_b32 a193, v234
s_waitcnt lgkmcnt(5)
s_nop 0
v_mfma_f32_32x32x16_bf16 v[48:63], v[104:107], v[116:119], v[48:63]
s_add_u32 m0, s75, 35840
ds_read_b64_tr_b16 v[88:89], v142 offset:36864
ds_read_b64_tr_b16 v[90:91], v142 offset:37376
buffer_load_dwordx4 v155, s[4:7], s73 offen lds
v_accvgpr_write_b32 a209, v238
v_accvgpr_write_b32 a225, v239
v_fmamk_f32 v232, v2, 0x40800000, v7
v_add_f32 v233, v232, v2
v_cos_f32 v234, v232
v_cos_f32 v235, v233
v_sin_f32 v236, v232
v_sin_f32 v237, v233
s_waitcnt lgkmcnt(4)
v_mfma_f32_32x32x16_bf16 v[16:31], v[80:83], v[112:115], v[16:31]
ds_read_b128 v[116:119], v139 offset:32768
ds_read_b64_tr_b16 v[96:97], v140 offset:38912
ds_read_b64_tr_b16 v[98:99], v140 offset:39424
v_mfma_f32_16x16x32_bf16 v[120:123], v[80:83], v[124:127], v[120:123]
v_cvt_pk_bf16_f32 v234, v234, v235
v_cvt_pk_bf16_f32 v238, -v236, -v237
v_cvt_pk_bf16_f32 v239, v236, v237
v_accvgpr_write_b32 a194, v234
s_waitcnt lgkmcnt(5)
s_nop 0
v_mfma_f32_32x32x16_bf16 v[32:47], v[84:87], v[112:115], v[32:47]
s_add_u32 m0, s76, 58240
ds_read_b64_tr_b16 v[100:101], v141 offset:38912
ds_read_b64_tr_b16 v[102:103], v141 offset:39424
buffer_load_dwordx4 v157, s[20:23], s74 offen offset:128 lds
v_accvgpr_write_b32 a210, v238
v_accvgpr_write_b32 a226, v239
v_fmamk_f32 v232, v2, 0x40c00000, v7
v_add_f32_e64 v233, v232, v2
v_cos_f32 v234, v232
s_waitcnt lgkmcnt(5)
v_mfma_f32_32x32x16_bf16 v[48:63], v[88:91], v[112:115], v[48:63]
ds_read_b64_tr_b16 v[104:105], v142 offset:38912
ds_read_b64_tr_b16 v[106:107], v142 offset:39424
s_lshl_b32 s72, s36, 7
s_lshl_b32 s77, s52, 5
s_add_u32 s72, s72, s77
s_lshl_b32 s72, s72, 3
s_add_u32 s72, s72, 65536
v_lshlrev_b32 v231, 3, v4
v_add_u32 v231, s72, v231
buffer_load_dwordx2 v[158:159], v231, s[8:11], 0 offen sc1
s_waitcnt vmcnt(9)
s_cmp_lg_u32 s52, 0
s_cbranch_scc1 L_polld32
s_waitcnt vmcnt(4)
s_mov_b32 s79, 0
L_poll31:
v_cmp_ne_u32 vcc, s56, v12
v_cmp_ne_u32 s[62:63], s56, v13
s_nop 0
s_or_b64 vcc, vcc, s[62:63]
v_cmp_ne_u32 s[62:63], s56, v14
s_nop 0
s_or_b64 vcc, vcc, s[62:63]
v_cmp_ne_u32 s[62:63], s56, v15
s_nop 0
s_or_b64 vcc, vcc, s[62:63]
s_add_u32 s79, s79, 1
s_cmp_eq_u64 vcc, 0
s_cbranch_scc1 L_polld32
buffer_load_dword v12, v8, s[8:11], 0 offen sc1
buffer_load_dword v13, v9, s[8:11], 0 offen sc1
buffer_load_dword v14, v10, s[8:11], 0 offen sc1
buffer_load_dword v15, v11, s[8:11], 0 offen sc1
s_waitcnt vmcnt(0)
s_cmp_lt_u32 s79, 200000
s_cbranch_scc1 L_poll31
L_polld32:
s_barrier
s_waitcnt lgkmcnt(4)
v_mfma_f32_32x32x16_bf16 v[16:31], v[96:99], v[116:119], v[16:31]
ds_read_b128 v[112:115], v128 offset:0
ds_read_b64_tr_b16 v[80:81], v132 offset:0
ds_read_b64_tr_b16 v[82:83], v132 offset:512
v_mfma_f32_16x16x32_bf16 v[120:123], v[96:99], v[124:127], v[120:123]
v_cos_f32 v235, v233
v_sin_f32_e64 v236, v232
v_sin_f32 v237, v233
s_waitcnt lgkmcnt(5)
v_mfma_f32_32x32x16_bf16 v[32:47], v[100:103], v[116:119], v[32:47]
s_lshl_b32 s3, s52, 13
s_add_u32 m0, s3, 131072
s_mov_b32 s72, 0
ds_read_b64_tr_b16 v[84:85], v133 offset:0
ds_read_b64_tr_b16 v[86:87], v133 offset:512
buffer_load_dwordx4 v224, s[8:11], s72 offen sc1 lds
s_waitcnt lgkmcnt(5)
s_nop 0
v_mfma_f32_32x32x16_bf16 v[48:63], v[104:107], v[116:119], v[48:63]
s_add_u32 m0, s3, 132096
s_mov_b32 s72, 659456
ds_read_b64_tr_b16 v[88:89], v134 offset:0
ds_read_b64_tr_b16 v[90:91], v134 offset:512
buffer_load_dwordx4 v225, s[8:11], s72 offen sc1 lds
v_cvt_pk_bf16_f32 v234, v234, v235
v_cvt_pk_bf16_f32 v238, -v236, -v237
v_cvt_pk_bf16_f32 v239, v236, v237
v_accvgpr_write_b32 a195, v234
v_accvgpr_write_b32 a211, v238
v_accvgpr_write_b32 a227, v239
s_waitcnt lgkmcnt(4)
s_nop 0
v_mfma_f32_32x32x16_bf16 v[16:31], v[80:83], v[112:115], v[16:31]
ds_read_b128 v[116:119], v129 offset:0
ds_read_b64_tr_b16 v[96:97], v132 offset:2048
ds_read_b64_tr_b16 v[98:99], v132 offset:2560
v_mfma_f32_16x16x32_bf16 v[120:123], v[80:83], v[124:127], v[120:123]
v_fmamk_f32 v232, v2, 0x41800000, v7
v_add_f32 v233, v232, v2
v_cos_f32 v234, v232
v_cos_f32 v235, v233
s_waitcnt lgkmcnt(5)
v_mfma_f32_32x32x16_bf16 v[32:47], v[84:87], v[112:115], v[32:47]
s_add_u32 m0, s3, 133120
s_mov_b32 s72, 2637824
ds_read_b64_tr_b16 v[100:101], v133 offset:2048
ds_read_b64_tr_b16 v[102:103], v133 offset:2560
buffer_load_dwordx4 v224, s[8:11], s72 offen sc1 lds
v_sin_f32 v236, v232
s_waitcnt lgkmcnt(5)
v_mfma_f32_32x32x16_bf16 v[48:63], v[88:91], v[112:115], v[48:63]
s_add_u32 m0, s3, 134144
s_mov_b32 s72, 3297280
ds_read_b64_tr_b16 v[104:105], v134 offset:2048
ds_read_b64_tr_b16 v[106:107], v134 offset:2560
buffer_load_dwordx4 v225, s[8:11], s72 offen sc1 lds
v_sin_f32_e64 v237, v233
v_cvt_pk_bf16_f32 v234, v234, v235
v_cvt_pk_bf16_f32 v238, -v236, -v237
s_waitcnt lgkmcnt(4)
s_nop 0
v_mfma_f32_32x32x16_bf16 v[16:31], v[96:99], v[116:119], v[16:31]
ds_read_b128 v[112:115], v130 offset:0
ds_read_b64_tr_b16 v[80:81], v132 offset:4096
ds_read_b64_tr_b16 v[82:83], v132 offset:4608
v_mfma_f32_16x16x32_bf16 v[120:123], v[96:99], v[124:127], v[120:123]
v_cvt_pk_bf16_f32 v239, v236, v237
v_accvgpr_write_b32 a196, v234
v_accvgpr_write_b32 a212, v238
v_accvgpr_write_b32 a228, v239
v_fmamk_f32 v232, v2, 0x41900000, v7
s_waitcnt lgkmcnt(5)
s_nop 0
v_mfma_f32_32x32x16_bf16 v[32:47], v[100:103], v[116:119], v[32:47]
s_add_u32 m0, s3, 135168
s_mov_b32 s72, 20608
ds_read_b64_tr_b16 v[84:85], v133 offset:4096
ds_read_b64_tr_b16 v[86:87], v133 offset:4608
buffer_load_dwordx4 v224, s[8:11], s72 offen sc1 lds
v_add_f32 v233, v232, v2
s_waitcnt lgkmcnt(5)
v_mfma_f32_32x32x16_bf16 v[48:63], v[104:107], v[116:119], v[48:63]
s_add_u32 m0, s3, 136192
s_mov_b32 s72, 680064
ds_read_b64_tr_b16 v[88:89], v134 offset:4096
ds_read_b64_tr_b16 v[90:91], v134 offset:4608
buffer_load_dwordx4 v225, s[8:11], s72 offen sc1 lds
v_cos_f32 v234, v232
v_cos_f32 v235, v233
v_sin_f32 v236, v232
s_waitcnt lgkmcnt(4)
v_mfma_f32_32x32x16_bf16 v[16:31], v[80:83], v[112:115], v[16:31]
ds_read_b128 v[116:119], v131 offset:0
ds_read_b64_tr_b16 v[96:97], v132 offset:6144
ds_read_b64_tr_b16 v[98:99], v132 offset:6656
v_mfma_f32_16x16x32_bf16 v[120:123], v[80:83], v[124:127], v[120:123]
v_sin_f32_e64 v237, v233
v_cvt_pk_bf16_f32 v234, v234, v235
v_cvt_pk_bf16_f32 v238, -v236, -v237
v_cvt_pk_bf16_f32 v239, v236, v237
s_waitcnt lgkmcnt(5)
s_nop 0
v_mfma_f32_32x32x16_bf16 v[32:47], v[84:87], v[112:115], v[32:47]
s_add_u32 m0, s3, 137216
s_mov_b32 s72, 2658432
ds_read_b64_tr_b16 v[100:101], v133 offset:6144
ds_read_b64_tr_b16 v[102:103], v133 offset:6656
buffer_load_dwordx4 v224, s[8:11], s72 offen sc1 lds
v_accvgpr_write_b32 a197, v234
s_waitcnt lgkmcnt(5)
s_nop 0
v_mfma_f32_32x32x16_bf16 v[48:63], v[88:91], v[112:115], v[48:63]
s_add_u32 m0, s3, 138240
s_mov_b32 s72, 3317888
ds_read_b64_tr_b16 v[104:105], v134 offset:6144
ds_read_b64_tr_b16 v[106:107], v134 offset:6656
buffer_load_dwordx4 v225, s[8:11], s72 offen sc1 lds
v_accvgpr_write_b32 a213, v238
v_accvgpr_write_b32 a229, v239
v_fmamk_f32 v232, v2, 0x41a00000, v7
v_add_f32 v233, v232, v2
s_waitcnt vmcnt(9)
s_barrier
s_waitcnt lgkmcnt(4)
v_mfma_f32_32x32x16_bf16 v[16:31], v[96:99], v[116:119], v[16:31]
ds_read_b128 v[112:115], v128 offset:32768
ds_read_b64_tr_b16 v[80:81], v132 offset:32768
ds_read_b64_tr_b16 v[82:83], v132 offset:33280
v_mfma_f32_16x16x32_bf16 v[120:123], v[96:99], v[124:127], v[120:123]
v_cos_f32_e64 v234, v232
v_cos_f32 v235, v233
s_waitcnt lgkmcnt(5)
v_mfma_f32_32x32x16_bf16 v[32:47], v[100:103], v[116:119], v[32:47]
s_mul_i32 s77, s12, 5
ds_read_b64_tr_b16 v[84:85], v133 offset:32768
ds_read_b64_tr_b16 v[86:87], v133 offset:33280
buffer_load_dwordx4 a[0:3], v246, s[8:11], s77 offen offset:0 sc1
s_waitcnt lgkmcnt(5)
v_mfma_f32_32x32x16_bf16 v[48:63], v[104:107], v[116:119], v[48:63]
ds_read_b64_tr_b16 v[88:89], v134 offset:32768
ds_read_b64_tr_b16 v[90:91], v134 offset:33280
buffer_load_dwordx4 a[4:7], v246, s[8:11], s77 offen offset:1024 sc1
v_sin_f32 v236, v232
v_sin_f32 v237, v233
v_cvt_pk_bf16_f32 v234, v234, v235
v_cvt_pk_bf16_f32 v238, -v236, -v237
v_cvt_pk_bf16_f32 v239, v236, v237
v_accvgpr_write_b32 a198, v234
v_accvgpr_write_b32 a214, v238
s_waitcnt lgkmcnt(4)
s_nop 0
v_mfma_f32_32x32x16_bf16 v[16:31], v[80:83], v[112:115], v[16:31]
ds_read_b128 v[116:119], v129 offset:32768
ds_read_b64_tr_b16 v[96:97], v132 offset:34816
ds_read_b64_tr_b16 v[98:99], v132 offset:35328
v_mfma_f32_16x16x32_bf16 v[120:123], v[80:83], v[124:127], v[120:123]
v_accvgpr_write_b32 a230, v239
v_fmamk_f32 v232, v2, 0x41b00000, v7
v_add_f32 v233, v232, v2
s_waitcnt lgkmcnt(5)
v_mfma_f32_32x32x16_bf16 v[32:47], v[84:87], v[112:115], v[32:47]
ds_read_b64_tr_b16 v[100:101], v133 offset:34816
ds_read_b64_tr_b16 v[102:103], v133 offset:35328
buffer_load_dwordx4 a[8:11], v246, s[8:11], s77 offen offset:2048 sc1
v_cos_f32 v234, v232
s_waitcnt lgkmcnt(5)
v_mfma_f32_32x32x16_bf16 v[48:63], v[88:91], v[112:115], v[48:63]
ds_read_b64_tr_b16 v[104:105], v134 offset:34816
ds_read_b64_tr_b16 v[106:107], v134 offset:35328
buffer_load_dwordx4 a[12:15], v246, s[8:11], s77 offen offset:3072 sc1
v_cos_f32 v235, v233
v_sin_f32 v236, v232
v_sin_f32_e64 v237, v233
v_cvt_pk_bf16_f32 v234, v234, v235
v_cvt_pk_bf16_f32 v238, -v236, -v237
s_waitcnt lgkmcnt(4)
s_nop 0
v_mfma_f32_32x32x16_bf16 v[16:31], v[96:99], v[116:119], v[16:31]
ds_read_b128 v[112:115], v130 offset:32768
ds_read_b64_tr_b16 v[80:81], v132 offset:36864
ds_read_b64_tr_b16 v[82:83], v132 offset:37376
v_mfma_f32_16x16x32_bf16 v[120:123], v[96:99], v[124:127], v[120:123]
v_cvt_pk_bf16_f32 v239, v236, v237
v_accvgpr_write_b32 a199, v234
v_accvgpr_write_b32 a215, v238
s_waitcnt lgkmcnt(5)
v_mfma_f32_32x32x16_bf16 v[32:47], v[100:103], v[116:119], v[32:47]
ds_read_b64_tr_b16 v[84:85], v133 offset:36864
ds_read_b64_tr_b16 v[86:87], v133 offset:37376
buffer_load_dwordx4 a[16:19], v247, s[8:11], s77 offen offset:0 sc1
v_accvgpr_write_b32 a231, v239
s_lshl_b32 s92, s52, 7
s_add_u32 s92, s92, 65536
s_waitcnt lgkmcnt(5)
v_mfma_f32_32x32x16_bf16 v[48:63], v[104:107], v[116:119], v[48:63]
s_mul_i32 s77, s13, 5
ds_read_b64_tr_b16 v[88:89], v134 offset:36864
ds_read_b64_tr_b16 v[90:91], v134 offset:37376
buffer_load_dwordx4 a[20:23], v246, s[8:11], s77 offen offset:0 sc1
v_lshrrev_b32 v2, 4, v1
v_lshlrev_b32 v2, 4, v2
v_and_b32_e64 v5, 1, v1
v_lshl_or_b32 v2, v5, 6, v2
v_add_u32_e64 v2, s92, v2
s_mul_i32 s92, s52, 110592
s_add_u32 s92, s92, s50
v_bfe_u32 v7, v1, 4, 1
v_mul_u32_u24 v7, 55296, v7
v_and_b32 v5, 15, v1
v_lshl_add_u32 v7, v5, 4, v7
v_lshl_add_u32 v7, v3, 8, v7
v_lshlrev_b32_e64 v5, 4, v3
v_add_u32 v5, 65536, v5
s_waitcnt lgkmcnt(4)
v_mfma_f32_32x32x16_bf16 v[16:31], v[80:83], v[112:115], v[16:31]
ds_read_b128 v[116:119], v131 offset:32768
ds_read_b64_tr_b16 v[96:97], v132 offset:38912
ds_read_b64_tr_b16 v[98:99], v132 offset:39424
v_mfma_f32_16x16x32_bf16 v[120:123], v[80:83], v[124:127], v[120:123]
s_add_u32 s94, s52, 0
s_cmp_ge_u32 s94, 3
s_cselect_b32 s95, 3, 0
s_sub_u32 s94, s94, s95
s_waitcnt lgkmcnt(5)
v_mfma_f32_32x32x16_bf16 v[32:47], v[84:87], v[112:115], v[32:47]
ds_read_b64_tr_b16 v[100:101], v133 offset:38912
ds_read_b64_tr_b16 v[102:103], v133 offset:39424
buffer_load_dwordx4 a[24:27], v246, s[8:11], s77 offen offset:1024 sc1
s_cmp_ge_u32 s94, 3
s_cselect_b32 s95, 3, 0
s_sub_u32 s94, s94, s95
s_waitcnt lgkmcnt(5)
v_mfma_f32_32x32x16_bf16 v[48:63], v[88:91], v[112:115], v[48:63]
ds_read_b64_tr_b16 v[104:105], v134 offset:38912
ds_read_b64_tr_b16 v[106:107], v134 offset:39424
buffer_load_dwordx4 a[28:31], v246, s[8:11], s77 offen offset:2048 sc1
s_lshl_b32 s64, s94, 7
s_lshl_b32 s94, s94, 10
s_add_u32 s68, s94, s92
s_add_u32 s94, s52, 1
s_cmp_ge_u32 s94, 3
s_cselect_b32 s95, 3, 0
s_sub_u32 s94, s94, s95
s_cmp_ge_u32 s94, 3
s_cselect_b32 s95, 3, 0
s_sub_u32 s94, s94, s95
s_lshl_b32 s65, s94, 7
s_lshl_b32 s94, s94, 10
s_add_u32 s69, s94, s92
s_add_u32 s94, s52, 2
s_cmp_ge_u32 s94, 3
s_cselect_b32 s95, 3, 0
s_sub_u32 s94, s94, s95
s_cmp_ge_u32 s94, 3
s_cselect_b32 s95, 3, 0
s_sub_u32 s94, s94, s95
s_lshl_b32 s66, s94, 7
s_lshl_b32 s94, s94, 10
s_add_u32 s70, s94, s92
s_waitcnt lgkmcnt(4)
v_mfma_f32_32x32x16_bf16 v[16:31], v[96:99], v[116:119], v[16:31]
v_mfma_f32_16x16x32_bf16 v[120:123], v[96:99], v[124:127], v[120:123]
s_waitcnt lgkmcnt(2)
v_mfma_f32_32x32x16_bf16 v[32:47], v[100:103], v[116:119], v[32:47]
buffer_load_dwordx4 a[32:35], v246, s[8:11], s77 offen offset:3072 sc1
s_waitcnt lgkmcnt(0)
v_mfma_f32_32x32x16_bf16 v[48:63], v[104:107], v[116:119], v[48:63]
buffer_load_dwordx4 a[36:39], v247, s[8:11], s77 offen offset:0 sc1
s_mov_b32 exec_lo, 0x00030003
s_mov_b32 exec_hi, 0x00030003
ds_write_b128 v2, v[120:123]
s_mov_b64 exec, -1
v_add_u32 v9, s64, v5
v_add_u32 v10, s65, v5
v_add_u32 v11, s66, v5
s_waitcnt vmcnt(18)
s_mov_b32 s79, 0
L_st33:
v_cmp_ne_u32 vcc, s56, v159
s_add_u32 s79, s79, 1
s_cmp_eq_u64 vcc, 0
s_cbranch_scc1 L_std34
buffer_load_dwordx2 v[158:159], v231, s[8:11], 0 offen sc1
s_waitcnt vmcnt(0)
s_cmp_lt_u32 s79, 200000
s_cbranch_scc1 L_st33
L_std34:
v_lshlrev_b32_e64 v158, 16, v158
s_waitcnt lgkmcnt(0)
s_barrier
ds_read_b128 v[112:115], v9 offset:0
ds_read_b128 v[116:119], v9 offset:32
ds_read_b128 v[120:123], v9 offset:64
ds_read_b128 v[124:127], v9 offset:96
ds_read_b128 v[128:131], v10 offset:0
ds_read_b128 v[132:135], v10 offset:32
ds_read_b128 v[136:139], v10 offset:64
ds_read_b128 v[140:143], v10 offset:96
s_waitcnt lgkmcnt(6)
s_nop 0
v_pk_fma_f32 v[16:17], v[158:159], v[112:113], v[16:17] op_sel_hi:[0,1,1] neg_lo:[1,0,0] neg_hi:[1,0,0]
v_pk_fma_f32 v[18:19], v[158:159], v[114:115], v[18:19] op_sel_hi:[0,1,1] neg_lo:[1,0,0] neg_hi:[1,0,0]
v_pk_fma_f32 v[20:21], v[158:159], v[116:117], v[20:21] op_sel_hi:[0,1,1] neg_lo:[1,0,0] neg_hi:[1,0,0]
v_pk_fma_f32 v[22:23], v[158:159], v[118:119], v[22:23] op_sel_hi:[0,1,1] neg_lo:[1,0,0] neg_hi:[1,0,0]
v_cvt_pk_bf16_f32 v80, v16, v17
v_cvt_pk_bf16_f32 v81, v18, v19
v_cvt_pk_bf16_f32 v82, v20, v21
v_cvt_pk_bf16_f32 v83, v22, v23
v_pk_max_i16 v80, v80, 0
v_pk_max_i16 v81, v81, 0
v_pk_max_i16 v82, v82, 0
v_pk_max_i16 v83, v83, 0
buffer_store_dwordx4 v[80:83], v7, s[8:11], s68 offen offset:0 sc1
s_waitcnt lgkmcnt(4)
s_nop 0
v_pk_fma_f32 v[24:25], v[158:159], v[120:121], v[24:25] op_sel_hi:[0,1,1] neg_lo:[1,0,0] neg_hi:[1,0,0]
v_pk_fma_f32 v[26:27], v[158:159], v[122:123], v[26:27] op_sel_hi:[0,1,1] neg_lo:[1,0,0] neg_hi:[1,0,0]
v_pk_fma_f32 v[28:29], v[158:159], v[124:125], v[28:29] op_sel_hi:[0,1,1] neg_lo:[1,0,0] neg_hi:[1,0,0]
v_pk_fma_f32 v[30:31], v[158:159], v[126:127], v[30:31] op_sel_hi:[0,1,1] neg_lo:[1,0,0] neg_hi:[1,0,0]
v_cvt_pk_bf16_f32 v84, v24, v25
v_cvt_pk_bf16_f32 v85, v26, v27
v_cvt_pk_bf16_f32 v86, v28, v29
v_cvt_pk_bf16_f32 v87, v30, v31
v_pk_max_i16 v84, v84, 0
v_pk_max_i16 v85, v85, 0
v_pk_max_i16 v86, v86, 0
v_pk_max_i16 v87, v87, 0
buffer_store_dwordx4 v[84:87], v7, s[8:11], s68 offen offset:512 sc1
ds_read_b128 v[112:115], v11 offset:0
ds_read_b128 v[116:119], v11 offset:32
ds_read_b128 v[120:123], v11 offset:64
ds_read_b128 v[124:127], v11 offset:96
s_waitcnt lgkmcnt(6)
s_nop 0
v_pk_fma_f32 v[32:33], v[158:159], v[128:129], v[32:33] op_sel_hi:[0,1,1] neg_lo:[1,0,0] neg_hi:[1,0,0]
v_pk_fma_f32 v[34:35], v[158:159], v[130:131], v[34:35] op_sel_hi:[0,1,1] neg_lo:[1,0,0] neg_hi:[1,0,0]
v_pk_fma_f32 v[36:37], v[158:159], v[132:133], v[36:37] op_sel_hi:[0,1,1] neg_lo:[1,0,0] neg_hi:[1,0,0]
v_pk_fma_f32 v[38:39], v[158:159], v[134:135], v[38:39] op_sel_hi:[0,1,1] neg_lo:[1,0,0] neg_hi:[1,0,0]
v_cvt_pk_bf16_f32 v88, v32, v33
v_cvt_pk_bf16_f32 v89, v34, v35
v_cvt_pk_bf16_f32 v90, v36, v37
v_cvt_pk_bf16_f32 v91, v38, v39
v_pk_max_i16 v88, v88, 0
v_pk_max_i16 v89, v89, 0
v_pk_max_i16 v90, v90, 0
v_pk_max_i16 v91, v91, 0
buffer_store_dwordx4 v[88:91], v7, s[8:11], s69 offen offset:0 sc1
s_waitcnt lgkmcnt(4)
s_nop 0
v_pk_fma_f32 v[40:41], v[158:159], v[136:137], v[40:41] op_sel_hi:[0,1,1] neg_lo:[1,0,0] neg_hi:[1,0,0]
v_pk_fma_f32 v[42:43], v[158:159], v[138:139], v[42:43] op_sel_hi:[0,1,1] neg_lo:[1,0,0] neg_hi:[1,0,0]
v_pk_fma_f32 v[44:45], v[158:159], v[140:141], v[44:45] op_sel_hi:[0,1,1] neg_lo:[1,0,0] neg_hi:[1,0,0]
v_pk_fma_f32 v[46:47], v[158:159], v[142:143], v[46:47] op_sel_hi:[0,1,1] neg_lo:[1,0,0] neg_hi:[1,0,0]
v_cvt_pk_bf16_f32 v92, v40, v41
v_cvt_pk_bf16_f32 v93, v42, v43
v_cvt_pk_bf16_f32 v94, v44, v45
v_cvt_pk_bf16_f32 v95, v46, v47
v_pk_max_i16 v92, v92, 0
v_pk_max_i16 v93, v93, 0
v_pk_max_i16 v94, v94, 0
v_pk_max_i16 v95, v95, 0
buffer_store_dwordx4 v[92:95], v7, s[8:11], s69 offen offset:512 sc1
s_waitcnt lgkmcnt(2)
s_nop 0
v_pk_fma_f32 v[48:49], v[158:159], v[112:113], v[48:49] op_sel_hi:[0,1,1] neg_lo:[1,0,0] neg_hi:[1,0,0]
v_pk_fma_f32 v[50:51], v[158:159], v[114:115], v[50:51] op_sel_hi:[0,1,1] neg_lo:[1,0,0] neg_hi:[1,0,0]
v_pk_fma_f32 v[52:53], v[158:159], v[116:117], v[52:53] op_sel_hi:[0,1,1] neg_lo:[1,0,0] neg_hi:[1,0,0]
v_pk_fma_f32 v[54:55], v[158:159], v[118:119], v[54:55] op_sel_hi:[0,1,1] neg_lo:[1,0,0] neg_hi:[1,0,0]
v_cvt_pk_bf16_f32 v96, v48, v49
v_cvt_pk_bf16_f32 v97, v50, v51
v_cvt_pk_bf16_f32 v98, v52, v53
v_cvt_pk_bf16_f32 v99, v54, v55
v_pk_max_i16 v96, v96, 0
v_pk_max_i16 v97, v97, 0
v_pk_max_i16 v98, v98, 0
v_pk_max_i16 v99, v99, 0
buffer_store_dwordx4 v[96:99], v7, s[8:11], s70 offen offset:0 sc1
s_waitcnt lgkmcnt(0)
s_nop 0
v_pk_fma_f32 v[56:57], v[158:159], v[120:121], v[56:57] op_sel_hi:[0,1,1] neg_lo:[1,0,0] neg_hi:[1,0,0]
v_pk_fma_f32 v[58:59], v[158:159], v[122:123], v[58:59] op_sel_hi:[0,1,1] neg_lo:[1,0,0] neg_hi:[1,0,0]
v_pk_fma_f32 v[60:61], v[158:159], v[124:125], v[60:61] op_sel_hi:[0,1,1] neg_lo:[1,0,0] neg_hi:[1,0,0]
v_pk_fma_f32 v[62:63], v[158:159], v[126:127], v[62:63] op_sel_hi:[0,1,1] neg_lo:[1,0,0] neg_hi:[1,0,0]
v_cvt_pk_bf16_f32 v100, v56, v57
v_cvt_pk_bf16_f32 v101, v58, v59
v_cvt_pk_bf16_f32 v102, v60, v61
v_cvt_pk_bf16_f32 v103, v62, v63
v_pk_max_i16 v100, v100, 0
v_pk_max_i16 v101, v101, 0
v_pk_max_i16 v102, v102, 0
v_pk_max_i16 v103, v103, 0
buffer_store_dwordx4 v[100:103], v7, s[8:11], s70 offen offset:512 sc1
s_waitcnt vmcnt(16)
s_barrier
ds_read_b128 v[16:19], v226 offset:0
ds_read_b128 v[32:35], v227 offset:0
ds_read_b128 v[20:23], v226 offset:8192
ds_read_b128 v[36:39], v227 offset:8192
ds_read_b128 v[24:27], v228 offset:0
ds_read_b128 v[40:43], v229 offset:0
ds_read_b128 v[28:31], v228 offset:8192
ds_read_b128 v[44:47], v229 offset:8192
s_waitcnt lgkmcnt(7)
v_mfma_f32_32x32x16_bf16 v[48:63], v[16:19], a[184:187], 0
s_mul_i32 s77, s14, 5
buffer_load_dwordx4 a[40:43], v246, s[8:11], s77 offen offset:0 sc1
v_mfma_f32_32x32x16_bf16 v[64:79], v[16:19], a[200:203], 0
s_waitcnt lgkmcnt(6)
v_mfma_f32_32x32x16_bf16 v[48:63], v[32:35], a[216:219], v[48:63]
v_mfma_f32_32x32x16_bf16 v[64:79], v[32:35], a[184:187], v[64:79]
s_waitcnt lgkmcnt(5)
v_mfma_f32_32x32x16_bf16 v[48:63], v[20:23], a[188:191], v[48:63]
buffer_load_dwordx4 a[44:47], v246, s[8:11], s77 offen offset:1024 sc1
v_mfma_f32_32x32x16_bf16 v[64:79], v[20:23], a[204:207], v[64:79]
s_waitcnt lgkmcnt(4)
v_mfma_f32_32x32x16_bf16 v[48:63], v[36:39], a[220:223], v[48:63]
v_mfma_f32_32x32x16_bf16 v[64:79], v[36:39], a[188:191], v[64:79]
buffer_load_dwordx4 a[48:51], v246, s[8:11], s77 offen offset:2048 sc1
s_waitcnt lgkmcnt(3)
v_mfma_f32_32x32x16_bf16 v[48:63], v[24:27], a[192:195], v[48:63]
v_mfma_f32_32x32x16_bf16 v[64:79], v[24:27], a[208:211], v[64:79]
s_waitcnt lgkmcnt(2)
v_mfma_f32_32x32x16_bf16 v[48:63], v[40:43], a[224:227], v[48:63]
v_mfma_f32_32x32x16_bf16 v[64:79], v[40:43], a[192:195], v[64:79]
buffer_load_dwordx4 a[52:55], v246, s[8:11], s77 offen offset:3072 sc1
s_waitcnt lgkmcnt(1)
v_mfma_f32_32x32x16_bf16 v[48:63], v[28:31], a[196:199], v[48:63]
v_mfma_f32_32x32x16_bf16 v[64:79], v[28:31], a[212:215], v[64:79]
s_waitcnt lgkmcnt(0)
s_nop 0
v_mfma_f32_32x32x16_bf16 v[48:63], v[44:47], a[228:231], v[48:63]
buffer_load_dwordx4 a[56:59], v247, s[8:11], s77 offen offset:0 sc1
v_mfma_f32_32x32x16_bf16 v[64:79], v[44:47], a[196:199], v[64:79]
ds_read_b128 v[32:35], v230 offset:0
ds_read_b128 v[36:39], v230 offset:8192
ds_read_b128 v[40:43], v230 offset:16384
ds_read_b128 v[44:47], v230 offset:24576
s_lshl_b32 s95, s52, 12
s_add_u32 s95, s95, 98304
v_add_u32 v120, s95, v6
v_xor_b32 v121, 4096, v120
s_nop 1
v_pk_mul_f32 v[112:113], v[48:49], v[160:161]
s_nop 0
v_pk_mul_f32 v[114:115], v[64:65], v[160:161]
v_pk_fma_f32 v[112:113], v[64:65], v[176:177], v[112:113]
v_pk_fma_f32 v[114:115], v[48:49], v[176:177], v[114:115] neg_lo:[1,0,0] neg_hi:[1,0,0]
v_cvt_pk_bf16_f32 v16, v112, v113
v_cvt_pk_bf16_f32 v24, v114, v115
v_pk_mul_f32 v[116:117], v[50:51], v[162:163]
v_pk_mul_f32 v[118:119], v[66:67], v[162:163]
v_pk_fma_f32 v[116:117], v[66:67], v[178:179], v[116:117]
s_mul_i32 s77, s15, 5
s_nop 0
buffer_load_dwordx4 a[60:63], v246, s[8:11], s77 offen offset:0 sc1
v_pk_fma_f32 v[118:119], v[50:51], v[178:179], v[118:119] neg_lo:[1,0,0] neg_hi:[1,0,0]
v_cvt_pk_bf16_f32 v17, v116, v117
v_cvt_pk_bf16_f32 v25, v118, v119
v_pk_mul_f32 v[112:113], v[52:53], v[164:165]
v_pk_mul_f32 v[114:115], v[68:69], v[164:165]
v_pk_fma_f32 v[112:113], v[68:69], v[180:181], v[112:113]
v_pk_fma_f32 v[114:115], v[52:53], v[180:181], v[114:115] neg_lo:[1,0,0] neg_hi:[1,0,0]
v_cvt_pk_bf16_f32 v18, v112, v113
v_cvt_pk_bf16_f32 v26, v114, v115
v_pk_mul_f32 v[116:117], v[54:55], v[166:167]
v_pk_mul_f32 v[118:119], v[70:71], v[166:167]
v_pk_fma_f32 v[116:117], v[70:71], v[182:183], v[116:117]
v_pk_fma_f32 v[118:119], v[54:55], v[182:183], v[118:119] neg_lo:[1,0,0] neg_hi:[1,0,0]
v_cvt_pk_bf16_f32 v19, v116, v117
v_cvt_pk_bf16_f32 v27, v118, v119
v_pk_mul_f32 v[112:113], v[56:57], v[168:169]
v_pk_mul_f32 v[114:115], v[72:73], v[168:169]
v_pk_fma_f32 v[112:113], v[72:73], v[184:185], v[112:113]
v_pk_fma_f32 v[114:115], v[56:57], v[184:185], v[114:115] neg_lo:[1,0,0] neg_hi:[1,0,0]
v_cvt_pk_bf16_f32 v20, v112, v113
v_cvt_pk_bf16_f32 v28, v114, v115
v_pk_mul_f32 v[116:117], v[58:59], v[170:171]
v_pk_mul_f32 v[118:119], v[74:75], v[170:171]
v_pk_fma_f32 v[116:117], v[74:75], v[186:187], v[116:117]
v_pk_fma_f32 v[118:119], v[58:59], v[186:187], v[118:119] neg_lo:[1,0,0] neg_hi:[1,0,0]
buffer_load_dwordx4 a[64:67], v246, s[8:11], s77 offen offset:1024 sc1
v_cvt_pk_bf16_f32 v21, v116, v117
v_cvt_pk_bf16_f32 v29, v118, v119
v_pk_mul_f32 v[112:113], v[60:61], v[172:173]
v_pk_mul_f32 v[114:115], v[76:77], v[172:173]
v_pk_fma_f32 v[112:113], v[76:77], v[188:189], v[112:113]
v_pk_fma_f32 v[114:115], v[60:61], v[188:189], v[114:115] neg_lo:[1,0,0] neg_hi:[1,0,0]
v_cvt_pk_bf16_f32 v22, v112, v113
v_cvt_pk_bf16_f32 v30, v114, v115
v_pk_mul_f32 v[116:117], v[62:63], v[174:175]
v_pk_mul_f32 v[118:119], v[78:79], v[174:175]
v_pk_fma_f32 v[116:117], v[78:79], v[190:191], v[116:117]
v_pk_fma_f32 v[118:119], v[62:63], v[190:191], v[118:119] neg_lo:[1,0,0] neg_hi:[1,0,0]
v_cvt_pk_bf16_f32 v23, v116, v117
v_cvt_pk_bf16_f32 v31, v118, v119
s_waitcnt lgkmcnt(0)
v_mfma_f32_32x32x16_bf16 v[80:95], a[232:235], v[16:19], 0
v_lshlrev_b32 v48, 16, v32
v_and_b32 v64, 0xffff0000, v32
v_lshlrev_b32_e64 v49, 16, v33
v_and_b32 v65, 0xffff0000, v33
v_mfma_f32_32x32x16_bf16 v[96:111], a[240:243], v[16:19], 0
v_lshlrev_b32_e64 v50, 16, v34
v_and_b32 v66, 0xffff0000, v34
buffer_load_dwordx4 a[68:71], v246, s[8:11], s77 offen offset:2048 sc1
v_lshlrev_b32_e64 v51, 16, v35
v_and_b32 v67, 0xffff0000, v35
v_mfma_f32_32x32x16_bf16 v[80:95], a[248:251], v[24:27], v[80:95]
v_lshlrev_b32_e64 v52, 16, v36
v_and_b32 v68, 0xffff0000, v36
v_lshlrev_b32_e64 v53, 16, v37
v_and_b32 v69, 0xffff0000, v37
v_mfma_f32_32x32x16_bf16 v[96:111], a[232:235], v[24:27], v[96:111]
v_lshlrev_b32_e64 v54, 16, v38
v_and_b32 v70, 0xffff0000, v38
v_lshlrev_b32_e64 v55, 16, v39
v_and_b32 v71, 0xffff0000, v39
v_mfma_f32_32x32x16_bf16 v[80:95], a[236:239], v[20:23], v[80:95]
v_lshlrev_b32_e64 v56, 16, v40
v_and_b32 v72, 0xffff0000, v40
v_lshlrev_b32_e64 v57, 16, v41
v_and_b32 v73, 0xffff0000, v41
v_mfma_f32_32x32x16_bf16 v[96:111], a[244:247], v[20:23], v[96:111]
buffer_load_dwordx4 a[72:75], v246, s[8:11], s77 offen offset:3072 sc1
v_lshlrev_b32_e64 v58, 16, v42
v_and_b32 v74, 0xffff0000, v42
v_lshlrev_b32_e64 v59, 16, v43
v_and_b32 v75, 0xffff0000, v43
v_mfma_f32_32x32x16_bf16 v[80:95], a[252:255], v[28:31], v[80:95]
v_lshlrev_b32_e64 v60, 16, v44
v_and_b32 v76, 0xffff0000, v44
v_lshlrev_b32_e64 v61, 16, v45
v_and_b32 v77, 0xffff0000, v45
v_mfma_f32_32x32x16_bf16 v[96:111], a[236:239], v[28:31], v[96:111]
v_lshlrev_b32_e64 v62, 16, v46
v_and_b32 v78, 0xffff0000, v46
v_lshlrev_b32_e64 v63, 16, v47
v_and_b32 v79, 0xffff0000, v47
s_nop 2
v_pk_mul_f32 v[112:113], v[80:81], v[48:49]
s_nop 3
v_pk_mul_f32 v[114:115], v[96:97], v[48:49]
v_pk_fma_f32 v[112:113], v[96:97], v[64:65], v[112:113] neg_lo:[1,0,0] neg_hi:[1,0,0]
v_pk_fma_f32 v[114:115], v[80:81], v[64:65], v[114:115]
v_cvt_pk_bf16_f32 v16, v112, v113
buffer_load_dwordx4 a[76:79], v247, s[8:11], s77 offen offset:0 sc1
v_cvt_pk_bf16_f32 v24, v114, v115
v_pk_mul_f32 v[116:117], v[82:83], v[50:51]
v_pk_mul_f32 v[118:119], v[98:99], v[50:51]
v_pk_fma_f32 v[116:117], v[98:99], v[66:67], v[116:117] neg_lo:[1,0,0] neg_hi:[1,0,0]
v_pk_fma_f32 v[118:119], v[82:83], v[66:67], v[118:119]
v_cvt_pk_bf16_f32 v17, v116, v117
v_cvt_pk_bf16_f32 v25, v118, v119
v_pk_mul_f32 v[112:113], v[84:85], v[52:53]
v_pk_mul_f32 v[114:115], v[100:101], v[52:53]
v_pk_fma_f32 v[112:113], v[100:101], v[68:69], v[112:113] neg_lo:[1,0,0] neg_hi:[1,0,0]
v_pk_fma_f32 v[114:115], v[84:85], v[68:69], v[114:115]
v_cvt_pk_bf16_f32 v18, v112, v113
v_cvt_pk_bf16_f32 v26, v114, v115
v_pk_mul_f32 v[116:117], v[86:87], v[54:55]
v_pk_mul_f32 v[118:119], v[102:103], v[54:55]
v_pk_fma_f32 v[116:117], v[102:103], v[70:71], v[116:117] neg_lo:[1,0,0] neg_hi:[1,0,0]
v_pk_fma_f32 v[118:119], v[86:87], v[70:71], v[118:119]
v_cvt_pk_bf16_f32 v19, v116, v117
v_cvt_pk_bf16_f32 v27, v118, v119
v_pk_mul_f32 v[112:113], v[88:89], v[56:57]
v_pk_mul_f32 v[114:115], v[104:105], v[56:57]
v_pk_fma_f32 v[112:113], v[104:105], v[72:73], v[112:113] neg_lo:[1,0,0] neg_hi:[1,0,0]
v_pk_fma_f32 v[114:115], v[88:89], v[72:73], v[114:115]
v_cvt_pk_bf16_f32 v20, v112, v113
v_cvt_pk_bf16_f32 v28, v114, v115
v_pk_mul_f32 v[116:117], v[90:91], v[58:59]
s_mul_i32 s77, s16, 5
s_nop 0
buffer_load_dwordx4 a[80:83], v246, s[8:11], s77 offen offset:0 sc1
v_pk_mul_f32 v[118:119], v[106:107], v[58:59]
v_pk_fma_f32 v[116:117], v[106:107], v[74:75], v[116:117] neg_lo:[1,0,0] neg_hi:[1,0,0]
v_pk_fma_f32 v[118:119], v[90:91], v[74:75], v[118:119]
v_cvt_pk_bf16_f32 v21, v116, v117
v_cvt_pk_bf16_f32 v29, v118, v119
v_pk_mul_f32 v[112:113], v[92:93], v[60:61]
v_pk_mul_f32 v[114:115], v[108:109], v[60:61]
v_pk_fma_f32 v[112:113], v[108:109], v[76:77], v[112:113] neg_lo:[1,0,0] neg_hi:[1,0,0]
v_pk_fma_f32 v[114:115], v[92:93], v[76:77], v[114:115]
v_cvt_pk_bf16_f32 v22, v112, v113
v_cvt_pk_bf16_f32 v30, v114, v115
v_pk_mul_f32 v[116:117], v[94:95], v[62:63]
v_pk_mul_f32 v[118:119], v[110:111], v[62:63]
v_pk_fma_f32 v[116:117], v[110:111], v[78:79], v[116:117] neg_lo:[1,0,0] neg_hi:[1,0,0]
v_pk_fma_f32 v[118:119], v[94:95], v[78:79], v[118:119]
v_cvt_pk_bf16_f32 v23, v116, v117
v_cvt_pk_bf16_f32 v31, v118, v119
s_waitcnt vmcnt(11)
s_lshr_b32 s92, s52, 1
s_lshl_b32 s92, s92, 5
s_and_b32 s93, s52, 1
s_add_u32 s92, s92, s93
s_mul_i32 s92, s92, 16
s_add_u32 s92, s92, s51
v_mov_b32 v8, s56
v_mov_b32 v9, 0
s_mov_b64 exec, 1
buffer_store_dword v8, v9, s[8:11], s92 offen sc1
s_mov_b64 exec, -1
buffer_load_dwordx4 a[84:87], v246, s[8:11], s77 offen offset:1024 sc1
v_mfma_f32_32x32x16_bf16 v[48:63], v[16:19], a[232:235], 0
v_and_b32 v122, 0x13, v4
v_bfe_u32 v123, v4, 2, 1
v_mfma_f32_32x32x16_bf16 v[64:79], v[16:19], a[248:251], 0
v_lshl_or_b32 v122, v123, 3, v122
v_mfma_f32_32x32x16_bf16 v[48:63], v[24:27], a[240:243], v[48:63]
v_bfe_u32 v123, v4, 3, 1
v_lshl_or_b32 v122, v123, 2, v122
v_mfma_f32_32x32x16_bf16 v[64:79], v[24:27], a[232:235], v[64:79]
buffer_load_dwordx4 a[88:91], v246, s[8:11], s77 offen offset:2048 sc1
s_and_b32 s95, s39, 1
s_bfe_u32 s96, s39, 0x10002
s_lshl_b32 s96, s96, 1
s_or_b32 s95, s95, s96
v_mfma_f32_32x32x16_bf16 v[48:63], v[20:23], a[236:239], v[48:63]
s_and_b32 s96, s52, 1
s_lshl_b32 s96, s96, 1
s_xor_b32 s95, s95, s96
s_lshl_b32 s95, s95, 5
s_lshr_b32 s96, s52, 1
s_mul_i32 s96, s96, 8704
s_add_u32 s96, s96, 114688
v_mfma_f32_32x32x16_bf16 v[64:79], v[20:23], a[252:255], v[64:79]
v_mul_u32_u24 v122, 272, v122
v_lshl_add_u32 v122, v3, 4, v122
v_add_u32_e64 v122, s96, v122
v_mfma_f32_32x32x16_bf16 v[48:63], v[28:31], a[244:247], v[48:63]
buffer_load_dwordx4 a[92:95], v246, s[8:11], s77 offen offset:3072 sc1
s_xor_b32 s98, s95, 32
v_add_u32 v123, s98, v122
v_add_u32 v122, s95, v122
s_and_b32 s95, s52, 1
s_mul_i32 s98, s95, 4352
s_add_u32 s96, s96, s98
v_mfma_f32_32x32x16_bf16 v[64:79], v[28:31], a[236:239], v[64:79]
v_lshrrev_b32 v124, 4, v1
v_mul_u32_u24 v124, 272, v124
v_and_b32_e64 v125, 15, v1
v_lshl_add_u32 v124, v125, 4, v124
v_add_u32 v124, s96, v124
s_lshr_b32 s96, s52, 1
s_mul_i32 s96, s96, 160
s_add_u32 s96, s96, s39
s_lshl_b32 s96, s96, 13
s_cmp_eq_u32 s39, 160
s_cselect_b32 s96, 128, s96
s_lshl_b32 s95, s95, 12
s_add_u32 s96, s96, s95
s_add_u32 s96, s96, 18874368
s_mul_i32 s93, s39, 2
s_lshr_b32 s94, s52, 1
s_add_u32 s93, s93, s94
s_cmp_eq_u32 s93, 0
s_cselect_b32 s58, 0x00ff00ff, -1
s_cmp_eq_u32 s93, 320
s_cselect_b32 s58, 0x00ff00ff, s58
s_mov_b32 s59, s58
s_nop 0
buffer_load_dwordx4 a[96:99], v247, s[8:11], s77 offen offset:0 sc1
s_cmp_eq_u32 s93, 321
s_cselect_b32 s96, 268435456, s96
v_pk_mul_f32 v[112:113], v[48:49], v[192:193]
v_pk_mul_f32 v[114:115], v[64:65], v[192:193]
v_pk_fma_f32 v[112:113], v[64:65], v[208:209], v[112:113] neg_lo:[1,0,0] neg_hi:[1,0,0]
v_pk_fma_f32 v[114:115], v[48:49], v[208:209], v[114:115]
v_cvt_pk_bf16_f32 v16, v112, v113
v_cvt_pk_bf16_f32 v24, v114, v115
v_pk_mul_f32 v[116:117], v[50:51], v[194:195]
v_pk_mul_f32 v[118:119], v[66:67], v[194:195]
v_pk_fma_f32 v[116:117], v[66:67], v[210:211], v[116:117] neg_lo:[1,0,0] neg_hi:[1,0,0]
v_pk_fma_f32 v[118:119], v[50:51], v[210:211], v[118:119]
v_cvt_pk_bf16_f32 v17, v116, v117
v_cvt_pk_bf16_f32 v25, v118, v119
v_pk_mul_f32 v[112:113], v[52:53], v[196:197]
v_pk_mul_f32 v[114:115], v[68:69], v[196:197]
v_pk_fma_f32 v[112:113], v[68:69], v[212:213], v[112:113] neg_lo:[1,0,0] neg_hi:[1,0,0]
v_pk_fma_f32 v[114:115], v[52:53], v[212:213], v[114:115]
v_cvt_pk_bf16_f32 v18, v112, v113
v_cvt_pk_bf16_f32 v26, v114, v115
v_pk_mul_f32 v[116:117], v[54:55], v[198:199]
v_pk_mul_f32 v[118:119], v[70:71], v[198:199]
v_pk_fma_f32 v[116:117], v[70:71], v[214:215], v[116:117] neg_lo:[1,0,0] neg_hi:[1,0,0]
s_mul_i32 s77, s17, 5
s_nop 0
buffer_load_dwordx4 a[100:103], v246, s[8:11], s77 offen offset:0 sc1
v_pk_fma_f32 v[118:119], v[54:55], v[214:215], v[118:119]
v_cvt_pk_bf16_f32 v19, v116, v117
v_cvt_pk_bf16_f32 v27, v118, v119
v_pk_mul_f32 v[112:113], v[56:57], v[200:201]
v_pk_mul_f32 v[114:115], v[72:73], v[200:201]
v_pk_fma_f32 v[112:113], v[72:73], v[216:217], v[112:113] neg_lo:[1,0,0] neg_hi:[1,0,0]
v_pk_fma_f32 v[114:115], v[56:57], v[216:217], v[114:115]
v_cvt_pk_bf16_f32 v20, v112, v113
v_cvt_pk_bf16_f32 v28, v114, v115
v_pk_mul_f32 v[116:117], v[58:59], v[202:203]
v_pk_mul_f32 v[118:119], v[74:75], v[202:203]
v_pk_fma_f32 v[116:117], v[74:75], v[218:219], v[116:117] neg_lo:[1,0,0] neg_hi:[1,0,0]
v_pk_fma_f32 v[118:119], v[58:59], v[218:219], v[118:119]
v_cvt_pk_bf16_f32 v21, v116, v117
v_cvt_pk_bf16_f32 v29, v118, v119
v_pk_mul_f32 v[112:113], v[60:61], v[204:205]
v_pk_mul_f32 v[114:115], v[76:77], v[204:205]
v_pk_fma_f32 v[112:113], v[76:77], v[220:221], v[112:113] neg_lo:[1,0,0] neg_hi:[1,0,0]
v_pk_fma_f32 v[114:115], v[60:61], v[220:221], v[114:115]
v_cvt_pk_bf16_f32 v22, v112, v113
v_cvt_pk_bf16_f32 v30, v114, v115
v_pk_mul_f32 v[116:117], v[62:63], v[206:207]
v_pk_mul_f32 v[118:119], v[78:79], v[206:207]
v_pk_fma_f32 v[116:117], v[78:79], v[222:223], v[116:117] neg_lo:[1,0,0] neg_hi:[1,0,0]
v_pk_fma_f32 v[118:119], v[62:63], v[222:223], v[118:119]
buffer_load_dwordx4 a[104:107], v246, s[8:11], s77 offen offset:1024 sc1
v_cvt_pk_bf16_f32 v23, v116, v117
v_cvt_pk_bf16_f32 v31, v118, v119
ds_write_b128 v120, v[16:19] offset:0
ds_write_b128 v120, v[20:23] offset:1024
ds_write_b128 v120, v[24:27] offset:2048
ds_write_b128 v120, v[28:31] offset:3072
v_mfma_f32_32x32x16_bf16 v[80:95], a[184:187], v[16:19], 0
v_mfma_f32_32x32x16_bf16 v[96:111], a[216:219], v[16:19], 0
v_mfma_f32_32x32x16_bf16 v[80:95], a[200:203], v[24:27], v[80:95]
v_mfma_f32_32x32x16_bf16 v[96:111], a[184:187], v[24:27], v[96:111]
buffer_load_dwordx4 a[108:111], v246, s[8:11], s77 offen offset:2048 sc1
s_waitcnt lgkmcnt(0)
s_barrier
ds_read_b128 v[32:35], v121 offset:0
ds_read_b128 v[36:39], v121 offset:1024
ds_read_b128 v[40:43], v121 offset:2048
ds_read_b128 v[44:47], v121 offset:3072
v_mfma_f32_32x32x16_bf16 v[80:95], a[188:191], v[20:23], v[80:95]
v_mfma_f32_32x32x16_bf16 v[96:111], a[220:223], v[20:23], v[96:111]
buffer_load_dwordx4 a[112:115], v246, s[8:11], s77 offen offset:3072 sc1
v_mfma_f32_32x32x16_bf16 v[80:95], a[204:207], v[28:31], v[80:95]
v_mfma_f32_32x32x16_bf16 v[96:111], a[188:191], v[28:31], v[96:111]
s_waitcnt lgkmcnt(0)
s_nop 0
v_mfma_f32_32x32x16_bf16 v[80:95], a[192:195], v[32:35], v[80:95]
v_mfma_f32_32x32x16_bf16 v[96:111], a[224:227], v[32:35], v[96:111]
buffer_load_dwordx4 a[116:119], v247, s[8:11], s77 offen offset:0 sc1
v_mfma_f32_32x32x16_bf16 v[80:95], a[208:211], v[40:43], v[80:95]
v_mfma_f32_32x32x16_bf16 v[96:111], a[192:195], v[40:43], v[96:111]
v_mfma_f32_32x32x16_bf16 v[80:95], a[196:199], v[36:39], v[80:95]
s_mul_i32 s77, s18, 5
buffer_load_dwordx4 a[120:123], v246, s[8:11], s77 offen offset:0 sc1
v_mfma_f32_32x32x16_bf16 v[96:111], a[228:231], v[36:39], v[96:111]
v_mfma_f32_32x32x16_bf16 v[80:95], a[212:215], v[44:47], v[80:95]
v_mfma_f32_32x32x16_bf16 v[96:111], a[196:199], v[44:47], v[96:111]
s_nop 10
v_cvt_pk_bf16_f32 v16, v80, v81
v_cvt_pk_bf16_f32 v17, v82, v83
v_cvt_pk_bf16_f32 v18, v84, v85
v_cvt_pk_bf16_f32 v19, v86, v87
ds_write_b128 v122, v[16:19] offset:0
v_cvt_pk_bf16_f32 v20, v88, v89
v_cvt_pk_bf16_f32 v21, v90, v91
v_cvt_pk_bf16_f32 v22, v92, v93
v_cvt_pk_bf16_f32 v23, v94, v95
ds_write_b128 v123, v[20:23] offset:0
v_cvt_pk_bf16_f32 v24, v96, v97
v_cvt_pk_bf16_f32 v25, v98, v99
v_cvt_pk_bf16_f32 v26, v100, v101
v_cvt_pk_bf16_f32 v27, v102, v103
ds_write_b128 v122, v[24:27] offset:128
v_cvt_pk_bf16_f32 v28, v104, v105
v_cvt_pk_bf16_f32 v29, v106, v107
v_cvt_pk_bf16_f32 v30, v108, v109
v_cvt_pk_bf16_f32 v31, v110, v111
ds_write_b128 v123, v[28:31] offset:128
s_waitcnt lgkmcnt(0)
s_barrier
ds_read_b128 v[32:35], v124 offset:0
ds_read_b128 v[36:39], v124 offset:1088
ds_read_b128 v[40:43], v124 offset:2176
ds_read_b128 v[44:47], v124 offset:3264
s_waitcnt lgkmcnt(3)
s_mov_b64 exec, s[58:59]
buffer_store_dwordx4 v[32:35], v6, s[8:11], s96 offen offset:0 sc1
s_mov_b64 exec, -1
s_waitcnt lgkmcnt(2)
s_mov_b64 exec, s[58:59]
buffer_store_dwordx4 v[36:39], v6, s[8:11], s96 offen offset:1024 sc1
s_mov_b64 exec, -1
s_waitcnt lgkmcnt(1)
s_mov_b64 exec, s[58:59]
buffer_store_dwordx4 v[40:43], v6, s[8:11], s96 offen offset:2048 sc1
s_mov_b64 exec, -1
s_waitcnt lgkmcnt(0)
s_mov_b64 exec, s[58:59]
buffer_store_dwordx4 v[44:47], v6, s[8:11], s96 offen offset:3072 sc1
s_mov_b64 exec, -1
buffer_load_dwordx4 a[124:127], v246, s[8:11], s77 offen offset:1024 sc1
s_mul_i32 s92, s41, 40
v_and_b32 v158, 15, v1
v_add_u32 v159, s92, v158
v_cvt_f32_u32 v112, v159
v_add_f32 v113, 0x41800000, v112
v_and_b32 v159, 7, v158
v_lshrrev_b32 v158, 3, v158
v_mul_u32_u24 v158, 320, v158
v_add3_u32 v159, v159, v158, s92
v_add_u32_e64 v159, 32, v159
v_cvt_f32_u32 v114, v159
s_and_b32 s92, s52, 1
s_mul_i32 s92, s92, 160
s_lshr_b32 s93, s52, 1
s_add_u32 s92, s92, s93
v_lshrrev_b32_e64 v158, 4, v1
v_lshl_add_u32 v158, v158, 3, s92
v_cvt_f32_u32_e64 v115, v158
s_mul_i32 s92, s52, 15360
s_add_u32 s92, s92, 0
v_add_u32 v134, s92, v6
buffer_load_dwordx4 a[128:131], v246, s[8:11], s77 offen offset:2048 sc1
v_mul_f32 v158, 0.5, v112
v_fract_f32 v158, v158
v_mul_f32 v112, 0x3acccccd, v112
v_cos_f32 v158, v158
v_mul_f32 v159, v115, v112
v_cvt_pk_bf16_f32 v160, 1.0, v158
v_fract_f32 v159, v159
v_add_f32 v158, v112, v112
v_mul_f32 v135, 0x41d00000, v112
v_cos_f32_e64 v116, v159
v_sin_f32 v117, -v159
v_cos_f32_e64 v122, v158
v_sin_f32 v123, -v158
buffer_load_dwordx4 a[132:135], v246, s[8:11], s77 offen offset:3072 sc1
v_cos_f32_e64 v128, v135
v_sin_f32 v129, -v135
v_mul_f32 v158, 0.5, v113
v_fract_f32 v158, v158
v_mul_f32 v113, 0x3acccccd, v113
v_cos_f32 v158, v158
v_mul_f32 v159, v115, v113
v_cvt_pk_bf16_f32 v161, 1.0, v158
v_fract_f32 v159, v159
v_add_f32 v158, v113, v113
v_mul_f32 v135, 0x41d00000, v113
v_cos_f32_e64 v118, v159
v_sin_f32 v119, -v159
buffer_load_dwordx4 a[136:139], v247, s[8:11], s77 offen offset:0 sc1
v_cos_f32_e64 v124, v158
v_sin_f32 v125, -v158
v_cos_f32_e64 v130, v135
v_sin_f32 v131, -v135
v_mul_f32 v158, 0.5, v114
v_fract_f32 v158, v158
v_mul_f32 v114, 0x3acccccd, v114
v_cos_f32 v158, v158
v_mul_f32 v159, v115, v114
v_cvt_pk_bf16_f32 v162, 1.0, v158
v_fract_f32 v159, v159
v_add_f32 v158, v114, v114
v_mul_f32 v135, 0x41d00000, v114
v_cos_f32 v120, v159
s_mul_i32 s77, s19, 5
buffer_load_dwordx4 a[140:143], v246, s[8:11], s77 offen offset:0 sc1
v_sin_f32 v121, -v159
v_cos_f32_e64 v126, v158
v_sin_f32 v127, -v158
v_cos_f32_e64 v132, v135
v_sin_f32 v133, -v135
v_cvt_pk_bf16_f32 v136, v116, v117
v_pk_mul_f32 v[164:165], v[116:117], v[122:123] op_sel_hi:[1,0]
v_pk_fma_f32 v[116:117], v[116:117], v[122:123], v[164:165] op_sel:[1,1,0] op_sel_hi:[0,1,1] neg_lo:[1,0,0]
v_cvt_pk_bf16_f32 v140, v118, v119
v_pk_mul_f32 v[166:167], v[118:119], v[124:125] op_sel_hi:[1,0]
v_pk_fma_f32 v[118:119], v[118:119], v[124:125], v[166:167] op_sel:[1,1,0] op_sel_hi:[0,1,1] neg_lo:[1,0,0]
v_cvt_pk_bf16_f32 v144, v120, v121
buffer_load_dwordx4 a[144:147], v246, s[8:11], s77 offen offset:1024 sc1
v_pk_mul_f32 v[168:169], v[120:121], v[126:127] op_sel_hi:[1,0]
v_pk_fma_f32 v[120:121], v[120:121], v[126:127], v[168:169] op_sel:[1,1,0] op_sel_hi:[0,1,1] neg_lo:[1,0,0]
v_cvt_pk_bf16_f32 v137, v116, v117
v_pk_mul_f32 v[164:165], v[116:117], v[122:123] op_sel_hi:[1,0]
v_pk_fma_f32 v[116:117], v[116:117], v[122:123], v[164:165] op_sel:[1,1,0] op_sel_hi:[0,1,1] neg_lo:[1,0,0]
v_cvt_pk_bf16_f32 v141, v118, v119
v_pk_mul_f32 v[166:167], v[118:119], v[124:125] op_sel_hi:[1,0]
v_pk_fma_f32 v[118:119], v[118:119], v[124:125], v[166:167] op_sel:[1,1,0] op_sel_hi:[0,1,1] neg_lo:[1,0,0]
v_cvt_pk_bf16_f32 v145, v120, v121
v_pk_mul_f32 v[168:169], v[120:121], v[126:127] op_sel_hi:[1,0]
v_pk_fma_f32 v[120:121], v[120:121], v[126:127], v[168:169] op_sel:[1,1,0] op_sel_hi:[0,1,1] neg_lo:[1,0,0]
v_cvt_pk_bf16_f32 v138, v116, v117
v_pk_mul_f32 v[164:165], v[116:117], v[122:123] op_sel_hi:[1,0]
v_pk_fma_f32 v[116:117], v[116:117], v[122:123], v[164:165] op_sel:[1,1,0] op_sel_hi:[0,1,1] neg_lo:[1,0,0]
v_cvt_pk_bf16_f32 v142, v118, v119
v_pk_mul_f32 v[166:167], v[118:119], v[124:125] op_sel_hi:[1,0]
v_pk_fma_f32 v[118:119], v[118:119], v[124:125], v[166:167] op_sel:[1,1,0] op_sel_hi:[0,1,1] neg_lo:[1,0,0]
v_cvt_pk_bf16_f32 v146, v120, v121
v_pk_mul_f32 v[168:169], v[120:121], v[126:127] op_sel_hi:[1,0]
buffer_load_dwordx4 a[148:151], v246, s[8:11], s77 offen offset:2048 sc1
v_pk_fma_f32 v[120:121], v[120:121], v[126:127], v[168:169] op_sel:[1,1,0] op_sel_hi:[0,1,1] neg_lo:[1,0,0]
v_cvt_pk_bf16_f32 v139, v116, v117
v_pk_mul_f32 v[164:165], v[116:117], v[128:129] op_sel_hi:[1,0]
v_pk_fma_f32 v[116:117], v[116:117], v[128:129], v[164:165] op_sel:[1,1,0] op_sel_hi:[0,1,1] neg_lo:[1,0,0]
v_cmp_eq_f32 vcc, 0, v115
s_nop 1
v_cndmask_b32_e64 v136, v136, v160, vcc
ds_write_b128 v134, v[136:139] offset:0
v_cvt_pk_bf16_f32 v143, v118, v119
v_pk_mul_f32 v[166:167], v[118:119], v[130:131] op_sel_hi:[1,0]
v_pk_fma_f32 v[118:119], v[118:119], v[130:131], v[166:167] op_sel:[1,1,0] op_sel_hi:[0,1,1] neg_lo:[1,0,0]
v_cmp_eq_f32 vcc, 0, v115
s_nop 1
v_cndmask_b32_e64 v140, v140, v161, vcc
ds_write_b128 v134, v[140:143] offset:1024
v_cvt_pk_bf16_f32 v147, v120, v121
v_pk_mul_f32 v[168:169], v[120:121], v[132:133] op_sel_hi:[1,0]
v_pk_fma_f32 v[120:121], v[120:121], v[132:133], v[168:169] op_sel:[1,1,0] op_sel_hi:[0,1,1] neg_lo:[1,0,0]
v_cmp_eq_f32 vcc, 0, v115
s_nop 1
v_cndmask_b32_e64 v144, v144, v162, vcc
buffer_load_dwordx4 a[152:155], v246, s[8:11], s77 offen offset:3072 sc1
ds_write_b128 v134, v[144:147] offset:2048
v_cvt_pk_bf16_f32 v172, v116, v117
v_pk_mul_f32 v[164:165], v[116:117], v[122:123] op_sel_hi:[1,0]
v_pk_fma_f32 v[116:117], v[116:117], v[122:123], v[164:165] op_sel:[1,1,0] op_sel_hi:[0,1,1] neg_lo:[1,0,0]
v_cvt_pk_bf16_f32 v176, v118, v119
v_pk_mul_f32 v[166:167], v[118:119], v[124:125] op_sel_hi:[1,0]
v_pk_fma_f32 v[118:119], v[118:119], v[124:125], v[166:167] op_sel:[1,1,0] op_sel_hi:[0,1,1] neg_lo:[1,0,0]
v_cvt_pk_bf16_f32 v180, v120, v121
v_pk_mul_f32 v[168:169], v[120:121], v[126:127] op_sel_hi:[1,0]
v_pk_fma_f32 v[120:121], v[120:121], v[126:127], v[168:169] op_sel:[1,1,0] op_sel_hi:[0,1,1] neg_lo:[1,0,0]
v_cvt_pk_bf16_f32 v173, v116, v117
v_pk_mul_f32 v[164:165], v[116:117], v[122:123] op_sel_hi:[1,0]
v_pk_fma_f32 v[116:117], v[116:117], v[122:123], v[164:165] op_sel:[1,1,0] op_sel_hi:[0,1,1] neg_lo:[1,0,0]
v_cvt_pk_bf16_f32 v177, v118, v119
v_pk_mul_f32 v[166:167], v[118:119], v[124:125] op_sel_hi:[1,0]
v_pk_fma_f32 v[118:119], v[118:119], v[124:125], v[166:167] op_sel:[1,1,0] op_sel_hi:[0,1,1] neg_lo:[1,0,0]
v_cvt_pk_bf16_f32 v181, v120, v121
buffer_load_dwordx4 a[156:159], v247, s[8:11], s77 offen offset:0 sc1
v_pk_mul_f32 v[168:169], v[120:121], v[126:127] op_sel_hi:[1,0]
v_pk_fma_f32 v[120:121], v[120:121], v[126:127], v[168:169] op_sel:[1,1,0] op_sel_hi:[0,1,1] neg_lo:[1,0,0]
v_cvt_pk_bf16_f32 v174, v116, v117
v_pk_mul_f32 v[164:165], v[116:117], v[122:123] op_sel_hi:[1,0]
v_pk_fma_f32 v[116:117], v[116:117], v[122:123], v[164:165] op_sel:[1,1,0] op_sel_hi:[0,1,1] neg_lo:[1,0,0]
v_cvt_pk_bf16_f32 v178, v118, v119
v_pk_mul_f32 v[166:167], v[118:119], v[124:125] op_sel_hi:[1,0]
v_pk_fma_f32 v[118:119], v[118:119], v[124:125], v[166:167] op_sel:[1,1,0] op_sel_hi:[0,1,1] neg_lo:[1,0,0]
v_cvt_pk_bf16_f32 v182, v120, v121
v_pk_mul_f32 v[168:169], v[120:121], v[126:127] op_sel_hi:[1,0]
v_pk_fma_f32 v[120:121], v[120:121], v[126:127], v[168:169] op_sel:[1,1,0] op_sel_hi:[0,1,1] neg_lo:[1,0,0]
v_cvt_pk_bf16_f32 v175, v116, v117
v_pk_mul_f32 v[164:165], v[116:117], v[128:129] op_sel_hi:[1,0]
v_pk_fma_f32 v[116:117], v[116:117], v[128:129], v[164:165] op_sel:[1,1,0] op_sel_hi:[0,1,1] neg_lo:[1,0,0]
ds_write_b128 v134, v[172:175] offset:3072
v_cvt_pk_bf16_f32 v179, v118, v119
v_pk_mul_f32 v[166:167], v[118:119], v[130:131] op_sel_hi:[1,0]
v_pk_fma_f32 v[118:119], v[118:119], v[130:131], v[166:167] op_sel:[1,1,0] op_sel_hi:[0,1,1] neg_lo:[1,0,0]
ds_write_b128 v134, v[176:179] offset:4096
s_mul_i32 s77, s24, 5
s_nop 0
buffer_load_dwordx4 a[160:163], v246, s[8:11], s77 offen offset:0 sc1
v_cvt_pk_bf16_f32 v183, v120, v121
v_pk_mul_f32 v[168:169], v[120:121], v[132:133] op_sel_hi:[1,0]
v_pk_fma_f32 v[120:121], v[120:121], v[132:133], v[168:169] op_sel:[1,1,0] op_sel_hi:[0,1,1] neg_lo:[1,0,0]
ds_write_b128 v134, v[180:183] offset:5120
v_cvt_pk_bf16_f32 v136, v116, v117
v_pk_mul_f32 v[164:165], v[116:117], v[122:123] op_sel_hi:[1,0]
v_pk_fma_f32 v[116:117], v[116:117], v[122:123], v[164:165] op_sel:[1,1,0] op_sel_hi:[0,1,1] neg_lo:[1,0,0]
v_cvt_pk_bf16_f32 v140, v118, v119
v_pk_mul_f32 v[166:167], v[118:119], v[124:125] op_sel_hi:[1,0]
v_pk_fma_f32 v[118:119], v[118:119], v[124:125], v[166:167] op_sel:[1,1,0] op_sel_hi:[0,1,1] neg_lo:[1,0,0]
v_cvt_pk_bf16_f32 v144, v120, v121
v_pk_mul_f32 v[168:169], v[120:121], v[126:127] op_sel_hi:[1,0]
v_pk_fma_f32 v[120:121], v[120:121], v[126:127], v[168:169] op_sel:[1,1,0] op_sel_hi:[0,1,1] neg_lo:[1,0,0]
v_cvt_pk_bf16_f32 v137, v116, v117
v_pk_mul_f32 v[164:165], v[116:117], v[122:123] op_sel_hi:[1,0]
v_pk_fma_f32 v[116:117], v[116:117], v[122:123], v[164:165] op_sel:[1,1,0] op_sel_hi:[0,1,1] neg_lo:[1,0,0]
v_cvt_pk_bf16_f32 v141, v118, v119
v_pk_mul_f32 v[166:167], v[118:119], v[124:125] op_sel_hi:[1,0]
buffer_load_dwordx4 a[164:167], v246, s[8:11], s77 offen offset:1024 sc1
v_pk_fma_f32 v[118:119], v[118:119], v[124:125], v[166:167] op_sel:[1,1,0] op_sel_hi:[0,1,1] neg_lo:[1,0,0]
v_cvt_pk_bf16_f32 v145, v120, v121
v_pk_mul_f32 v[168:169], v[120:121], v[126:127] op_sel_hi:[1,0]
v_pk_fma_f32 v[120:121], v[120:121], v[126:127], v[168:169] op_sel:[1,1,0] op_sel_hi:[0,1,1] neg_lo:[1,0,0]
v_cvt_pk_bf16_f32 v138, v116, v117
v_pk_mul_f32 v[164:165], v[116:117], v[122:123] op_sel_hi:[1,0]
v_pk_fma_f32 v[116:117], v[116:117], v[122:123], v[164:165] op_sel:[1,1,0] op_sel_hi:[0,1,1] neg_lo:[1,0,0]
v_cvt_pk_bf16_f32 v142, v118, v119
v_pk_mul_f32 v[166:167], v[118:119], v[124:125] op_sel_hi:[1,0]
v_pk_fma_f32 v[118:119], v[118:119], v[124:125], v[166:167] op_sel:[1,1,0] op_sel_hi:[0,1,1] neg_lo:[1,0,0]
v_cvt_pk_bf16_f32 v146, v120, v121
v_pk_mul_f32 v[168:169], v[120:121], v[126:127] op_sel_hi:[1,0]
v_pk_fma_f32 v[120:121], v[120:121], v[126:127], v[168:169] op_sel:[1,1,0] op_sel_hi:[0,1,1] neg_lo:[1,0,0]
v_cvt_pk_bf16_f32 v139, v116, v117
v_pk_mul_f32 v[164:165], v[116:117], v[128:129] op_sel_hi:[1,0]
v_pk_fma_f32 v[116:117], v[116:117], v[128:129], v[164:165] op_sel:[1,1,0] op_sel_hi:[0,1,1] neg_lo:[1,0,0]
ds_write_b128 v134, v[136:139] offset:6144
v_cvt_pk_bf16_f32 v143, v118, v119
v_pk_mul_f32 v[166:167], v[118:119], v[130:131] op_sel_hi:[1,0]
buffer_load_dwordx4 a[168:171], v246, s[8:11], s77 offen offset:2048 sc1
v_pk_fma_f32 v[118:119], v[118:119], v[130:131], v[166:167] op_sel:[1,1,0] op_sel_hi:[0,1,1] neg_lo:[1,0,0]
ds_write_b128 v134, v[140:143] offset:7168
v_cvt_pk_bf16_f32 v147, v120, v121
v_pk_mul_f32 v[168:169], v[120:121], v[132:133] op_sel_hi:[1,0]
v_pk_fma_f32 v[120:121], v[120:121], v[132:133], v[168:169] op_sel:[1,1,0] op_sel_hi:[0,1,1] neg_lo:[1,0,0]
ds_write_b128 v134, v[144:147] offset:8192
v_cvt_pk_bf16_f32 v172, v116, v117
v_pk_mul_f32 v[164:165], v[116:117], v[122:123] op_sel_hi:[1,0]
v_pk_fma_f32 v[116:117], v[116:117], v[122:123], v[164:165] op_sel:[1,1,0] op_sel_hi:[0,1,1] neg_lo:[1,0,0]
v_cvt_pk_bf16_f32 v176, v118, v119
v_pk_mul_f32 v[166:167], v[118:119], v[124:125] op_sel_hi:[1,0]
v_pk_fma_f32 v[118:119], v[118:119], v[124:125], v[166:167] op_sel:[1,1,0] op_sel_hi:[0,1,1] neg_lo:[1,0,0]
v_cvt_pk_bf16_f32 v180, v120, v121
v_pk_mul_f32 v[168:169], v[120:121], v[126:127] op_sel_hi:[1,0]
v_pk_fma_f32 v[120:121], v[120:121], v[126:127], v[168:169] op_sel:[1,1,0] op_sel_hi:[0,1,1] neg_lo:[1,0,0]
v_cvt_pk_bf16_f32 v173, v116, v117
v_pk_mul_f32 v[164:165], v[116:117], v[122:123] op_sel_hi:[1,0]
v_pk_fma_f32 v[116:117], v[116:117], v[122:123], v[164:165] op_sel:[1,1,0] op_sel_hi:[0,1,1] neg_lo:[1,0,0]
v_cvt_pk_bf16_f32 v177, v118, v119
buffer_load_dwordx4 a[172:175], v246, s[8:11], s77 offen offset:3072 sc1
v_pk_mul_f32 v[166:167], v[118:119], v[124:125] op_sel_hi:[1,0]
v_pk_fma_f32 v[118:119], v[118:119], v[124:125], v[166:167] op_sel:[1,1,0] op_sel_hi:[0,1,1] neg_lo:[1,0,0]
v_cvt_pk_bf16_f32 v181, v120, v121
v_pk_mul_f32 v[168:169], v[120:121], v[126:127] op_sel_hi:[1,0]
v_pk_fma_f32 v[120:121], v[120:121], v[126:127], v[168:169] op_sel:[1,1,0] op_sel_hi:[0,1,1] neg_lo:[1,0,0]
v_cvt_pk_bf16_f32 v174, v116, v117
v_pk_mul_f32 v[164:165], v[116:117], v[122:123] op_sel_hi:[1,0]
v_pk_fma_f32 v[116:117], v[116:117], v[122:123], v[164:165] op_sel:[1,1,0] op_sel_hi:[0,1,1] neg_lo:[1,0,0]
v_cvt_pk_bf16_f32 v178, v118, v119
v_pk_mul_f32 v[166:167], v[118:119], v[124:125] op_sel_hi:[1,0]
v_pk_fma_f32 v[118:119], v[118:119], v[124:125], v[166:167] op_sel:[1,1,0] op_sel_hi:[0,1,1] neg_lo:[1,0,0]
v_cvt_pk_bf16_f32 v182, v120, v121
v_pk_mul_f32 v[168:169], v[120:121], v[126:127] op_sel_hi:[1,0]
v_pk_fma_f32 v[120:121], v[120:121], v[126:127], v[168:169] op_sel:[1,1,0] op_sel_hi:[0,1,1] neg_lo:[1,0,0]
v_cvt_pk_bf16_f32 v175, v116, v117
v_pk_mul_f32 v[164:165], v[116:117], v[128:129] op_sel_hi:[1,0]
v_pk_fma_f32 v[116:117], v[116:117], v[128:129], v[164:165] op_sel:[1,1,0] op_sel_hi:[0,1,1] neg_lo:[1,0,0]
ds_write_b128 v134, v[172:175] offset:9216
v_cvt_pk_bf16_f32 v179, v118, v119
buffer_load_dwordx4 a[176:179], v247, s[8:11], s77 offen offset:0 sc1
v_pk_mul_f32 v[166:167], v[118:119], v[130:131] op_sel_hi:[1,0]
v_pk_fma_f32 v[118:119], v[118:119], v[130:131], v[166:167] op_sel:[1,1,0] op_sel_hi:[0,1,1] neg_lo:[1,0,0]
ds_write_b128 v134, v[176:179] offset:10240
v_cvt_pk_bf16_f32 v183, v120, v121
v_pk_mul_f32 v[168:169], v[120:121], v[132:133] op_sel_hi:[1,0]
v_pk_fma_f32 v[120:121], v[120:121], v[132:133], v[168:169] op_sel:[1,1,0] op_sel_hi:[0,1,1] neg_lo:[1,0,0]
ds_write_b128 v134, v[180:183] offset:11264
v_cvt_pk_bf16_f32 v136, v116, v117
v_pk_mul_f32 v[164:165], v[116:117], v[122:123] op_sel_hi:[1,0]
v_pk_fma_f32 v[116:117], v[116:117], v[122:123], v[164:165] op_sel:[1,1,0] op_sel_hi:[0,1,1] neg_lo:[1,0,0]
v_cvt_pk_bf16_f32 v140, v118, v119
v_pk_mul_f32 v[166:167], v[118:119], v[124:125] op_sel_hi:[1,0]
v_pk_fma_f32 v[118:119], v[118:119], v[124:125], v[166:167] op_sel:[1,1,0] op_sel_hi:[0,1,1] neg_lo:[1,0,0]
v_cvt_pk_bf16_f32 v144, v120, v121
v_pk_mul_f32 v[168:169], v[120:121], v[126:127] op_sel_hi:[1,0]
v_pk_fma_f32 v[120:121], v[120:121], v[126:127], v[168:169] op_sel:[1,1,0] op_sel_hi:[0,1,1] neg_lo:[1,0,0]
v_cvt_pk_bf16_f32 v137, v116, v117
v_pk_mul_f32 v[164:165], v[116:117], v[122:123] op_sel_hi:[1,0]
v_pk_fma_f32 v[116:117], v[116:117], v[122:123], v[164:165] op_sel:[1,1,0] op_sel_hi:[0,1,1] neg_lo:[1,0,0]
s_mul_i32 s77, s25, 5
s_nop 0
buffer_load_dwordx4 a[180:183], v246, s[8:11], s77 offen offset:0 sc1
v_cvt_pk_bf16_f32 v141, v118, v119
v_pk_mul_f32 v[166:167], v[118:119], v[124:125] op_sel_hi:[1,0]
v_pk_fma_f32 v[118:119], v[118:119], v[124:125], v[166:167] op_sel:[1,1,0] op_sel_hi:[0,1,1] neg_lo:[1,0,0]
v_cvt_pk_bf16_f32 v145, v120, v121
v_pk_mul_f32 v[168:169], v[120:121], v[126:127] op_sel_hi:[1,0]
v_pk_fma_f32 v[120:121], v[120:121], v[126:127], v[168:169] op_sel:[1,1,0] op_sel_hi:[0,1,1] neg_lo:[1,0,0]
v_cvt_pk_bf16_f32 v138, v116, v117
v_pk_mul_f32 v[164:165], v[116:117], v[122:123] op_sel_hi:[1,0]
v_pk_fma_f32 v[116:117], v[116:117], v[122:123], v[164:165] op_sel:[1,1,0] op_sel_hi:[0,1,1] neg_lo:[1,0,0]
v_cvt_pk_bf16_f32 v142, v118, v119
v_pk_mul_f32 v[166:167], v[118:119], v[124:125] op_sel_hi:[1,0]
v_pk_fma_f32 v[118:119], v[118:119], v[124:125], v[166:167] op_sel:[1,1,0] op_sel_hi:[0,1,1] neg_lo:[1,0,0]
v_cvt_pk_bf16_f32 v146, v120, v121
v_pk_mul_f32 v[168:169], v[120:121], v[126:127] op_sel_hi:[1,0]
v_pk_fma_f32 v[120:121], v[120:121], v[126:127], v[168:169] op_sel:[1,1,0] op_sel_hi:[0,1,1] neg_lo:[1,0,0]
v_cvt_pk_bf16_f32 v139, v116, v117
ds_write_b128 v134, v[136:139] offset:12288
v_cvt_pk_bf16_f32 v143, v118, v119
buffer_load_dwordx4 a[184:187], v246, s[8:11], s77 offen offset:1024 sc1
ds_write_b128 v134, v[140:143] offset:13312
v_cvt_pk_bf16_f32 v147, v120, v121
ds_write_b128 v134, v[144:147] offset:14336
buffer_load_dwordx4 a[188:191], v246, s[8:11], s77 offen offset:2048 sc1
buffer_load_dwordx4 a[192:195], v246, s[8:11], s77 offen offset:3072 sc1
buffer_load_dwordx4 a[196:199], v247, s[8:11], s77 offen offset:0 sc1
s_mul_i32 s77, s26, 5
buffer_load_dwordx4 a[200:203], v246, s[8:11], s77 offen offset:0 sc1
s_waitcnt vmcnt(20)
s_waitcnt lgkmcnt(0)
s_barrier
s_cmp_lg_u32 s52, 0
s_cbranch_scc1 L_fs36
s_bfe_u32 s92, s39, 0x20002
s_mul_i32 s92, s92, 41
s_lshr_b32 s93, s39, 4
s_lshl_b32 s93, s93, 2
s_add_u32 s92, s92, s93
s_and_b32 s93, s39, 3
s_add_u32 s92, s92, s93
s_mul_i32 s92, s92, 16
s_add_u32 s92, s92, 524288
v_mov_b32 v8, s56
v_mov_b32 v9, 0
s_mov_b64 exec, 1
buffer_store_dword v8, v9, s[8:11], s92 offen sc1
s_mov_b64 exec, -1
L_fs36:
buffer_load_dwordx4 a[204:207], v246, s[8:11], s77 offen offset:1024 sc1
v_and_b32 v5, 15, v1
v_lshrrev_b32_e64 v2, 4, v1
s_add_u32 s92, s52, 0
s_and_b32 s92, s92, 3
s_lshl_b32 s97, s40, 2
s_add_u32 s92, s92, s97
s_mul_i32 s92, s92, 55296
s_lshl_b32 s97, s52, 10
s_add_u32 s92, s92, s97
s_add_u32 s92, s92, 10485760
v_add_u32_e64 v10, s92, v6
s_add_u32 s92, s52, 1
s_and_b32 s92, s92, 3
s_lshl_b32 s97, s40, 2
s_add_u32 s92, s92, s97
s_mul_i32 s92, s92, 55296
s_lshl_b32 s97, s52, 10
s_add_u32 s92, s92, s97
s_add_u32 s92, s92, 10485760
buffer_load_dwordx4 a[208:211], v246, s[8:11], s77 offen offset:2048 sc1
v_add_u32_e64 v11, s92, v6
s_add_u32 s92, s52, 2
s_and_b32 s92, s92, 3
s_lshl_b32 s97, s40, 2
s_add_u32 s92, s92, s97
s_mul_i32 s92, s92, 55296
s_lshl_b32 s97, s52, 10
s_add_u32 s92, s92, s97
s_add_u32 s92, s92, 10485760
v_add_u32_e64 v12, s92, v6
s_add_u32 s92, s52, 3
s_and_b32 s92, s92, 3
s_lshl_b32 s97, s40, 2
s_add_u32 s92, s92, s97
s_mul_i32 s92, s92, 55296
s_lshl_b32 s97, s52, 10
s_add_u32 s92, s92, s97
s_add_u32 s92, s92, 10485760
v_add_u32_e64 v13, s92, v6
buffer_load_dwordx4 a[212:215], v246, s[8:11], s77 offen offset:3072 sc1
s_cmp_eq_u32 s52, 0
s_cselect_b32 s92, 40, 39
s_mul_i32 s93, s52, 656
s_add_u32 s93, s93, 524288
v_min_u32 v196, s92, v1
v_mul_u32_u24 v196, 16, v196
v_add_u32 v196, s93, v196
s_lshl_b32 s92, s40, 8
s_lshl_b32 s93, s52, 15
s_add_u32 s92, s92, s93
s_add_u32 s92, s92, 18874368
v_lshlrev_b32_e64 v199, 13, v2
v_lshl_add_u32 v199, v5, 4, v199
v_add_u32_e64 v199, s92, v199
v_bfe_u32 v200, v1, 2, 2
v_lshlrev_b32_e64 v201, 10, v2
v_lshl_add_u32 v201, v200, 7, v201
v_lshrrev_b32 v200, 1, v200
v_and_b32 v7, 1, v2
v_lshl_or_b32 v200, v7, 1, v200
v_xor_b32_e64 v200, s52, v200
v_lshl_add_u32 v201, v200, 5, v201
buffer_load_dwordx4 a[216:219], v247, s[8:11], s77 offen offset:0 sc1
v_and_b32_e64 v200, 3, v1
v_lshl_add_u32 v201, v200, 3, v201
v_add_u32 v200, 65536, v201
v_add_u32 v201, 106496, v201
v_add_u32_e64 v202, 0, v6
s_mul_i32 s92, s52, 2560
s_add_u32 s76, s92, 147456
v_mul_u32_u24 v243, 160, v5
v_add_u32_e64 v243, s76, v243
v_lshl_add_u32 v244, v7, 3, v243
v_lshrrev_b32_e64 v7, 1, v2
v_mul_u32_u24 v7, 80, v7
v_add3_u32 v244, v244, v7, 64
v_lshl_add_u32 v243, v2, 3, v243
v_add_u32_e64 v197, s76, v6
s_mul_i32 s92, s52, 655360
s_add_u32 s92, s92, s49
s_mul_i32 s77, s27, 5
buffer_load_dwordx4 a[220:223], v246, s[8:11], s77 offen offset:0 sc1
v_add_u32_e64 v7, 0, v1
v_mul_u32_u24 v2, 6554, v7
v_lshrrev_b32 v2, 16, v2
v_mul_u32_u24 v198, 10, v2
v_sub_u32_e64 v7, v7, v198
v_mul_u32_u24 v2, 40960, v2
v_cmp_lt_u32_e64 vcc, 4, v7
v_lshl_add_u32 v2, v7, 4, v2
v_add_u32 v7, 560, v2
v_cndmask_b32 v2, v2, v7, vcc
v_add_u32 v240, s92, v2
v_add_u32_e64 v7, 64, v1
v_mul_u32_u24 v2, 6554, v7
v_lshrrev_b32 v2, 16, v2
v_mul_u32_u24 v198, 10, v2
v_sub_u32_e64 v7, v7, v198
v_mul_u32_u24 v2, 40960, v2
v_cmp_lt_u32_e64 vcc, 4, v7
v_lshl_add_u32 v2, v7, 4, v2
v_add_u32 v7, 560, v2
v_cndmask_b32_e64 v2, v2, v7, vcc
buffer_load_dwordx4 a[224:227], v246, s[8:11], s77 offen offset:1024 sc1
v_add_u32_e64 v241, s92, v2
v_add_u32 v7, 128, v1
v_mul_u32_u24 v2, 6554, v7
v_lshrrev_b32 v2, 16, v2
v_mul_u32_u24 v198, 10, v2
v_sub_u32_e64 v7, v7, v198
v_mul_u32_u24 v2, 40960, v2
v_cmp_lt_u32_e64 vcc, 4, v7
v_lshl_add_u32 v2, v7, 4, v2
v_add_u32 v7, 560, v2
v_cndmask_b32 v2, v2, v7, vcc
v_add_u32 v242, s92, v2
v_lshlrev_b32 v5, 3, v5
s_lshl_b32 s75, s52, 10
buffer_load_dwordx4 a[228:231], v246, s[8:11], s77 offen offset:2048 sc1
s_lshl_b32 s92, s40, 5
v_add_u32 v7, s92, v4
v_mul_u32_u24_e64 v7, 16, v7
v_add_u32 v7, 262144, v7
buffer_load_dword v14, v7, s[8:11], 0 offen sc1
buffer_load_dwordx4 a[232:235], v246, s[8:11], s77 offen offset:3072 sc1
buffer_load_dwordx4 a[236:239], v247, s[8:11], s77 offen offset:0 sc1
s_mul_i32 s77, s57, 5
buffer_load_dwordx4 a[240:243], v246, s[8:11], s77 offen offset:0 sc1
buffer_load_dwordx4 a[244:247], v246, s[8:11], s77 offen offset:1024 sc1
buffer_load_dwordx4 a[248:251], v246, s[8:11], s77 offen offset:2048 sc1
buffer_load_dwordx4 a[252:255], v246, s[8:11], s77 offen offset:3072 sc1
buffer_load_dwordx4 v[208:211], v247, s[8:11], s77 offen offset:0 sc1
s_cmp_ge_u32 s52, 2
s_cbranch_scc1 L_w1335
s_nop 0
s_mov_b32 s77, 266240
buffer_load_dwordx4 v[212:215], v246, s[8:11], s77 offen offset:0 sc1
buffer_load_dwordx4 v[216:219], v246, s[8:11], s77 offen offset:1024 sc1
buffer_load_dwordx4 v[220:223], v246, s[8:11], s77 offen offset:2048 sc1
buffer_load_dwordx4 v[224:227], v246, s[8:11], s77 offen offset:3072 sc1
buffer_load_dwordx4 v[228:231], v247, s[8:11], s77 offen offset:0 sc1
L_w1335:
s_waitcnt vmcnt(7)
s_mov_b32 s79, 0
L_poll37:
v_cmp_ne_u32 vcc, s56, v14
s_add_u32 s79, s79, 1
s_cmp_eq_u64 vcc, 0
s_cbranch_scc1 L_polld38
buffer_load_dword v14, v7, s[8:11], 0 offen sc1
s_waitcnt vmcnt(0)
s_cmp_lt_u32 s79, 200000
s_cbranch_scc1 L_poll37
L_polld38:
L_join4:
buffer_load_dwordx4 v[96:99], v10, s[8:11], s12 offen sc1
buffer_load_dwordx4 v[100:103], v11, s[8:11], s12 offen sc1
buffer_load_dwordx4 v[104:107], v12, s[8:11], s12 offen sc1
buffer_load_dwordx4 v[108:111], v13, s[8:11], s12 offen sc1
buffer_load_dwordx4 v[112:115], v10, s[8:11], s13 offen sc1
buffer_load_dwordx4 v[116:119], v11, s[8:11], s13 offen sc1
buffer_load_dwordx4 v[120:123], v12, s[8:11], s13 offen sc1
buffer_load_dwordx4 v[124:127], v13, s[8:11], s13 offen sc1
buffer_load_dwordx4 v[128:131], v10, s[8:11], s14 offen sc1
buffer_load_dwordx4 v[132:135], v11, s[8:11], s14 offen sc1
buffer_load_dwordx4 v[136:139], v12, s[8:11], s14 offen sc1
buffer_load_dwordx4 v[140:143], v13, s[8:11], s14 offen sc1
buffer_load_dwordx4 v[144:147], v10, s[8:11], s15 offen sc1
buffer_load_dwordx4 v[148:151], v11, s[8:11], s15 offen sc1
buffer_load_dwordx4 v[152:155], v12, s[8:11], s15 offen sc1
buffer_load_dwordx4 v[156:159], v13, s[8:11], s15 offen sc1
s_waitcnt vmcnt(12)
s_nop 0
v_mfma_f32_16x16x32_bf16 v[16:19], a[0:3], v[96:99], 0
buffer_load_dwordx4 v[160:163], v10, s[8:11], s16 offen sc1
v_mfma_f32_16x16x32_bf16 v[20:23], a[4:7], v[96:99], 0
v_mfma_f32_16x16x32_bf16 v[24:27], a[8:11], v[96:99], 0
v_mfma_f32_16x16x32_bf16 v[28:31], a[12:15], v[96:99], 0
v_mfma_f32_16x16x32_bf16 v[32:35], a[16:19], v[96:99], 0
buffer_load_dwordx4 v[164:167], v11, s[8:11], s16 offen sc1
v_mfma_f32_16x16x32_bf16 v[36:39], a[0:3], v[100:103], 0
v_mfma_f32_16x16x32_bf16 v[40:43], a[4:7], v[100:103], 0
v_mfma_f32_16x16x32_bf16 v[44:47], a[8:11], v[100:103], 0
v_mfma_f32_16x16x32_bf16 v[48:51], a[12:15], v[100:103], 0
v_mfma_f32_16x16x32_bf16 v[52:55], a[16:19], v[100:103], 0
buffer_load_dwordx4 v[168:171], v12, s[8:11], s16 offen sc1
v_mfma_f32_16x16x32_bf16 v[56:59], a[0:3], v[104:107], 0
v_mfma_f32_16x16x32_bf16 v[60:63], a[4:7], v[104:107], 0
v_mfma_f32_16x16x32_bf16 v[64:67], a[8:11], v[104:107], 0
v_mfma_f32_16x16x32_bf16 v[68:71], a[12:15], v[104:107], 0
v_mfma_f32_16x16x32_bf16 v[72:75], a[16:19], v[104:107], 0
buffer_load_dwordx4 v[172:175], v13, s[8:11], s16 offen sc1
v_mfma_f32_16x16x32_bf16 v[76:79], a[0:3], v[108:111], 0
v_mfma_f32_16x16x32_bf16 v[80:83], a[4:7], v[108:111], 0
v_mfma_f32_16x16x32_bf16 v[84:87], a[8:11], v[108:111], 0
v_mfma_f32_16x16x32_bf16 v[88:91], a[12:15], v[108:111], 0
v_mfma_f32_16x16x32_bf16 v[92:95], a[16:19], v[108:111], 0
s_waitcnt vmcnt(12)
s_nop 0
v_mfma_f32_16x16x32_bf16 v[16:19], a[20:23], v[112:115], v[16:19]
buffer_load_dwordx4 v[96:99], v10, s[8:11], s17 offen sc1
v_mfma_f32_16x16x32_bf16 v[20:23], a[24:27], v[112:115], v[20:23]
ds_read_b128 a[0:3], v202 offset:0
v_mfma_f32_16x16x32_bf16 v[24:27], a[28:31], v[112:115], v[24:27]
v_mfma_f32_16x16x32_bf16 v[28:31], a[32:35], v[112:115], v[28:31]
v_mfma_f32_16x16x32_bf16 v[32:35], a[36:39], v[112:115], v[32:35]
buffer_load_dwordx4 v[100:103], v11, s[8:11], s17 offen sc1
v_mfma_f32_16x16x32_bf16 v[36:39], a[20:23], v[116:119], v[36:39]
ds_read_b128 a[4:7], v202 offset:1024
v_mfma_f32_16x16x32_bf16 v[40:43], a[24:27], v[116:119], v[40:43]
v_mfma_f32_16x16x32_bf16 v[44:47], a[28:31], v[116:119], v[44:47]
v_mfma_f32_16x16x32_bf16 v[48:51], a[32:35], v[116:119], v[48:51]
v_mfma_f32_16x16x32_bf16 v[52:55], a[36:39], v[116:119], v[52:55]
buffer_load_dwordx4 v[104:107], v12, s[8:11], s17 offen sc1
ds_read_b128 a[8:11], v202 offset:2048
v_mfma_f32_16x16x32_bf16 v[56:59], a[20:23], v[120:123], v[56:59]
v_mfma_f32_16x16x32_bf16 v[60:63], a[24:27], v[120:123], v[60:63]
v_mfma_f32_16x16x32_bf16 v[64:67], a[28:31], v[120:123], v[64:67]
v_mfma_f32_16x16x32_bf16 v[68:71], a[32:35], v[120:123], v[68:71]
ds_read_b128 a[12:15], v202 offset:3072
v_mfma_f32_16x16x32_bf16 v[72:75], a[36:39], v[120:123], v[72:75]
buffer_load_dwordx4 v[108:111], v13, s[8:11], s17 offen sc1
v_mfma_f32_16x16x32_bf16 v[76:79], a[20:23], v[124:127], v[76:79]
v_mfma_f32_16x16x32_bf16 v[80:83], a[24:27], v[124:127], v[80:83]
v_mfma_f32_16x16x32_bf16 v[84:87], a[28:31], v[124:127], v[84:87]
ds_read_b128 a[16:19], v202 offset:4096
v_mfma_f32_16x16x32_bf16 v[88:91], a[32:35], v[124:127], v[88:91]
v_mfma_f32_16x16x32_bf16 v[92:95], a[36:39], v[124:127], v[92:95]
s_waitcnt vmcnt(12)
s_nop 0
v_mfma_f32_16x16x32_bf16 v[16:19], a[40:43], v[128:131], v[16:19]
buffer_load_dwordx4 v[112:115], v10, s[8:11], s18 offen sc1
v_mfma_f32_16x16x32_bf16 v[20:23], a[44:47], v[128:131], v[20:23]
ds_read_b128 a[20:23], v202 offset:5120
v_mfma_f32_16x16x32_bf16 v[24:27], a[48:51], v[128:131], v[24:27]
v_mfma_f32_16x16x32_bf16 v[28:31], a[52:55], v[128:131], v[28:31]
buffer_load_dwordx4 v[116:119], v11, s[8:11], s18 offen sc1
v_mfma_f32_16x16x32_bf16 v[32:35], a[56:59], v[128:131], v[32:35]
v_mfma_f32_16x16x32_bf16 v[36:39], a[40:43], v[132:135], v[36:39]
ds_read_b128 a[24:27], v202 offset:6144
v_mfma_f32_16x16x32_bf16 v[40:43], a[44:47], v[132:135], v[40:43]
v_mfma_f32_16x16x32_bf16 v[44:47], a[48:51], v[132:135], v[44:47]
buffer_load_dwordx4 v[120:123], v12, s[8:11], s18 offen sc1
v_mfma_f32_16x16x32_bf16 v[48:51], a[52:55], v[132:135], v[48:51]
v_mfma_f32_16x16x32_bf16 v[52:55], a[56:59], v[132:135], v[52:55]
ds_read_b128 a[28:31], v202 offset:7168
v_mfma_f32_16x16x32_bf16 v[56:59], a[40:43], v[136:139], v[56:59]
v_mfma_f32_16x16x32_bf16 v[60:63], a[44:47], v[136:139], v[60:63]
buffer_load_dwordx4 v[124:127], v13, s[8:11], s18 offen sc1
v_mfma_f32_16x16x32_bf16 v[64:67], a[48:51], v[136:139], v[64:67]
v_mfma_f32_16x16x32_bf16 v[68:71], a[52:55], v[136:139], v[68:71]
ds_read_b128 a[32:35], v202 offset:8192
v_mfma_f32_16x16x32_bf16 v[72:75], a[56:59], v[136:139], v[72:75]
v_mfma_f32_16x16x32_bf16 v[76:79], a[40:43], v[140:143], v[76:79]
s_add_u32 m0, s76, 0
s_nop 0
buffer_load_dwordx4 v240, s[4:7], 0 offen lds
v_mfma_f32_16x16x32_bf16 v[80:83], a[44:47], v[140:143], v[80:83]
v_mfma_f32_16x16x32_bf16 v[84:87], a[48:51], v[140:143], v[84:87]
ds_read_b128 a[36:39], v202 offset:9216
v_mfma_f32_16x16x32_bf16 v[88:91], a[52:55], v[140:143], v[88:91]
v_mfma_f32_16x16x32_bf16 v[92:95], a[56:59], v[140:143], v[92:95]
s_waitcnt vmcnt(13)
s_nop 0
v_mfma_f32_16x16x32_bf16 v[16:19], a[60:63], v[144:147], v[16:19]
buffer_load_dwordx4 v[128:131], v10, s[8:11], s19 offen sc1
v_mfma_f32_16x16x32_bf16 v[20:23], a[64:67], v[144:147], v[20:23]
ds_read_b128 a[40:43], v202 offset:10240
v_mfma_f32_16x16x32_bf16 v[24:27], a[68:71], v[144:147], v[24:27]
v_mfma_f32_16x16x32_bf16 v[28:31], a[72:75], v[144:147], v[28:31]
buffer_load_dwordx4 v[132:135], v11, s[8:11], s19 offen sc1
v_mfma_f32_16x16x32_bf16 v[32:35], a[76:79], v[144:147], v[32:35]
v_mfma_f32_16x16x32_bf16 v[36:39], a[60:63], v[148:151], v[36:39]
ds_read_b128 a[44:47], v202 offset:11264
v_mfma_f32_16x16x32_bf16 v[40:43], a[64:67], v[148:151], v[40:43]
v_mfma_f32_16x16x32_bf16 v[44:47], a[68:71], v[148:151], v[44:47]
buffer_load_dwordx4 v[136:139], v12, s[8:11], s19 offen sc1
v_mfma_f32_16x16x32_bf16 v[48:51], a[72:75], v[148:151], v[48:51]
v_mfma_f32_16x16x32_bf16 v[52:55], a[76:79], v[148:151], v[52:55]
ds_read_b128 a[48:51], v202 offset:12288
v_mfma_f32_16x16x32_bf16 v[56:59], a[60:63], v[152:155], v[56:59]
v_mfma_f32_16x16x32_bf16 v[60:63], a[64:67], v[152:155], v[60:63]
buffer_load_dwordx4 v[140:143], v13, s[8:11], s19 offen sc1
v_mfma_f32_16x16x32_bf16 v[64:67], a[68:71], v[152:155], v[64:67]
v_mfma_f32_16x16x32_bf16 v[68:71], a[72:75], v[152:155], v[68:71]
ds_read_b128 a[52:55], v202 offset:13312
v_mfma_f32_16x16x32_bf16 v[72:75], a[76:79], v[152:155], v[72:75]
v_mfma_f32_16x16x32_bf16 v[76:79], a[60:63], v[156:159], v[76:79]
s_add_u32 m0, s76, 1024
s_nop 0
s_nop 0
buffer_load_dwordx4 v241, s[4:7], 0 offen lds
v_mfma_f32_16x16x32_bf16 v[80:83], a[64:67], v[156:159], v[80:83]
v_mfma_f32_16x16x32_bf16 v[84:87], a[68:71], v[156:159], v[84:87]
ds_read_b128 a[56:59], v202 offset:14336
v_mfma_f32_16x16x32_bf16 v[88:91], a[72:75], v[156:159], v[88:91]
v_mfma_f32_16x16x32_bf16 v[92:95], a[76:79], v[156:159], v[92:95]
s_waitcnt vmcnt(14)
s_nop 0
v_mfma_f32_16x16x32_bf16 v[16:19], a[80:83], v[160:163], v[16:19]
buffer_load_dwordx4 v[144:147], v10, s[8:11], s24 offen sc1
v_mfma_f32_16x16x32_bf16 v[20:23], a[84:87], v[160:163], v[20:23]
ds_read_b128 a[60:63], v202 offset:15360
v_mfma_f32_16x16x32_bf16 v[24:27], a[88:91], v[160:163], v[24:27]
v_mfma_f32_16x16x32_bf16 v[28:31], a[92:95], v[160:163], v[28:31]
buffer_load_dwordx4 v[148:151], v11, s[8:11], s24 offen sc1
v_mfma_f32_16x16x32_bf16 v[32:35], a[96:99], v[160:163], v[32:35]
v_mfma_f32_16x16x32_bf16 v[36:39], a[80:83], v[164:167], v[36:39]
ds_read_b128 a[64:67], v202 offset:16384
v_mfma_f32_16x16x32_bf16 v[40:43], a[84:87], v[164:167], v[40:43]
v_mfma_f32_16x16x32_bf16 v[44:47], a[88:91], v[164:167], v[44:47]
buffer_load_dwordx4 v[152:155], v12, s[8:11], s24 offen sc1
v_mfma_f32_16x16x32_bf16 v[48:51], a[92:95], v[164:167], v[48:51]
v_mfma_f32_16x16x32_bf16 v[52:55], a[96:99], v[164:167], v[52:55]
ds_read_b128 a[68:71], v202 offset:17408
v_mfma_f32_16x16x32_bf16 v[56:59], a[80:83], v[168:171], v[56:59]
v_mfma_f32_16x16x32_bf16 v[60:63], a[84:87], v[168:171], v[60:63]
buffer_load_dwordx4 v[156:159], v13, s[8:11], s24 offen sc1
v_mfma_f32_16x16x32_bf16 v[64:67], a[88:91], v[168:171], v[64:67]
v_mfma_f32_16x16x32_bf16 v[68:71], a[92:95], v[168:171], v[68:71]
ds_read_b128 a[72:75], v202 offset:18432
v_mfma_f32_16x16x32_bf16 v[72:75], a[96:99], v[168:171], v[72:75]
v_mfma_f32_16x16x32_bf16 v[76:79], a[80:83], v[172:175], v[76:79]
s_add_u32 m0, s76, 2048
s_mov_b32 exec_hi, 0
buffer_load_dwordx4 v242, s[4:7], 0 offen lds
s_mov_b32 exec_hi, -1
v_mfma_f32_16x16x32_bf16 v[80:83], a[84:87], v[172:175], v[80:83]
v_mfma_f32_16x16x32_bf16 v[84:87], a[88:91], v[172:175], v[84:87]
ds_read_b128 a[76:79], v202 offset:19456
v_mfma_f32_16x16x32_bf16 v[88:91], a[92:95], v[172:175], v[88:91]
v_mfma_f32_16x16x32_bf16 v[92:95], a[96:99], v[172:175], v[92:95]
s_waitcnt vmcnt(15)
s_nop 0
v_mfma_f32_16x16x32_bf16 v[16:19], a[100:103], v[96:99], v[16:19]
buffer_load_dwordx4 v[160:163], v10, s[8:11], s25 offen sc1
v_mfma_f32_16x16x32_bf16 v[20:23], a[104:107], v[96:99], v[20:23]
ds_read_b128 a[80:83], v202 offset:20480
v_mfma_f32_16x16x32_bf16 v[24:27], a[108:111], v[96:99], v[24:27]
v_mfma_f32_16x16x32_bf16 v[28:31], a[112:115], v[96:99], v[28:31]
v_mfma_f32_16x16x32_bf16 v[32:35], a[116:119], v[96:99], v[32:35]
buffer_load_dwordx4 v[164:167], v11, s[8:11], s25 offen sc1
v_mfma_f32_16x16x32_bf16 v[36:39], a[100:103], v[100:103], v[36:39]
ds_read_b128 a[84:87], v202 offset:21504
v_mfma_f32_16x16x32_bf16 v[40:43], a[104:107], v[100:103], v[40:43]
v_mfma_f32_16x16x32_bf16 v[44:47], a[108:111], v[100:103], v[44:47]
v_mfma_f32_16x16x32_bf16 v[48:51], a[112:115], v[100:103], v[48:51]
v_mfma_f32_16x16x32_bf16 v[52:55], a[116:119], v[100:103], v[52:55]
buffer_load_dwordx4 v[168:171], v12, s[8:11], s25 offen sc1
ds_read_b128 a[88:91], v202 offset:22528
v_mfma_f32_16x16x32_bf16 v[56:59], a[100:103], v[104:107], v[56:59]
v_mfma_f32_16x16x32_bf16 v[60:63], a[104:107], v[104:107], v[60:63]
v_mfma_f32_16x16x32_bf16 v[64:67], a[108:111], v[104:107], v[64:67]
v_mfma_f32_16x16x32_bf16 v[68:71], a[112:115], v[104:107], v[68:71]
ds_read_b128 a[92:95], v202 offset:23552
v_mfma_f32_16x16x32_bf16 v[72:75], a[116:119], v[104:107], v[72:75]
buffer_load_dwordx4 v[172:175], v13, s[8:11], s25 offen sc1
v_mfma_f32_16x16x32_bf16 v[76:79], a[100:103], v[108:111], v[76:79]
v_mfma_f32_16x16x32_bf16 v[80:83], a[104:107], v[108:111], v[80:83]
v_mfma_f32_16x16x32_bf16 v[84:87], a[108:111], v[108:111], v[84:87]
ds_read_b128 a[96:99], v202 offset:24576
v_mfma_f32_16x16x32_bf16 v[88:91], a[112:115], v[108:111], v[88:91]
v_mfma_f32_16x16x32_bf16 v[92:95], a[116:119], v[108:111], v[92:95]
s_waitcnt vmcnt(15)
s_nop 0
v_mfma_f32_16x16x32_bf16 v[16:19], a[120:123], v[112:115], v[16:19]
buffer_load_dwordx4 v[96:99], v10, s[8:11], s26 offen sc1
v_mfma_f32_16x16x32_bf16 v[20:23], a[124:127], v[112:115], v[20:23]
ds_read_b128 a[100:103], v202 offset:25600
v_mfma_f32_16x16x32_bf16 v[24:27], a[128:131], v[112:115], v[24:27]
v_mfma_f32_16x16x32_bf16 v[28:31], a[132:135], v[112:115], v[28:31]
v_mfma_f32_16x16x32_bf16 v[32:35], a[136:139], v[112:115], v[32:35]
buffer_load_dwordx4 v[100:103], v11, s[8:11], s26 offen sc1
v_mfma_f32_16x16x32_bf16 v[36:39], a[120:123], v[116:119], v[36:39]
ds_read_b128 a[104:107], v202 offset:26624
v_mfma_f32_16x16x32_bf16 v[40:43], a[124:127], v[116:119], v[40:43]
v_mfma_f32_16x16x32_bf16 v[44:47], a[128:131], v[116:119], v[44:47]
v_mfma_f32_16x16x32_bf16 v[48:51], a[132:135], v[116:119], v[48:51]
v_mfma_f32_16x16x32_bf16 v[52:55], a[136:139], v[116:119], v[52:55]
buffer_load_dwordx4 v[104:107], v12, s[8:11], s26 offen sc1
ds_read_b128 a[108:111], v202 offset:27648
v_mfma_f32_16x16x32_bf16 v[56:59], a[120:123], v[120:123], v[56:59]
v_mfma_f32_16x16x32_bf16 v[60:63], a[124:127], v[120:123], v[60:63]
v_mfma_f32_16x16x32_bf16 v[64:67], a[128:131], v[120:123], v[64:67]
v_mfma_f32_16x16x32_bf16 v[68:71], a[132:135], v[120:123], v[68:71]
ds_read_b128 a[112:115], v202 offset:28672
v_mfma_f32_16x16x32_bf16 v[72:75], a[136:139], v[120:123], v[72:75]
buffer_load_dwordx4 v[108:111], v13, s[8:11], s26 offen sc1
v_mfma_f32_16x16x32_bf16 v[76:79], a[120:123], v[124:127], v[76:79]
v_mfma_f32_16x16x32_bf16 v[80:83], a[124:127], v[124:127], v[80:83]
v_mfma_f32_16x16x32_bf16 v[84:87], a[128:131], v[124:127], v[84:87]
ds_read_b128 a[116:119], v202 offset:29696
v_mfma_f32_16x16x32_bf16 v[88:91], a[132:135], v[124:127], v[88:91]
v_mfma_f32_16x16x32_bf16 v[92:95], a[136:139], v[124:127], v[92:95]
s_waitcnt vmcnt(14)
s_nop 0
v_mfma_f32_16x16x32_bf16 v[16:19], a[140:143], v[128:131], v[16:19]
buffer_load_dwordx4 v[112:115], v10, s[8:11], s27 offen sc1
v_mfma_f32_16x16x32_bf16 v[20:23], a[144:147], v[128:131], v[20:23]
ds_read_b128 a[120:123], v202 offset:30720
v_mfma_f32_16x16x32_bf16 v[24:27], a[148:151], v[128:131], v[24:27]
v_mfma_f32_16x16x32_bf16 v[28:31], a[152:155], v[128:131], v[28:31]
v_mfma_f32_16x16x32_bf16 v[32:35], a[156:159], v[128:131], v[32:35]
buffer_load_dwordx4 v[116:119], v11, s[8:11], s27 offen sc1
v_mfma_f32_16x16x32_bf16 v[36:39], a[140:143], v[132:135], v[36:39]
ds_read_b128 a[124:127], v202 offset:31744
v_mfma_f32_16x16x32_bf16 v[40:43], a[144:147], v[132:135], v[40:43]
v_mfma_f32_16x16x32_bf16 v[44:47], a[148:151], v[132:135], v[44:47]
v_mfma_f32_16x16x32_bf16 v[48:51], a[152:155], v[132:135], v[48:51]
v_mfma_f32_16x16x32_bf16 v[52:55], a[156:159], v[132:135], v[52:55]
buffer_load_dwordx4 v[120:123], v12, s[8:11], s27 offen sc1
ds_read_b128 a[128:131], v202 offset:32768
v_mfma_f32_16x16x32_bf16 v[56:59], a[140:143], v[136:139], v[56:59]
v_mfma_f32_16x16x32_bf16 v[60:63], a[144:147], v[136:139], v[60:63]
v_mfma_f32_16x16x32_bf16 v[64:67], a[148:151], v[136:139], v[64:67]
v_mfma_f32_16x16x32_bf16 v[68:71], a[152:155], v[136:139], v[68:71]
ds_read_b128 a[132:135], v202 offset:33792
v_mfma_f32_16x16x32_bf16 v[72:75], a[156:159], v[136:139], v[72:75]
buffer_load_dwordx4 v[124:127], v13, s[8:11], s27 offen sc1
v_mfma_f32_16x16x32_bf16 v[76:79], a[140:143], v[140:143], v[76:79]
v_mfma_f32_16x16x32_bf16 v[80:83], a[144:147], v[140:143], v[80:83]
v_mfma_f32_16x16x32_bf16 v[84:87], a[148:151], v[140:143], v[84:87]
ds_read_b128 a[136:139], v202 offset:34816
v_mfma_f32_16x16x32_bf16 v[88:91], a[152:155], v[140:143], v[88:91]
v_mfma_f32_16x16x32_bf16 v[92:95], a[156:159], v[140:143], v[92:95]
s_waitcnt vmcnt(13)
s_nop 0
v_mfma_f32_16x16x32_bf16 v[16:19], a[160:163], v[144:147], v[16:19]
buffer_load_dwordx4 v[128:131], v10, s[8:11], s57 offen sc1
v_mfma_f32_16x16x32_bf16 v[20:23], a[164:167], v[144:147], v[20:23]
ds_read_b128 a[140:143], v202 offset:35840
v_mfma_f32_16x16x32_bf16 v[24:27], a[168:171], v[144:147], v[24:27]
v_mfma_f32_16x16x32_bf16 v[28:31], a[172:175], v[144:147], v[28:31]
buffer_load_dwordx4 v[132:135], v11, s[8:11], s57 offen sc1
v_mfma_f32_16x16x32_bf16 v[32:35], a[176:179], v[144:147], v[32:35]
v_mfma_f32_16x16x32_bf16 v[36:39], a[160:163], v[148:151], v[36:39]
ds_read_b128 a[144:147], v202 offset:36864
v_mfma_f32_16x16x32_bf16 v[40:43], a[164:167], v[148:151], v[40:43]
v_mfma_f32_16x16x32_bf16 v[44:47], a[168:171], v[148:151], v[44:47]
buffer_load_dwordx4 v[136:139], v12, s[8:11], s57 offen sc1
v_mfma_f32_16x16x32_bf16 v[48:51], a[172:175], v[148:151], v[48:51]
v_mfma_f32_16x16x32_bf16 v[52:55], a[176:179], v[148:151], v[52:55]
ds_read_b128 a[148:151], v202 offset:37888
v_mfma_f32_16x16x32_bf16 v[56:59], a[160:163], v[152:155], v[56:59]
v_mfma_f32_16x16x32_bf16 v[60:63], a[164:167], v[152:155], v[60:63]
buffer_load_dwordx4 v[140:143], v13, s[8:11], s57 offen sc1
v_mfma_f32_16x16x32_bf16 v[64:67], a[168:171], v[152:155], v[64:67]
v_mfma_f32_16x16x32_bf16 v[68:71], a[172:175], v[152:155], v[68:71]
ds_read_b128 a[152:155], v202 offset:38912
v_mfma_f32_16x16x32_bf16 v[72:75], a[176:179], v[152:155], v[72:75]
v_mfma_f32_16x16x32_bf16 v[76:79], a[160:163], v[156:159], v[76:79]
buffer_load_dword v203, v196, s[8:11], 0 offen sc1
v_mfma_f32_16x16x32_bf16 v[80:83], a[164:167], v[156:159], v[80:83]
v_mfma_f32_16x16x32_bf16 v[84:87], a[168:171], v[156:159], v[84:87]
ds_read_b128 a[156:159], v202 offset:39936
v_mfma_f32_16x16x32_bf16 v[88:91], a[172:175], v[156:159], v[88:91]
v_mfma_f32_16x16x32_bf16 v[92:95], a[176:179], v[156:159], v[92:95]
s_waitcnt vmcnt(13)
v_mfma_f32_16x16x32_bf16 v[16:19], a[180:183], v[160:163], v[16:19]
s_cmp_ge_u32 s52, 2
s_cbranch_scc1 L_h1339
s_nop 0
s_mov_b32 s72, 53248
buffer_load_dwordx4 v[144:147], v10, s[8:11], s72 offen sc1
buffer_load_dwordx4 v[148:151], v11, s[8:11], s72 offen sc1
buffer_load_dwordx4 v[152:155], v12, s[8:11], s72 offen sc1
buffer_load_dwordx4 v[156:159], v13, s[8:11], s72 offen sc1
L_h1339:
v_mfma_f32_16x16x32_bf16 v[20:23], a[184:187], v[160:163], v[20:23]
ds_read_b128 a[160:163], v202 offset:40960
v_mfma_f32_16x16x32_bf16 v[24:27], a[188:191], v[160:163], v[24:27]
v_mfma_f32_16x16x32_bf16 v[28:31], a[192:195], v[160:163], v[28:31]
v_mfma_f32_16x16x32_bf16 v[32:35], a[196:199], v[160:163], v[32:35]
v_mfma_f32_16x16x32_bf16 v[36:39], a[180:183], v[164:167], v[36:39]
ds_read_b128 a[164:167], v202 offset:41984
v_mfma_f32_16x16x32_bf16 v[40:43], a[184:187], v[164:167], v[40:43]
v_mfma_f32_16x16x32_bf16 v[44:47], a[188:191], v[164:167], v[44:47]
v_mfma_f32_16x16x32_bf16 v[48:51], a[192:195], v[164:167], v[48:51]
v_mfma_f32_16x16x32_bf16 v[52:55], a[196:199], v[164:167], v[52:55]
ds_read_b128 a[168:171], v202 offset:43008
v_mfma_f32_16x16x32_bf16 v[56:59], a[180:183], v[168:171], v[56:59]
v_mfma_f32_16x16x32_bf16 v[60:63], a[184:187], v[168:171], v[60:63]
v_mfma_f32_16x16x32_bf16 v[64:67], a[188:191], v[168:171], v[64:67]
v_mfma_f32_16x16x32_bf16 v[68:71], a[192:195], v[168:171], v[68:71]
ds_read_b128 a[172:175], v202 offset:44032
v_mfma_f32_16x16x32_bf16 v[72:75], a[196:199], v[168:171], v[72:75]
v_mfma_f32_16x16x32_bf16 v[76:79], a[180:183], v[172:175], v[76:79]
v_mfma_f32_16x16x32_bf16 v[80:83], a[184:187], v[172:175], v[80:83]
v_mfma_f32_16x16x32_bf16 v[84:87], a[188:191], v[172:175], v[84:87]
ds_read_b128 a[176:179], v202 offset:45056
v_mfma_f32_16x16x32_bf16 v[88:91], a[192:195], v[172:175], v[88:91]
v_mfma_f32_16x16x32_bf16 v[92:95], a[196:199], v[172:175], v[92:95]
s_waitcnt vmcnt(9)
v_mfma_f32_16x16x32_bf16 v[16:19], a[200:203], v[96:99], v[16:19]
s_waitcnt vmcnt(0)
s_mov_b32 s79, 0
L_poll40:
v_cmp_ne_u32_e64 vcc, s56, v203
s_add_u32 s79, s79, 1
s_cmp_eq_u64 vcc, 0
s_cbranch_scc1 L_polld41
buffer_load_dword v203, v196, s[8:11], 0 offen sc1
s_waitcnt vmcnt(0)
s_cmp_lt_u32 s79, 200000
s_cbranch_scc1 L_poll40
L_polld41:
v_mfma_f32_16x16x32_bf16 v[20:23], a[204:207], v[96:99], v[20:23]
ds_read_b128 a[180:183], v202 offset:46080
v_mfma_f32_16x16x32_bf16 v[24:27], a[208:211], v[96:99], v[24:27]
s_lshl_b32 s92, s40, 6
s_lshl_b32 s93, s52, 4
s_add_u32 s92, s92, s93
s_lshl_b32 s92, s92, 3
s_add_u32 s92, s92, 65536
buffer_load_dword v206, v5, s[8:11], s92 offen sc1
v_mfma_f32_16x16x32_bf16 v[28:31], a[212:215], v[96:99], v[28:31]
v_mfma_f32_16x16x32_bf16 v[32:35], a[216:219], v[96:99], v[32:35]
v_mfma_f32_16x16x32_bf16 v[36:39], a[200:203], v[100:103], v[36:39]
s_add_u32 m0, s75, 65536
s_mov_b32 s73, 0
s_nop 0
buffer_load_dwordx4 v199, s[8:11], s73 offen sc1 lds
ds_read_b128 a[184:187], v202 offset:47104
v_mfma_f32_16x16x32_bf16 v[40:43], a[204:207], v[100:103], v[40:43]
v_mfma_f32_16x16x32_bf16 v[44:47], a[208:211], v[100:103], v[44:47]
v_mfma_f32_16x16x32_bf16 v[48:51], a[212:215], v[100:103], v[48:51]
s_add_u32 m0, s75, 69632
s_mov_b32 s73, 131072
buffer_load_dwordx4 v199, s[8:11], s73 offen sc1 lds
v_mfma_f32_16x16x32_bf16 v[52:55], a[216:219], v[100:103], v[52:55]
ds_read_b128 a[188:191], v202 offset:48128
v_mfma_f32_16x16x32_bf16 v[56:59], a[200:203], v[104:107], v[56:59]
s_add_u32 m0, s75, 73728
s_mov_b32 s73, 262144
buffer_load_dwordx4 v199, s[8:11], s73 offen sc1 lds
v_mfma_f32_16x16x32_bf16 v[60:63], a[204:207], v[104:107], v[60:63]
v_mfma_f32_16x16x32_bf16 v[64:67], a[208:211], v[104:107], v[64:67]
v_mfma_f32_16x16x32_bf16 v[68:71], a[212:215], v[104:107], v[68:71]
s_add_u32 m0, s75, 77824
s_mov_b32 s73, 393216
buffer_load_dwordx4 v199, s[8:11], s73 offen sc1 lds
ds_read_b128 a[192:195], v202 offset:49152
v_mfma_f32_16x16x32_bf16 v[72:75], a[216:219], v[104:107], v[72:75]
v_mfma_f32_16x16x32_bf16 v[76:79], a[200:203], v[108:111], v[76:79]
v_mfma_f32_16x16x32_bf16 v[80:83], a[204:207], v[108:111], v[80:83]
s_add_u32 m0, s75, 81920
s_mov_b32 s73, 524288
buffer_load_dwordx4 v199, s[8:11], s73 offen sc1 lds
v_mfma_f32_16x16x32_bf16 v[84:87], a[208:211], v[108:111], v[84:87]
ds_read_b128 a[196:199], v202 offset:50176
v_mfma_f32_16x16x32_bf16 v[88:91], a[212:215], v[108:111], v[88:91]
v_mfma_f32_16x16x32_bf16 v[92:95], a[216:219], v[108:111], v[92:95]
v_mfma_f32_16x16x32_bf16 v[16:19], a[220:223], v[112:115], v[16:19]
s_add_u32 m0, s75, 86016
s_mov_b32 s73, 655360
buffer_load_dwordx4 v199, s[8:11], s73 offen sc1 lds
v_mfma_f32_16x16x32_bf16 v[20:23], a[224:227], v[112:115], v[20:23]
ds_read_b128 a[200:203], v202 offset:51200
v_mfma_f32_16x16x32_bf16 v[24:27], a[228:231], v[112:115], v[24:27]
v_mfma_f32_16x16x32_bf16 v[28:31], a[232:235], v[112:115], v[28:31]
s_add_u32 m0, s75, 90112
s_mov_b32 s73, 786432
buffer_load_dwordx4 v199, s[8:11], s73 offen sc1 lds
v_mfma_f32_16x16x32_bf16 v[32:35], a[236:239], v[112:115], v[32:35]
v_mfma_f32_16x16x32_bf16 v[36:39], a[220:223], v[116:119], v[36:39]
ds_read_b128 a[204:207], v202 offset:52224
v_mfma_f32_16x16x32_bf16 v[40:43], a[224:227], v[116:119], v[40:43]
v_mfma_f32_16x16x32_bf16 v[44:47], a[228:231], v[116:119], v[44:47]
s_add_u32 m0, s75, 94208
s_mov_b32 s73, 917504
buffer_load_dwordx4 v199, s[8:11], s73 offen sc1 lds
v_mfma_f32_16x16x32_bf16 v[48:51], a[232:235], v[116:119], v[48:51]
v_mfma_f32_16x16x32_bf16 v[52:55], a[236:239], v[116:119], v[52:55]
ds_read_b128 a[208:211], v202 offset:53248
v_mfma_f32_16x16x32_bf16 v[56:59], a[220:223], v[120:123], v[56:59]
v_mfma_f32_16x16x32_bf16 v[60:63], a[224:227], v[120:123], v[60:63]
s_add_u32 m0, s75, 98304
s_mov_b32 s73, 1048576
buffer_load_dwordx4 v199, s[8:11], s73 offen sc1 lds
v_mfma_f32_16x16x32_bf16 v[64:67], a[228:231], v[120:123], v[64:67]
v_mfma_f32_16x16x32_bf16 v[68:71], a[232:235], v[120:123], v[68:71]
ds_read_b128 a[212:215], v202 offset:54272
v_mfma_f32_16x16x32_bf16 v[72:75], a[236:239], v[120:123], v[72:75]
v_mfma_f32_16x16x32_bf16 v[76:79], a[220:223], v[124:127], v[76:79]
s_add_u32 m0, s75, 102400
s_mov_b32 s73, 1179648
buffer_load_dwordx4 v199, s[8:11], s73 offen sc1 lds
v_mfma_f32_16x16x32_bf16 v[80:83], a[224:227], v[124:127], v[80:83]
v_mfma_f32_16x16x32_bf16 v[84:87], a[228:231], v[124:127], v[84:87]
ds_read_b128 a[216:219], v202 offset:55296
v_mfma_f32_16x16x32_bf16 v[88:91], a[232:235], v[124:127], v[88:91]
v_mfma_f32_16x16x32_bf16 v[92:95], a[236:239], v[124:127], v[92:95]
v_mfma_f32_16x16x32_bf16 v[16:19], a[240:243], v[128:131], v[16:19]
s_add_u32 m0, s75, 106496
s_mov_b32 s73, 1310720
buffer_load_dwordx4 v199, s[8:11], s73 offen sc1 lds
v_mfma_f32_16x16x32_bf16 v[20:23], a[244:247], v[128:131], v[20:23]
ds_read_b128 a[220:223], v202 offset:56320
v_mfma_f32_16x16x32_bf16 v[24:27], a[248:251], v[128:131], v[24:27]
v_mfma_f32_16x16x32_bf16 v[28:31], a[252:255], v[128:131], v[28:31]
s_add_u32 m0, s75, 110592
s_mov_b32 s73, 1441792
buffer_load_dwordx4 v199, s[8:11], s73 offen sc1 lds
v_mfma_f32_16x16x32_bf16 v[32:35], v[208:211], v[128:131], v[32:35]
v_mfma_f32_16x16x32_bf16 v[36:39], a[240:243], v[132:135], v[36:39]
ds_read_b128 a[224:227], v202 offset:57344
v_mfma_f32_16x16x32_bf16 v[40:43], a[244:247], v[132:135], v[40:43]
v_mfma_f32_16x16x32_bf16 v[44:47], a[248:251], v[132:135], v[44:47]
s_add_u32 m0, s75, 114688
s_mov_b32 s73, 1572864
buffer_load_dwordx4 v199, s[8:11], s73 offen sc1 lds
v_mfma_f32_16x16x32_bf16 v[48:51], a[252:255], v[132:135], v[48:51]
v_mfma_f32_16x16x32_bf16 v[52:55], v[208:211], v[132:135], v[52:55]
ds_read_b128 a[228:231], v202 offset:58368
v_mfma_f32_16x16x32_bf16 v[56:59], a[240:243], v[136:139], v[56:59]
v_mfma_f32_16x16x32_bf16 v[60:63], a[244:247], v[136:139], v[60:63]
s_add_u32 m0, s75, 118784
s_mov_b32 s73, 1703936
buffer_load_dwordx4 v199, s[8:11], s73 offen sc1 lds
v_mfma_f32_16x16x32_bf16 v[64:67], a[248:251], v[136:139], v[64:67]
v_mfma_f32_16x16x32_bf16 v[68:71], a[252:255], v[136:139], v[68:71]
ds_read_b128 a[232:235], v202 offset:59392
v_mfma_f32_16x16x32_bf16 v[72:75], v[208:211], v[136:139], v[72:75]
v_mfma_f32_16x16x32_bf16 v[76:79], a[240:243], v[140:143], v[76:79]
s_add_u32 m0, s75, 122880
s_mov_b32 s73, 1835008
buffer_load_dwordx4 v199, s[8:11], s73 offen sc1 lds
v_mfma_f32_16x16x32_bf16 v[80:83], a[244:247], v[140:143], v[80:83]
v_mfma_f32_16x16x32_bf16 v[84:87], a[248:251], v[140:143], v[84:87]
ds_read_b128 a[236:239], v202 offset:60416
v_mfma_f32_16x16x32_bf16 v[88:91], a[252:255], v[140:143], v[88:91]
v_mfma_f32_16x16x32_bf16 v[92:95], v[208:211], v[140:143], v[92:95]
s_add_u32 m0, s75, 126976
s_mov_b32 s73, 1966080
buffer_load_dwordx4 v199, s[8:11], s73 offen sc1 lds
s_add_u32 m0, s75, 131072
s_mov_b32 s73, 2097152
buffer_load_dwordx4 v199, s[8:11], s73 offen sc1 lds
s_add_u32 m0, s75, 135168
s_mov_b32 s73, 2228224
buffer_load_dwordx4 v199, s[8:11], s73 offen sc1 lds
s_add_u32 m0, s75, 139264
s_mov_b32 s73, 2359296
buffer_load_dwordx4 v199, s[8:11], s73 offen sc1 lds
s_add_u32 m0, s75, 143360
s_mov_b32 s73, 2490368
buffer_load_dwordx4 v199, s[8:11], s73 offen sc1 lds
s_cmp_ge_u32 s52, 2
s_cbranch_scc1 L_s1342
s_waitcnt vmcnt(21)
s_nop 0
v_mfma_f32_16x16x32_bf16 v[36:39], v[212:215], v[148:151], v[36:39]
v_mfma_f32_16x16x32_bf16 v[40:43], v[216:219], v[148:151], v[40:43]
v_mfma_f32_16x16x32_bf16 v[44:47], v[220:223], v[148:151], v[44:47]
v_mfma_f32_16x16x32_bf16 v[48:51], v[224:227], v[148:151], v[48:51]
v_mfma_f32_16x16x32_bf16 v[52:55], v[228:231], v[148:151], v[52:55]
v_mfma_f32_16x16x32_bf16 v[56:59], v[212:215], v[152:155], v[56:59]
v_mfma_f32_16x16x32_bf16 v[60:63], v[216:219], v[152:155], v[60:63]
v_mfma_f32_16x16x32_bf16 v[64:67], v[220:223], v[152:155], v[64:67]
v_mfma_f32_16x16x32_bf16 v[68:71], v[224:227], v[152:155], v[68:71]
v_mfma_f32_16x16x32_bf16 v[72:75], v[228:231], v[152:155], v[72:75]
v_mfma_f32_16x16x32_bf16 v[76:79], v[212:215], v[156:159], v[76:79]
v_mfma_f32_16x16x32_bf16 v[80:83], v[216:219], v[156:159], v[80:83]
v_mfma_f32_16x16x32_bf16 v[84:87], v[220:223], v[156:159], v[84:87]
v_mfma_f32_16x16x32_bf16 v[88:91], v[224:227], v[156:159], v[88:91]
v_mfma_f32_16x16x32_bf16 v[92:95], v[228:231], v[156:159], v[92:95]
v_mfma_f32_16x16x32_bf16 v[16:19], v[212:215], v[144:147], v[16:19]
v_mfma_f32_16x16x32_bf16 v[20:23], v[216:219], v[144:147], v[20:23]
v_mfma_f32_16x16x32_bf16 v[24:27], v[220:223], v[144:147], v[24:27]
v_mfma_f32_16x16x32_bf16 v[28:31], v[224:227], v[144:147], v[28:31]
v_mfma_f32_16x16x32_bf16 v[32:35], v[228:231], v[144:147], v[32:35]
L_s1342:
s_cmp_lg_u32 s53, 0
s_cbranch_scc1 L_gen43
s_cmp_lg_u32 s52, 0
s_cbranch_scc1 L_fs44
s_mov_b32 s92, 0
v_mov_b32 v8, s56
v_mov_b32 v9, 0
s_mov_b64 exec, 1
buffer_store_dword v8, v9, s[8:11], s92 offen sc1
s_mov_b64 exec, -1
L_fs44:
L_gen43:
s_add_u32 s92, s52, 1
s_and_b32 s92, s92, 3
s_mul_i32 s92, s92, 15360
s_add_u32 s92, s92, 0
v_add_u32_e64 v11, s92, v6
s_add_u32 s92, s52, 2
s_and_b32 s92, s92, 3
s_mul_i32 s92, s92, 15360
s_add_u32 s92, s92, 5120
v_add_u32_e64 v12, s92, v6
s_add_u32 s92, s52, 3
s_and_b32 s92, s92, 3
s_mul_i32 s92, s92, 15360
s_add_u32 s92, s92, 10240
v_add_u32_e64 v13, s92, v6
s_mul_i32 s92, s52, 15360
s_add_u32 s92, s92, 0
v_add_u32 v10, s92, v6
s_waitcnt lgkmcnt(0)
s_barrier
ds_write_b128 v11, v[36:39] offset:0
ds_write_b128 v11, v[40:43] offset:1024
ds_write_b128 v11, v[44:47] offset:2048
ds_write_b128 v11, v[48:51] offset:3072
ds_write_b128 v11, v[52:55] offset:4096
ds_write_b128 v12, v[56:59] offset:0
ds_write_b128 v12, v[60:63] offset:1024
ds_write_b128 v12, v[64:67] offset:2048
ds_write_b128 v12, v[68:71] offset:3072
ds_write_b128 v12, v[72:75] offset:4096
ds_write_b128 v13, v[76:79] offset:0
ds_write_b128 v13, v[80:83] offset:1024
ds_write_b128 v13, v[84:87] offset:2048
ds_write_b128 v13, v[88:91] offset:3072
ds_write_b128 v13, v[92:95] offset:4096
s_waitcnt vmcnt(20)
s_nop 0
ds_read_b64 v[208:209], v243 offset:0
ds_read_b64 v[210:211], v243 offset:32
ds_read_b64 v[212:213], v243 offset:80
ds_read_b64 v[214:215], v243 offset:112
ds_read_b64 v[216:217], v244 offset:0
v_and_b32 v14, 0xffff0000, v206
v_rcp_f32 v14, v14
s_nop 0
v_mul_f32 v15, 0xbfb8aa3b, v14
v_mul_f32 v14, 0x35cccccd, v14
s_waitcnt vmcnt(0)
s_waitcnt lgkmcnt(0)
s_barrier
s_nop 0
ds_read_b64_tr_b16 v[180:181], v200 offset:0
ds_read_b64_tr_b16 v[182:183], v200 offset:512
ds_read_b64_tr_b16 v[184:185], v200 offset:4096
ds_read_b64_tr_b16 v[186:187], v200 offset:4608
ds_read_b64_tr_b16 v[188:189], v200 offset:8192
ds_read_b64_tr_b16 v[190:191], v200 offset:8704
ds_read_b128 v[96:99], v10 offset:0
ds_read_b128 v[100:103], v10 offset:1024
ds_read_b128 v[104:107], v10 offset:2048
ds_read_b128 v[108:111], v10 offset:3072
ds_read_b128 v[112:115], v10 offset:4096
ds_read_b128 v[116:119], v10 offset:5120
ds_read_b128 v[120:123], v10 offset:6144
ds_read_b128 v[124:127], v10 offset:7168
ds_read_b128 v[128:131], v10 offset:8192
ds_read_b128 v[132:135], v10 offset:9216
ds_read_b128 v[136:139], v10 offset:10240
ds_read_b128 v[140:143], v10 offset:11264
ds_read_b128 v[144:147], v10 offset:12288
ds_read_b128 v[148:151], v10 offset:13312
ds_read_b128 v[152:155], v10 offset:14336
s_waitcnt lgkmcnt(15)
v_mfma_f32_16x16x32_bf16 v[160:163], a[0:3], v[180:183], 0
ds_read_b64_tr_b16 v[192:193], v200 offset:12288
ds_read_b64_tr_b16 v[194:195], v200 offset:12800
v_mfma_f32_16x16x32_bf16 v[164:167], a[4:7], v[180:183], 0
v_lshlrev_b32 v36, 16, v208
v_and_b32 v37, 0xffff0000, v208
v_mfma_f32_16x16x32_bf16 v[176:179], a[8:11], v[180:183], 0
v_lshlrev_b32_e64 v38, 16, v209
v_and_b32 v39, 0xffff0000, v209
s_waitcnt lgkmcnt(15)
v_mfma_f32_16x16x32_bf16 v[160:163], a[12:15], v[184:187], v[160:163]
ds_read_b64_tr_b16 v[180:181], v200 offset:16384
ds_read_b64_tr_b16 v[182:183], v200 offset:16896
v_mfma_f32_16x16x32_bf16 v[164:167], a[16:19], v[184:187], v[164:167]
v_lshlrev_b32 v40, 16, v210
v_and_b32 v41, 0xffff0000, v210
v_mfma_f32_16x16x32_bf16 v[176:179], a[20:23], v[184:187], v[176:179]
v_lshlrev_b32_e64 v42, 16, v211
v_and_b32 v43, 0xffff0000, v211
s_waitcnt lgkmcnt(15)
v_mfma_f32_16x16x32_bf16 v[160:163], a[24:27], v[188:191], v[160:163]
ds_read_b64_tr_b16 v[184:185], v200 offset:20480
ds_read_b64_tr_b16 v[186:187], v200 offset:20992
v_mfma_f32_16x16x32_bf16 v[164:167], a[28:31], v[188:191], v[164:167]
v_lshlrev_b32 v44, 16, v212
v_and_b32 v45, 0xffff0000, v212
v_mfma_f32_16x16x32_bf16 v[176:179], a[32:35], v[188:191], v[176:179]
v_lshlrev_b32_e64 v46, 16, v213
v_and_b32 v47, 0xffff0000, v213
s_waitcnt lgkmcnt(4)
v_mfma_f32_16x16x32_bf16 v[160:163], a[36:39], v[192:195], v[160:163]
ds_read_b64_tr_b16 v[188:189], v200 offset:24576
ds_read_b64_tr_b16 v[190:191], v200 offset:25088
v_mfma_f32_16x16x32_bf16 v[164:167], a[40:43], v[192:195], v[164:167]
v_lshlrev_b32 v48, 16, v214
v_and_b32 v49, 0xffff0000, v214
v_mfma_f32_16x16x32_bf16 v[176:179], a[44:47], v[192:195], v[176:179]
v_lshlrev_b32_e64 v50, 16, v215
v_and_b32 v51, 0xffff0000, v215
v_lshlrev_b32_e64 v52, 16, v216
v_and_b32 v53, 0xffff0000, v216
v_lshlrev_b32_e64 v54, 16, v217
v_and_b32 v55, 0xffff0000, v217
v_pk_add_f32 v[16:17], v[16:17], v[96:97]
v_pk_add_f32 v[18:19], v[18:19], v[98:99]
v_pk_add_f32 v[20:21], v[20:21], v[100:101]
v_pk_add_f32 v[22:23], v[22:23], v[102:103]
v_pk_add_f32 v[24:25], v[24:25], v[104:105]
v_pk_add_f32 v[26:27], v[26:27], v[106:107]
v_pk_add_f32 v[28:29], v[28:29], v[108:109]
v_pk_add_f32 v[30:31], v[30:31], v[110:111]
v_pk_add_f32 v[32:33], v[32:33], v[112:113]
v_pk_add_f32 v[34:35], v[34:35], v[114:115]
v_pk_add_f32 v[16:17], v[16:17], v[116:117]
v_pk_add_f32 v[18:19], v[18:19], v[118:119]
v_pk_add_f32 v[20:21], v[20:21], v[120:121]
v_pk_add_f32 v[22:23], v[22:23], v[122:123]
v_pk_add_f32 v[24:25], v[24:25], v[124:125]
v_pk_add_f32 v[26:27], v[26:27], v[126:127]
v_pk_add_f32 v[28:29], v[28:29], v[128:129]
v_pk_add_f32 v[30:31], v[30:31], v[130:131]
v_pk_add_f32 v[32:33], v[32:33], v[132:133]
v_pk_add_f32 v[34:35], v[34:35], v[134:135]
v_pk_add_f32 v[16:17], v[16:17], v[136:137]
v_pk_add_f32 v[18:19], v[18:19], v[138:139]
v_pk_add_f32 v[20:21], v[20:21], v[140:141]
v_pk_add_f32 v[22:23], v[22:23], v[142:143]
v_pk_add_f32 v[24:25], v[24:25], v[144:145]
v_pk_add_f32 v[26:27], v[26:27], v[146:147]
v_pk_add_f32 v[28:29], v[28:29], v[148:149]
v_pk_add_f32 v[30:31], v[30:31], v[150:151]
v_pk_add_f32 v[32:33], v[32:33], v[152:153]
v_pk_add_f32 v[34:35], v[34:35], v[154:155]
v_pk_mul_f32 v[96:97], v[16:17], v[14:15] op_sel:[0,1] op_sel_hi:[1,1]
v_pk_mul_f32 v[98:99], v[18:19], v[14:15] op_sel:[0,1] op_sel_hi:[1,1]
v_pk_mul_f32 v[100:101], v[20:21], v[14:15] op_sel:[0,1] op_sel_hi:[1,1]
v_pk_mul_f32 v[102:103], v[22:23], v[14:15] op_sel:[0,1] op_sel_hi:[1,1]
v_pk_mul_f32 v[104:105], v[24:25], v[14:15] op_sel:[0,1] op_sel_hi:[1,1]
v_pk_mul_f32 v[106:107], v[26:27], v[14:15] op_sel:[0,1] op_sel_hi:[1,1]
v_pk_mul_f32 v[108:109], v[28:29], v[14:15] op_sel:[0,1] op_sel_hi:[1,1]
v_pk_mul_f32 v[110:111], v[30:31], v[14:15] op_sel:[0,1] op_sel_hi:[1,1]
v_pk_mul_f32 v[112:113], v[32:33], v[14:15] op_sel:[0,1] op_sel_hi:[1,1]
v_pk_mul_f32 v[114:115], v[34:35], v[14:15] op_sel:[0,1] op_sel_hi:[1,1]
v_pk_mul_f32 v[16:17], v[16:17], v[14:15] op_sel_hi:[1,0]
v_pk_mul_f32 v[18:19], v[18:19], v[14:15] op_sel_hi:[1,0]
v_pk_mul_f32 v[20:21], v[20:21], v[14:15] op_sel_hi:[1,0]
v_pk_mul_f32 v[22:23], v[22:23], v[14:15] op_sel_hi:[1,0]
v_pk_mul_f32 v[24:25], v[24:25], v[14:15] op_sel_hi:[1,0]
v_pk_mul_f32 v[26:27], v[26:27], v[14:15] op_sel_hi:[1,0]
v_pk_mul_f32 v[28:29], v[28:29], v[14:15] op_sel_hi:[1,0]
v_pk_mul_f32 v[30:31], v[30:31], v[14:15] op_sel_hi:[1,0]
v_pk_mul_f32 v[32:33], v[32:33], v[14:15] op_sel_hi:[1,0]
v_pk_mul_f32 v[34:35], v[34:35], v[14:15] op_sel_hi:[1,0]
s_waitcnt lgkmcnt(4)
v_mfma_f32_16x16x32_bf16 v[160:163], a[48:51], v[180:183], v[160:163]
ds_read_b64_tr_b16 v[192:193], v200 offset:28672
ds_read_b64_tr_b16 v[194:195], v200 offset:29184
v_mfma_f32_16x16x32_bf16 v[164:167], a[52:55], v[180:183], v[164:167]
v_exp_f32 v96, v96
v_mfma_f32_16x16x32_bf16 v[176:179], a[56:59], v[180:183], v[176:179]
v_exp_f32 v97, v97
s_waitcnt lgkmcnt(4)
v_mfma_f32_16x16x32_bf16 v[160:163], a[60:63], v[184:187], v[160:163]
ds_read_b64_tr_b16 v[180:181], v200 offset:32768
ds_read_b64_tr_b16 v[182:183], v200 offset:33280
v_mfma_f32_16x16x32_bf16 v[164:167], a[64:67], v[184:187], v[164:167]
v_exp_f32_e64 v98, v98
v_mfma_f32_16x16x32_bf16 v[176:179], a[68:71], v[184:187], v[176:179]
v_exp_f32 v99, v99
s_waitcnt lgkmcnt(4)
v_mfma_f32_16x16x32_bf16 v[160:163], a[72:75], v[188:191], v[160:163]
ds_read_b64_tr_b16 v[184:185], v200 offset:36864
ds_read_b64_tr_b16 v[186:187], v200 offset:37376
v_mfma_f32_16x16x32_bf16 v[164:167], a[76:79], v[188:191], v[164:167]
v_exp_f32_e64 v100, v100
v_mfma_f32_16x16x32_bf16 v[176:179], a[80:83], v[188:191], v[176:179]
v_exp_f32 v101, v101
s_waitcnt lgkmcnt(4)
v_mfma_f32_16x16x32_bf16 v[160:163], a[84:87], v[192:195], v[160:163]
ds_read_b64_tr_b16 v[188:189], v201 offset:0
ds_read_b64_tr_b16 v[190:191], v201 offset:512
v_mfma_f32_16x16x32_bf16 v[164:167], a[88:91], v[192:195], v[164:167]
v_exp_f32_e64 v102, v102
v_mfma_f32_16x16x32_bf16 v[176:179], a[92:95], v[192:195], v[176:179]
v_exp_f32 v103, v103
s_waitcnt lgkmcnt(4)
v_mfma_f32_16x16x32_bf16 v[160:163], a[96:99], v[180:183], v[160:163]
ds_read_b64_tr_b16 v[192:193], v201 offset:4096
ds_read_b64_tr_b16 v[194:195], v201 offset:4608
v_mfma_f32_16x16x32_bf16 v[164:167], a[100:103], v[180:183], v[164:167]
v_exp_f32_e64 v104, v104
v_mfma_f32_16x16x32_bf16 v[176:179], a[104:107], v[180:183], v[176:179]
v_exp_f32 v105, v105
s_waitcnt lgkmcnt(4)
v_mfma_f32_16x16x32_bf16 v[160:163], a[108:111], v[184:187], v[160:163]
ds_read_b64_tr_b16 v[180:181], v201 offset:8192
ds_read_b64_tr_b16 v[182:183], v201 offset:8704
v_mfma_f32_16x16x32_bf16 v[164:167], a[112:115], v[184:187], v[164:167]
v_exp_f32_e64 v106, v106
v_mfma_f32_16x16x32_bf16 v[176:179], a[116:119], v[184:187], v[176:179]
v_exp_f32 v107, v107
s_waitcnt lgkmcnt(4)
v_mfma_f32_16x16x32_bf16 v[168:171], a[120:123], v[188:191], 0
ds_read_b64_tr_b16 v[184:185], v201 offset:12288
ds_read_b64_tr_b16 v[186:187], v201 offset:12800
v_mfma_f32_16x16x32_bf16 v[172:175], a[124:127], v[188:191], 0
v_exp_f32_e64 v108, v108
v_mfma_f32_16x16x32_bf16 v[176:179], a[128:131], v[188:191], v[176:179]
v_exp_f32 v109, v109
s_waitcnt lgkmcnt(4)
v_mfma_f32_16x16x32_bf16 v[168:171], a[132:135], v[192:195], v[168:171]
ds_read_b64_tr_b16 v[188:189], v201 offset:16384
ds_read_b64_tr_b16 v[190:191], v201 offset:16896
v_mfma_f32_16x16x32_bf16 v[172:175], a[136:139], v[192:195], v[172:175]
v_exp_f32_e64 v110, v110
v_mfma_f32_16x16x32_bf16 v[176:179], a[140:143], v[192:195], v[176:179]
v_exp_f32 v111, v111
s_waitcnt lgkmcnt(4)
v_mfma_f32_16x16x32_bf16 v[168:171], a[144:147], v[180:183], v[168:171]
ds_read_b64_tr_b16 v[192:193], v201 offset:20480
ds_read_b64_tr_b16 v[194:195], v201 offset:20992
v_mfma_f32_16x16x32_bf16 v[172:175], a[148:151], v[180:183], v[172:175]
v_exp_f32_e64 v112, v112
v_mfma_f32_16x16x32_bf16 v[176:179], a[152:155], v[180:183], v[176:179]
v_exp_f32 v113, v113
s_waitcnt lgkmcnt(4)
v_mfma_f32_16x16x32_bf16 v[168:171], a[156:159], v[184:187], v[168:171]
ds_read_b64_tr_b16 v[180:181], v201 offset:24576
ds_read_b64_tr_b16 v[182:183], v201 offset:25088
v_mfma_f32_16x16x32_bf16 v[172:175], a[160:163], v[184:187], v[172:175]
v_exp_f32_e64 v114, v114
v_mfma_f32_16x16x32_bf16 v[176:179], a[164:167], v[184:187], v[176:179]
v_exp_f32 v115, v115
s_waitcnt lgkmcnt(4)
v_mfma_f32_16x16x32_bf16 v[168:171], a[168:171], v[188:191], v[168:171]
ds_read_b64_tr_b16 v[184:185], v201 offset:28672
ds_read_b64_tr_b16 v[186:187], v201 offset:29184
v_mfma_f32_16x16x32_bf16 v[172:175], a[172:175], v[188:191], v[172:175]
v_add_f32_e64 v96, 1.0, v96
v_mfma_f32_16x16x32_bf16 v[176:179], a[176:179], v[188:191], v[176:179]
v_add_f32_e64 v97, 1.0, v97
v_rcp_f32 v96, v96
s_waitcnt lgkmcnt(4)
v_mfma_f32_16x16x32_bf16 v[168:171], a[180:183], v[192:195], v[168:171]
ds_read_b64_tr_b16 v[188:189], v201 offset:32768
ds_read_b64_tr_b16 v[190:191], v201 offset:33280
v_mfma_f32_16x16x32_bf16 v[172:175], a[184:187], v[192:195], v[172:175]
v_add_f32 v98, 1.0, v98
v_rcp_f32 v97, v97
v_mfma_f32_16x16x32_bf16 v[176:179], a[188:191], v[192:195], v[176:179]
v_add_f32_e64 v99, 1.0, v99
v_rcp_f32 v98, v98
s_waitcnt lgkmcnt(4)
v_mfma_f32_16x16x32_bf16 v[168:171], a[192:195], v[180:183], v[168:171]
ds_read_b64_tr_b16 v[192:193], v201 offset:36864
ds_read_b64_tr_b16 v[194:195], v201 offset:37376
v_mfma_f32_16x16x32_bf16 v[172:175], a[196:199], v[180:183], v[172:175]
v_add_f32 v100, 1.0, v100
v_rcp_f32 v99, v99
v_mfma_f32_16x16x32_bf16 v[176:179], a[200:203], v[180:183], v[176:179]
v_add_f32_e64 v101, 1.0, v101
v_rcp_f32 v100, v100
s_waitcnt lgkmcnt(4)
v_mfma_f32_16x16x32_bf16 v[168:171], a[204:207], v[184:187], v[168:171]
v_add_f32 v102, 1.0, v102
v_rcp_f32 v101, v101
v_mfma_f32_16x16x32_bf16 v[172:175], a[208:211], v[184:187], v[172:175]
v_add_f32 v103, 1.0, v103
v_rcp_f32 v102, v102
v_mfma_f32_16x16x32_bf16 v[176:179], a[212:215], v[184:187], v[176:179]
v_add_f32_e64 v104, 1.0, v104
v_rcp_f32 v103, v103
s_waitcnt lgkmcnt(2)
v_mfma_f32_16x16x32_bf16 v[168:171], a[216:219], v[188:191], v[168:171]
v_add_f32 v105, 1.0, v105
v_rcp_f32 v104, v104
v_mfma_f32_16x16x32_bf16 v[172:175], a[220:223], v[188:191], v[172:175]
v_add_f32 v106, 1.0, v106
v_rcp_f32 v105, v105
v_mfma_f32_16x16x32_bf16 v[176:179], a[224:227], v[188:191], v[176:179]
v_add_f32_e64 v107, 1.0, v107
v_rcp_f32 v106, v106
s_waitcnt lgkmcnt(0)
v_mfma_f32_16x16x32_bf16 v[168:171], a[228:231], v[192:195], v[168:171]
v_add_f32 v108, 1.0, v108
v_rcp_f32 v107, v107
v_mfma_f32_16x16x32_bf16 v[172:175], a[232:235], v[192:195], v[172:175]
v_add_f32 v109, 1.0, v109
v_rcp_f32 v108, v108
v_mfma_f32_16x16x32_bf16 v[176:179], a[236:239], v[192:195], v[176:179]
v_add_f32 v110, 1.0, v110
v_rcp_f32 v109, v109
v_add_f32 v111, 1.0, v111
v_rcp_f32 v110, v110
v_add_f32 v112, 1.0, v112
v_rcp_f32 v111, v111
v_add_f32 v113, 1.0, v113
v_rcp_f32 v112, v112
v_add_f32 v114, 1.0, v114
v_rcp_f32 v113, v113
v_add_f32 v115, 1.0, v115
v_rcp_f32 v114, v114
v_rcp_f32_e64 v115, v115
v_pk_mul_f32 v[16:17], v[16:17], v[96:97]
v_pk_mul_f32 v[18:19], v[18:19], v[98:99]
v_pk_mul_f32 v[20:21], v[20:21], v[100:101]
v_pk_mul_f32 v[22:23], v[22:23], v[102:103]
v_pk_mul_f32 v[24:25], v[24:25], v[104:105]
v_pk_mul_f32 v[26:27], v[26:27], v[106:107]
v_pk_mul_f32 v[28:29], v[28:29], v[108:109]
v_pk_mul_f32 v[30:31], v[30:31], v[110:111]
v_pk_mul_f32 v[32:33], v[32:33], v[112:113]
v_pk_mul_f32 v[34:35], v[34:35], v[114:115]
v_pk_add_f32 v[10:11], v[160:161], v[168:169]
v_pk_fma_f32 v[10:11], v[10:11], v[16:17], v[36:37]
v_cvt_pk_bf16_f32 v96, v10, v11
v_pk_add_f32 v[12:13], v[162:163], v[170:171]
v_pk_fma_f32 v[12:13], v[12:13], v[18:19], v[38:39]
v_cvt_pk_bf16_f32 v97, v12, v13
ds_write_b64 v243, v[96:97] offset:0
v_pk_add_f32 v[10:11], v[164:165], v[172:173]
v_pk_fma_f32 v[10:11], v[10:11], v[20:21], v[40:41]
v_cvt_pk_bf16_f32 v98, v10, v11
v_pk_add_f32 v[12:13], v[166:167], v[174:175]
v_pk_fma_f32 v[12:13], v[12:13], v[22:23], v[42:43]
v_cvt_pk_bf16_f32 v99, v12, v13
ds_write_b64 v243, v[98:99] offset:32
v_pk_add_f32 v[10:11], v[160:161], v[168:169] neg_lo:[0,1] neg_hi:[0,1]
v_pk_fma_f32 v[10:11], v[10:11], v[24:25], v[44:45]
v_cvt_pk_bf16_f32 v100, v10, v11
v_pk_add_f32 v[12:13], v[162:163], v[170:171] neg_lo:[0,1] neg_hi:[0,1]
v_pk_fma_f32 v[12:13], v[12:13], v[26:27], v[46:47]
v_cvt_pk_bf16_f32 v101, v12, v13
ds_write_b64 v243, v[100:101] offset:80
v_pk_add_f32 v[10:11], v[164:165], v[172:173] neg_lo:[0,1] neg_hi:[0,1]
v_pk_fma_f32 v[10:11], v[10:11], v[28:29], v[48:49]
v_cvt_pk_bf16_f32 v102, v10, v11
v_pk_add_f32 v[12:13], v[166:167], v[174:175] neg_lo:[0,1] neg_hi:[0,1]
v_pk_fma_f32 v[12:13], v[12:13], v[30:31], v[50:51]
v_cvt_pk_bf16_f32 v103, v12, v13
ds_write_b64 v243, v[102:103] offset:112
v_pk_fma_f32 v[10:11], v[176:177], v[32:33], v[52:53]
v_cvt_pk_bf16_f32 v104, v10, v11
v_pk_fma_f32 v[12:13], v[178:179], v[34:35], v[54:55]
v_cvt_pk_bf16_f32 v105, v12, v13
ds_write_b64 v244, v[104:105] offset:0
s_waitcnt lgkmcnt(0)
ds_read_b128 v[108:111], v197 offset:0
ds_read_b128 v[112:115], v197 offset:1024
ds_read_b128 v[116:119], v197 offset:2048
s_waitcnt lgkmcnt(2)
buffer_store_dwordx4 v[108:111], v240, s[28:31], 0 offen
s_waitcnt lgkmcnt(1)
buffer_store_dwordx4 v[112:115], v241, s[28:31], 0 offen
s_waitcnt lgkmcnt(0)
s_mov_b32 exec_hi, 0
buffer_store_dwordx4 v[116:119], v242, s[28:31], 0 offen
s_mov_b32 exec_hi, -1
L_fin:
L_end:
s_endpgm
.p2align 8
.type tab_data,@object
tab_data:
.long 0x3f803f80,0x3f803f80,0x3f803f80,0x3f803f80,0x0,0x0,0x0,0x0
.long 0x3f733f80,0x3f163f4f,0x248d3e9e,0xbf16be9e,0x0,0x0,0x0,0x0
.long 0x3f4f3f80,0xbe9e3e9e,0xbf80bf4f,0xbe9ebf4f,0x0,0x0,0x0,0x0
.long 0x3f163f80,0xbf73be9e,0xa554bf4f,0x3f733f4f,0x0,0x0,0x0,0x0
.long 0x3e9e3f80,0xbf4fbf4f,0x3f803e9e,0xbf4f3e9e,0x0,0x0,0x0,0x0
.long 0x248d3f80,0xa554bf80,0x248d3f80,0xa554bf80,0x0,0x0,0x0,0x0
.long 0xbe9e3f80,0x3f4fbf4f,0xbf803e9e,0x3f4f3e9e,0x0,0x0,0x0,0x0
.long 0xbf163f80,0x3f73be9e,0xa554bf4f,0xbf733f4f,0x0,0x0,0x0,0x0
.long 0xbf4f3f80,0x3e9e3e9e,0x3f80bf4f,0x3e9ebf4f,0x0,0x0,0x0,0x0
.long 0xbf733f80,0xbf163f4f,0x248d3e9e,0x3f16be9e,0x0,0x0,0x0,0x0
.long 0xbf803f80,0xbf803f80,0xbf803f80,0xbf803f80,0x0,0x0,0x0,0x0
.long 0x0,0x0,0x0,0x0,0x0,0x0,0x0,0x0
.long 0x0,0x0,0x0,0x0,0x0,0x0,0x0,0x0
.long 0x0,0x0,0x0,0x0,0x0,0x0,0x0,0x0
.long 0x0,0x0,0x0,0x0,0x0,0x0,0x0,0x0
.long 0x0,0x0,0x0,0x0,0x0,0x0,0x0,0x0
.long 0x3f803f80,0x3f803f80,0x3f803f80,0x3f803f80,0x0,0x0,0x0,0x0
.long 0xbf73bf4f,0xbf73bf80,0xbf16bf4f,0xa554be9e,0x0,0x0,0x0,0x0
.long 0x3f4f3e9e,0x3f4f3f80,0xbe9e3e9e,0xbf80bf4f,0x0,0x0,0x0,0x0
.long 0xbf163e9e,0xbf16bf80,0x3f733e9e,0x248d3f4f,0x0,0x0,0x0,0x0
.long 0x3e9ebf4f,0x3e9e3f80,0xbf4fbf4f,0x3f803e9e,0x0,0x0,0x0,0x0
.long 0x248d3f80,0xa554bf80,0x248d3f80,0xa554bf80,0x0,0x0,0x0,0x0
.long 0xbe9ebf4f,0xbe9e3f80,0x3f4fbf4f,0xbf803e9e,0x0,0x0,0x0,0x0
.long 0x3f163e9e,0x3f16bf80,0xbf733e9e,0x248d3f4f,0x0,0x0,0x0,0x0
.long 0xbf4f3e9e,0xbf4f3f80,0x3e9e3e9e,0x3f80bf4f,0x0,0x0,0x0,0x0
.long 0x3f73bf4f,0x3f73bf80,0x3f16bf4f,0xa554be9e,0x0,0x0,0x0,0x0
.long 0xbf803f80,0xbf803f80,0xbf803f80,0xbf803f80,0x0,0x0,0x0,0x0
.long 0x0,0x0,0x0,0x0,0x0,0x0,0x0,0x0
.long 0x0,0x0,0x0,0x0,0x0,0x0,0x0,0x0
.long 0x0,0x0,0x0,0x0,0x0,0x0,0x0,0x0
.long 0x0,0x0,0x0,0x0,0x0,0x0,0x0,0x0
.long 0x0,0x0,0x0,0x0,0x0,0x0,0x0,0x0
.long 0x3f803f80,0x3f803f80,0x0,0x0,0x0,0x0,0x3f803f80,0x3f803f80
.long 0x3f163e9e,0x3f733f4f,0x0,0x0,0x0,0x0,0x3f733f80,0x3f163f4f
.long 0xbe9ebf4f,0x3f4f3e9e,0x0,0x0,0x0,0x0,0x3f4f3f80,0xbe9e3e9e
.long 0xbf73bf4f,0x3f16be9e,0x0,0x0,0x0,0x0,0x3f163f80,0xbf73be9e
.long 0xbf4f3e9e,0x3e9ebf4f,0x0,0x0,0x0,0x0,0x3e9e3f80,0xbf4fbf4f
.long 0x248d3f80,0xa554bf80,0x0,0x0,0x0,0x0,0x248d3f80,0xa554bf80
.long 0x3f4f3e9e,0xbe9ebf4f,0x0,0x0,0x0,0x0,0xbe9e3f80,0x3f4fbf4f
.long 0x3f73bf4f,0xbf16be9e,0x0,0x0,0x0,0x0,0xbf163f80,0x3f73be9e
.long 0x3e9ebf4f,0xbf4f3e9e,0x0,0x0,0x0,0x0,0xbf4f3f80,0x3e9e3e9e
.long 0xbf163e9e,0xbf733f4f,0x0,0x0,0x0,0x0,0xbf733f80,0xbf163f4f
.long 0xbf803f80,0xbf803f80,0x0,0x0,0x0,0x0,0xbf803f80,0xbf803f80
.long 0x0,0x0,0x0,0x0,0x0,0x0,0x0,0x0
.long 0x0,0x0,0x0,0x0,0x0,0x0,0x0,0x0
.long 0x0,0x0,0x0,0x0,0x0,0x0,0x0,0x0
.long 0x0,0x0,0x0,0x0,0x0,0x0,0x0,0x0
.long 0x0,0x0,0x0,0x0,0x0,0x0,0x0,0x0
.long 0x0,0x0,0x0,0x0,0x3f803f80,0x3f803f80,0x3f803f80,0x3f803f80
.long 0x0,0x0,0x0,0x0,0x248d3e9e,0xbf16be9e,0xbf73bf4f,0xbf73bf80
.long 0x0,0x0,0x0,0x0,0xbf80bf4f,0xbe9ebf4f,0x3f4f3e9e,0x3f4f3f80
.long 0x0,0x0,0x0,0x0,0xa554bf4f,0x3f733f4f,0xbf163e9e,0xbf16bf80
.long 0x0,0x0,0x0,0x0,0x3f803e9e,0xbf4f3e9e,0x3e9ebf4f,0x3e9e3f80
.long 0x0,0x0,0x0,0x0,0x248d3f80,0xa554bf80,0x248d3f80,0xa554bf80
.long 0x0,0x0,0x0,0x0,0xbf803e9e,0x3f4f3e9e,0xbe9ebf4f,0xbe9e3f80
.long 0x0,0x0,0x0,0x0,0xa554bf4f,0xbf733f4f,0x3f163e9e,0x3f16bf80
.long 0x0,0x0,0x0,0x0,0x3f80bf4f,0x3e9ebf4f,0xbf4f3e9e,0xbf4f3f80
.long 0x0,0x0,0x0,0x0,0x248d3e9e,0x3f16be9e,0x3f73bf4f,0x3f73bf80
.long 0x0,0x0,0x0,0x0,0xbf803f80,0xbf803f80,0xbf803f80,0xbf803f80
.long 0x0,0x0,0x0,0x0,0x0,0x0,0x0,0x0
.long 0x0,0x0,0x0,0x0,0x0,0x0,0x0,0x0
.long 0x0,0x0,0x0,0x0,0x0,0x0,0x0,0x0
.long 0x0,0x0,0x0,0x0,0x0,0x0,0x0,0x0
.long 0x0,0x0,0x0,0x0,0x0,0x0,0x0,0x0
.long 0x0,0x0,0x0,0x0,0x3f803f80,0x3f803f80,0x3f803f80,0x3f803f80
.long 0x0,0x0,0x0,0x0,0xbf16bf4f,0xa554be9e,0x3f163e9e,0x3f733f4f
.long 0x0,0x0,0x0,0x0,0xbe9e3e9e,0xbf80bf4f,0xbe9ebf4f,0x3f4f3e9e
.long 0x0,0x0,0x0,0x0,0x3f733e9e,0x248d3f4f,0xbf73bf4f,0x3f16be9e
.long 0x0,0x0,0x0,0x0,0xbf4fbf4f,0x3f803e9e,0xbf4f3e9e,0x3e9ebf4f
.long 0x0,0x0,0x0,0x0,0x248d3f80,0xa554bf80,0x248d3f80,0xa554bf80
.long 0x0,0x0,0x0,0x0,0x3f4fbf4f,0xbf803e9e,0x3f4f3e9e,0xbe9ebf4f
.long 0x0,0x0,0x0,0x0,0xbf733e9e,0x248d3f4f,0x3f73bf4f,0xbf16be9e
.long 0x0,0x0,0x0,0x0,0x3e9e3e9e,0x3f80bf4f,0x3e9ebf4f,0xbf4f3e9e
.long 0x0,0x0,0x0,0x0,0x3f16bf4f,0xa554be9e,0xbf163e9e,0xbf733f4f
.long 0x0,0x0,0x0,0x0,0xbf803f80,0xbf803f80,0xbf803f80,0xbf803f80
.long 0x0,0x0,0x0,0x0,0x0,0x0,0x0,0x0
.long 0x0,0x0,0x0,0x0,0x0,0x0,0x0,0x0
.long 0x0,0x0,0x0,0x0,0x0,0x0,0x0,0x0
.long 0x0,0x0,0x0,0x0,0x0,0x0,0x0,0x0
.long 0x0,0x0,0x0,0x0,0x0,0x0,0x0,0x0
.long 0x0,0x0,0x0,0x0,0x0,0x0,0x0,0x0
.long 0x0,0x0,0x0,0x0,0x0,0x0,0x0,0x0
.long 0x0,0x0,0x0,0x0,0x0,0x0,0x0,0x0
.long 0x0,0x0,0x0,0x0,0x0,0x0,0x0,0x0
.long 0x0,0x0,0x0,0x0,0x0,0x0,0x0,0x0
.long 0x0,0x0,0x0,0x0,0x0,0x0,0x0,0x0
.long 0x0,0x0,0x0,0x0,0x0,0x0,0x0,0x0
.long 0x0,0x0,0x0,0x0,0x0,0x0,0x0,0x0
.long 0x0,0x0,0x0,0x0,0x0,0x0,0x0,0x0
.long 0x0,0x0,0x0,0x0,0x0,0x0,0x0,0x0
.long 0x0,0x0,0x0,0x0,0x0,0x0,0x0,0x0
.long 0x0,0x0,0x0,0x0,0x0,0x0,0x0,0x0
.long 0x0,0x0,0x0,0x0,0x0,0x0,0x0,0x0
.long 0x0,0x0,0x0,0x0,0x0,0x0,0x0,0x0
.long 0x0,0x0,0x0,0x0,0x0,0x0,0x0,0x0
.long 0x0,0x0,0x0,0x0,0x0,0x0,0x0,0x0
.long 0x80008000,0x80008000,0x80008000,0x80008000,0x0,0x0,0x0,0x0
.long 0xbe9e8000,0xbf4fbf16,0xbf80bf73,0xbf4fbf73,0x0,0x0,0x0,0x0
.long 0xbf168000,0xbf73bf73,0xa50dbf16,0x3f733f16,0x0,0x0,0x0,0x0
.long 0xbf4f8000,0xbe9ebf73,0x3f803f16,0xbe9e3f16,0x0,0x0,0x0,0x0
.long 0xbf738000,0x3f16bf16,0x80003f73,0xbf16bf73,0x0,0x0,0x0,0x0
.long 0xbf808000,0x3f80a50d,0xbf808000,0x3f80a50d,0x0,0x0,0x0,0x0
.long 0xbf738000,0x3f163f16,0xa50dbf73,0xbf163f73,0x0,0x0,0x0,0x0
.long 0xbf4f8000,0xbe9e3f73,0x3f80bf16,0xbe9ebf16,0x0,0x0,0x0,0x0
.long 0xbf168000,0xbf733f73,0x80003f16,0x3f73bf16,0x0,0x0,0x0,0x0
.long 0xbe9e8000,0xbf4f3f16,0xbf803f73,0xbf4f3f73,0x0,0x0,0x0,0x0
.long 0xa50d8000,0xa50d8000,0xa50d8000,0xa50d8000,0x0,0x0,0x0,0x0
.long 0x0,0x0,0x0,0x0,0x0,0x0,0x0,0x0
.long 0x0,0x0,0x0,0x0,0x0,0x0,0x0,0x0
.long 0x0,0x0,0x0,0x0,0x0,0x0,0x0,0x0
.long 0x0,0x0,0x0,0x0,0x0,0x0,0x0,0x0
.long 0x0,0x0,0x0,0x0,0x0,0x0,0x0,0x0
.long 0x80008000,0x80008000,0x80008000,0x80008000,0x0,0x0,0x0,0x0
.long 0xbe9ebf16,0x3e9ea50d,0x3f4f3f16,0x3f803f73,0x0,0x0,0x0,0x0
.long 0x3f163f73,0xbf168000,0xbf73bf73,0xa50dbf16,0x0,0x0,0x0,0x0
.long 0xbf4fbf73,0x3f4fa50d,0x3e9e3f73,0xbf80bf16,0x0,0x0,0x0,0x0
.long 0x3f733f16,0xbf738000,0x3f16bf16,0x80003f73,0x0,0x0,0x0,0x0
.long 0xbf808000,0x3f80a50d,0xbf808000,0x3f80a50d,0x0,0x0,0x0,0x0
.long 0x3f73bf16,0xbf738000,0x3f163f16,0xa50dbf73,0x0,0x0,0x0,0x0
.long 0xbf4f3f73,0x3f4fa50d,0x3e9ebf73,0xbf803f16,0x0,0x0,0x0,0x0
.long 0x3f16bf73,0xbf168000,0xbf733f73,0x80003f16,0x0,0x0,0x0,0x0
.long 0xbe9e3f16,0x3e9ea50d,0x3f4fbf16,0x3f80bf73,0x0,0x0,0x0,0x0
.long 0xa50d8000,0xa50d8000,0xa50d8000,0xa50d8000,0x0,0x0,0x0,0x0
.long 0x0,0x0,0x0,0x0,0x0,0x0,0x0,0x0
.long 0x0,0x0,0x0,0x0,0x0,0x0,0x0,0x0
.long 0x0,0x0,0x0,0x0,0x0,0x0,0x0,0x0
.long 0x0,0x0,0x0,0x0,0x0,0x0,0x0,0x0
.long 0x0,0x0,0x0,0x0,0x0,0x0,0x0,0x0
.long 0x80008000,0x80008000,0x0,0x0,0x0,0x0,0x80008000,0x80008000
.long 0x3f4f3f73,0x3e9e3f16,0x0,0x0,0x0,0x0,0xbe9e8000,0xbf4fbf16
.long 0x3f733f16,0x3f163f73,0x0,0x0,0x0,0x0,0xbf168000,0xbf73bf73
.long 0x3e9ebf16,0x3f4f3f73,0x0,0x0,0x0,0x0,0xbf4f8000,0xbe9ebf73
.long 0xbf16bf73,0x3f733f16,0x0,0x0,0x0,0x0,0xbf738000,0x3f16bf16
.long 0xbf808000,0x3f80a50d,0x0,0x0,0x0,0x0,0xbf808000,0x3f80a50d
.long 0xbf163f73,0x3f73bf16,0x0,0x0,0x0,0x0,0xbf738000,0x3f163f16
.long 0x3e9e3f16,0x3f4fbf73,0x0,0x0,0x0,0x0,0xbf4f8000,0xbe9e3f73
.long 0x3f73bf16,0x3f16bf73,0x0,0x0,0x0,0x0,0xbf168000,0xbf733f73
.long 0x3f4fbf73,0x3e9ebf16,0x0,0x0,0x0,0x0,0xbe9e8000,0xbf4f3f16
.long 0xa50d8000,0xa50d8000,0x0,0x0,0x0,0x0,0xa50d8000,0xa50d8000
.long 0x0,0x0,0x0,0x0,0x0,0x0,0x0,0x0
.long 0x0,0x0,0x0,0x0,0x0,0x0,0x0,0x0
.long 0x0,0x0,0x0,0x0,0x0,0x0,0x0,0x0
.long 0x0,0x0,0x0,0x0,0x0,0x0,0x0,0x0
.long 0x0,0x0,0x0,0x0,0x0,0x0,0x0,0x0
.long 0x0,0x0,0x0,0x0,0x80008000,0x80008000,0x80008000,0x80008000
.long 0x0,0x0,0x0,0x0,0xbf80bf73,0xbf4fbf73,0xbe9ebf16,0x3e9ea50d
.long 0x0,0x0,0x0,0x0,0xa50dbf16,0x3f733f16,0x3f163f73,0xbf168000
.long 0x0,0x0,0x0,0x0,0x3f803f16,0xbe9e3f16,0xbf4fbf73,0x3f4fa50d
.long 0x0,0x0,0x0,0x0,0x80003f73,0xbf16bf73,0x3f733f16,0xbf738000
.long 0x0,0x0,0x0,0x0,0xbf808000,0x3f80a50d,0xbf808000,0x3f80a50d
.long 0x0,0x0,0x0,0x0,0xa50dbf73,0xbf163f73,0x3f73bf16,0xbf738000
.long 0x0,0x0,0x0,0x0,0x3f80bf16,0xbe9ebf16,0xbf4f3f73,0x3f4fa50d
.long 0x0,0x0,0x0,0x0,0x80003f16,0x3f73bf16,0x3f16bf73,0xbf168000
.long 0x0,0x0,0x0,0x0,0xbf803f73,0xbf4f3f73,0xbe9e3f16,0x3e9ea50d
.long 0x0,0x0,0x0,0x0,0xa50d8000,0xa50d8000,0xa50d8000,0xa50d8000
.long 0x0,0x0,0x0,0x0,0x0,0x0,0x0,0x0
.long 0x0,0x0,0x0,0x0,0x0,0x0,0x0,0x0
.long 0x0,0x0,0x0,0x0,0x0,0x0,0x0,0x0
.long 0x0,0x0,0x0,0x0,0x0,0x0,0x0,0x0
.long 0x0,0x0,0x0,0x0,0x0,0x0,0x0,0x0
.long 0x0,0x0,0x0,0x0,0x80008000,0x80008000,0x80008000,0x80008000
.long 0x0,0x0,0x0,0x0,0x3f4f3f16,0x3f803f73,0x3f4f3f73,0x3e9e3f16
.long 0x0,0x0,0x0,0x0,0xbf73bf73,0xa50dbf16,0x3f733f16,0x3f163f73
.long 0x0,0x0,0x0,0x0,0x3e9e3f73,0xbf80bf16,0x3e9ebf16,0x3f4f3f73
.long 0x0,0x0,0x0,0x0,0x3f16bf16,0x80003f73,0xbf16bf73,0x3f733f16
.long 0x0,0x0,0x0,0x0,0xbf808000,0x3f80a50d,0xbf808000,0x3f80a50d
.long 0x0,0x0,0x0,0x0,0x3f163f16,0xa50dbf73,0xbf163f73,0x3f73bf16
.long 0x0,0x0,0x0,0x0,0x3e9ebf73,0xbf803f16,0x3e9e3f16,0x3f4fbf73
.long 0x0,0x0,0x0,0x0,0xbf733f73,0x80003f16,0x3f73bf16,0x3f16bf73
.long 0x0,0x0,0x0,0x0,0x3f4fbf16,0x3f80bf73,0x3f4fbf73,0x3e9ebf16
.long 0x0,0x0,0x0,0x0,0xa50d8000,0xa50d8000,0xa50d8000,0xa50d8000
.long 0x0,0x0,0x0,0x0,0x0,0x0,0x0,0x0
.long 0x0,0x0,0x0,0x0,0x0,0x0,0x0,0x0
.long 0x0,0x0,0x0,0x0,0x0,0x0,0x0,0x0
.long 0x0,0x0,0x0,0x0,0x0,0x0,0x0,0x0
.long 0x0,0x0,0x0,0x0,0x0,0x0,0x0,0x0
.long 0x0,0x0,0x0,0x0,0x0,0x0,0x0,0x0
.long 0x0,0x0,0x0,0x0,0x0,0x0,0x0,0x0
.long 0x0,0x0,0x0,0x0,0x0,0x0,0x0,0x0
.long 0x0,0x0,0x0,0x0,0x0,0x0,0x0,0x0
.long 0x0,0x0,0x0,0x0,0x0,0x0,0x0,0x0
.long 0x0,0x0,0x0,0x0,0x0,0x0,0x0,0x0
.long 0x0,0x0,0x0,0x0,0x0,0x0,0x0,0x0
.long 0x0,0x0,0x0,0x0,0x0,0x0,0x0,0x0
.long 0x0,0x0,0x0,0x0,0x0,0x0,0x0,0x0
.long 0x0,0x0,0x0,0x0,0x0,0x0,0x0,0x0
.long 0x0,0x0,0x0,0x0,0x0,0x0,0x0,0x0
.long 0x0,0x0,0x0,0x0,0x0,0x0,0x0,0x0
.long 0x0,0x0,0x0,0x0,0x0,0x0,0x0,0x0
.long 0x0,0x0,0x0,0x0,0x0,0x0,0x0,0x0
.long 0x0,0x0,0x0,0x0,0x0,0x0,0x0,0x0
.long 0x0,0x0,0x0,0x0,0x0,0x0,0x0,0x0
.long 0x3f803f80,0x3f803f80,0x3f803f80,0x3f803f80,0x3f7b3f80,0x3f553f6d,0x3f0e3f35,0x3e483ec4
.long 0x3f6d3f80,0x3ec43f35,0xbec4248d,0xbf6dbf35,0x3f553f80,0xbe483ec4,0xbf7bbf35,0xbf0ebf6d
.long 0x248d3f80,0xa554bf80,0x248d3f80,0xa554bf80,0xbe483f80,0x3f0ebf6d,0xbf553f35,0x3f7bbec4
.long 0xbec43f80,0x3f6dbf35,0xbf6d248d,0x3ec43f35,0xbf0e3f80,0x3f7bbec4,0xbe48bf35,0xbf553f6d
.long 0x3f353f80,0xbf35248d,0xbf35bf80,0x3f35a554,0x3f0e3f80,0xbf7bbec4,0x3e48bf35,0x3f553f6d
.long 0x3ec43f80,0xbf6dbf35,0x3f6da554,0xbec43f35,0x3e483f80,0xbf0ebf6d,0x3f553f35,0xbf7bbec4
.long 0xbf353f80,0x3f35a554,0x3f35bf80,0xbf35248d,0xbf553f80,0x3e483ec4,0x3f7bbf35,0x3f0ebf6d
.long 0xbf6d3f80,0xbec43f35,0x3ec4a554,0x3f6dbf35,0xbf7b3f80,0xbf553f6d,0xbf0e3f35,0xbe483ec4
.long 0xbf803f80,0xbf803f80,0xbf803f80,0xbf803f80,0xbf7b3f80,0xbf553f6d,0xbf0e3f35,0xbe483ec4
.long 0xbf6d3f80,0xbec43f35,0x3ec4248d,0x3f6dbf35,0xbf553f80,0x3e483ec4,0x3f7bbf35,0x3f0ebf6d
.long 0xa5543f80,0x248dbf80,0xa5543f80,0x248dbf80,0x3e483f80,0xbf0ebf6d,0x3f553f35,0xbf7bbec4
.long 0x3ec43f80,0xbf6dbf35,0x3f6d248d,0xbec43f35,0x3f0e3f80,0xbf7bbec4,0x3e48bf35,0x3f553f6d
.long 0xbf353f80,0x3f35248d,0x3f35bf80,0xbf35a554,0xbf0e3f80,0x3f7bbec4,0xbe48bf35,0xbf553f6d
.long 0xbec43f80,0x3f6dbf35,0xbf6da554,0x3ec43f35,0xbe483f80,0x3f0ebf6d,0xbf553f35,0x3f7bbec4
.long 0x3f353f80,0xbf35a554,0xbf35bf80,0x3f35248d,0x3f553f80,0xbe483ec4,0xbf7bbf35,0xbf0ebf6d
.long 0x3f6d3f80,0x3ec43f35,0xbec4a554,0xbf6dbf35,0x3f7b3f80,0x3f553f6d,0x3f0e3f35,0x3e483ec4
.long 0x3f803f80,0x3f803f80,0x3f803f80,0x3f803f80,0xbe48248d,0xbf0ebec4,0xbf55bf35,0xbf7bbf6d
.long 0xbf6dbf80,0xbec4bf35,0x3ec4a554,0x3f6d3f35,0x3f0ea554,0x3f7b3f6d,0x3e483f35,0xbf55bec4
.long 0x248d3f80,0xa554bf80,0x248d3f80,0xa554bf80,0xbf7b248d,0x3f553ec4,0xbf0ebf35,0x3e483f6d
.long 0x3ec4bf80,0xbf6d3f35,0x3f6da554,0xbec4bf35,0x3f55a554,0x3e48bf6d,0xbf7b3f35,0x3f0e3ec4
.long 0x3f353f80,0xbf35248d,0xbf35bf80,0x3f35a554,0xbf55248d,0xbe48bf6d,0x3f7b3f35,0xbf0e3ec4
.long 0xbec4bf80,0x3f6d3f35,0xbf6d248d,0x3ec4bf35,0x3f7ba554,0xbf553ec4,0x3f0ebf35,0xbe483f6d
.long 0xbf353f80,0x3f35a554,0x3f35bf80,0xbf35248d,0xbf0e248d,0xbf7b3f6d,0xbe483f35,0x3f55bec4
.long 0x3f6dbf80,0x3ec4bf35,0xbec4248d,0xbf6d3f35,0x3e48a554,0x3f0ebec4,0x3f55bf35,0x3f7bbf6d
.long 0xbf803f80,0xbf803f80,0xbf803f80,0xbf803f80,0x3e48248d,0x3f0ebec4,0x3f55bf35,0x3f7bbf6d
.long 0x3f6dbf80,0x3ec4bf35,0xbec4a554,0xbf6d3f35,0xbf0ea554,0xbf7b3f6d,0xbe483f35,0x3f55bec4
.long 0xa5543f80,0x248dbf80,0xa5543f80,0x248dbf80,0x3f7b248d,0xbf553ec4,0x3f0ebf35,0xbe483f6d
.long 0xbec4bf80,0x3f6d3f35,0xbf6da554,0x3ec4bf35,0xbf55a554,0xbe48bf6d,0x3f7b3f35,0xbf0e3ec4
.long 0xbf353f80,0x3f35248d,0x3f35bf80,0xbf35a554,0x3f55248d,0x3e48bf6d,0xbf7b3f35,0x3f0e3ec4
.long 0x3ec4bf80,0xbf6d3f35,0x3f6d248d,0xbec4bf35,0xbf7ba554,0x3f553ec4,0xbf0ebf35,0x3e483f6d
.long 0x3f353f80,0xbf35a554,0xbf35bf80,0x3f35248d,0x3f0e248d,0x3f7b3f6d,0x3e483f35,0xbf55bec4
.long 0xbf6dbf80,0xbec4bf35,0x3ec4248d,0x3f6d3f35,0xbe48a554,0xbf0ebec4,0xbf55bf35,0xbf7bbf6d
.long 0x3f803f80,0x3f803f80,0x3f803f80,0x3f803f80,0xbf7bbf80,0xbf55bf6d,0xbf0ebf35,0xbe48bec4
.long 0x3f6d3f80,0x3ec43f35,0xbec4248d,0xbf6dbf35,0xbf55bf80,0x3e48bec4,0x3f7b3f35,0x3f0e3f6d
.long 0x248d3f80,0xa554bf80,0x248d3f80,0xa554bf80,0x3e48bf80,0xbf0e3f6d,0x3f55bf35,0xbf7b3ec4
.long 0xbec43f80,0x3f6dbf35,0xbf6d248d,0x3ec43f35,0x3f0ebf80,0xbf7b3ec4,0x3e483f35,0x3f55bf6d
.long 0x3f353f80,0xbf35248d,0xbf35bf80,0x3f35a554,0xbf0ebf80,0x3f7b3ec4,0xbe483f35,0xbf55bf6d
.long 0x3ec43f80,0xbf6dbf35,0x3f6da554,0xbec43f35,0xbe48bf80,0x3f0e3f6d,0xbf55bf35,0x3f7b3ec4
.long 0xbf353f80,0x3f35a554,0x3f35bf80,0xbf35248d,0x3f55bf80,0xbe48bec4,0xbf7b3f35,0xbf0e3f6d
.long 0xbf6d3f80,0xbec43f35,0x3ec4a554,0x3f6dbf35,0x3f7bbf80,0x3f55bf6d,0x3f0ebf35,0x3e48bec4
.long 0xbf803f80,0xbf803f80,0xbf803f80,0xbf803f80,0x3f7bbf80,0x3f55bf6d,0x3f0ebf35,0x3e48bec4
.long 0xbf6d3f80,0xbec43f35,0x3ec4248d,0x3f6dbf35,0x3f55bf80,0xbe48bec4,0xbf7b3f35,0xbf0e3f6d
.long 0xa5543f80,0x248dbf80,0xa5543f80,0x248dbf80,0xbe48bf80,0x3f0e3f6d,0xbf55bf35,0x3f7b3ec4
.long 0x3ec43f80,0xbf6dbf35,0x3f6d248d,0xbec43f35,0xbf0ebf80,0x3f7b3ec4,0xbe483f35,0xbf55bf6d
.long 0xbf353f80,0x3f35248d,0x3f35bf80,0xbf35a554,0x3f0ebf80,0xbf7b3ec4,0x3e483f35,0x3f55bf6d
.long 0xbec43f80,0x3f6dbf35,0xbf6da554,0x3ec43f35,0x3e48bf80,0xbf0e3f6d,0x3f55bf35,0xbf7b3ec4
.long 0x3f353f80,0xbf35a554,0xbf35bf80,0x3f35248d,0xbf55bf80,0x3e48bec4,0x3f7b3f35,0x3f0e3f6d
.long 0x3f6d3f80,0x3ec43f35,0xbec4a554,0xbf6dbf35,0xbf7bbf80,0xbf55bf6d,0xbf0ebf35,0xbe48bec4
.long 0x3f803f80,0x3f803f80,0x3f803f80,0x3f803f80,0x3e48a554,0x3f0e3ec4,0x3f553f35,0x3f7b3f6d
.long 0xbf6dbf80,0xbec4bf35,0x3ec4a554,0x3f6d3f35,0xbf0e248d,0xbf7bbf6d,0xbe48bf35,0x3f553ec4
.long 0x248d3f80,0xa554bf80,0x248d3f80,0xa554bf80,0x3f7ba554,0xbf55bec4,0x3f0e3f35,0xbe48bf6d
.long 0x3ec4bf80,0xbf6d3f35,0x3f6da554,0xbec4bf35,0xbf55248d,0xbe483f6d,0x3f7bbf35,0xbf0ebec4
.long 0x3f353f80,0xbf35248d,0xbf35bf80,0x3f35a554,0x3f55a554,0x3e483f6d,0xbf7bbf35,0x3f0ebec4
.long 0xbec4bf80,0x3f6d3f35,0xbf6d248d,0x3ec4bf35,0xbf7b248d,0x3f55bec4,0xbf0e3f35,0x3e48bf6d
.long 0xbf353f80,0x3f35a554,0x3f35bf80,0xbf35248d,0x3f0ea554,0x3f7bbf6d,0x3e48bf35,0xbf553ec4
.long 0x3f6dbf80,0x3ec4bf35,0xbec4248d,0xbf6d3f35,0xbe48248d,0xbf0e3ec4,0xbf553f35,0xbf7b3f6d
.long 0xbf803f80,0xbf803f80,0xbf803f80,0xbf803f80,0xbe48a554,0xbf0e3ec4,0xbf553f35,0xbf7b3f6d
.long 0x3f6dbf80,0x3ec4bf35,0xbec4a554,0xbf6d3f35,0x3f0e248d,0x3f7bbf6d,0x3e48bf35,0xbf553ec4
.long 0xa5543f80,0x248dbf80,0xa5543f80,0x248dbf80,0xbf7ba554,0x3f55bec4,0xbf0e3f35,0x3e48bf6d
.long 0xbec4bf80,0x3f6d3f35,0xbf6da554,0x3ec4bf35,0x3f55248d,0x3e483f6d,0xbf7bbf35,0x3f0ebec4
.long 0xbf353f80,0x3f35248d,0x3f35bf80,0xbf35a554,0xbf55a554,0xbe483f6d,0x3f7bbf35,0xbf0ebec4
.long 0x3ec4bf80,0xbf6d3f35,0x3f6d248d,0xbec4bf35,0x3f7b248d,0xbf55bec4,0x3f0e3f35,0xbe48bf6d
.long 0x3f353f80,0xbf35a554,0xbf35bf80,0x3f35248d,0xbf0ea554,0xbf7bbf6d,0xbe48bf35,0x3f553ec4
.long 0xbf6dbf80,0xbec4bf35,0x3ec4248d,0x3f6d3f35,0x3e48248d,0x3f0e3ec4,0x3f553f35,0x3f7b3f6d
.long 0x80008000,0x80008000,0x80008000,0x80008000,0xbe488000,0xbf0ebec4,0xbf55bf35,0xbf7bbf6d
.long 0xbec48000,0xbf6dbf35,0xbf6dbf80,0xbec4bf35,0xbf0e8000,0xbf7bbf6d,0xbe48bf35,0x3f553ec4
.long 0xbf808000,0x3f80a50d,0xbf808000,0x3f80a50d,0xbf7b8000,0x3f553ec4,0xbf0ebf35,0x3e483f6d
.long 0xbf6d8000,0x3ec43f35,0x3ec4bf80,0xbf6d3f35,0xbf558000,0xbe483f6d,0x3f7bbf35,0xbf0ebec4
.long 0xbf358000,0xbf35bf80,0x3f35a50d,0x3f353f80,0xbf558000,0xbe48bf6d,0x3f7b3f35,0xbf0e3ec4
.long 0xbf6d8000,0x3ec4bf35,0x3ec43f80,0xbf6dbf35,0xbf7b8000,0x3f55bec4,0xbf0e3f35,0x3e48bf6d
.long 0xbf358000,0xbf353f80,0x3f35a50d,0x3f35bf80,0xbf0e8000,0xbf7b3f6d,0xbe483f35,0x3f55bec4
.long 0xbec48000,0xbf6d3f35,0xbf6d3f80,0xbec43f35,0xbe488000,0xbf0e3ec4,0xbf553f35,0xbf7b3f6d
.long 0xa50d8000,0xa50d8000,0xa50d8000,0xa50d8000,0x3e488000,0x3f0ebec4,0x3f55bf35,0x3f7bbf6d
.long 0x3ec48000,0x3f6dbf35,0x3f6dbf80,0x3ec4bf35,0x3f0e8000,0x3f7bbf6d,0x3e48bf35,0xbf553ec4
.long 0x3f808000,0xbf80a50d,0x3f808000,0xbf80a50d,0x3f7b8000,0xbf553ec4,0x3f0ebf35,0xbe483f6d
.long 0x3f6d8000,0xbec43f35,0xbec4bf80,0x3f6d3f35,0x3f558000,0x3e483f6d,0xbf7bbf35,0x3f0ebec4
.long 0x3f358000,0x3f35bf80,0xbf35a50d,0xbf353f80,0x3f558000,0x3e48bf6d,0xbf7b3f35,0x3f0e3ec4
.long 0x3f6d8000,0xbec4bf35,0xbec43f80,0x3f6dbf35,0x3f7b8000,0xbf55bec4,0x3f0e3f35,0xbe48bf6d
.long 0x3f358000,0x3f353f80,0xbf35a50d,0xbf35bf80,0x3f0e8000,0x3f7b3f6d,0x3e483f35,0xbf55bec4
.long 0x3ec48000,0x3f6d3f35,0x3f6d3f80,0x3ec43f35,0x3e488000,0x3f0e3ec4,0x3f553f35,0x3f7b3f6d
.long 0x80008000,0x80008000,0x80008000,0x80008000,0xbf7bbf80,0xbf55bf6d,0xbf0ebf35,0xbe48bec4
.long 0x3ec4a50d,0x3f6d3f35,0x3f6d3f80,0x3ec43f35,0x3f553f80,0xbe483ec4,0xbf7bbf35,0xbf0ebf6d
.long 0xbf808000,0x3f80a50d,0xbf808000,0x3f80a50d,0x3e48bf80,0xbf0e3f6d,0x3f55bf35,0xbf7b3ec4
.long 0x3f6da50d,0xbec4bf35,0xbec43f80,0x3f6dbf35,0xbf0e3f80,0x3f7bbec4,0xbe48bf35,0xbf553f6d
.long 0xbf358000,0xbf35bf80,0x3f35a50d,0x3f353f80,0xbf0ebf80,0x3f7b3ec4,0xbe483f35,0xbf55bf6d
.long 0x3f6da50d,0xbec43f35,0xbec4bf80,0x3f6d3f35,0x3e483f80,0xbf0ebf6d,0x3f553f35,0xbf7bbec4
.long 0xbf358000,0xbf353f80,0x3f35a50d,0x3f35bf80,0x3f55bf80,0xbe48bec4,0xbf7b3f35,0xbf0e3f6d
.long 0x3ec4a50d,0x3f6dbf35,0x3f6dbf80,0x3ec4bf35,0xbf7b3f80,0xbf553f6d,0xbf0e3f35,0xbe483ec4
.long 0xa50d8000,0xa50d8000,0xa50d8000,0xa50d8000,0x3f7bbf80,0x3f55bf6d,0x3f0ebf35,0x3e48bec4
.long 0xbec4a50d,0xbf6d3f35,0xbf6d3f80,0xbec43f35,0xbf553f80,0x3e483ec4,0x3f7bbf35,0x3f0ebf6d
.long 0x3f808000,0xbf80a50d,0x3f808000,0xbf80a50d,0xbe48bf80,0x3f0e3f6d,0xbf55bf35,0x3f7b3ec4
.long 0xbf6da50d,0x3ec4bf35,0x3ec43f80,0xbf6dbf35,0x3f0e3f80,0xbf7bbec4,0x3e48bf35,0x3f553f6d
.long 0x3f358000,0x3f35bf80,0xbf35a50d,0xbf353f80,0x3f0ebf80,0xbf7b3ec4,0x3e483f35,0x3f55bf6d
.long 0xbf6da50d,0x3ec43f35,0x3ec4bf80,0xbf6d3f35,0xbe483f80,0x3f0ebf6d,0xbf553f35,0x3f7bbec4
.long 0x3f358000,0x3f353f80,0xbf35a50d,0xbf35bf80,0xbf55bf80,0x3e48bec4,0x3f7b3f35,0x3f0e3f6d
.long 0xbec4a50d,0xbf6dbf35,0xbf6dbf80,0xbec4bf35,0x3f7b3f80,0x3f553f6d,0x3f0e3f35,0x3e483ec4
.long 0x80008000,0x80008000,0x80008000,0x80008000,0x3e48a50d,0x3f0e3ec4,0x3f553f35,0x3f7b3f6d
.long 0xbec48000,0xbf6dbf35,0xbf6dbf80,0xbec4bf35,0x3f0ea50d,0x3f7b3f6d,0x3e483f35,0xbf55bec4
.long 0xbf808000,0x3f80a50d,0xbf808000,0x3f80a50d,0x3f7ba50d,0xbf55bec4,0x3f0e3f35,0xbe48bf6d
.long 0xbf6d8000,0x3ec43f35,0x3ec4bf80,0xbf6d3f35,0x3f55a50d,0x3e48bf6d,0xbf7b3f35,0x3f0e3ec4
.long 0xbf358000,0xbf35bf80,0x3f35a50d,0x3f353f80,0x3f55a50d,0x3e483f6d,0xbf7bbf35,0x3f0ebec4
.long 0xbf6d8000,0x3ec4bf35,0x3ec43f80,0xbf6dbf35,0x3f7ba50d,0xbf553ec4,0x3f0ebf35,0xbe483f6d
.long 0xbf358000,0xbf353f80,0x3f35a50d,0x3f35bf80,0x3f0ea50d,0x3f7bbf6d,0x3e48bf35,0xbf553ec4
.long 0xbec48000,0xbf6d3f35,0xbf6d3f80,0xbec43f35,0x3e48a50d,0x3f0ebec4,0x3f55bf35,0x3f7bbf6d
.long 0xa50d8000,0xa50d8000,0xa50d8000,0xa50d8000,0xbe48a50d,0xbf0e3ec4,0xbf553f35,0xbf7b3f6d
.long 0x3ec48000,0x3f6dbf35,0x3f6dbf80,0x3ec4bf35,0xbf0ea50d,0xbf7b3f6d,0xbe483f35,0x3f55bec4
.long 0x3f808000,0xbf80a50d,0x3f808000,0xbf80a50d,0xbf7ba50d,0x3f55bec4,0xbf0e3f35,0x3e48bf6d
.long 0x3f6d8000,0xbec43f35,0xbec4bf80,0x3f6d3f35,0xbf55a50d,0xbe48bf6d,0x3f7b3f35,0xbf0e3ec4
.long 0x3f358000,0x3f35bf80,0xbf35a50d,0xbf353f80,0xbf55a50d,0xbe483f6d,0x3f7bbf35,0xbf0ebec4
.long 0x3f6d8000,0xbec4bf35,0xbec43f80,0x3f6dbf35,0xbf7ba50d,0x3f553ec4,0xbf0ebf35,0x3e483f6d
.long 0x3f358000,0x3f353f80,0xbf35a50d,0xbf35bf80,0xbf0ea50d,0xbf7bbf6d,0xbe48bf35,0x3f553ec4
.long 0x3ec48000,0x3f6d3f35,0x3f6d3f80,0x3ec43f35,0xbe48a50d,0xbf0ebec4,0xbf55bf35,0xbf7bbf6d
.long 0x80008000,0x80008000,0x80008000,0x80008000,0x3f7b3f80,0x3f553f6d,0x3f0e3f35,0x3e483ec4
.long 0x3ec4a50d,0x3f6d3f35,0x3f6d3f80,0x3ec43f35,0xbf55bf80,0x3e48bec4,0x3f7b3f35,0x3f0e3f6d
.long 0xbf808000,0x3f80a50d,0xbf808000,0x3f80a50d,0xbe483f80,0x3f0ebf6d,0xbf553f35,0x3f7bbec4
.long 0x3f6da50d,0xbec4bf35,0xbec43f80,0x3f6dbf35,0x3f0ebf80,0xbf7b3ec4,0x3e483f35,0x3f55bf6d
.long 0xbf358000,0xbf35bf80,0x3f35a50d,0x3f353f80,0x3f0e3f80,0xbf7bbec4,0x3e48bf35,0x3f553f6d
.long 0x3f6da50d,0xbec43f35,0xbec4bf80,0x3f6d3f35,0xbe48bf80,0x3f0e3f6d,0xbf55bf35,0x3f7b3ec4
.long 0xbf358000,0xbf353f80,0x3f35a50d,0x3f35bf80,0xbf553f80,0x3e483ec4,0x3f7bbf35,0x3f0ebf6d
.long 0x3ec4a50d,0x3f6dbf35,0x3f6dbf80,0x3ec4bf35,0x3f7bbf80,0x3f55bf6d,0x3f0ebf35,0x3e48bec4
.long 0xa50d8000,0xa50d8000,0xa50d8000,0xa50d8000,0xbf7b3f80,0xbf553f6d,0xbf0e3f35,0xbe483ec4
.long 0xbec4a50d,0xbf6d3f35,0xbf6d3f80,0xbec43f35,0x3f55bf80,0xbe48bec4,0xbf7b3f35,0xbf0e3f6d
.long 0x3f808000,0xbf80a50d,0x3f808000,0xbf80a50d,0x3e483f80,0xbf0ebf6d,0x3f553f35,0xbf7bbec4
.long 0xbf6da50d,0x3ec4bf35,0x3ec43f80,0xbf6dbf35,0xbf0ebf80,0x3f7b3ec4,0xbe483f35,0xbf55bf6d
.long 0x3f358000,0x3f35bf80,0xbf35a50d,0xbf353f80,0xbf0e3f80,0x3f7bbec4,0xbe48bf35,0xbf553f6d
.long 0xbf6da50d,0x3ec43f35,0x3ec4bf80,0xbf6d3f35,0x3e48bf80,0xbf0e3f6d,0x3f55bf35,0xbf7b3ec4
.long 0x3f358000,0x3f353f80,0xbf35a50d,0xbf35bf80,0x3f553f80,0xbe483ec4,0xbf7bbf35,0xbf0ebf6d
.long 0xbec4a50d,0xbf6dbf35,0xbf6dbf80,0xbec4bf35,0xbf7bbf80,0xbf55bf6d,0xbf0ebf35,0xbe48bec4
.long 0x0,0x0,0x0,0x0,0x3e480000,0x3f0e3ec4,0x3f553f35,0x3f7b3f6d
.long 0x3ec40000,0x3f6d3f35,0x3f6d3f80,0x3ec43f35,0x3f0e0000,0x3f7b3f6d,0x3e483f35,0xbf55bec4
.long 0x3f800000,0xbf80250d,0x3f800000,0xbf80250d,0x3f7b0000,0xbf55bec4,0x3f0e3f35,0xbe48bf6d
.long 0x3f6d0000,0xbec4bf35,0xbec43f80,0x3f6dbf35,0x3f550000,0x3e48bf6d,0xbf7b3f35,0x3f0e3ec4
.long 0x3f350000,0x3f353f80,0xbf35250d,0xbf35bf80,0x3f550000,0x3e483f6d,0xbf7bbf35,0x3f0ebec4
.long 0x3f6d0000,0xbec43f35,0xbec4bf80,0x3f6d3f35,0x3f7b0000,0xbf553ec4,0x3f0ebf35,0xbe483f6d
.long 0x3f350000,0x3f35bf80,0xbf35250d,0xbf353f80,0x3f0e0000,0x3f7bbf6d,0x3e48bf35,0xbf553ec4
.long 0x3ec40000,0x3f6dbf35,0x3f6dbf80,0x3ec4bf35,0x3e480000,0x3f0ebec4,0x3f55bf35,0x3f7bbf6d
.long 0x250d0000,0x250d0000,0x250d0000,0x250d0000,0xbe480000,0xbf0e3ec4,0xbf553f35,0xbf7b3f6d
.long 0xbec40000,0xbf6d3f35,0xbf6d3f80,0xbec43f35,0xbf0e0000,0xbf7b3f6d,0xbe483f35,0x3f55bec4
.long 0xbf800000,0x3f80250d,0xbf800000,0x3f80250d,0xbf7b0000,0x3f55bec4,0xbf0e3f35,0x3e48bf6d
.long 0xbf6d0000,0x3ec4bf35,0x3ec43f80,0xbf6dbf35,0xbf550000,0xbe48bf6d,0x3f7b3f35,0xbf0e3ec4
.long 0xbf350000,0xbf353f80,0x3f35250d,0x3f35bf80,0xbf550000,0xbe483f6d,0x3f7bbf35,0xbf0ebec4
.long 0xbf6d0000,0x3ec43f35,0x3ec4bf80,0xbf6d3f35,0xbf7b0000,0x3f553ec4,0xbf0ebf35,0x3e483f6d
.long 0xbf350000,0xbf35bf80,0x3f35250d,0x3f353f80,0xbf0e0000,0xbf7bbf6d,0xbe48bf35,0x3f553ec4
.long 0xbec40000,0xbf6dbf35,0xbf6dbf80,0xbec4bf35,0xbe480000,0xbf0ebec4,0xbf55bf35,0xbf7bbf6d
.long 0x0,0x0,0x0,0x0,0x3f7b3f80,0x3f553f6d,0x3f0e3f35,0x3e483ec4
.long 0xbec4250d,0xbf6dbf35,0xbf6dbf80,0xbec4bf35,0xbf55bf80,0x3e48bec4,0x3f7b3f35,0x3f0e3f6d
.long 0x3f800000,0xbf80250d,0x3f800000,0xbf80250d,0xbe483f80,0x3f0ebf6d,0xbf553f35,0x3f7bbec4
.long 0xbf6d250d,0x3ec43f35,0x3ec4bf80,0xbf6d3f35,0x3f0ebf80,0xbf7b3ec4,0x3e483f35,0x3f55bf6d
.long 0x3f350000,0x3f353f80,0xbf35250d,0xbf35bf80,0x3f0e3f80,0xbf7bbec4,0x3e48bf35,0x3f553f6d
.long 0xbf6d250d,0x3ec4bf35,0x3ec43f80,0xbf6dbf35,0xbe48bf80,0x3f0e3f6d,0xbf55bf35,0x3f7b3ec4
.long 0x3f350000,0x3f35bf80,0xbf35250d,0xbf353f80,0xbf553f80,0x3e483ec4,0x3f7bbf35,0x3f0ebf6d
.long 0xbec4250d,0xbf6d3f35,0xbf6d3f80,0xbec43f35,0x3f7bbf80,0x3f55bf6d,0x3f0ebf35,0x3e48bec4
.long 0x250d0000,0x250d0000,0x250d0000,0x250d0000,0xbf7b3f80,0xbf553f6d,0xbf0e3f35,0xbe483ec4
.long 0x3ec4250d,0x3f6dbf35,0x3f6dbf80,0x3ec4bf35,0x3f55bf80,0xbe48bec4,0xbf7b3f35,0xbf0e3f6d
.long 0xbf800000,0x3f80250d,0xbf800000,0x3f80250d,0x3e483f80,0xbf0ebf6d,0x3f553f35,0xbf7bbec4
.long 0x3f6d250d,0xbec43f35,0xbec4bf80,0x3f6d3f35,0xbf0ebf80,0x3f7b3ec4,0xbe483f35,0xbf55bf6d
.long 0xbf350000,0xbf353f80,0x3f35250d,0x3f35bf80,0xbf0e3f80,0x3f7bbec4,0xbe48bf35,0xbf553f6d
.long 0x3f6d250d,0xbec4bf35,0xbec43f80,0x3f6dbf35,0x3e48bf80,0xbf0e3f6d,0x3f55bf35,0xbf7b3ec4
.long 0xbf350000,0xbf35bf80,0x3f35250d,0x3f353f80,0x3f553f80,0xbe483ec4,0xbf7bbf35,0xbf0ebf6d
.long 0x3ec4250d,0x3f6d3f35,0x3f6d3f80,0x3ec43f35,0xbf7bbf80,0xbf55bf6d,0xbf0ebf35,0xbe48bec4
.long 0x0,0x0,0x0,0x0,0xbe48250d,0xbf0ebec4,0xbf55bf35,0xbf7bbf6d
.long 0x3ec40000,0x3f6d3f35,0x3f6d3f80,0x3ec43f35,0xbf0e250d,0xbf7bbf6d,0xbe48bf35,0x3f553ec4
.long 0x3f800000,0xbf80250d,0x3f800000,0xbf80250d,0xbf7b250d,0x3f553ec4,0xbf0ebf35,0x3e483f6d
.long 0x3f6d0000,0xbec4bf35,0xbec43f80,0x3f6dbf35,0xbf55250d,0xbe483f6d,0x3f7bbf35,0xbf0ebec4
.long 0x3f350000,0x3f353f80,0xbf35250d,0xbf35bf80,0xbf55250d,0xbe48bf6d,0x3f7b3f35,0xbf0e3ec4
.long 0x3f6d0000,0xbec43f35,0xbec4bf80,0x3f6d3f35,0xbf7b250d,0x3f55bec4,0xbf0e3f35,0x3e48bf6d
.long 0x3f350000,0x3f35bf80,0xbf35250d,0xbf353f80,0xbf0e250d,0xbf7b3f6d,0xbe483f35,0x3f55bec4
.long 0x3ec40000,0x3f6dbf35,0x3f6dbf80,0x3ec4bf35,0xbe48250d,0xbf0e3ec4,0xbf553f35,0xbf7b3f6d
.long 0x250d0000,0x250d0000,0x250d0000,0x250d0000,0x3e48250d,0x3f0ebec4,0x3f55bf35,0x3f7bbf6d
.long 0xbec40000,0xbf6d3f35,0xbf6d3f80,0xbec43f35,0x3f0e250d,0x3f7bbf6d,0x3e48bf35,0xbf553ec4
.long 0xbf800000,0x3f80250d,0xbf800000,0x3f80250d,0x3f7b250d,0xbf553ec4,0x3f0ebf35,0xbe483f6d
.long 0xbf6d0000,0x3ec4bf35,0x3ec43f80,0xbf6dbf35,0x3f55250d,0x3e483f6d,0xbf7bbf35,0x3f0ebec4
.long 0xbf350000,0xbf353f80,0x3f35250d,0x3f35bf80,0x3f55250d,0x3e48bf6d,0xbf7b3f35,0x3f0e3ec4
.long 0xbf6d0000,0x3ec43f35,0x3ec4bf80,0xbf6d3f35,0x3f7b250d,0xbf55bec4,0x3f0e3f35,0xbe48bf6d
.long 0xbf350000,0xbf35bf80,0x3f35250d,0x3f353f80,0x3f0e250d,0x3f7b3f6d,0x3e483f35,0xbf55bec4
.long 0xbec40000,0xbf6dbf35,0xbf6dbf80,0xbec4bf35,0x3e48250d,0x3f0e3ec4,0x3f553f35,0x3f7b3f6d
.long 0x0,0x0,0x0,0x0,0xbf7bbf80,0xbf55bf6d,0xbf0ebf35,0xbe48bec4
.long 0xbec4250d,0xbf6dbf35,0xbf6dbf80,0xbec4bf35,0x3f553f80,0xbe483ec4,0xbf7bbf35,0xbf0ebf6d
.long 0x3f800000,0xbf80250d,0x3f800000,0xbf80250d,0x3e48bf80,0xbf0e3f6d,0x3f55bf35,0xbf7b3ec4
.long 0xbf6d250d,0x3ec43f35,0x3ec4bf80,0xbf6d3f35,0xbf0e3f80,0x3f7bbec4,0xbe48bf35,0xbf553f6d
.long 0x3f350000,0x3f353f80,0xbf35250d,0xbf35bf80,0xbf0ebf80,0x3f7b3ec4,0xbe483f35,0xbf55bf6d
.long 0xbf6d250d,0x3ec4bf35,0x3ec43f80,0xbf6dbf35,0x3e483f80,0xbf0ebf6d,0x3f553f35,0xbf7bbec4
.long 0x3f350000,0x3f35bf80,0xbf35250d,0xbf353f80,0x3f55bf80,0xbe48bec4,0xbf7b3f35,0xbf0e3f6d
.long 0xbec4250d,0xbf6d3f35,0xbf6d3f80,0xbec43f35,0xbf7b3f80,0xbf553f6d,0xbf0e3f35,0xbe483ec4
.long 0x250d0000,0x250d0000,0x250d0000,0x250d0000,0x3f7bbf80,0x3f55bf6d,0x3f0ebf35,0x3e48bec4
.long 0x3ec4250d,0x3f6dbf35,0x3f6dbf80,0x3ec4bf35,0xbf553f80,0x3e483ec4,0x3f7bbf35,0x3f0ebf6d
.long 0xbf800000,0x3f80250d,0xbf800000,0x3f80250d,0xbe48bf80,0x3f0e3f6d,0xbf55bf35,0x3f7b3ec4
.long 0x3f6d250d,0xbec43f35,0xbec4bf80,0x3f6d3f35,0x3f0e3f80,0xbf7bbec4,0x3e48bf35,0x3f553f6d
.long 0xbf350000,0xbf353f80,0x3f35250d,0x3f35bf80,0x3f0ebf80,0xbf7b3ec4,0x3e483f35,0x3f55bf6d
.long 0x3f6d250d,0xbec4bf35,0xbec43f80,0x3f6dbf35,0xbe483f80,0x3f0ebf6d,0xbf553f35,0x3f7bbec4
.long 0xbf350000,0xbf35bf80,0x3f35250d,0x3f353f80,0xbf55bf80,0x3e48bec4,0x3f7b3f35,0x3f0e3f6d
.long 0x3ec4250d,0x3f6d3f35,0x3f6d3f80,0x3ec43f35,0x3f7b3f80,0x3f553f6d,0x3f0e3f35,0x3e483ec4
.long 0x20000,0x20040,0x20110,0x20150,0x20550,0x20510,0x20660,0x20620
.long 0x20a20,0x20a60,0x20b30,0x20b70,0x20f70,0x20f30,0x21000,0x21040
.long 0x22800,0x22840,0x22910,0x22950,0x22d50,0x22d10,0x22e60,0x22e20
.long 0x23220,0x23260,0x23330,0x23370,0x23770,0x23730,0x23800,0x23840
.long 0x21440,0x21400,0x21550,0x21510,0x21910,0x21950,0x21a20,0x21a60
.long 0x21e60,0x21e20,0x21f70,0x21f30,0x22330,0x22370,0x22440,0x22400
.long 0x23c40,0x23c00,0x23d50,0x23d10,0x24110,0x24150,0x24220,0x24260
.long 0x24660,0x24620,0x24770,0x24730,0x24b30,0x24b70,0x24c40,0x24c00
.long 0x25000,0x24fb0,0x24f70,0x24ea0,0x25080,0x24ae0,0x24a20,0x249d0
.long 0x25080,0x24590,0x24550,0x24480,0x25080,0x240c0,0x24000,0x23fb0
.long 0x25080,0x227b0,0x22770,0x226a0,0x25080,0x222e0,0x22220,0x221d0
.long 0x25080,0x21d90,0x21d50,0x21c80,0x25080,0x218c0,0x21800,0x217b0
.long 0x25080,0x23bf0,0x23b30,0x23ae0,0x25080,0x236a0,0x23660,0x23590
.long 0x25080,0x231d0,0x23110,0x230c0,0x25080,0x22c80,0x22c40,0x22bf0
.long 0x25080,0x213f0,0x21330,0x212e0,0x25080,0x20ea0,0x20e60,0x20d90
.long 0x25080,0x209d0,0x20910,0x208c0,0x25080,0x20480,0x20440,0x203f0
.long 0x20080,0x200c0,0x20190,0x201d0,0x205d0,0x20590,0x206e0,0x206a0
.long 0x20aa0,0x20ae0,0x20bb0,0x20bf0,0x20ff0,0x20fb0,0x21080,0x210c0
.long 0x22880,0x228c0,0x22990,0x229d0,0x22dd0,0x22d90,0x22ee0,0x22ea0
.long 0x232a0,0x232e0,0x233b0,0x233f0,0x237f0,0x237b0,0x23880,0x238c0
.long 0x214c0,0x21480,0x215d0,0x21590,0x21990,0x219d0,0x21aa0,0x21ae0
.long 0x21ee0,0x21ea0,0x21ff0,0x21fb0,0x223b0,0x223f0,0x224c0,0x22480
.long 0x23cc0,0x23c80,0x23dd0,0x23d90,0x24190,0x241d0,0x242a0,0x242e0
.long 0x246e0,0x246a0,0x247f0,0x247b0,0x24bb0,0x24bf0,0x24cc0,0x24c80
.long 0x24ff0,0x24f30,0x24ee0,0x24e20,0x24aa0,0x24a60,0x24990,0x24950
.long 0x245d0,0x24510,0x244c0,0x24400,0x24080,0x24040,0x23ff0,0x23f30
.long 0x227f0,0x22730,0x226e0,0x22620,0x222a0,0x22260,0x22190,0x22150
.long 0x21dd0,0x21d10,0x21cc0,0x21c00,0x21880,0x21840,0x217f0,0x21730
.long 0x23bb0,0x23b70,0x23aa0,0x23a60,0x236e0,0x23620,0x235d0,0x23510
.long 0x23190,0x23150,0x23080,0x23040,0x22cc0,0x22c00,0x22bb0,0x22b70
.long 0x213b0,0x21370,0x212a0,0x21260,0x20ee0,0x20e20,0x20dd0,0x20d10
.long 0x20990,0x20950,0x20880,0x20840,0x204c0,0x20400,0x203b0,0x20370
.long 0x20220,0x20260,0x20010,0x20050,0x20770,0x20730,0x20540,0x20500
.long 0x20c40,0x20c00,0x20a30,0x20a70,0x21110,0x21150,0x20f60,0x20f20
.long 0x22a20,0x22a60,0x22810,0x22850,0x22f70,0x22f30,0x22d40,0x22d00
.long 0x23440,0x23400,0x23230,0x23270,0x23910,0x23950,0x23760,0x23720
.long 0x21660,0x21620,0x21450,0x21410,0x21b30,0x21b70,0x21900,0x21940
.long 0x22000,0x22040,0x21e70,0x21e30,0x22550,0x22510,0x22320,0x22360
.long 0x23e60,0x23e20,0x23c50,0x23c10,0x24330,0x24370,0x24100,0x24140
.long 0x24800,0x24840,0x24670,0x24630,0x24d50,0x24d10,0x24b20,0x24b60
.long 0x24e60,0x24d90,0x25010,0x24fa0,0x24910,0x248c0,0x25090,0x24af0
.long 0x24440,0x243f0,0x25090,0x24580,0x23f70,0x23ea0,0x25090,0x240d0
.long 0x22660,0x22590,0x25090,0x227a0,0x22110,0x220c0,0x25090,0x222f0
.long 0x21c40,0x21bf0,0x25090,0x21d80,0x21770,0x216a0,0x25090,0x218d0
.long 0x23a20,0x239d0,0x25090,0x23be0,0x23550,0x23480,0x25090,0x236b0
.long 0x23000,0x22fb0,0x25090,0x231c0,0x22b30,0x22ae0,0x25090,0x22c90
.long 0x21220,0x211d0,0x25090,0x213e0,0x20d50,0x20c80,0x25090,0x20eb0
.long 0x20800,0x207b0,0x25090,0x209c0,0x20330,0x202e0,0x25090,0x20490
.long 0x202a0,0x25080,0x20090,0x200d0,0x207f0,0x25080,0x205c0,0x20580
.long 0x20cc0,0x25080,0x20ab0,0x20af0,0x21190,0x25080,0x20fe0,0x20fa0
.long 0x22aa0,0x25080,0x22890,0x228d0,0x22ff0,0x25080,0x22dc0,0x22d80
.long 0x234c0,0x25080,0x232b0,0x232f0,0x23990,0x25080,0x237e0,0x237a0
.long 0x216e0,0x25080,0x214d0,0x21490,0x21bb0,0x25080,0x21980,0x219c0
.long 0x22080,0x25080,0x21ef0,0x21eb0,0x225d0,0x25080,0x223a0,0x223e0
.long 0x23ee0,0x25080,0x23cd0,0x23c90,0x243b0,0x25080,0x24180,0x241c0
.long 0x24880,0x25080,0x246f0,0x246b0,0x24dd0,0x25080,0x24ba0,0x24be0
.long 0x25080,0x25080,0x24fe0,0x24f20,0x25080,0x25080,0x24ab0,0x24a70
.long 0x25080,0x25080,0x245c0,0x24500,0x25080,0x25080,0x24090,0x24050
.long 0x25080,0x25080,0x227e0,0x22720,0x25080,0x25080,0x222b0,0x22270
.long 0x25080,0x25080,0x21dc0,0x21d00,0x25080,0x25080,0x21890,0x21850
.long 0x25080,0x25080,0x23ba0,0x23b60,0x25080,0x25080,0x236f0,0x23630
.long 0x25080,0x25080,0x23180,0x23140,0x25080,0x25080,0x22cd0,0x22c10
.long 0x25080,0x25080,0x213a0,0x21360,0x25080,0x25080,0x20ef0,0x20e30
.long 0x25080,0x25080,0x20980,0x20940,0x25080,0x25080,0x204d0,0x20410
.long 0x20100,0x20140,0x20230,0x20270,0x20670,0x20630,0x20760,0x20720
.long 0x20b20,0x20b60,0x20c50,0x20c10,0x21010,0x21050,0x21100,0x21140
.long 0x22900,0x22940,0x22a30,0x22a70,0x22e70,0x22e30,0x22f60,0x22f20
.long 0x23320,0x23360,0x23450,0x23410,0x23810,0x23850,0x23900,0x23940
.long 0x21540,0x21500,0x21670,0x21630,0x21a30,0x21a70,0x21b20,0x21b60
.long 0x21f60,0x21f20,0x22010,0x22050,0x22450,0x22410,0x22540,0x22500
.long 0x23d40,0x23d00,0x23e70,0x23e30,0x24230,0x24270,0x24320,0x24360
.long 0x24760,0x24720,0x24810,0x24850,0x24c50,0x24c10,0x24d40,0x24d00
.long 0x24f60,0x24eb0,0x24e70,0x24d80,0x24a30,0x249c0,0x24900,0x248d0
.long 0x24540,0x24490,0x24450,0x243e0,0x24010,0x23fa0,0x23f60,0x23eb0
.long 0x22760,0x226b0,0x22670,0x22580,0x22230,0x221c0,0x22100,0x220d0
.long 0x21d40,0x21c90,0x21c50,0x21be0,0x21810,0x217a0,0x21760,0x216b0
.long 0x23b20,0x23af0,0x23a30,0x239c0,0x23670,0x23580,0x23540,0x23490
.long 0x23100,0x230d0,0x23010,0x22fa0,0x22c50,0x22be0,0x22b20,0x22af0
.long 0x21320,0x212f0,0x21230,0x211c0,0x20e70,0x20d80,0x20d40,0x20c90
.long 0x20900,0x208d0,0x20810,0x207a0,0x20450,0x203e0,0x20320,0x202f0
.long 0x20180,0x201c0,0x202b0,0x25090,0x206f0,0x206b0,0x207e0,0x25090
.long 0x20ba0,0x20be0,0x20cd0,0x25090,0x21090,0x210d0,0x21180,0x25090
.long 0x22980,0x229c0,0x22ab0,0x25090,0x22ef0,0x22eb0,0x22fe0,0x25090
.long 0x233a0,0x233e0,0x234d0,0x25090,0x23890,0x238d0,0x23980,0x25090
.long 0x215c0,0x21580,0x216f0,0x25090,0x21ab0,0x21af0,0x21ba0,0x25090
.long 0x21fe0,0x21fa0,0x22090,0x25090,0x224d0,0x22490,0x225c0,0x25090
.long 0x23dc0,0x23d80,0x23ef0,0x25090,0x242b0,0x242f0,0x243a0,0x25090
.long 0x247e0,0x247a0,0x24890,0x25090,0x24cd0,0x24c90,0x24dc0,0x25090
.long 0x24ef0,0x24e30,0x25090,0x25090,0x24980,0x24940,0x25090,0x25090
.long 0x244d0,0x24410,0x25090,0x25090,0x23fe0,0x23f20,0x25090,0x25090
.long 0x226f0,0x22630,0x25090,0x25090,0x22180,0x22140,0x25090,0x25090
.long 0x21cd0,0x21c10,0x25090,0x25090,0x217e0,0x21720,0x25090,0x25090
.long 0x23ab0,0x23a70,0x25090,0x25090,0x235c0,0x23500,0x25090,0x25090
.long 0x23090,0x23050,0x25090,0x25090,0x22ba0,0x22b60,0x25090,0x25090
.long 0x212b0,0x21270,0x25090,0x25090,0x20dc0,0x20d00,0x25090,0x25090
.long 0x20890,0x20850,0x25090,0x25090,0x203a0,0x20360,0x25090,0x25090
.long 0x20004,0x20044,0x20114,0x20154,0x20554,0x20514,0x20664,0x20624
.long 0x20a24,0x20a64,0x20b34,0x20b74,0x20f74,0x20f34,0x21004,0x21044
.long 0x22804,0x22844,0x22914,0x22954,0x22d54,0x22d14,0x22e64,0x22e24
.long 0x23224,0x23264,0x23334,0x23374,0x23774,0x23734,0x23804,0x23844
.long 0x21444,0x21404,0x21554,0x21514,0x21914,0x21954,0x21a24,0x21a64
.long 0x21e64,0x21e24,0x21f74,0x21f34,0x22334,0x22374,0x22444,0x22404
.long 0x23c44,0x23c04,0x23d54,0x23d14,0x24114,0x24154,0x24224,0x24264
.long 0x24664,0x24624,0x24774,0x24734,0x24b34,0x24b74,0x24c44,0x24c04
.long 0x25004,0x24fb4,0x24f74,0x24ea4,0x25084,0x24ae4,0x24a24,0x249d4
.long 0x25084,0x24594,0x24554,0x24484,0x25084,0x240c4,0x24004,0x23fb4
.long 0x25084,0x227b4,0x22774,0x226a4,0x25084,0x222e4,0x22224,0x221d4
.long 0x25084,0x21d94,0x21d54,0x21c84,0x25084,0x218c4,0x21804,0x217b4
.long 0x25084,0x23bf4,0x23b34,0x23ae4,0x25084,0x236a4,0x23664,0x23594
.long 0x25084,0x231d4,0x23114,0x230c4,0x25084,0x22c84,0x22c44,0x22bf4
.long 0x25084,0x213f4,0x21334,0x212e4,0x25084,0x20ea4,0x20e64,0x20d94
.long 0x25084,0x209d4,0x20914,0x208c4,0x25084,0x20484,0x20444,0x203f4
.long 0x20084,0x200c4,0x20194,0x201d4,0x205d4,0x20594,0x206e4,0x206a4
.long 0x20aa4,0x20ae4,0x20bb4,0x20bf4,0x20ff4,0x20fb4,0x21084,0x210c4
.long 0x22884,0x228c4,0x22994,0x229d4,0x22dd4,0x22d94,0x22ee4,0x22ea4
.long 0x232a4,0x232e4,0x233b4,0x233f4,0x237f4,0x237b4,0x23884,0x238c4
.long 0x214c4,0x21484,0x215d4,0x21594,0x21994,0x219d4,0x21aa4,0x21ae4
.long 0x21ee4,0x21ea4,0x21ff4,0x21fb4,0x223b4,0x223f4,0x224c4,0x22484
.long 0x23cc4,0x23c84,0x23dd4,0x23d94,0x24194,0x241d4,0x242a4,0x242e4
.long 0x246e4,0x246a4,0x247f4,0x247b4,0x24bb4,0x24bf4,0x24cc4,0x24c84
.long 0x24ff4,0x24f34,0x24ee4,0x24e24,0x24aa4,0x24a64,0x24994,0x24954
.long 0x245d4,0x24514,0x244c4,0x24404,0x24084,0x24044,0x23ff4,0x23f34
.long 0x227f4,0x22734,0x226e4,0x22624,0x222a4,0x22264,0x22194,0x22154
.long 0x21dd4,0x21d14,0x21cc4,0x21c04,0x21884,0x21844,0x217f4,0x21734
.long 0x23bb4,0x23b74,0x23aa4,0x23a64,0x236e4,0x23624,0x235d4,0x23514
.long 0x23194,0x23154,0x23084,0x23044,0x22cc4,0x22c04,0x22bb4,0x22b74
.long 0x213b4,0x21374,0x212a4,0x21264,0x20ee4,0x20e24,0x20dd4,0x20d14
.long 0x20994,0x20954,0x20884,0x20844,0x204c4,0x20404,0x203b4,0x20374
.long 0x20224,0x20264,0x20014,0x20054,0x20774,0x20734,0x20544,0x20504
.long 0x20c44,0x20c04,0x20a34,0x20a74,0x21114,0x21154,0x20f64,0x20f24
.long 0x22a24,0x22a64,0x22814,0x22854,0x22f74,0x22f34,0x22d44,0x22d04
.long 0x23444,0x23404,0x23234,0x23274,0x23914,0x23954,0x23764,0x23724
.long 0x21664,0x21624,0x21454,0x21414,0x21b34,0x21b74,0x21904,0x21944
.long 0x22004,0x22044,0x21e74,0x21e34,0x22554,0x22514,0x22324,0x22364
.long 0x23e64,0x23e24,0x23c54,0x23c14,0x24334,0x24374,0x24104,0x24144
.long 0x24804,0x24844,0x24674,0x24634,0x24d54,0x24d14,0x24b24,0x24b64
.long 0x24e64,0x24d94,0x25014,0x24fa4,0x24914,0x248c4,0x25094,0x24af4
.long 0x24444,0x243f4,0x25094,0x24584,0x23f74,0x23ea4,0x25094,0x240d4
.long 0x22664,0x22594,0x25094,0x227a4,0x22114,0x220c4,0x25094,0x222f4
.long 0x21c44,0x21bf4,0x25094,0x21d84,0x21774,0x216a4,0x25094,0x218d4
.long 0x23a24,0x239d4,0x25094,0x23be4,0x23554,0x23484,0x25094,0x236b4
.long 0x23004,0x22fb4,0x25094,0x231c4,0x22b34,0x22ae4,0x25094,0x22c94
.long 0x21224,0x211d4,0x25094,0x213e4,0x20d54,0x20c84,0x25094,0x20eb4
.long 0x20804,0x207b4,0x25094,0x209c4,0x20334,0x202e4,0x25094,0x20494
.long 0x202a4,0x25084,0x20094,0x200d4,0x207f4,0x25084,0x205c4,0x20584
.long 0x20cc4,0x25084,0x20ab4,0x20af4,0x21194,0x25084,0x20fe4,0x20fa4
.long 0x22aa4,0x25084,0x22894,0x228d4,0x22ff4,0x25084,0x22dc4,0x22d84
.long 0x234c4,0x25084,0x232b4,0x232f4,0x23994,0x25084,0x237e4,0x237a4
.long 0x216e4,0x25084,0x214d4,0x21494,0x21bb4,0x25084,0x21984,0x219c4
.long 0x22084,0x25084,0x21ef4,0x21eb4,0x225d4,0x25084,0x223a4,0x223e4
.long 0x23ee4,0x25084,0x23cd4,0x23c94,0x243b4,0x25084,0x24184,0x241c4
.long 0x24884,0x25084,0x246f4,0x246b4,0x24dd4,0x25084,0x24ba4,0x24be4
.long 0x25084,0x25084,0x24fe4,0x24f24,0x25084,0x25084,0x24ab4,0x24a74
.long 0x25084,0x25084,0x245c4,0x24504,0x25084,0x25084,0x24094,0x24054
.long 0x25084,0x25084,0x227e4,0x22724,0x25084,0x25084,0x222b4,0x22274
.long 0x25084,0x25084,0x21dc4,0x21d04,0x25084,0x25084,0x21894,0x21854
.long 0x25084,0x25084,0x23ba4,0x23b64,0x25084,0x25084,0x236f4,0x23634
.long 0x25084,0x25084,0x23184,0x23144,0x25084,0x25084,0x22cd4,0x22c14
.long 0x25084,0x25084,0x213a4,0x21364,0x25084,0x25084,0x20ef4,0x20e34
.long 0x25084,0x25084,0x20984,0x20944,0x25084,0x25084,0x204d4,0x20414
.long 0x20104,0x20144,0x20234,0x20274,0x20674,0x20634,0x20764,0x20724
.long 0x20b24,0x20b64,0x20c54,0x20c14,0x21014,0x21054,0x21104,0x21144
.long 0x22904,0x22944,0x22a34,0x22a74,0x22e74,0x22e34,0x22f64,0x22f24
.long 0x23324,0x23364,0x23454,0x23414,0x23814,0x23854,0x23904,0x23944
.long 0x21544,0x21504,0x21674,0x21634,0x21a34,0x21a74,0x21b24,0x21b64
.long 0x21f64,0x21f24,0x22014,0x22054,0x22454,0x22414,0x22544,0x22504
.long 0x23d44,0x23d04,0x23e74,0x23e34,0x24234,0x24274,0x24324,0x24364
.long 0x24764,0x24724,0x24814,0x24854,0x24c54,0x24c14,0x24d44,0x24d04
.long 0x24f64,0x24eb4,0x24e74,0x24d84,0x24a34,0x249c4,0x24904,0x248d4
.long 0x24544,0x24494,0x24454,0x243e4,0x24014,0x23fa4,0x23f64,0x23eb4
.long 0x22764,0x226b4,0x22674,0x22584,0x22234,0x221c4,0x22104,0x220d4
.long 0x21d44,0x21c94,0x21c54,0x21be4,0x21814,0x217a4,0x21764,0x216b4
.long 0x23b24,0x23af4,0x23a34,0x239c4,0x23674,0x23584,0x23544,0x23494
.long 0x23104,0x230d4,0x23014,0x22fa4,0x22c54,0x22be4,0x22b24,0x22af4
.long 0x21324,0x212f4,0x21234,0x211c4,0x20e74,0x20d84,0x20d44,0x20c94
.long 0x20904,0x208d4,0x20814,0x207a4,0x20454,0x203e4,0x20324,0x202f4
.long 0x20184,0x201c4,0x202b4,0x25094,0x206f4,0x206b4,0x207e4,0x25094
.long 0x20ba4,0x20be4,0x20cd4,0x25094,0x21094,0x210d4,0x21184,0x25094
.long 0x22984,0x229c4,0x22ab4,0x25094,0x22ef4,0x22eb4,0x22fe4,0x25094
.long 0x233a4,0x233e4,0x234d4,0x25094,0x23894,0x238d4,0x23984,0x25094
.long 0x215c4,0x21584,0x216f4,0x25094,0x21ab4,0x21af4,0x21ba4,0x25094
.long 0x21fe4,0x21fa4,0x22094,0x25094,0x224d4,0x22494,0x225c4,0x25094
.long 0x23dc4,0x23d84,0x23ef4,0x25094,0x242b4,0x242f4,0x243a4,0x25094
.long 0x247e4,0x247a4,0x24894,0x25094,0x24cd4,0x24c94,0x24dc4,0x25094
.long 0x24ef4,0x24e34,0x25094,0x25094,0x24984,0x24944,0x25094,0x25094
.long 0x244d4,0x24414,0x25094,0x25094,0x23fe4,0x23f24,0x25094,0x25094
.long 0x226f4,0x22634,0x25094,0x25094,0x22184,0x22144,0x25094,0x25094
.long 0x21cd4,0x21c14,0x25094,0x25094,0x217e4,0x21724,0x25094,0x25094
.long 0x23ab4,0x23a74,0x25094,0x25094,0x235c4,0x23504,0x25094,0x25094
.long 0x23094,0x23054,0x25094,0x25094,0x22ba4,0x22b64,0x25094,0x25094
.long 0x212b4,0x21274,0x25094,0x25094,0x20dc4,0x20d04,0x25094,0x25094
.long 0x20894,0x20854,0x25094,0x25094,0x203a4,0x20364,0x25094,0x25094
.long 0x20008,0x20048,0x20118,0x20158,0x20558,0x20518,0x20668,0x20628
.long 0x20a28,0x20a68,0x20b38,0x20b78,0x20f78,0x20f38,0x21008,0x21048
.long 0x22808,0x22848,0x22918,0x22958,0x22d58,0x22d18,0x22e68,0x22e28
.long 0x23228,0x23268,0x23338,0x23378,0x23778,0x23738,0x23808,0x23848
.long 0x21448,0x21408,0x21558,0x21518,0x21918,0x21958,0x21a28,0x21a68
.long 0x21e68,0x21e28,0x21f78,0x21f38,0x22338,0x22378,0x22448,0x22408
.long 0x23c48,0x23c08,0x23d58,0x23d18,0x24118,0x24158,0x24228,0x24268
.long 0x24668,0x24628,0x24778,0x24738,0x24b38,0x24b78,0x24c48,0x24c08
.long 0x25008,0x24fb8,0x24f78,0x24ea8,0x25088,0x24ae8,0x24a28,0x249d8
.long 0x25088,0x24598,0x24558,0x24488,0x25088,0x240c8,0x24008,0x23fb8
.long 0x25088,0x227b8,0x22778,0x226a8,0x25088,0x222e8,0x22228,0x221d8
.long 0x25088,0x21d98,0x21d58,0x21c88,0x25088,0x218c8,0x21808,0x217b8
.long 0x25088,0x23bf8,0x23b38,0x23ae8,0x25088,0x236a8,0x23668,0x23598
.long 0x25088,0x231d8,0x23118,0x230c8,0x25088,0x22c88,0x22c48,0x22bf8
.long 0x25088,0x213f8,0x21338,0x212e8,0x25088,0x20ea8,0x20e68,0x20d98
.long 0x25088,0x209d8,0x20918,0x208c8,0x25088,0x20488,0x20448,0x203f8
.long 0x20088,0x200c8,0x20198,0x201d8,0x205d8,0x20598,0x206e8,0x206a8
.long 0x20aa8,0x20ae8,0x20bb8,0x20bf8,0x20ff8,0x20fb8,0x21088,0x210c8
.long 0x22888,0x228c8,0x22998,0x229d8,0x22dd8,0x22d98,0x22ee8,0x22ea8
.long 0x232a8,0x232e8,0x233b8,0x233f8,0x237f8,0x237b8,0x23888,0x238c8
.long 0x214c8,0x21488,0x215d8,0x21598,0x21998,0x219d8,0x21aa8,0x21ae8
.long 0x21ee8,0x21ea8,0x21ff8,0x21fb8,0x223b8,0x223f8,0x224c8,0x22488
.long 0x23cc8,0x23c88,0x23dd8,0x23d98,0x24198,0x241d8,0x242a8,0x242e8
.long 0x246e8,0x246a8,0x247f8,0x247b8,0x24bb8,0x24bf8,0x24cc8,0x24c88
.long 0x24ff8,0x24f38,0x24ee8,0x24e28,0x24aa8,0x24a68,0x24998,0x24958
.long 0x245d8,0x24518,0x244c8,0x24408,0x24088,0x24048,0x23ff8,0x23f38
.long 0x227f8,0x22738,0x226e8,0x22628,0x222a8,0x22268,0x22198,0x22158
.long 0x21dd8,0x21d18,0x21cc8,0x21c08,0x21888,0x21848,0x217f8,0x21738
.long 0x23bb8,0x23b78,0x23aa8,0x23a68,0x236e8,0x23628,0x235d8,0x23518
.long 0x23198,0x23158,0x23088,0x23048,0x22cc8,0x22c08,0x22bb8,0x22b78
.long 0x213b8,0x21378,0x212a8,0x21268,0x20ee8,0x20e28,0x20dd8,0x20d18
.long 0x20998,0x20958,0x20888,0x20848,0x204c8,0x20408,0x203b8,0x20378
.long 0x20228,0x20268,0x20018,0x20058,0x20778,0x20738,0x20548,0x20508
.long 0x20c48,0x20c08,0x20a38,0x20a78,0x21118,0x21158,0x20f68,0x20f28
.long 0x22a28,0x22a68,0x22818,0x22858,0x22f78,0x22f38,0x22d48,0x22d08
.long 0x23448,0x23408,0x23238,0x23278,0x23918,0x23958,0x23768,0x23728
.long 0x21668,0x21628,0x21458,0x21418,0x21b38,0x21b78,0x21908,0x21948
.long 0x22008,0x22048,0x21e78,0x21e38,0x22558,0x22518,0x22328,0x22368
.long 0x23e68,0x23e28,0x23c58,0x23c18,0x24338,0x24378,0x24108,0x24148
.long 0x24808,0x24848,0x24678,0x24638,0x24d58,0x24d18,0x24b28,0x24b68
.long 0x24e68,0x24d98,0x25018,0x24fa8,0x24918,0x248c8,0x25098,0x24af8
.long 0x24448,0x243f8,0x25098,0x24588,0x23f78,0x23ea8,0x25098,0x240d8
.long 0x22668,0x22598,0x25098,0x227a8,0x22118,0x220c8,0x25098,0x222f8
.long 0x21c48,0x21bf8,0x25098,0x21d88,0x21778,0x216a8,0x25098,0x218d8
.long 0x23a28,0x239d8,0x25098,0x23be8,0x23558,0x23488,0x25098,0x236b8
.long 0x23008,0x22fb8,0x25098,0x231c8,0x22b38,0x22ae8,0x25098,0x22c98
.long 0x21228,0x211d8,0x25098,0x213e8,0x20d58,0x20c88,0x25098,0x20eb8
.long 0x20808,0x207b8,0x25098,0x209c8,0x20338,0x202e8,0x25098,0x20498
.long 0x202a8,0x25088,0x20098,0x200d8,0x207f8,0x25088,0x205c8,0x20588
.long 0x20cc8,0x25088,0x20ab8,0x20af8,0x21198,0x25088,0x20fe8,0x20fa8
.long 0x22aa8,0x25088,0x22898,0x228d8,0x22ff8,0x25088,0x22dc8,0x22d88
.long 0x234c8,0x25088,0x232b8,0x232f8,0x23998,0x25088,0x237e8,0x237a8
.long 0x216e8,0x25088,0x214d8,0x21498,0x21bb8,0x25088,0x21988,0x219c8
.long 0x22088,0x25088,0x21ef8,0x21eb8,0x225d8,0x25088,0x223a8,0x223e8
.long 0x23ee8,0x25088,0x23cd8,0x23c98,0x243b8,0x25088,0x24188,0x241c8
.long 0x24888,0x25088,0x246f8,0x246b8,0x24dd8,0x25088,0x24ba8,0x24be8
.long 0x25088,0x25088,0x24fe8,0x24f28,0x25088,0x25088,0x24ab8,0x24a78
.long 0x25088,0x25088,0x245c8,0x24508,0x25088,0x25088,0x24098,0x24058
.long 0x25088,0x25088,0x227e8,0x22728,0x25088,0x25088,0x222b8,0x22278
.long 0x25088,0x25088,0x21dc8,0x21d08,0x25088,0x25088,0x21898,0x21858
.long 0x25088,0x25088,0x23ba8,0x23b68,0x25088,0x25088,0x236f8,0x23638
.long 0x25088,0x25088,0x23188,0x23148,0x25088,0x25088,0x22cd8,0x22c18
.long 0x25088,0x25088,0x213a8,0x21368,0x25088,0x25088,0x20ef8,0x20e38
.long 0x25088,0x25088,0x20988,0x20948,0x25088,0x25088,0x204d8,0x20418
.long 0x20108,0x20148,0x20238,0x20278,0x20678,0x20638,0x20768,0x20728
.long 0x20b28,0x20b68,0x20c58,0x20c18,0x21018,0x21058,0x21108,0x21148
.long 0x22908,0x22948,0x22a38,0x22a78,0x22e78,0x22e38,0x22f68,0x22f28
.long 0x23328,0x23368,0x23458,0x23418,0x23818,0x23858,0x23908,0x23948
.long 0x21548,0x21508,0x21678,0x21638,0x21a38,0x21a78,0x21b28,0x21b68
.long 0x21f68,0x21f28,0x22018,0x22058,0x22458,0x22418,0x22548,0x22508
.long 0x23d48,0x23d08,0x23e78,0x23e38,0x24238,0x24278,0x24328,0x24368
.long 0x24768,0x24728,0x24818,0x24858,0x24c58,0x24c18,0x24d48,0x24d08
.long 0x24f68,0x24eb8,0x24e78,0x24d88,0x24a38,0x249c8,0x24908,0x248d8
.long 0x24548,0x24498,0x24458,0x243e8,0x24018,0x23fa8,0x23f68,0x23eb8
.long 0x22768,0x226b8,0x22678,0x22588,0x22238,0x221c8,0x22108,0x220d8
.long 0x21d48,0x21c98,0x21c58,0x21be8,0x21818,0x217a8,0x21768,0x216b8
.long 0x23b28,0x23af8,0x23a38,0x239c8,0x23678,0x23588,0x23548,0x23498
.long 0x23108,0x230d8,0x23018,0x22fa8,0x22c58,0x22be8,0x22b28,0x22af8
.long 0x21328,0x212f8,0x21238,0x211c8,0x20e78,0x20d88,0x20d48,0x20c98
.long 0x20908,0x208d8,0x20818,0x207a8,0x20458,0x203e8,0x20328,0x202f8
.long 0x20188,0x201c8,0x202b8,0x25098,0x206f8,0x206b8,0x207e8,0x25098
.long 0x20ba8,0x20be8,0x20cd8,0x25098,0x21098,0x210d8,0x21188,0x25098
.long 0x22988,0x229c8,0x22ab8,0x25098,0x22ef8,0x22eb8,0x22fe8,0x25098
.long 0x233a8,0x233e8,0x234d8,0x25098,0x23898,0x238d8,0x23988,0x25098
.long 0x215c8,0x21588,0x216f8,0x25098,0x21ab8,0x21af8,0x21ba8,0x25098
.long 0x21fe8,0x21fa8,0x22098,0x25098,0x224d8,0x22498,0x225c8,0x25098
.long 0x23dc8,0x23d88,0x23ef8,0x25098,0x242b8,0x242f8,0x243a8,0x25098
.long 0x247e8,0x247a8,0x24898,0x25098,0x24cd8,0x24c98,0x24dc8,0x25098
.long 0x24ef8,0x24e38,0x25098,0x25098,0x24988,0x24948,0x25098,0x25098
.long 0x244d8,0x24418,0x25098,0x25098,0x23fe8,0x23f28,0x25098,0x25098
.long 0x226f8,0x22638,0x25098,0x25098,0x22188,0x22148,0x25098,0x25098
.long 0x21cd8,0x21c18,0x25098,0x25098,0x217e8,0x21728,0x25098,0x25098
.long 0x23ab8,0x23a78,0x25098,0x25098,0x235c8,0x23508,0x25098,0x25098
.long 0x23098,0x23058,0x25098,0x25098,0x22ba8,0x22b68,0x25098,0x25098
.long 0x212b8,0x21278,0x25098,0x25098,0x20dc8,0x20d08,0x25098,0x25098
.long 0x20898,0x20858,0x25098,0x25098,0x203a8,0x20368,0x25098,0x25098
.long 0x2000c,0x2004c,0x2011c,0x2015c,0x2055c,0x2051c,0x2066c,0x2062c
.long 0x20a2c,0x20a6c,0x20b3c,0x20b7c,0x20f7c,0x20f3c,0x2100c,0x2104c
.long 0x2280c,0x2284c,0x2291c,0x2295c,0x22d5c,0x22d1c,0x22e6c,0x22e2c
.long 0x2322c,0x2326c,0x2333c,0x2337c,0x2377c,0x2373c,0x2380c,0x2384c
.long 0x2144c,0x2140c,0x2155c,0x2151c,0x2191c,0x2195c,0x21a2c,0x21a6c
.long 0x21e6c,0x21e2c,0x21f7c,0x21f3c,0x2233c,0x2237c,0x2244c,0x2240c
.long 0x23c4c,0x23c0c,0x23d5c,0x23d1c,0x2411c,0x2415c,0x2422c,0x2426c
.long 0x2466c,0x2462c,0x2477c,0x2473c,0x24b3c,0x24b7c,0x24c4c,0x24c0c
.long 0x2500c,0x24fbc,0x24f7c,0x24eac,0x2508c,0x24aec,0x24a2c,0x249dc
.long 0x2508c,0x2459c,0x2455c,0x2448c,0x2508c,0x240cc,0x2400c,0x23fbc
.long 0x2508c,0x227bc,0x2277c,0x226ac,0x2508c,0x222ec,0x2222c,0x221dc
.long 0x2508c,0x21d9c,0x21d5c,0x21c8c,0x2508c,0x218cc,0x2180c,0x217bc
.long 0x2508c,0x23bfc,0x23b3c,0x23aec,0x2508c,0x236ac,0x2366c,0x2359c
.long 0x2508c,0x231dc,0x2311c,0x230cc,0x2508c,0x22c8c,0x22c4c,0x22bfc
.long 0x2508c,0x213fc,0x2133c,0x212ec,0x2508c,0x20eac,0x20e6c,0x20d9c
.long 0x2508c,0x209dc,0x2091c,0x208cc,0x2508c,0x2048c,0x2044c,0x203fc
.long 0x2008c,0x200cc,0x2019c,0x201dc,0x205dc,0x2059c,0x206ec,0x206ac
.long 0x20aac,0x20aec,0x20bbc,0x20bfc,0x20ffc,0x20fbc,0x2108c,0x210cc
.long 0x2288c,0x228cc,0x2299c,0x229dc,0x22ddc,0x22d9c,0x22eec,0x22eac
.long 0x232ac,0x232ec,0x233bc,0x233fc,0x237fc,0x237bc,0x2388c,0x238cc
.long 0x214cc,0x2148c,0x215dc,0x2159c,0x2199c,0x219dc,0x21aac,0x21aec
.long 0x21eec,0x21eac,0x21ffc,0x21fbc,0x223bc,0x223fc,0x224cc,0x2248c
.long 0x23ccc,0x23c8c,0x23ddc,0x23d9c,0x2419c,0x241dc,0x242ac,0x242ec
.long 0x246ec,0x246ac,0x247fc,0x247bc,0x24bbc,0x24bfc,0x24ccc,0x24c8c
.long 0x24ffc,0x24f3c,0x24eec,0x24e2c,0x24aac,0x24a6c,0x2499c,0x2495c
.long 0x245dc,0x2451c,0x244cc,0x2440c,0x2408c,0x2404c,0x23ffc,0x23f3c
.long 0x227fc,0x2273c,0x226ec,0x2262c,0x222ac,0x2226c,0x2219c,0x2215c
.long 0x21ddc,0x21d1c,0x21ccc,0x21c0c,0x2188c,0x2184c,0x217fc,0x2173c
.long 0x23bbc,0x23b7c,0x23aac,0x23a6c,0x236ec,0x2362c,0x235dc,0x2351c
.long 0x2319c,0x2315c,0x2308c,0x2304c,0x22ccc,0x22c0c,0x22bbc,0x22b7c
.long 0x213bc,0x2137c,0x212ac,0x2126c,0x20eec,0x20e2c,0x20ddc,0x20d1c
.long 0x2099c,0x2095c,0x2088c,0x2084c,0x204cc,0x2040c,0x203bc,0x2037c
.long 0x2022c,0x2026c,0x2001c,0x2005c,0x2077c,0x2073c,0x2054c,0x2050c
.long 0x20c4c,0x20c0c,0x20a3c,0x20a7c,0x2111c,0x2115c,0x20f6c,0x20f2c
.long 0x22a2c,0x22a6c,0x2281c,0x2285c,0x22f7c,0x22f3c,0x22d4c,0x22d0c
.long 0x2344c,0x2340c,0x2323c,0x2327c,0x2391c,0x2395c,0x2376c,0x2372c
.long 0x2166c,0x2162c,0x2145c,0x2141c,0x21b3c,0x21b7c,0x2190c,0x2194c
.long 0x2200c,0x2204c,0x21e7c,0x21e3c,0x2255c,0x2251c,0x2232c,0x2236c
.long 0x23e6c,0x23e2c,0x23c5c,0x23c1c,0x2433c,0x2437c,0x2410c,0x2414c
.long 0x2480c,0x2484c,0x2467c,0x2463c,0x24d5c,0x24d1c,0x24b2c,0x24b6c
.long 0x24e6c,0x24d9c,0x2501c,0x24fac,0x2491c,0x248cc,0x2509c,0x24afc
.long 0x2444c,0x243fc,0x2509c,0x2458c,0x23f7c,0x23eac,0x2509c,0x240dc
.long 0x2266c,0x2259c,0x2509c,0x227ac,0x2211c,0x220cc,0x2509c,0x222fc
.long 0x21c4c,0x21bfc,0x2509c,0x21d8c,0x2177c,0x216ac,0x2509c,0x218dc
.long 0x23a2c,0x239dc,0x2509c,0x23bec,0x2355c,0x2348c,0x2509c,0x236bc
.long 0x2300c,0x22fbc,0x2509c,0x231cc,0x22b3c,0x22aec,0x2509c,0x22c9c
.long 0x2122c,0x211dc,0x2509c,0x213ec,0x20d5c,0x20c8c,0x2509c,0x20ebc
.long 0x2080c,0x207bc,0x2509c,0x209cc,0x2033c,0x202ec,0x2509c,0x2049c
.long 0x202ac,0x2508c,0x2009c,0x200dc,0x207fc,0x2508c,0x205cc,0x2058c
.long 0x20ccc,0x2508c,0x20abc,0x20afc,0x2119c,0x2508c,0x20fec,0x20fac
.long 0x22aac,0x2508c,0x2289c,0x228dc,0x22ffc,0x2508c,0x22dcc,0x22d8c
.long 0x234cc,0x2508c,0x232bc,0x232fc,0x2399c,0x2508c,0x237ec,0x237ac
.long 0x216ec,0x2508c,0x214dc,0x2149c,0x21bbc,0x2508c,0x2198c,0x219cc
.long 0x2208c,0x2508c,0x21efc,0x21ebc,0x225dc,0x2508c,0x223ac,0x223ec
.long 0x23eec,0x2508c,0x23cdc,0x23c9c,0x243bc,0x2508c,0x2418c,0x241cc
.long 0x2488c,0x2508c,0x246fc,0x246bc,0x24ddc,0x2508c,0x24bac,0x24bec
.long 0x2508c,0x2508c,0x24fec,0x24f2c,0x2508c,0x2508c,0x24abc,0x24a7c
.long 0x2508c,0x2508c,0x245cc,0x2450c,0x2508c,0x2508c,0x2409c,0x2405c
.long 0x2508c,0x2508c,0x227ec,0x2272c,0x2508c,0x2508c,0x222bc,0x2227c
.long 0x2508c,0x2508c,0x21dcc,0x21d0c,0x2508c,0x2508c,0x2189c,0x2185c
.long 0x2508c,0x2508c,0x23bac,0x23b6c,0x2508c,0x2508c,0x236fc,0x2363c
.long 0x2508c,0x2508c,0x2318c,0x2314c,0x2508c,0x2508c,0x22cdc,0x22c1c
.long 0x2508c,0x2508c,0x213ac,0x2136c,0x2508c,0x2508c,0x20efc,0x20e3c
.long 0x2508c,0x2508c,0x2098c,0x2094c,0x2508c,0x2508c,0x204dc,0x2041c
.long 0x2010c,0x2014c,0x2023c,0x2027c,0x2067c,0x2063c,0x2076c,0x2072c
.long 0x20b2c,0x20b6c,0x20c5c,0x20c1c,0x2101c,0x2105c,0x2110c,0x2114c
.long 0x2290c,0x2294c,0x22a3c,0x22a7c,0x22e7c,0x22e3c,0x22f6c,0x22f2c
.long 0x2332c,0x2336c,0x2345c,0x2341c,0x2381c,0x2385c,0x2390c,0x2394c
.long 0x2154c,0x2150c,0x2167c,0x2163c,0x21a3c,0x21a7c,0x21b2c,0x21b6c
.long 0x21f6c,0x21f2c,0x2201c,0x2205c,0x2245c,0x2241c,0x2254c,0x2250c
.long 0x23d4c,0x23d0c,0x23e7c,0x23e3c,0x2423c,0x2427c,0x2432c,0x2436c
.long 0x2476c,0x2472c,0x2481c,0x2485c,0x24c5c,0x24c1c,0x24d4c,0x24d0c
.long 0x24f6c,0x24ebc,0x24e7c,0x24d8c,0x24a3c,0x249cc,0x2490c,0x248dc
.long 0x2454c,0x2449c,0x2445c,0x243ec,0x2401c,0x23fac,0x23f6c,0x23ebc
.long 0x2276c,0x226bc,0x2267c,0x2258c,0x2223c,0x221cc,0x2210c,0x220dc
.long 0x21d4c,0x21c9c,0x21c5c,0x21bec,0x2181c,0x217ac,0x2176c,0x216bc
.long 0x23b2c,0x23afc,0x23a3c,0x239cc,0x2367c,0x2358c,0x2354c,0x2349c
.long 0x2310c,0x230dc,0x2301c,0x22fac,0x22c5c,0x22bec,0x22b2c,0x22afc
.long 0x2132c,0x212fc,0x2123c,0x211cc,0x20e7c,0x20d8c,0x20d4c,0x20c9c
.long 0x2090c,0x208dc,0x2081c,0x207ac,0x2045c,0x203ec,0x2032c,0x202fc
.long 0x2018c,0x201cc,0x202bc,0x2509c,0x206fc,0x206bc,0x207ec,0x2509c
.long 0x20bac,0x20bec,0x20cdc,0x2509c,0x2109c,0x210dc,0x2118c,0x2509c
.long 0x2298c,0x229cc,0x22abc,0x2509c,0x22efc,0x22ebc,0x22fec,0x2509c
.long 0x233ac,0x233ec,0x234dc,0x2509c,0x2389c,0x238dc,0x2398c,0x2509c
.long 0x215cc,0x2158c,0x216fc,0x2509c,0x21abc,0x21afc,0x21bac,0x2509c
.long 0x21fec,0x21fac,0x2209c,0x2509c,0x224dc,0x2249c,0x225cc,0x2509c
.long 0x23dcc,0x23d8c,0x23efc,0x2509c,0x242bc,0x242fc,0x243ac,0x2509c
.long 0x247ec,0x247ac,0x2489c,0x2509c,0x24cdc,0x24c9c,0x24dcc,0x2509c
.long 0x24efc,0x24e3c,0x2509c,0x2509c,0x2498c,0x2494c,0x2509c,0x2509c
.long 0x244dc,0x2441c,0x2509c,0x2509c,0x23fec,0x23f2c,0x2509c,0x2509c
.long 0x226fc,0x2263c,0x2509c,0x2509c,0x2218c,0x2214c,0x2509c,0x2509c
.long 0x21cdc,0x21c1c,0x2509c,0x2509c,0x217ec,0x2172c,0x2509c,0x2509c
.long 0x23abc,0x23a7c,0x2509c,0x2509c,0x235cc,0x2350c,0x2509c,0x2509c
.long 0x2309c,0x2305c,0x2509c,0x2509c,0x22bac,0x22b6c,0x2509c,0x2509c
.long 0x212bc,0x2127c,0x2509c,0x2509c,0x20dcc,0x20d0c,0x2509c,0x2509c
.long 0x2089c,0x2085c,0x2509c,0x2509c,0x203ac,0x2036c,0x2509c,0x2509c
.long 0x0,0x20,0x40,0x60,0x80,0xa0,0xc0,0xe0
.long 0x110,0x130,0x150,0x170,0x190,0x1b0,0x1d0,0x1f0
.long 0x220,0x200,0x260,0x240,0x2a0,0x280,0x2e0,0x2c0
.long 0x330,0x310,0x370,0x350,0x3b0,0x390,0x3f0,0x3d0
.long 0x440,0x460,0x400,0x420,0x4c0,0x4e0,0x480,0x4a0
.long 0x550,0x570,0x510,0x530,0x5d0,0x5f0,0x590,0x5b0
.long 0x660,0x640,0x620,0x600,0x6e0,0x6c0,0x6a0,0x680
.long 0x770,0x750,0x730,0x710,0x7f0,0x7d0,0x7b0,0x790
.long 0x800,0x820,0x840,0x860,0x880,0x8a0,0x8c0,0x8e0
.long 0x910,0x930,0x950,0x970,0x990,0x9b0,0x9d0,0x9f0
.long 0xa20,0xa00,0xa60,0xa40,0xaa0,0xa80,0xae0,0xac0
.long 0xb30,0xb10,0xb70,0xb50,0xbb0,0xb90,0xbf0,0xbd0
.long 0xc40,0xc60,0xc00,0xc20,0xcc0,0xce0,0xc80,0xca0
.long 0xd50,0xd70,0xd10,0xd30,0xdd0,0xdf0,0xd90,0xdb0
.long 0xe60,0xe40,0xe20,0xe00,0xee0,0xec0,0xea0,0xe80
.long 0xf70,0xf50,0xf30,0xf10,0xff0,0xfd0,0xfb0,0xf90
.long 0x10,0x30,0x50,0x70,0x90,0xb0,0xd0,0xf0
.long 0x100,0x120,0x140,0x160,0x180,0x1a0,0x1c0,0x1e0
.long 0x230,0x210,0x270,0x250,0x2b0,0x290,0x2f0,0x2d0
.long 0x320,0x300,0x360,0x340,0x3a0,0x380,0x3e0,0x3c0
.long 0x450,0x470,0x410,0x430,0x4d0,0x4f0,0x490,0x4b0
.long 0x540,0x560,0x500,0x520,0x5c0,0x5e0,0x580,0x5a0
.long 0x670,0x650,0x630,0x610,0x6f0,0x6d0,0x6b0,0x690
.long 0x760,0x740,0x720,0x700,0x7e0,0x7c0,0x7a0,0x780
.long 0x810,0x830,0x850,0x870,0x890,0x8b0,0x8d0,0x8f0
.long 0x900,0x920,0x940,0x960,0x980,0x9a0,0x9c0,0x9e0
.long 0xa30,0xa10,0xa70,0xa50,0xab0,0xa90,0xaf0,0xad0
.long 0xb20,0xb00,0xb60,0xb40,0xba0,0xb80,0xbe0,0xbc0
.long 0xc50,0xc70,0xc10,0xc30,0xcd0,0xcf0,0xc90,0xcb0
.long 0xd40,0xd60,0xd00,0xd20,0xdc0,0xde0,0xd80,0xda0
.long 0xe70,0xe50,0xe30,0xe10,0xef0,0xed0,0xeb0,0xe90
.long 0xf60,0xf40,0xf20,0xf00,0xfe0,0xfc0,0xfa0,0xf80
.long 0x0,0x40,0x25100,0x25140,0xa000,0xa040,0x25108,0x25148
.long 0x14000,0x14040,0x25110,0x253c0,0x1e000,0x1e040,0x25118,0x253c8
.long 0x28000,0x28040,0x25600,0x25640,0x32000,0x32040,0x25608,0x25648
.long 0x3c000,0x3c040,0x25610,0x258c0,0x46000,0x46040,0x25618,0x258c8
.long 0x50000,0x50040,0x25b00,0x25b40,0x5a000,0x5a040,0x25b08,0x25b48
.long 0x64000,0x64040,0x25b10,0x25dc0,0x6e000,0x6e040,0x25b18,0x25dc8
.long 0x78000,0x78040,0x26000,0x26040,0x82000,0x82040,0x26008,0x26048
.long 0x8c000,0x8c040,0x26010,0x262c0,0x96000,0x96040,0x26018,0x262c8
.long 0x8,0x48,0x25150,0x25190,0xa008,0xa048,0x25158,0x25198
.long 0x14008,0x14048,0x25160,0x25410,0x1e008,0x1e048,0x25168,0x25418
.long 0x28008,0x28048,0x25650,0x25690,0x32008,0x32048,0x25658,0x25698
.long 0x3c008,0x3c048,0x25660,0x25910,0x46008,0x46048,0x25668,0x25918
.long 0x50008,0x50048,0x25b50,0x25b90,0x5a008,0x5a048,0x25b58,0x25b98
.long 0x64008,0x64048,0x25b60,0x25e10,0x6e008,0x6e048,0x25b68,0x25e18
.long 0x78008,0x78048,0x26050,0x26090,0x82008,0x82048,0x26058,0x26098
.long 0x8c008,0x8c048,0x26060,0x26310,0x96008,0x96048,0x26068,0x26318
.long 0x10,0x2c0,0x251a0,0x251e0,0xa010,0xa2c0,0x251a8,0x251e8
.long 0x14010,0x142c0,0x251b0,0x25460,0x1e010,0x1e2c0,0x251b8,0x25468
.long 0x28010,0x282c0,0x256a0,0x256e0,0x32010,0x322c0,0x256a8,0x256e8
.long 0x3c010,0x3c2c0,0x256b0,0x25960,0x46010,0x462c0,0x256b8,0x25968
.long 0x50010,0x502c0,0x25ba0,0x25be0,0x5a010,0x5a2c0,0x25ba8,0x25be8
.long 0x64010,0x642c0,0x25bb0,0x25e60,0x6e010,0x6e2c0,0x25bb8,0x25e68
.long 0x78010,0x782c0,0x260a0,0x260e0,0x82010,0x822c0,0x260a8,0x260e8
.long 0x8c010,0x8c2c0,0x260b0,0x26360,0x96010,0x962c0,0x260b8,0x26368
.long 0x18,0x2c8,0x251f0,0x25230,0xa018,0xa2c8,0x251f8,0x25238
.long 0x14018,0x142c8,0x25200,0x254b0,0x1e018,0x1e2c8,0x25208,0x254b8
.long 0x28018,0x282c8,0x256f0,0x25730,0x32018,0x322c8,0x256f8,0x25738
.long 0x3c018,0x3c2c8,0x25700,0x259b0,0x46018,0x462c8,0x25708,0x259b8
.long 0x50018,0x502c8,0x25bf0,0x25c30,0x5a018,0x5a2c8,0x25bf8,0x25c38
.long 0x64018,0x642c8,0x25c00,0x25eb0,0x6e018,0x6e2c8,0x25c08,0x25eb8
.long 0x78018,0x782c8,0x260f0,0x26130,0x82018,0x822c8,0x260f8,0x26138
.long 0x8c018,0x8c2c8,0x26100,0x263b0,0x96018,0x962c8,0x26108,0x263b8
.long 0x254e0,0x0,0x1000,0x10ec00,0x254e8,0x10,0x1010,0x10ec10
.long 0x254f0,0x20,0x1020,0x10ec20,0x254f8,0x30,0x1030,0x10ec30
.long 0x259e0,0x40,0x1040,0x10ec40,0x259e8,0x50,0x1050,0x10ec50
.long 0x259f0,0x60,0x1060,0x10ec60,0x259f8,0x70,0x1070,0x10ec70
.long 0x25ee0,0x80,0x1080,0x10ec80,0x25ee8,0x90,0x1090,0x10ec90
.long 0x25ef0,0xa0,0x10a0,0x10eca0,0x25ef8,0xb0,0x10b0,0x10ecb0
.long 0x263e0,0xc0,0x10c0,0x10ecc0,0x263e8,0xd0,0x10d0,0x10ecd0
.long 0x263f0,0xe0,0x10e0,0x10ece0,0x263f8,0xf0,0x10f0,0x10ecf0
.long 0x25530,0x43800,0x44800,0x152400,0x25538,0x43810,0x44810,0x152410
.long 0x25540,0x43820,0x44820,0x152420,0x25548,0x43830,0x44830,0x152430
.long 0x25a30,0x43840,0x44840,0x152440,0x25a38,0x43850,0x44850,0x152450
.long 0x25a40,0x43860,0x44860,0x152460,0x25a48,0x43870,0x44870,0x152470
.long 0x25f30,0x43880,0x44880,0x152480,0x25f38,0x43890,0x44890,0x152490
.long 0x25f40,0x438a0,0x448a0,0x1524a0,0x25f48,0x438b0,0x448b0,0x1524b0
.long 0x26430,0x438c0,0x448c0,0x1524c0,0x26438,0x438d0,0x448d0,0x1524d0
.long 0x26440,0x438e0,0x448e0,0x1524e0,0x26448,0x438f0,0x448f0,0x1524f0
.long 0x25580,0x87000,0x88000,0x195c00,0x25588,0x87010,0x88010,0x195c10
.long 0x25590,0x87020,0x88020,0x195c20,0x25598,0x87030,0x88030,0x195c30
.long 0x25a80,0x87040,0x88040,0x195c40,0x25a88,0x87050,0x88050,0x195c50
.long 0x25a90,0x87060,0x88060,0x195c60,0x25a98,0x87070,0x88070,0x195c70
.long 0x25f80,0x87080,0x88080,0x195c80,0x25f88,0x87090,0x88090,0x195c90
.long 0x25f90,0x870a0,0x880a0,0x195ca0,0x25f98,0x870b0,0x880b0,0x195cb0
.long 0x26480,0x870c0,0x880c0,0x195cc0,0x26488,0x870d0,0x880d0,0x195cd0
.long 0x26490,0x870e0,0x880e0,0x195ce0,0x26498,0x870f0,0x880f0,0x195cf0
.long 0x255d0,0xca800,0xcb800,0x1d9400,0x255d8,0xca810,0xcb810,0x1d9410
.long 0x255e0,0xca820,0xcb820,0x1d9420,0x255e8,0xca830,0xcb830,0x1d9430
.long 0x25ad0,0xca840,0xcb840,0x1d9440,0x25ad8,0xca850,0xcb850,0x1d9450
.long 0x25ae0,0xca860,0xcb860,0x1d9460,0x25ae8,0xca870,0xcb870,0x1d9470
.long 0x25fd0,0xca880,0xcb880,0x1d9480,0x25fd8,0xca890,0xcb890,0x1d9490
.long 0x25fe0,0xca8a0,0xcb8a0,0x1d94a0,0x25fe8,0xca8b0,0xcb8b0,0x1d94b0
.long 0x264d0,0xca8c0,0xcb8c0,0x1d94c0,0x264d8,0xca8d0,0xcb8d0,0x1d94d0
.long 0x264e0,0xca8e0,0xcb8e0,0x1d94e0,0x264e8,0xca8f0,0xcb8f0,0x1d94f0
.long 0x1000,0x1020,0x1040,0x1060,0x1080,0x10a0,0x10c0,0x10e0
.long 0x1110,0x1130,0x1150,0x1170,0x1190,0x11b0,0x11d0,0x11f0
.long 0x1220,0x1200,0x1260,0x1240,0x12a0,0x1280,0x12e0,0x12c0
.long 0x1330,0x1310,0x1370,0x1350,0x13b0,0x1390,0x13f0,0x13d0
.long 0x1440,0x1460,0x1400,0x1420,0x14c0,0x14e0,0x1480,0x14a0
.long 0x1550,0x1570,0x1510,0x1530,0x15d0,0x15f0,0x1590,0x15b0
.long 0x1660,0x1640,0x1620,0x1600,0x16e0,0x16c0,0x16a0,0x1680
.long 0x1770,0x1750,0x1730,0x1710,0x17f0,0x17d0,0x17b0,0x1790
.long 0x1800,0x1820,0x1840,0x1860,0x1880,0x18a0,0x18c0,0x18e0
.long 0x1910,0x1930,0x1950,0x1970,0x1990,0x19b0,0x19d0,0x19f0
.long 0x1a20,0x1a00,0x1a60,0x1a40,0x1aa0,0x1a80,0x1ae0,0x1ac0
.long 0x1b30,0x1b10,0x1b70,0x1b50,0x1bb0,0x1b90,0x1bf0,0x1bd0
.long 0x1c40,0x1c60,0x1c00,0x1c20,0x1cc0,0x1ce0,0x1c80,0x1ca0
.long 0x1d50,0x1d70,0x1d10,0x1d30,0x1dd0,0x1df0,0x1d90,0x1db0
.long 0x1e60,0x1e40,0x1e20,0x1e00,0x1ee0,0x1ec0,0x1ea0,0x1e80
.long 0x1f70,0x1f50,0x1f30,0x1f10,0x1ff0,0x1fd0,0x1fb0,0x1f90
.long 0x1010,0x1030,0x1050,0x1070,0x1090,0x10b0,0x10d0,0x10f0
.long 0x1100,0x1120,0x1140,0x1160,0x1180,0x11a0,0x11c0,0x11e0
.long 0x1230,0x1210,0x1270,0x1250,0x12b0,0x1290,0x12f0,0x12d0
.long 0x1320,0x1300,0x1360,0x1340,0x13a0,0x1380,0x13e0,0x13c0
.long 0x1450,0x1470,0x1410,0x1430,0x14d0,0x14f0,0x1490,0x14b0
.long 0x1540,0x1560,0x1500,0x1520,0x15c0,0x15e0,0x1580,0x15a0
.long 0x1670,0x1650,0x1630,0x1610,0x16f0,0x16d0,0x16b0,0x1690
.long 0x1760,0x1740,0x1720,0x1700,0x17e0,0x17c0,0x17a0,0x1780
.long 0x1810,0x1830,0x1850,0x1870,0x1890,0x18b0,0x18d0,0x18f0
.long 0x1900,0x1920,0x1940,0x1960,0x1980,0x19a0,0x19c0,0x19e0
.long 0x1a30,0x1a10,0x1a70,0x1a50,0x1ab0,0x1a90,0x1af0,0x1ad0
.long 0x1b20,0x1b00,0x1b60,0x1b40,0x1ba0,0x1b80,0x1be0,0x1bc0
.long 0x1c50,0x1c70,0x1c10,0x1c30,0x1cd0,0x1cf0,0x1c90,0x1cb0
.long 0x1d40,0x1d60,0x1d00,0x1d20,0x1dc0,0x1de0,0x1d80,0x1da0
.long 0x1e70,0x1e50,0x1e30,0x1e10,0x1ef0,0x1ed0,0x1eb0,0x1e90
.long 0x1f60,0x1f40,0x1f20,0x1f00,0x1fe0,0x1fc0,0x1fa0,0x1f80
.long 0xa0000,0xa0040,0x25120,0x25240,0xaa000,0xaa040,0x25128,0x25248
.long 0xb4000,0xb4040,0x25130,0x25250,0xbe000,0xbe040,0x25138,0x25258
.long 0xc8000,0xc8040,0x25620,0x25740,0xd2000,0xd2040,0x25628,0x25748
.long 0xdc000,0xdc040,0x25630,0x25750,0xe6000,0xe6040,0x25638,0x25758
.long 0xf0000,0xf0040,0x25b20,0x25c40,0xfa000,0xfa040,0x25b28,0x25c48
.long 0x104000,0x104040,0x25b30,0x25c50,0x10e000,0x10e040,0x25b38,0x25c58
.long 0x118000,0x118040,0x26020,0x26140,0x122000,0x122040,0x26028,0x26148
.long 0x12c000,0x12c040,0x26030,0x26150,0x136000,0x136040,0x26038,0x26158
.long 0xa0008,0xa0048,0x25170,0x25290,0xaa008,0xaa048,0x25178,0x25298
.long 0xb4008,0xb4048,0x25180,0x252a0,0xbe008,0xbe048,0x25188,0x252a8
.long 0xc8008,0xc8048,0x25670,0x25790,0xd2008,0xd2048,0x25678,0x25798
.long 0xdc008,0xdc048,0x25680,0x257a0,0xe6008,0xe6048,0x25688,0x257a8
.long 0xf0008,0xf0048,0x25b70,0x25c90,0xfa008,0xfa048,0x25b78,0x25c98
.long 0x104008,0x104048,0x25b80,0x25ca0,0x10e008,0x10e048,0x25b88,0x25ca8
.long 0x118008,0x118048,0x26070,0x26190,0x122008,0x122048,0x26078,0x26198
.long 0x12c008,0x12c048,0x26080,0x261a0,0x136008,0x136048,0x26088,0x261a8
.long 0xa0010,0xa02c0,0x251c0,0x252e0,0xaa010,0xaa2c0,0x251c8,0x252e8
.long 0xb4010,0xb42c0,0x251d0,0x252f0,0xbe010,0xbe2c0,0x251d8,0x252f8
.long 0xc8010,0xc82c0,0x256c0,0x257e0,0xd2010,0xd22c0,0x256c8,0x257e8
.long 0xdc010,0xdc2c0,0x256d0,0x257f0,0xe6010,0xe62c0,0x256d8,0x257f8
.long 0xf0010,0xf02c0,0x25bc0,0x25ce0,0xfa010,0xfa2c0,0x25bc8,0x25ce8
.long 0x104010,0x1042c0,0x25bd0,0x25cf0,0x10e010,0x10e2c0,0x25bd8,0x25cf8
.long 0x118010,0x1182c0,0x260c0,0x261e0,0x122010,0x1222c0,0x260c8,0x261e8
.long 0x12c010,0x12c2c0,0x260d0,0x261f0,0x136010,0x1362c0,0x260d8,0x261f8
.long 0xa0018,0xa02c8,0x25210,0x25330,0xaa018,0xaa2c8,0x25218,0x25338
.long 0xb4018,0xb42c8,0x25220,0x25340,0xbe018,0xbe2c8,0x25228,0x25348
.long 0xc8018,0xc82c8,0x25710,0x25830,0xd2018,0xd22c8,0x25718,0x25838
.long 0xdc018,0xdc2c8,0x25720,0x25840,0xe6018,0xe62c8,0x25728,0x25848
.long 0xf0018,0xf02c8,0x25c10,0x25d30,0xfa018,0xfa2c8,0x25c18,0x25d38
.long 0x104018,0x1042c8,0x25c20,0x25d40,0x10e018,0x10e2c8,0x25c28,0x25d48
.long 0x118018,0x1182c8,0x26110,0x26230,0x122018,0x1222c8,0x26118,0x26238
.long 0x12c018,0x12c2c8,0x26120,0x26240,0x136018,0x1362c8,0x26128,0x26248
.long 0x25280,0x400,0x10e000,0x10f000,0x25288,0x410,0x10e010,0x10f010
.long 0x25500,0x420,0x10e020,0x10f020,0x25508,0x430,0x10e030,0x10f030
.long 0x25780,0x440,0x10e040,0x10f040,0x25788,0x450,0x10e050,0x10f050
.long 0x25a00,0x460,0x10e060,0x10f060,0x25a08,0x470,0x10e070,0x10f070
.long 0x25c80,0x480,0x10e080,0x10f080,0x25c88,0x490,0x10e090,0x10f090
.long 0x25f00,0x4a0,0x10e0a0,0x10f0a0,0x25f08,0x4b0,0x10e0b0,0x10f0b0
.long 0x26180,0x4c0,0x10e0c0,0x10f0c0,0x26188,0x4d0,0x10e0d0,0x10f0d0
.long 0x26400,0x4e0,0x10e0e0,0x10f0e0,0x26408,0x4f0,0x10e0f0,0x10f0f0
.long 0x252d0,0x43c00,0x151800,0x152800,0x252d8,0x43c10,0x151810,0x152810
.long 0x25550,0x43c20,0x151820,0x152820,0x25558,0x43c30,0x151830,0x152830
.long 0x257d0,0x43c40,0x151840,0x152840,0x257d8,0x43c50,0x151850,0x152850
.long 0x25a50,0x43c60,0x151860,0x152860,0x25a58,0x43c70,0x151870,0x152870
.long 0x25cd0,0x43c80,0x151880,0x152880,0x25cd8,0x43c90,0x151890,0x152890
.long 0x25f50,0x43ca0,0x1518a0,0x1528a0,0x25f58,0x43cb0,0x1518b0,0x1528b0
.long 0x261d0,0x43cc0,0x1518c0,0x1528c0,0x261d8,0x43cd0,0x1518d0,0x1528d0
.long 0x26450,0x43ce0,0x1518e0,0x1528e0,0x26458,0x43cf0,0x1518f0,0x1528f0
.long 0x25320,0x87400,0x195000,0x196000,0x25328,0x87410,0x195010,0x196010
.long 0x255a0,0x87420,0x195020,0x196020,0x255a8,0x87430,0x195030,0x196030
.long 0x25820,0x87440,0x195040,0x196040,0x25828,0x87450,0x195050,0x196050
.long 0x25aa0,0x87460,0x195060,0x196060,0x25aa8,0x87470,0x195070,0x196070
.long 0x25d20,0x87480,0x195080,0x196080,0x25d28,0x87490,0x195090,0x196090
.long 0x25fa0,0x874a0,0x1950a0,0x1960a0,0x25fa8,0x874b0,0x1950b0,0x1960b0
.long 0x26220,0x874c0,0x1950c0,0x1960c0,0x26228,0x874d0,0x1950d0,0x1960d0
.long 0x264a0,0x874e0,0x1950e0,0x1960e0,0x264a8,0x874f0,0x1950f0,0x1960f0
.long 0x25370,0xcac00,0x1d8800,0x1d9800,0x25378,0xcac10,0x1d8810,0x1d9810
.long 0x255f0,0xcac20,0x1d8820,0x1d9820,0x255f8,0xcac30,0x1d8830,0x1d9830
.long 0x25870,0xcac40,0x1d8840,0x1d9840,0x25878,0xcac50,0x1d8850,0x1d9850
.long 0x25af0,0xcac60,0x1d8860,0x1d9860,0x25af8,0xcac70,0x1d8870,0x1d9870
.long 0x25d70,0xcac80,0x1d8880,0x1d9880,0x25d78,0xcac90,0x1d8890,0x1d9890
.long 0x25ff0,0xcaca0,0x1d88a0,0x1d98a0,0x25ff8,0xcacb0,0x1d88b0,0x1d98b0
.long 0x26270,0xcacc0,0x1d88c0,0x1d98c0,0x26278,0xcacd0,0x1d88d0,0x1d98d0
.long 0x264f0,0xcace0,0x1d88e0,0x1d98e0,0x264f8,0xcacf0,0x1d88f0,0x1d98f0
.long 0x2000,0x2020,0x2040,0x2060,0x2080,0x20a0,0x20c0,0x20e0
.long 0x2110,0x2130,0x2150,0x2170,0x2190,0x21b0,0x21d0,0x21f0
.long 0x2220,0x2200,0x2260,0x2240,0x22a0,0x2280,0x22e0,0x22c0
.long 0x2330,0x2310,0x2370,0x2350,0x23b0,0x2390,0x23f0,0x23d0
.long 0x2440,0x2460,0x2400,0x2420,0x24c0,0x24e0,0x2480,0x24a0
.long 0x2550,0x2570,0x2510,0x2530,0x25d0,0x25f0,0x2590,0x25b0
.long 0x2660,0x2640,0x2620,0x2600,0x26e0,0x26c0,0x26a0,0x2680
.long 0x2770,0x2750,0x2730,0x2710,0x27f0,0x27d0,0x27b0,0x2790
.long 0x2800,0x2820,0x2840,0x2860,0x2880,0x28a0,0x28c0,0x28e0
.long 0x2910,0x2930,0x2950,0x2970,0x2990,0x29b0,0x29d0,0x29f0
.long 0x2a20,0x2a00,0x2a60,0x2a40,0x2aa0,0x2a80,0x2ae0,0x2ac0
.long 0x2b30,0x2b10,0x2b70,0x2b50,0x2bb0,0x2b90,0x2bf0,0x2bd0
.long 0x2c40,0x2c60,0x2c00,0x2c20,0x2cc0,0x2ce0,0x2c80,0x2ca0
.long 0x2d50,0x2d70,0x2d10,0x2d30,0x2dd0,0x2df0,0x2d90,0x2db0
.long 0x2e60,0x2e40,0x2e20,0x2e00,0x2ee0,0x2ec0,0x2ea0,0x2e80
.long 0x2f70,0x2f50,0x2f30,0x2f10,0x2ff0,0x2fd0,0x2fb0,0x2f90
.long 0x2010,0x2030,0x2050,0x2070,0x2090,0x20b0,0x20d0,0x20f0
.long 0x2100,0x2120,0x2140,0x2160,0x2180,0x21a0,0x21c0,0x21e0
.long 0x2230,0x2210,0x2270,0x2250,0x22b0,0x2290,0x22f0,0x22d0
.long 0x2320,0x2300,0x2360,0x2340,0x23a0,0x2380,0x23e0,0x23c0
.long 0x2450,0x2470,0x2410,0x2430,0x24d0,0x24f0,0x2490,0x24b0
.long 0x2540,0x2560,0x2500,0x2520,0x25c0,0x25e0,0x2580,0x25a0
.long 0x2670,0x2650,0x2630,0x2610,0x26f0,0x26d0,0x26b0,0x2690
.long 0x2760,0x2740,0x2720,0x2700,0x27e0,0x27c0,0x27a0,0x2780
.long 0x2810,0x2830,0x2850,0x2870,0x2890,0x28b0,0x28d0,0x28f0
.long 0x2900,0x2920,0x2940,0x2960,0x2980,0x29a0,0x29c0,0x29e0
.long 0x2a30,0x2a10,0x2a70,0x2a50,0x2ab0,0x2a90,0x2af0,0x2ad0
.long 0x2b20,0x2b00,0x2b60,0x2b40,0x2ba0,0x2b80,0x2be0,0x2bc0
.long 0x2c50,0x2c70,0x2c10,0x2c30,0x2cd0,0x2cf0,0x2c90,0x2cb0
.long 0x2d40,0x2d60,0x2d00,0x2d20,0x2dc0,0x2de0,0x2d80,0x2da0
.long 0x2e70,0x2e50,0x2e30,0x2e10,0x2ef0,0x2ed0,0x2eb0,0x2e90
.long 0x2f60,0x2f40,0x2f20,0x2f00,0x2fe0,0x2fc0,0x2fa0,0x2f80
.long 0x140000,0x140040,0x25380,0x25260,0x14a000,0x14a040,0x25388,0x25268
.long 0x154000,0x154040,0x25390,0x25270,0x15e000,0x15e040,0x25398,0x25278
.long 0x168000,0x168040,0x25880,0x25760,0x172000,0x172040,0x25888,0x25768
.long 0x17c000,0x17c040,0x25890,0x25770,0x186000,0x186040,0x25898,0x25778
.long 0x190000,0x190040,0x25d80,0x25c60,0x19a000,0x19a040,0x25d88,0x25c68
.long 0x1a4000,0x1a4040,0x25d90,0x25c70,0x1ae000,0x1ae040,0x25d98,0x25c78
.long 0x1b8000,0x1b8040,0x26280,0x26160,0x1c2000,0x1c2040,0x26288,0x26168
.long 0x1cc000,0x1cc040,0x26290,0x26170,0x1d6000,0x1d6040,0x26298,0x26178
.long 0x140008,0x140048,0x253d0,0x252b0,0x14a008,0x14a048,0x253d8,0x252b8
.long 0x154008,0x154048,0x253e0,0x252c0,0x15e008,0x15e048,0x253e8,0x252c8
.long 0x168008,0x168048,0x258d0,0x257b0,0x172008,0x172048,0x258d8,0x257b8
.long 0x17c008,0x17c048,0x258e0,0x257c0,0x186008,0x186048,0x258e8,0x257c8
.long 0x190008,0x190048,0x25dd0,0x25cb0,0x19a008,0x19a048,0x25dd8,0x25cb8
.long 0x1a4008,0x1a4048,0x25de0,0x25cc0,0x1ae008,0x1ae048,0x25de8,0x25cc8
.long 0x1b8008,0x1b8048,0x262d0,0x261b0,0x1c2008,0x1c2048,0x262d8,0x261b8
.long 0x1cc008,0x1cc048,0x262e0,0x261c0,0x1d6008,0x1d6048,0x262e8,0x261c8
.long 0x140010,0x1402c0,0x25420,0x25300,0x14a010,0x14a2c0,0x25428,0x25308
.long 0x154010,0x1542c0,0x25430,0x25310,0x15e010,0x15e2c0,0x25438,0x25318
.long 0x168010,0x1682c0,0x25920,0x25800,0x172010,0x1722c0,0x25928,0x25808
.long 0x17c010,0x17c2c0,0x25930,0x25810,0x186010,0x1862c0,0x25938,0x25818
.long 0x190010,0x1902c0,0x25e20,0x25d00,0x19a010,0x19a2c0,0x25e28,0x25d08
.long 0x1a4010,0x1a42c0,0x25e30,0x25d10,0x1ae010,0x1ae2c0,0x25e38,0x25d18
.long 0x1b8010,0x1b82c0,0x26320,0x26200,0x1c2010,0x1c22c0,0x26328,0x26208
.long 0x1cc010,0x1cc2c0,0x26330,0x26210,0x1d6010,0x1d62c0,0x26338,0x26218
.long 0x140018,0x1402c8,0x25470,0x25350,0x14a018,0x14a2c8,0x25478,0x25358
.long 0x154018,0x1542c8,0x25480,0x25360,0x15e018,0x15e2c8,0x25488,0x25368
.long 0x168018,0x1682c8,0x25970,0x25850,0x172018,0x1722c8,0x25978,0x25858
.long 0x17c018,0x17c2c8,0x25980,0x25860,0x186018,0x1862c8,0x25988,0x25868
.long 0x190018,0x1902c8,0x25e70,0x25d50,0x19a018,0x19a2c8,0x25e78,0x25d58
.long 0x1a4018,0x1a42c8,0x25e80,0x25d60,0x1ae018,0x1ae2c8,0x25e88,0x25d68
.long 0x1b8018,0x1b82c8,0x26370,0x26250,0x1c2018,0x1c22c8,0x26378,0x26258
.long 0x1cc018,0x1cc2c8,0x26380,0x26260,0x1d6018,0x1d62c8,0x26388,0x26268
.long 0x25240,0x800,0x10e400,0x10000000,0x25248,0x810,0x10e410,0x10000000
.long 0x25250,0x820,0x10e420,0x10000000,0x25258,0x830,0x10e430,0x10000000
.long 0x25740,0x840,0x10e440,0x10000000,0x25748,0x850,0x10e450,0x10000000
.long 0x25750,0x860,0x10e460,0x10000000,0x25758,0x870,0x10e470,0x10000000
.long 0x25c40,0x880,0x10e480,0x10000000,0x25c48,0x890,0x10e490,0x10000000
.long 0x25c50,0x8a0,0x10e4a0,0x10000000,0x25c58,0x8b0,0x10e4b0,0x10000000
.long 0x26140,0x8c0,0x10e4c0,0x10000000,0x26148,0x8d0,0x10e4d0,0x10000000
.long 0x26150,0x8e0,0x10e4e0,0x10000000,0x26158,0x8f0,0x10e4f0,0x10000000
.long 0x25290,0x44000,0x151c00,0x10000000,0x25298,0x44010,0x151c10,0x10000000
.long 0x252a0,0x44020,0x151c20,0x10000000,0x252a8,0x44030,0x151c30,0x10000000
.long 0x25790,0x44040,0x151c40,0x10000000,0x25798,0x44050,0x151c50,0x10000000
.long 0x257a0,0x44060,0x151c60,0x10000000,0x257a8,0x44070,0x151c70,0x10000000
.long 0x25c90,0x44080,0x151c80,0x10000000,0x25c98,0x44090,0x151c90,0x10000000
.long 0x25ca0,0x440a0,0x151ca0,0x10000000,0x25ca8,0x440b0,0x151cb0,0x10000000
.long 0x26190,0x440c0,0x151cc0,0x10000000,0x26198,0x440d0,0x151cd0,0x10000000
.long 0x261a0,0x440e0,0x151ce0,0x10000000,0x261a8,0x440f0,0x151cf0,0x10000000
.long 0x252e0,0x87800,0x195400,0x10000000,0x252e8,0x87810,0x195410,0x10000000
.long 0x252f0,0x87820,0x195420,0x10000000,0x252f8,0x87830,0x195430,0x10000000
.long 0x257e0,0x87840,0x195440,0x10000000,0x257e8,0x87850,0x195450,0x10000000
.long 0x257f0,0x87860,0x195460,0x10000000,0x257f8,0x87870,0x195470,0x10000000
.long 0x25ce0,0x87880,0x195480,0x10000000,0x25ce8,0x87890,0x195490,0x10000000
.long 0x25cf0,0x878a0,0x1954a0,0x10000000,0x25cf8,0x878b0,0x1954b0,0x10000000
.long 0x261e0,0x878c0,0x1954c0,0x10000000,0x261e8,0x878d0,0x1954d0,0x10000000
.long 0x261f0,0x878e0,0x1954e0,0x10000000,0x261f8,0x878f0,0x1954f0,0x10000000
.long 0x25330,0xcb000,0x1d8c00,0x10000000,0x25338,0xcb010,0x1d8c10,0x10000000
.long 0x25340,0xcb020,0x1d8c20,0x10000000,0x25348,0xcb030,0x1d8c30,0x10000000
.long 0x25830,0xcb040,0x1d8c40,0x10000000,0x25838,0xcb050,0x1d8c50,0x10000000
.long 0x25840,0xcb060,0x1d8c60,0x10000000,0x25848,0xcb070,0x1d8c70,0x10000000
.long 0x25d30,0xcb080,0x1d8c80,0x10000000,0x25d38,0xcb090,0x1d8c90,0x10000000
.long 0x25d40,0xcb0a0,0x1d8ca0,0x10000000,0x25d48,0xcb0b0,0x1d8cb0,0x10000000
.long 0x26230,0xcb0c0,0x1d8cc0,0x10000000,0x26238,0xcb0d0,0x1d8cd0,0x10000000
.long 0x26240,0xcb0e0,0x1d8ce0,0x10000000,0x26248,0xcb0f0,0x1d8cf0,0x10000000
.long 0x3000,0x3020,0x3040,0x3060,0x3080,0x30a0,0x30c0,0x30e0
.long 0x3110,0x3130,0x3150,0x3170,0x3190,0x31b0,0x31d0,0x31f0
.long 0x3220,0x3200,0x3260,0x3240,0x32a0,0x3280,0x32e0,0x32c0
.long 0x3330,0x3310,0x3370,0x3350,0x33b0,0x3390,0x33f0,0x33d0
.long 0x3440,0x3460,0x3400,0x3420,0x34c0,0x34e0,0x3480,0x34a0
.long 0x3550,0x3570,0x3510,0x3530,0x35d0,0x35f0,0x3590,0x35b0
.long 0x3660,0x3640,0x3620,0x3600,0x36e0,0x36c0,0x36a0,0x3680
.long 0x3770,0x3750,0x3730,0x3710,0x37f0,0x37d0,0x37b0,0x3790
.long 0x3800,0x3820,0x3840,0x3860,0x3880,0x38a0,0x38c0,0x38e0
.long 0x3910,0x3930,0x3950,0x3970,0x3990,0x39b0,0x39d0,0x39f0
.long 0x3a20,0x3a00,0x3a60,0x3a40,0x3aa0,0x3a80,0x3ae0,0x3ac0
.long 0x3b30,0x3b10,0x3b70,0x3b50,0x3bb0,0x3b90,0x3bf0,0x3bd0
.long 0x3c40,0x3c60,0x3c00,0x3c20,0x3cc0,0x3ce0,0x3c80,0x3ca0
.long 0x3d50,0x3d70,0x3d10,0x3d30,0x3dd0,0x3df0,0x3d90,0x3db0
.long 0x3e60,0x3e40,0x3e20,0x3e00,0x3ee0,0x3ec0,0x3ea0,0x3e80
.long 0x3f70,0x3f50,0x3f30,0x3f10,0x3ff0,0x3fd0,0x3fb0,0x3f90
.long 0x3010,0x3030,0x3050,0x3070,0x3090,0x30b0,0x30d0,0x30f0
.long 0x3100,0x3120,0x3140,0x3160,0x3180,0x31a0,0x31c0,0x31e0
.long 0x3230,0x3210,0x3270,0x3250,0x32b0,0x3290,0x32f0,0x32d0
.long 0x3320,0x3300,0x3360,0x3340,0x33a0,0x3380,0x33e0,0x33c0
.long 0x3450,0x3470,0x3410,0x3430,0x34d0,0x34f0,0x3490,0x34b0
.long 0x3540,0x3560,0x3500,0x3520,0x35c0,0x35e0,0x3580,0x35a0
.long 0x3670,0x3650,0x3630,0x3610,0x36f0,0x36d0,0x36b0,0x3690
.long 0x3760,0x3740,0x3720,0x3700,0x37e0,0x37c0,0x37a0,0x3780
.long 0x3810,0x3830,0x3850,0x3870,0x3890,0x38b0,0x38d0,0x38f0
.long 0x3900,0x3920,0x3940,0x3960,0x3980,0x39a0,0x39c0,0x39e0
.long 0x3a30,0x3a10,0x3a70,0x3a50,0x3ab0,0x3a90,0x3af0,0x3ad0
.long 0x3b20,0x3b00,0x3b60,0x3b40,0x3ba0,0x3b80,0x3be0,0x3bc0
.long 0x3c50,0x3c70,0x3c10,0x3c30,0x3cd0,0x3cf0,0x3c90,0x3cb0
.long 0x3d40,0x3d60,0x3d00,0x3d20,0x3dc0,0x3de0,0x3d80,0x3da0
.long 0x3e70,0x3e50,0x3e30,0x3e10,0x3ef0,0x3ed0,0x3eb0,0x3e90
.long 0x3f60,0x3f40,0x3f20,0x3f00,0x3fe0,0x3fc0,0x3fa0,0x3f80
.long 0x1e0000,0x1e0040,0x253a0,0x254c0,0x1ea000,0x1ea040,0x253a8,0x254c8
.long 0x1f4000,0x1f4040,0x253b0,0x254d0,0x1fe000,0x1fe040,0x253b8,0x254d8
.long 0x208000,0x208040,0x258a0,0x259c0,0x212000,0x212040,0x258a8,0x259c8
.long 0x21c000,0x21c040,0x258b0,0x259d0,0x226000,0x226040,0x258b8,0x259d8
.long 0x230000,0x230040,0x25da0,0x25ec0,0x23a000,0x23a040,0x25da8,0x25ec8
.long 0x244000,0x244040,0x25db0,0x25ed0,0x24e000,0x24e040,0x25db8,0x25ed8
.long 0x258000,0x258040,0x262a0,0x263c0,0x262000,0x262040,0x262a8,0x263c8
.long 0x26c000,0x26c040,0x262b0,0x263d0,0x276000,0x276040,0x262b8,0x263d8
.long 0x1e0008,0x1e0048,0x253f0,0x25510,0x1ea008,0x1ea048,0x253f8,0x25518
.long 0x1f4008,0x1f4048,0x25400,0x25520,0x1fe008,0x1fe048,0x25408,0x25528
.long 0x208008,0x208048,0x258f0,0x25a10,0x212008,0x212048,0x258f8,0x25a18
.long 0x21c008,0x21c048,0x25900,0x25a20,0x226008,0x226048,0x25908,0x25a28
.long 0x230008,0x230048,0x25df0,0x25f10,0x23a008,0x23a048,0x25df8,0x25f18
.long 0x244008,0x244048,0x25e00,0x25f20,0x24e008,0x24e048,0x25e08,0x25f28
.long 0x258008,0x258048,0x262f0,0x26410,0x262008,0x262048,0x262f8,0x26418
.long 0x26c008,0x26c048,0x26300,0x26420,0x276008,0x276048,0x26308,0x26428
.long 0x1e0010,0x1e02c0,0x25440,0x25560,0x1ea010,0x1ea2c0,0x25448,0x25568
.long 0x1f4010,0x1f42c0,0x25450,0x25570,0x1fe010,0x1fe2c0,0x25458,0x25578
.long 0x208010,0x2082c0,0x25940,0x25a60,0x212010,0x2122c0,0x25948,0x25a68
.long 0x21c010,0x21c2c0,0x25950,0x25a70,0x226010,0x2262c0,0x25958,0x25a78
.long 0x230010,0x2302c0,0x25e40,0x25f60,0x23a010,0x23a2c0,0x25e48,0x25f68
.long 0x244010,0x2442c0,0x25e50,0x25f70,0x24e010,0x24e2c0,0x25e58,0x25f78
.long 0x258010,0x2582c0,0x26340,0x26460,0x262010,0x2622c0,0x26348,0x26468
.long 0x26c010,0x26c2c0,0x26350,0x26470,0x276010,0x2762c0,0x26358,0x26478
.long 0x1e0018,0x1e02c8,0x25490,0x255b0,0x1ea018,0x1ea2c8,0x25498,0x255b8
.long 0x1f4018,0x1f42c8,0x254a0,0x255c0,0x1fe018,0x1fe2c8,0x254a8,0x255c8
.long 0x208018,0x2082c8,0x25990,0x25ab0,0x212018,0x2122c8,0x25998,0x25ab8
.long 0x21c018,0x21c2c8,0x259a0,0x25ac0,0x226018,0x2262c8,0x259a8,0x25ac8
.long 0x230018,0x2302c8,0x25e90,0x25fb0,0x23a018,0x23a2c8,0x25e98,0x25fb8
.long 0x244018,0x2442c8,0x25ea0,0x25fc0,0x24e018,0x24e2c8,0x25ea8,0x25fc8
.long 0x258018,0x2582c8,0x26390,0x264b0,0x262018,0x2622c8,0x26398,0x264b8
.long 0x26c018,0x26c2c8,0x263a0,0x264c0,0x276018,0x2762c8,0x263a8,0x264c8
.long 0x25260,0xc00,0x10e800,0x10000000,0x25268,0xc10,0x10e810,0x10000000
.long 0x25270,0xc20,0x10e820,0x10000000,0x25278,0xc30,0x10e830,0x10000000
.long 0x25760,0xc40,0x10e840,0x10000000,0x25768,0xc50,0x10e850,0x10000000
.long 0x25770,0xc60,0x10e860,0x10000000,0x25778,0xc70,0x10e870,0x10000000
.long 0x25c60,0xc80,0x10e880,0x10000000,0x25c68,0xc90,0x10e890,0x10000000
.long 0x25c70,0xca0,0x10e8a0,0x10000000,0x25c78,0xcb0,0x10e8b0,0x10000000
.long 0x26160,0xcc0,0x10e8c0,0x10000000,0x26168,0xcd0,0x10e8d0,0x10000000
.long 0x26170,0xce0,0x10e8e0,0x10000000,0x26178,0xcf0,0x10e8f0,0x10000000
.long 0x252b0,0x44400,0x152000,0x10000000,0x252b8,0x44410,0x152010,0x10000000
.long 0x252c0,0x44420,0x152020,0x10000000,0x252c8,0x44430,0x152030,0x10000000
.long 0x257b0,0x44440,0x152040,0x10000000,0x257b8,0x44450,0x152050,0x10000000
.long 0x257c0,0x44460,0x152060,0x10000000,0x257c8,0x44470,0x152070,0x10000000
.long 0x25cb0,0x44480,0x152080,0x10000000,0x25cb8,0x44490,0x152090,0x10000000
.long 0x25cc0,0x444a0,0x1520a0,0x10000000,0x25cc8,0x444b0,0x1520b0,0x10000000
.long 0x261b0,0x444c0,0x1520c0,0x10000000,0x261b8,0x444d0,0x1520d0,0x10000000
.long 0x261c0,0x444e0,0x1520e0,0x10000000,0x261c8,0x444f0,0x1520f0,0x10000000
.long 0x25300,0x87c00,0x195800,0x10000000,0x25308,0x87c10,0x195810,0x10000000
.long 0x25310,0x87c20,0x195820,0x10000000,0x25318,0x87c30,0x195830,0x10000000
.long 0x25800,0x87c40,0x195840,0x10000000,0x25808,0x87c50,0x195850,0x10000000
.long 0x25810,0x87c60,0x195860,0x10000000,0x25818,0x87c70,0x195870,0x10000000
.long 0x25d00,0x87c80,0x195880,0x10000000,0x25d08,0x87c90,0x195890,0x10000000
.long 0x25d10,0x87ca0,0x1958a0,0x10000000,0x25d18,0x87cb0,0x1958b0,0x10000000
.long 0x26200,0x87cc0,0x1958c0,0x10000000,0x26208,0x87cd0,0x1958d0,0x10000000
.long 0x26210,0x87ce0,0x1958e0,0x10000000,0x26218,0x87cf0,0x1958f0,0x10000000
.long 0x25350,0xcb400,0x1d9000,0x10000000,0x25358,0xcb410,0x1d9010,0x10000000
.long 0x25360,0xcb420,0x1d9020,0x10000000,0x25368,0xcb430,0x1d9030,0x10000000
.long 0x25850,0xcb440,0x1d9040,0x10000000,0x25858,0xcb450,0x1d9050,0x10000000
.long 0x25860,0xcb460,0x1d9060,0x10000000,0x25868,0xcb470,0x1d9070,0x10000000
.long 0x25d50,0xcb480,0x1d9080,0x10000000,0x25d58,0xcb490,0x1d9090,0x10000000
.long 0x25d60,0xcb4a0,0x1d90a0,0x10000000,0x25d68,0xcb4b0,0x1d90b0,0x10000000
.long 0x26250,0xcb4c0,0x1d90c0,0x10000000,0x26258,0xcb4d0,0x1d90d0,0x10000000
.long 0x26260,0xcb4e0,0x1d90e0,0x10000000,0x26268,0xcb4f0,0x1d90f0,0x10000000
.long 0x4000,0x4040,0x6000,0x6040,0x4010,0x4050,0x6010,0x6050
.long 0x4008,0x4048,0x6008,0x6048,0x4018,0x4058,0x6018,0x6058
.long 0x4080,0x40c0,0x6080,0x60c0,0x4090,0x40d0,0x6090,0x60d0
.long 0x4088,0x40c8,0x6088,0x60c8,0x4098,0x40d8,0x6098,0x60d8
.long 0x4140,0x4100,0x6140,0x6100,0x4150,0x4110,0x6150,0x6110
.long 0x4148,0x4108,0x6148,0x6108,0x4158,0x4118,0x6158,0x6118
.long 0x41c0,0x4180,0x61c0,0x6180,0x41d0,0x4190,0x61d0,0x6190
.long 0x41c8,0x4188,0x61c8,0x6188,0x41d8,0x4198,0x61d8,0x6198
.long 0x4020,0x4060,0x6020,0x6060,0x4030,0x4070,0x6030,0x6070
.long 0x4028,0x4068,0x6028,0x6068,0x4038,0x4078,0x6038,0x6078
.long 0x40a0,0x40e0,0x60a0,0x60e0,0x40b0,0x40f0,0x60b0,0x60f0
.long 0x40a8,0x40e8,0x60a8,0x60e8,0x40b8,0x40f8,0x60b8,0x60f8
.long 0x4160,0x4120,0x6160,0x6120,0x4170,0x4130,0x6170,0x6130
.long 0x4168,0x4128,0x6168,0x6128,0x4178,0x4138,0x6178,0x6138
.long 0x41e0,0x41a0,0x61e0,0x61a0,0x41f0,0x41b0,0x61f0,0x61b0
.long 0x41e8,0x41a8,0x61e8,0x61a8,0x41f8,0x41b8,0x61f8,0x61b8
.long 0x4400,0x4440,0x6400,0x6440,0x4410,0x4450,0x6410,0x6450
.long 0x4408,0x4448,0x6408,0x6448,0x4418,0x4458,0x6418,0x6458
.long 0x4480,0x44c0,0x6480,0x64c0,0x4490,0x44d0,0x6490,0x64d0
.long 0x4488,0x44c8,0x6488,0x64c8,0x4498,0x44d8,0x6498,0x64d8
.long 0x4540,0x4500,0x6540,0x6500,0x4550,0x4510,0x6550,0x6510
.long 0x4548,0x4508,0x6548,0x6508,0x4558,0x4518,0x6558,0x6518
.long 0x45c0,0x4580,0x65c0,0x6580,0x45d0,0x4590,0x65d0,0x6590
.long 0x45c8,0x4588,0x65c8,0x6588,0x45d8,0x4598,0x65d8,0x6598
.long 0x4420,0x4460,0x6420,0x6460,0x4430,0x4470,0x6430,0x6470
.long 0x4428,0x4468,0x6428,0x6468,0x4438,0x4478,0x6438,0x6478
.long 0x44a0,0x44e0,0x64a0,0x64e0,0x44b0,0x44f0,0x64b0,0x64f0
.long 0x44a8,0x44e8,0x64a8,0x64e8,0x44b8,0x44f8,0x64b8,0x64f8
.long 0x4560,0x4520,0x6560,0x6520,0x4570,0x4530,0x6570,0x6530
.long 0x4568,0x4528,0x6568,0x6528,0x4578,0x4538,0x6578,0x6538
.long 0x45e0,0x45a0,0x65e0,0x65a0,0x45f0,0x45b0,0x65f0,0x65b0
.long 0x45e8,0x45a8,0x65e8,0x65a8,0x45f8,0x45b8,0x65f8,0x65b8
.long 0x4040,0x6000,0x6040,0x4000,0x4050,0x6010,0x6050,0x4010
.long 0x4048,0x6008,0x6048,0x4008,0x4058,0x6018,0x6058,0x4018
.long 0x40c0,0x6080,0x60c0,0x4080,0x40d0,0x6090,0x60d0,0x4090
.long 0x40c8,0x6088,0x60c8,0x4088,0x40d8,0x6098,0x60d8,0x4098
.long 0x4100,0x6140,0x6100,0x4140,0x4110,0x6150,0x6110,0x4150
.long 0x4108,0x6148,0x6108,0x4148,0x4118,0x6158,0x6118,0x4158
.long 0x4180,0x61c0,0x6180,0x41c0,0x4190,0x61d0,0x6190,0x41d0
.long 0x4188,0x61c8,0x6188,0x41c8,0x4198,0x61d8,0x6198,0x41d8
.long 0x4060,0x6020,0x6060,0x4020,0x4070,0x6030,0x6070,0x4030
.long 0x4068,0x6028,0x6068,0x4028,0x4078,0x6038,0x6078,0x4038
.long 0x40e0,0x60a0,0x60e0,0x40a0,0x40f0,0x60b0,0x60f0,0x40b0
.long 0x40e8,0x60a8,0x60e8,0x40a8,0x40f8,0x60b8,0x60f8,0x40b8
.long 0x4120,0x6160,0x6120,0x4160,0x4130,0x6170,0x6130,0x4170
.long 0x4128,0x6168,0x6128,0x4168,0x4138,0x6178,0x6138,0x4178
.long 0x41a0,0x61e0,0x61a0,0x41e0,0x41b0,0x61f0,0x61b0,0x41f0
.long 0x41a8,0x61e8,0x61a8,0x41e8,0x41b8,0x61f8,0x61b8,0x41f8
.long 0x4440,0x6400,0x6440,0x4400,0x4450,0x6410,0x6450,0x4410
.long 0x4448,0x6408,0x6448,0x4408,0x4458,0x6418,0x6458,0x4418
.long 0x44c0,0x6480,0x64c0,0x4480,0x44d0,0x6490,0x64d0,0x4490
.long 0x44c8,0x6488,0x64c8,0x4488,0x44d8,0x6498,0x64d8,0x4498
.long 0x4500,0x6540,0x6500,0x4540,0x4510,0x6550,0x6510,0x4550
.long 0x4508,0x6548,0x6508,0x4548,0x4518,0x6558,0x6518,0x4558
.long 0x4580,0x65c0,0x6580,0x45c0,0x4590,0x65d0,0x6590,0x45d0
.long 0x4588,0x65c8,0x6588,0x45c8,0x4598,0x65d8,0x6598,0x45d8
.long 0x4460,0x6420,0x6460,0x4420,0x4470,0x6430,0x6470,0x4430
.long 0x4468,0x6428,0x6468,0x4428,0x4478,0x6438,0x6478,0x4438
.long 0x44e0,0x64a0,0x64e0,0x44a0,0x44f0,0x64b0,0x64f0,0x44b0
.long 0x44e8,0x64a8,0x64e8,0x44a8,0x44f8,0x64b8,0x64f8,0x44b8
.long 0x4520,0x6560,0x6520,0x4560,0x4530,0x6570,0x6530,0x4570
.long 0x4528,0x6568,0x6528,0x4568,0x4538,0x6578,0x6538,0x4578
.long 0x45a0,0x65e0,0x65a0,0x45e0,0x45b0,0x65f0,0x65b0,0x45f0
.long 0x45a8,0x65e8,0x65a8,0x45e8,0x45b8,0x65f8,0x65b8,0x45f8
.long 0x6000,0x6040,0x4000,0x4040,0x6010,0x6050,0x4010,0x4050
.long 0x6008,0x6048,0x4008,0x4048,0x6018,0x6058,0x4018,0x4058
.long 0x6080,0x60c0,0x4080,0x40c0,0x6090,0x60d0,0x4090,0x40d0
.long 0x6088,0x60c8,0x4088,0x40c8,0x6098,0x60d8,0x4098,0x40d8
.long 0x6140,0x6100,0x4140,0x4100,0x6150,0x6110,0x4150,0x4110
.long 0x6148,0x6108,0x4148,0x4108,0x6158,0x6118,0x4158,0x4118
.long 0x61c0,0x6180,0x41c0,0x4180,0x61d0,0x6190,0x41d0,0x4190
.long 0x61c8,0x6188,0x41c8,0x4188,0x61d8,0x6198,0x41d8,0x4198
.long 0x6020,0x6060,0x4020,0x4060,0x6030,0x6070,0x4030,0x4070
.long 0x6028,0x6068,0x4028,0x4068,0x6038,0x6078,0x4038,0x4078
.long 0x60a0,0x60e0,0x40a0,0x40e0,0x60b0,0x60f0,0x40b0,0x40f0
.long 0x60a8,0x60e8,0x40a8,0x40e8,0x60b8,0x60f8,0x40b8,0x40f8
.long 0x6160,0x6120,0x4160,0x4120,0x6170,0x6130,0x4170,0x4130
.long 0x6168,0x6128,0x4168,0x4128,0x6178,0x6138,0x4178,0x4138
.long 0x61e0,0x61a0,0x41e0,0x41a0,0x61f0,0x61b0,0x41f0,0x41b0
.long 0x61e8,0x61a8,0x41e8,0x41a8,0x61f8,0x61b8,0x41f8,0x41b8
.long 0x6400,0x6440,0x4400,0x4440,0x6410,0x6450,0x4410,0x4450
.long 0x6408,0x6448,0x4408,0x4448,0x6418,0x6458,0x4418,0x4458
.long 0x6480,0x64c0,0x4480,0x44c0,0x6490,0x64d0,0x4490,0x44d0
.long 0x6488,0x64c8,0x4488,0x44c8,0x6498,0x64d8,0x4498,0x44d8
.long 0x6540,0x6500,0x4540,0x4500,0x6550,0x6510,0x4550,0x4510
.long 0x6548,0x6508,0x4548,0x4508,0x6558,0x6518,0x4558,0x4518
.long 0x65c0,0x6580,0x45c0,0x4580,0x65d0,0x6590,0x45d0,0x4590
.long 0x65c8,0x6588,0x45c8,0x4588,0x65d8,0x6598,0x45d8,0x4598
.long 0x6420,0x6460,0x4420,0x4460,0x6430,0x6470,0x4430,0x4470
.long 0x6428,0x6468,0x4428,0x4468,0x6438,0x6478,0x4438,0x4478
.long 0x64a0,0x64e0,0x44a0,0x44e0,0x64b0,0x64f0,0x44b0,0x44f0
.long 0x64a8,0x64e8,0x44a8,0x44e8,0x64b8,0x64f8,0x44b8,0x44f8
.long 0x6560,0x6520,0x4560,0x4520,0x6570,0x6530,0x4570,0x4530
.long 0x6568,0x6528,0x4568,0x4528,0x6578,0x6538,0x4578,0x4538
.long 0x65e0,0x65a0,0x45e0,0x45a0,0x65f0,0x65b0,0x45f0,0x45b0
.long 0x65e8,0x65a8,0x45e8,0x45a8,0x65f8,0x65b8,0x45f8,0x45b8
.long 0x6040,0x4000,0x4040,0x6000,0x6050,0x4010,0x4050,0x6010
.long 0x6048,0x4008,0x4048,0x6008,0x6058,0x4018,0x4058,0x6018
.long 0x60c0,0x4080,0x40c0,0x6080,0x60d0,0x4090,0x40d0,0x6090
.long 0x60c8,0x4088,0x40c8,0x6088,0x60d8,0x4098,0x40d8,0x6098
.long 0x6100,0x4140,0x4100,0x6140,0x6110,0x4150,0x4110,0x6150
.long 0x6108,0x4148,0x4108,0x6148,0x6118,0x4158,0x4118,0x6158
.long 0x6180,0x41c0,0x4180,0x61c0,0x6190,0x41d0,0x4190,0x61d0
.long 0x6188,0x41c8,0x4188,0x61c8,0x6198,0x41d8,0x4198,0x61d8
.long 0x6060,0x4020,0x4060,0x6020,0x6070,0x4030,0x4070,0x6030
.long 0x6068,0x4028,0x4068,0x6028,0x6078,0x4038,0x4078,0x6038
.long 0x60e0,0x40a0,0x40e0,0x60a0,0x60f0,0x40b0,0x40f0,0x60b0
.long 0x60e8,0x40a8,0x40e8,0x60a8,0x60f8,0x40b8,0x40f8,0x60b8
.long 0x6120,0x4160,0x4120,0x6160,0x6130,0x4170,0x4130,0x6170
.long 0x6128,0x4168,0x4128,0x6168,0x6138,0x4178,0x4138,0x6178
.long 0x61a0,0x41e0,0x41a0,0x61e0,0x61b0,0x41f0,0x41b0,0x61f0
.long 0x61a8,0x41e8,0x41a8,0x61e8,0x61b8,0x41f8,0x41b8,0x61f8
.long 0x6440,0x4400,0x4440,0x6400,0x6450,0x4410,0x4450,0x6410
.long 0x6448,0x4408,0x4448,0x6408,0x6458,0x4418,0x4458,0x6418
.long 0x64c0,0x4480,0x44c0,0x6480,0x64d0,0x4490,0x44d0,0x6490
.long 0x64c8,0x4488,0x44c8,0x6488,0x64d8,0x4498,0x44d8,0x6498
.long 0x6500,0x4540,0x4500,0x6540,0x6510,0x4550,0x4510,0x6550
.long 0x6508,0x4548,0x4508,0x6548,0x6518,0x4558,0x4518,0x6558
.long 0x6580,0x45c0,0x4580,0x65c0,0x6590,0x45d0,0x4590,0x65d0
.long 0x6588,0x45c8,0x4588,0x65c8,0x6598,0x45d8,0x4598,0x65d8
.long 0x6460,0x4420,0x4460,0x6420,0x6470,0x4430,0x4470,0x6430
.long 0x6468,0x4428,0x4468,0x6428,0x6478,0x4438,0x4478,0x6438
.long 0x64e0,0x44a0,0x44e0,0x64a0,0x64f0,0x44b0,0x44f0,0x64b0
.long 0x64e8,0x44a8,0x44e8,0x64a8,0x64f8,0x44b8,0x44f8,0x64b8
.long 0x6520,0x4560,0x4520,0x6560,0x6530,0x4570,0x4530,0x6570
.long 0x6528,0x4568,0x4528,0x6568,0x6538,0x4578,0x4538,0x6578
.long 0x65a0,0x45e0,0x45a0,0x65e0,0x65b0,0x45f0,0x45b0,0x65f0
.long 0x65a8,0x45e8,0x45a8,0x65e8,0x65b8,0x45f8,0x45b8,0x65f8
.long 0x4000,0x4040,0x6000,0x4000,0x4010,0x4050,0x6010,0x4010
.long 0x4008,0x4048,0x6008,0x4008,0x4018,0x4058,0x6018,0x4018
.long 0x4080,0x40c0,0x6080,0x4080,0x4090,0x40d0,0x6090,0x4090
.long 0x4088,0x40c8,0x6088,0x4088,0x4098,0x40d8,0x6098,0x4098
.long 0x4140,0x4100,0x6140,0x4140,0x4150,0x4110,0x6150,0x4150
.long 0x4148,0x4108,0x6148,0x4148,0x4158,0x4118,0x6158,0x4158
.long 0x41c0,0x4180,0x61c0,0x41c0,0x41d0,0x4190,0x61d0,0x41d0
.long 0x41c8,0x4188,0x61c8,0x41c8,0x41d8,0x4198,0x61d8,0x41d8
.long 0x4020,0x4060,0x6020,0x4020,0x4030,0x4070,0x6030,0x4030
.long 0x4028,0x4068,0x6028,0x4028,0x4038,0x4078,0x6038,0x4038
.long 0x40a0,0x40e0,0x60a0,0x40a0,0x40b0,0x40f0,0x60b0,0x40b0
.long 0x40a8,0x40e8,0x60a8,0x40a8,0x40b8,0x40f8,0x60b8,0x40b8
.long 0x4160,0x4120,0x6160,0x4160,0x4170,0x4130,0x6170,0x4170
.long 0x4168,0x4128,0x6168,0x4168,0x4178,0x4138,0x6178,0x4178
.long 0x41e0,0x41a0,0x61e0,0x41e0,0x41f0,0x41b0,0x61f0,0x41f0
.long 0x41e8,0x41a8,0x61e8,0x41e8,0x41f8,0x41b8,0x61f8,0x41f8
.long 0x4400,0x4440,0x6400,0x4400,0x4410,0x4450,0x6410,0x4410
.long 0x4408,0x4448,0x6408,0x4408,0x4418,0x4458,0x6418,0x4418
.long 0x4480,0x44c0,0x6480,0x4480,0x4490,0x44d0,0x6490,0x4490
.long 0x4488,0x44c8,0x6488,0x4488,0x4498,0x44d8,0x6498,0x4498
.long 0x4540,0x4500,0x6540,0x4540,0x4550,0x4510,0x6550,0x4550
.long 0x4548,0x4508,0x6548,0x4548,0x4558,0x4518,0x6558,0x4558
.long 0x45c0,0x4580,0x65c0,0x45c0,0x45d0,0x4590,0x65d0,0x45d0
.long 0x45c8,0x4588,0x65c8,0x45c8,0x45d8,0x4598,0x65d8,0x45d8
.long 0x4420,0x4460,0x6420,0x4420,0x4430,0x4470,0x6430,0x4430
.long 0x4428,0x4468,0x6428,0x4428,0x4438,0x4478,0x6438,0x4438
.long 0x44a0,0x44e0,0x64a0,0x44a0,0x44b0,0x44f0,0x64b0,0x44b0
.long 0x44a8,0x44e8,0x64a8,0x44a8,0x44b8,0x44f8,0x64b8,0x44b8
.long 0x4560,0x4520,0x6560,0x4560,0x4570,0x4530,0x6570,0x4570
.long 0x4568,0x4528,0x6568,0x4568,0x4578,0x4538,0x6578,0x4578
.long 0x45e0,0x45a0,0x65e0,0x45e0,0x45f0,0x45b0,0x65f0,0x45f0
.long 0x45e8,0x45a8,0x65e8,0x45e8,0x45f8,0x45b8,0x65f8,0x45f8
.long 0x4040,0x6000,0x4000,0x4040,0x4050,0x6010,0x4010,0x4050
.long 0x4048,0x6008,0x4008,0x4048,0x4058,0x6018,0x4018,0x4058
.long 0x40c0,0x6080,0x4080,0x40c0,0x40d0,0x6090,0x4090,0x40d0
.long 0x40c8,0x6088,0x4088,0x40c8,0x40d8,0x6098,0x4098,0x40d8
.long 0x4100,0x6140,0x4140,0x4100,0x4110,0x6150,0x4150,0x4110
.long 0x4108,0x6148,0x4148,0x4108,0x4118,0x6158,0x4158,0x4118
.long 0x4180,0x61c0,0x41c0,0x4180,0x4190,0x61d0,0x41d0,0x4190
.long 0x4188,0x61c8,0x41c8,0x4188,0x4198,0x61d8,0x41d8,0x4198
.long 0x4060,0x6020,0x4020,0x4060,0x4070,0x6030,0x4030,0x4070
.long 0x4068,0x6028,0x4028,0x4068,0x4078,0x6038,0x4038,0x4078
.long 0x40e0,0x60a0,0x40a0,0x40e0,0x40f0,0x60b0,0x40b0,0x40f0
.long 0x40e8,0x60a8,0x40a8,0x40e8,0x40f8,0x60b8,0x40b8,0x40f8
.long 0x4120,0x6160,0x4160,0x4120,0x4130,0x6170,0x4170,0x4130
.long 0x4128,0x6168,0x4168,0x4128,0x4138,0x6178,0x4178,0x4138
.long 0x41a0,0x61e0,0x41e0,0x41a0,0x41b0,0x61f0,0x41f0,0x41b0
.long 0x41a8,0x61e8,0x41e8,0x41a8,0x41b8,0x61f8,0x41f8,0x41b8
.long 0x4440,0x6400,0x4400,0x4440,0x4450,0x6410,0x4410,0x4450
.long 0x4448,0x6408,0x4408,0x4448,0x4458,0x6418,0x4418,0x4458
.long 0x44c0,0x6480,0x4480,0x44c0,0x44d0,0x6490,0x4490,0x44d0
.long 0x44c8,0x6488,0x4488,0x44c8,0x44d8,0x6498,0x4498,0x44d8
.long 0x4500,0x6540,0x4540,0x4500,0x4510,0x6550,0x4550,0x4510
.long 0x4508,0x6548,0x4548,0x4508,0x4518,0x6558,0x4558,0x4518
.long 0x4580,0x65c0,0x45c0,0x4580,0x4590,0x65d0,0x45d0,0x4590
.long 0x4588,0x65c8,0x45c8,0x4588,0x4598,0x65d8,0x45d8,0x4598
.long 0x4460,0x6420,0x4420,0x4460,0x4470,0x6430,0x4430,0x4470
.long 0x4468,0x6428,0x4428,0x4468,0x4478,0x6438,0x4438,0x4478
.long 0x44e0,0x64a0,0x44a0,0x44e0,0x44f0,0x64b0,0x44b0,0x44f0
.long 0x44e8,0x64a8,0x44a8,0x44e8,0x44f8,0x64b8,0x44b8,0x44f8
.long 0x4520,0x6560,0x4560,0x4520,0x4530,0x6570,0x4570,0x4530
.long 0x4528,0x6568,0x4568,0x4528,0x4538,0x6578,0x4578,0x4538
.long 0x45a0,0x65e0,0x45e0,0x45a0,0x45b0,0x65f0,0x45f0,0x45b0
.long 0x45a8,0x65e8,0x45e8,0x45a8,0x45b8,0x65f8,0x45f8,0x45b8
.long 0x6000,0x4000,0x4040,0x6000,0x6010,0x4010,0x4050,0x6010
.long 0x6008,0x4008,0x4048,0x6008,0x6018,0x4018,0x4058,0x6018
.long 0x6080,0x4080,0x40c0,0x6080,0x6090,0x4090,0x40d0,0x6090
.long 0x6088,0x4088,0x40c8,0x6088,0x6098,0x4098,0x40d8,0x6098
.long 0x6140,0x4140,0x4100,0x6140,0x6150,0x4150,0x4110,0x6150
.long 0x6148,0x4148,0x4108,0x6148,0x6158,0x4158,0x4118,0x6158
.long 0x61c0,0x41c0,0x4180,0x61c0,0x61d0,0x41d0,0x4190,0x61d0
.long 0x61c8,0x41c8,0x4188,0x61c8,0x61d8,0x41d8,0x4198,0x61d8
.long 0x6020,0x4020,0x4060,0x6020,0x6030,0x4030,0x4070,0x6030
.long 0x6028,0x4028,0x4068,0x6028,0x6038,0x4038,0x4078,0x6038
.long 0x60a0,0x40a0,0x40e0,0x60a0,0x60b0,0x40b0,0x40f0,0x60b0
.long 0x60a8,0x40a8,0x40e8,0x60a8,0x60b8,0x40b8,0x40f8,0x60b8
.long 0x6160,0x4160,0x4120,0x6160,0x6170,0x4170,0x4130,0x6170
.long 0x6168,0x4168,0x4128,0x6168,0x6178,0x4178,0x4138,0x6178
.long 0x61e0,0x41e0,0x41a0,0x61e0,0x61f0,0x41f0,0x41b0,0x61f0
.long 0x61e8,0x41e8,0x41a8,0x61e8,0x61f8,0x41f8,0x41b8,0x61f8
.long 0x6400,0x4400,0x4440,0x6400,0x6410,0x4410,0x4450,0x6410
.long 0x6408,0x4408,0x4448,0x6408,0x6418,0x4418,0x4458,0x6418
.long 0x6480,0x4480,0x44c0,0x6480,0x6490,0x4490,0x44d0,0x6490
.long 0x6488,0x4488,0x44c8,0x6488,0x6498,0x4498,0x44d8,0x6498
.long 0x6540,0x4540,0x4500,0x6540,0x6550,0x4550,0x4510,0x6550
.long 0x6548,0x4548,0x4508,0x6548,0x6558,0x4558,0x4518,0x6558
.long 0x65c0,0x45c0,0x4580,0x65c0,0x65d0,0x45d0,0x4590,0x65d0
.long 0x65c8,0x45c8,0x4588,0x65c8,0x65d8,0x45d8,0x4598,0x65d8
.long 0x6420,0x4420,0x4460,0x6420,0x6430,0x4430,0x4470,0x6430
.long 0x6428,0x4428,0x4468,0x6428,0x6438,0x4438,0x4478,0x6438
.long 0x64a0,0x44a0,0x44e0,0x64a0,0x64b0,0x44b0,0x44f0,0x64b0
.long 0x64a8,0x44a8,0x44e8,0x64a8,0x64b8,0x44b8,0x44f8,0x64b8
.long 0x6560,0x4560,0x4520,0x6560,0x6570,0x4570,0x4530,0x6570
.long 0x6568,0x4568,0x4528,0x6568,0x6578,0x4578,0x4538,0x6578
.long 0x65e0,0x45e0,0x45a0,0x65e0,0x65f0,0x45f0,0x45b0,0x65f0
.long 0x65e8,0x45e8,0x45a8,0x65e8,0x65f8,0x45f8,0x45b8,0x65f8
.long 0x4000,0x4040,0x6000,0x4000,0x4010,0x4050,0x6010,0x4010
.long 0x4008,0x4048,0x6008,0x4008,0x4018,0x4058,0x6018,0x4018
.long 0x4080,0x40c0,0x6080,0x4080,0x4090,0x40d0,0x6090,0x4090
.long 0x4088,0x40c8,0x6088,0x4088,0x4098,0x40d8,0x6098,0x4098
.long 0x4140,0x4100,0x6140,0x4140,0x4150,0x4110,0x6150,0x4150
.long 0x4148,0x4108,0x6148,0x4148,0x4158,0x4118,0x6158,0x4158
.long 0x41c0,0x4180,0x61c0,0x41c0,0x41d0,0x4190,0x61d0,0x41d0
.long 0x41c8,0x4188,0x61c8,0x41c8,0x41d8,0x4198,0x61d8,0x41d8
.long 0x4020,0x4060,0x6020,0x4020,0x4030,0x4070,0x6030,0x4030
.long 0x4028,0x4068,0x6028,0x4028,0x4038,0x4078,0x6038,0x4038
.long 0x40a0,0x40e0,0x60a0,0x40a0,0x40b0,0x40f0,0x60b0,0x40b0
.long 0x40a8,0x40e8,0x60a8,0x40a8,0x40b8,0x40f8,0x60b8,0x40b8
.long 0x4160,0x4120,0x6160,0x4160,0x4170,0x4130,0x6170,0x4170
.long 0x4168,0x4128,0x6168,0x4168,0x4178,0x4138,0x6178,0x4178
.long 0x41e0,0x41a0,0x61e0,0x41e0,0x41f0,0x41b0,0x61f0,0x41f0
.long 0x41e8,0x41a8,0x61e8,0x41e8,0x41f8,0x41b8,0x61f8,0x41f8
.long 0x4400,0x4440,0x6400,0x4400,0x4410,0x4450,0x6410,0x4410
.long 0x4408,0x4448,0x6408,0x4408,0x4418,0x4458,0x6418,0x4418
.long 0x4480,0x44c0,0x6480,0x4480,0x4490,0x44d0,0x6490,0x4490
.long 0x4488,0x44c8,0x6488,0x4488,0x4498,0x44d8,0x6498,0x4498
.long 0x4540,0x4500,0x6540,0x4540,0x4550,0x4510,0x6550,0x4550
.long 0x4548,0x4508,0x6548,0x4548,0x4558,0x4518,0x6558,0x4558
.long 0x45c0,0x4580,0x65c0,0x45c0,0x45d0,0x4590,0x65d0,0x45d0
.long 0x45c8,0x4588,0x65c8,0x45c8,0x45d8,0x4598,0x65d8,0x45d8
.long 0x4420,0x4460,0x6420,0x4420,0x4430,0x4470,0x6430,0x4430
.long 0x4428,0x4468,0x6428,0x4428,0x4438,0x4478,0x6438,0x4438
.long 0x44a0,0x44e0,0x64a0,0x44a0,0x44b0,0x44f0,0x64b0,0x44b0
.long 0x44a8,0x44e8,0x64a8,0x44a8,0x44b8,0x44f8,0x64b8,0x44b8
.long 0x4560,0x4520,0x6560,0x4560,0x4570,0x4530,0x6570,0x4570
.long 0x4568,0x4528,0x6568,0x4568,0x4578,0x4538,0x6578,0x4578
.long 0x45e0,0x45a0,0x65e0,0x45e0,0x45f0,0x45b0,0x65f0,0x45f0
.long 0x45e8,0x45a8,0x65e8,0x45e8,0x45f8,0x45b8,0x65f8,0x45f8
.long 0x4040,0x6000,0x6040,0x4040,0x4050,0x6010,0x6050,0x4050
.long 0x4048,0x6008,0x6048,0x4048,0x4058,0x6018,0x6058,0x4058
.long 0x40c0,0x6080,0x60c0,0x40c0,0x40d0,0x6090,0x60d0,0x40d0
.long 0x40c8,0x6088,0x60c8,0x40c8,0x40d8,0x6098,0x60d8,0x40d8
.long 0x4100,0x6140,0x6100,0x4100,0x4110,0x6150,0x6110,0x4110
.long 0x4108,0x6148,0x6108,0x4108,0x4118,0x6158,0x6118,0x4118
.long 0x4180,0x61c0,0x6180,0x4180,0x4190,0x61d0,0x6190,0x4190
.long 0x4188,0x61c8,0x6188,0x4188,0x4198,0x61d8,0x6198,0x4198
.long 0x4060,0x6020,0x6060,0x4060,0x4070,0x6030,0x6070,0x4070
.long 0x4068,0x6028,0x6068,0x4068,0x4078,0x6038,0x6078,0x4078
.long 0x40e0,0x60a0,0x60e0,0x40e0,0x40f0,0x60b0,0x60f0,0x40f0
.long 0x40e8,0x60a8,0x60e8,0x40e8,0x40f8,0x60b8,0x60f8,0x40f8
.long 0x4120,0x6160,0x6120,0x4120,0x4130,0x6170,0x6130,0x4130
.long 0x4128,0x6168,0x6128,0x4128,0x4138,0x6178,0x6138,0x4138
.long 0x41a0,0x61e0,0x61a0,0x41a0,0x41b0,0x61f0,0x61b0,0x41b0
.long 0x41a8,0x61e8,0x61a8,0x41a8,0x41b8,0x61f8,0x61b8,0x41b8
.long 0x4440,0x6400,0x6440,0x4440,0x4450,0x6410,0x6450,0x4450
.long 0x4448,0x6408,0x6448,0x4448,0x4458,0x6418,0x6458,0x4458
.long 0x44c0,0x6480,0x64c0,0x44c0,0x44d0,0x6490,0x64d0,0x44d0
.long 0x44c8,0x6488,0x64c8,0x44c8,0x44d8,0x6498,0x64d8,0x44d8
.long 0x4500,0x6540,0x6500,0x4500,0x4510,0x6550,0x6510,0x4510
.long 0x4508,0x6548,0x6508,0x4508,0x4518,0x6558,0x6518,0x4518
.long 0x4580,0x65c0,0x6580,0x4580,0x4590,0x65d0,0x6590,0x4590
.long 0x4588,0x65c8,0x6588,0x4588,0x4598,0x65d8,0x6598,0x4598
.long 0x4460,0x6420,0x6460,0x4460,0x4470,0x6430,0x6470,0x4470
.long 0x4468,0x6428,0x6468,0x4468,0x4478,0x6438,0x6478,0x4478
.long 0x44e0,0x64a0,0x64e0,0x44e0,0x44f0,0x64b0,0x64f0,0x44f0
.long 0x44e8,0x64a8,0x64e8,0x44e8,0x44f8,0x64b8,0x64f8,0x44f8
.long 0x4520,0x6560,0x6520,0x4520,0x4530,0x6570,0x6530,0x4530
.long 0x4528,0x6568,0x6528,0x4528,0x4538,0x6578,0x6538,0x4538
.long 0x45a0,0x65e0,0x65a0,0x45a0,0x45b0,0x65f0,0x65b0,0x45b0
.long 0x45a8,0x65e8,0x65a8,0x45a8,0x45b8,0x65f8,0x65b8,0x45b8
.long 0x6000,0x6040,0x4040,0x6000,0x6010,0x6050,0x4050,0x6010
.long 0x6008,0x6048,0x4048,0x6008,0x6018,0x6058,0x4058,0x6018
.long 0x6080,0x60c0,0x40c0,0x6080,0x6090,0x60d0,0x40d0,0x6090
.long 0x6088,0x60c8,0x40c8,0x6088,0x6098,0x60d8,0x40d8,0x6098
.long 0x6140,0x6100,0x4100,0x6140,0x6150,0x6110,0x4110,0x6150
.long 0x6148,0x6108,0x4108,0x6148,0x6158,0x6118,0x4118,0x6158
.long 0x61c0,0x6180,0x4180,0x61c0,0x61d0,0x6190,0x4190,0x61d0
.long 0x61c8,0x6188,0x4188,0x61c8,0x61d8,0x6198,0x4198,0x61d8
.long 0x6020,0x6060,0x4060,0x6020,0x6030,0x6070,0x4070,0x6030
.long 0x6028,0x6068,0x4068,0x6028,0x6038,0x6078,0x4078,0x6038
.long 0x60a0,0x60e0,0x40e0,0x60a0,0x60b0,0x60f0,0x40f0,0x60b0
.long 0x60a8,0x60e8,0x40e8,0x60a8,0x60b8,0x60f8,0x40f8,0x60b8
.long 0x6160,0x6120,0x4120,0x6160,0x6170,0x6130,0x4130,0x6170
.long 0x6168,0x6128,0x4128,0x6168,0x6178,0x6138,0x4138,0x6178
.long 0x61e0,0x61a0,0x41a0,0x61e0,0x61f0,0x61b0,0x41b0,0x61f0
.long 0x61e8,0x61a8,0x41a8,0x61e8,0x61f8,0x61b8,0x41b8,0x61f8
.long 0x6400,0x6440,0x4440,0x6400,0x6410,0x6450,0x4450,0x6410
.long 0x6408,0x6448,0x4448,0x6408,0x6418,0x6458,0x4458,0x6418
.long 0x6480,0x64c0,0x44c0,0x6480,0x6490,0x64d0,0x44d0,0x6490
.long 0x6488,0x64c8,0x44c8,0x6488,0x6498,0x64d8,0x44d8,0x6498
.long 0x6540,0x6500,0x4500,0x6540,0x6550,0x6510,0x4510,0x6550
.long 0x6548,0x6508,0x4508,0x6548,0x6558,0x6518,0x4518,0x6558
.long 0x65c0,0x6580,0x4580,0x65c0,0x65d0,0x6590,0x4590,0x65d0
.long 0x65c8,0x6588,0x4588,0x65c8,0x65d8,0x6598,0x4598,0x65d8
.long 0x6420,0x6460,0x4460,0x6420,0x6430,0x6470,0x4470,0x6430
.long 0x6428,0x6468,0x4468,0x6428,0x6438,0x6478,0x4478,0x6438
.long 0x64a0,0x64e0,0x44e0,0x64a0,0x64b0,0x64f0,0x44f0,0x64b0
.long 0x64a8,0x64e8,0x44e8,0x64a8,0x64b8,0x64f8,0x44f8,0x64b8
.long 0x6560,0x6520,0x4520,0x6560,0x6570,0x6530,0x4530,0x6570
.long 0x6568,0x6528,0x4528,0x6568,0x6578,0x6538,0x4538,0x6578
.long 0x65e0,0x65a0,0x45a0,0x65e0,0x65f0,0x65b0,0x45b0,0x65f0
.long 0x65e8,0x65a8,0x45a8,0x65e8,0x65f8,0x65b8,0x45b8,0x65f8
.long 0x6040,0x4040,0x6000,0x6040,0x6050,0x4050,0x6010,0x6050
.long 0x6048,0x4048,0x6008,0x6048,0x6058,0x4058,0x6018,0x6058
.long 0x60c0,0x40c0,0x6080,0x60c0,0x60d0,0x40d0,0x6090,0x60d0
.long 0x60c8,0x40c8,0x6088,0x60c8,0x60d8,0x40d8,0x6098,0x60d8
.long 0x6100,0x4100,0x6140,0x6100,0x6110,0x4110,0x6150,0x6110
.long 0x6108,0x4108,0x6148,0x6108,0x6118,0x4118,0x6158,0x6118
.long 0x6180,0x4180,0x61c0,0x6180,0x6190,0x4190,0x61d0,0x6190
.long 0x6188,0x4188,0x61c8,0x6188,0x6198,0x4198,0x61d8,0x6198
.long 0x6060,0x4060,0x6020,0x6060,0x6070,0x4070,0x6030,0x6070
.long 0x6068,0x4068,0x6028,0x6068,0x6078,0x4078,0x6038,0x6078
.long 0x60e0,0x40e0,0x60a0,0x60e0,0x60f0,0x40f0,0x60b0,0x60f0
.long 0x60e8,0x40e8,0x60a8,0x60e8,0x60f8,0x40f8,0x60b8,0x60f8
.long 0x6120,0x4120,0x6160,0x6120,0x6130,0x4130,0x6170,0x6130
.long 0x6128,0x4128,0x6168,0x6128,0x6138,0x4138,0x6178,0x6138
.long 0x61a0,0x41a0,0x61e0,0x61a0,0x61b0,0x41b0,0x61f0,0x61b0
.long 0x61a8,0x41a8,0x61e8,0x61a8,0x61b8,0x41b8,0x61f8,0x61b8
.long 0x6440,0x4440,0x6400,0x6440,0x6450,0x4450,0x6410,0x6450
.long 0x6448,0x4448,0x6408,0x6448,0x6458,0x4458,0x6418,0x6458
.long 0x64c0,0x44c0,0x6480,0x64c0,0x64d0,0x44d0,0x6490,0x64d0
.long 0x64c8,0x44c8,0x6488,0x64c8,0x64d8,0x44d8,0x6498,0x64d8
.long 0x6500,0x4500,0x6540,0x6500,0x6510,0x4510,0x6550,0x6510
.long 0x6508,0x4508,0x6548,0x6508,0x6518,0x4518,0x6558,0x6518
.long 0x6580,0x4580,0x65c0,0x6580,0x6590,0x4590,0x65d0,0x6590
.long 0x6588,0x4588,0x65c8,0x6588,0x6598,0x4598,0x65d8,0x6598
.long 0x6460,0x4460,0x6420,0x6460,0x6470,0x4470,0x6430,0x6470
.long 0x6468,0x4468,0x6428,0x6468,0x6478,0x4478,0x6438,0x6478
.long 0x64e0,0x44e0,0x64a0,0x64e0,0x64f0,0x44f0,0x64b0,0x64f0
.long 0x64e8,0x44e8,0x64a8,0x64e8,0x64f8,0x44f8,0x64b8,0x64f8
.long 0x6520,0x4520,0x6560,0x6520,0x6530,0x4530,0x6570,0x6530
.long 0x6528,0x4528,0x6568,0x6528,0x6538,0x4538,0x6578,0x6538
.long 0x65a0,0x45a0,0x65e0,0x65a0,0x65b0,0x45b0,0x65f0,0x65b0
.long 0x65a8,0x45a8,0x65e8,0x65a8,0x65b8,0x45b8,0x65f8,0x65b8
.long 0x4040,0x6000,0x6040,0x4040,0x4050,0x6010,0x6050,0x4050
.long 0x4048,0x6008,0x6048,0x4048,0x4058,0x6018,0x6058,0x4058
.long 0x40c0,0x6080,0x60c0,0x40c0,0x40d0,0x6090,0x60d0,0x40d0
.long 0x40c8,0x6088,0x60c8,0x40c8,0x40d8,0x6098,0x60d8,0x40d8
.long 0x4100,0x6140,0x6100,0x4100,0x4110,0x6150,0x6110,0x4110
.long 0x4108,0x6148,0x6108,0x4108,0x4118,0x6158,0x6118,0x4118
.long 0x4180,0x61c0,0x6180,0x4180,0x4190,0x61d0,0x6190,0x4190
.long 0x4188,0x61c8,0x6188,0x4188,0x4198,0x61d8,0x6198,0x4198
.long 0x4060,0x6020,0x6060,0x4060,0x4070,0x6030,0x6070,0x4070
.long 0x4068,0x6028,0x6068,0x4068,0x4078,0x6038,0x6078,0x4078
.long 0x40e0,0x60a0,0x60e0,0x40e0,0x40f0,0x60b0,0x60f0,0x40f0
.long 0x40e8,0x60a8,0x60e8,0x40e8,0x40f8,0x60b8,0x60f8,0x40f8
.long 0x4120,0x6160,0x6120,0x4120,0x4130,0x6170,0x6130,0x4130
.long 0x4128,0x6168,0x6128,0x4128,0x4138,0x6178,0x6138,0x4138
.long 0x41a0,0x61e0,0x61a0,0x41a0,0x41b0,0x61f0,0x61b0,0x41b0
.long 0x41a8,0x61e8,0x61a8,0x41a8,0x41b8,0x61f8,0x61b8,0x41b8
.long 0x4440,0x6400,0x6440,0x4440,0x4450,0x6410,0x6450,0x4450
.long 0x4448,0x6408,0x6448,0x4448,0x4458,0x6418,0x6458,0x4458
.long 0x44c0,0x6480,0x64c0,0x44c0,0x44d0,0x6490,0x64d0,0x44d0
.long 0x44c8,0x6488,0x64c8,0x44c8,0x44d8,0x6498,0x64d8,0x44d8
.long 0x4500,0x6540,0x6500,0x4500,0x4510,0x6550,0x6510,0x4510
.long 0x4508,0x6548,0x6508,0x4508,0x4518,0x6558,0x6518,0x4518
.long 0x4580,0x65c0,0x6580,0x4580,0x4590,0x65d0,0x6590,0x4590
.long 0x4588,0x65c8,0x6588,0x4588,0x4598,0x65d8,0x6598,0x4598
.long 0x4460,0x6420,0x6460,0x4460,0x4470,0x6430,0x6470,0x4470
.long 0x4468,0x6428,0x6468,0x4468,0x4478,0x6438,0x6478,0x4478
.long 0x44e0,0x64a0,0x64e0,0x44e0,0x44f0,0x64b0,0x64f0,0x44f0
.long 0x44e8,0x64a8,0x64e8,0x44e8,0x44f8,0x64b8,0x64f8,0x44f8
.long 0x4520,0x6560,0x6520,0x4520,0x4530,0x6570,0x6530,0x4530
.long 0x4528,0x6568,0x6528,0x4528,0x4538,0x6578,0x6538,0x4538
.long 0x45a0,0x65e0,0x65a0,0x45a0,0x45b0,0x65f0,0x65b0,0x45b0
.long 0x45a8,0x65e8,0x65a8,0x45a8,0x45b8,0x65f8,0x65b8,0x45b8
.long 0x0,0x0,0x0,0xa0,0x0,0x0,0x0,0x0
.long 0x700000,0x0,0x0,0x100000,0x700000,0x0,0xa00000,0x40000
.long 0x0,0x1e,0x0,0x0,0x4,0x0,0x8,0x0
.long 0x700000,0x0,0x780,0x1a1000,0x70a000,0x1400,0xa07800,0x40100
.long 0x4,0x0,0x0,0x0,0x8,0x0,0x2,0x0
.long 0x700000,0x2800,0x0,0x242000,0x714000,0x2800,0xbb0000,0x41000
.long 0x4,0x1e,0x0,0x0,0xc,0x0,0x0,0x0
.long 0x700000,0x2800,0x780,0x2e3000,0x71e000,0x3c00,0xbb7800,0x41100
.long 0x8,0x0,0x0,0x0,0x10,0x0,0x4,0x0
.long 0x700000,0x5000,0x0,0x384000,0x728000,0x5000,0xd60000,0x42000
.long 0x8,0x1e,0x0,0x0,0x14,0x0,0x2,0x0
.long 0x700000,0x5000,0x780,0x425000,0x732000,0x6400,0xd67800,0x42100
.long 0xc,0x0,0x0,0x0,0x18,0x0,0x6,0x0
.long 0x700000,0x7800,0x0,0x4c6000,0x73c000,0x7800,0xf10000,0x43000
.long 0xc,0x1e,0x0,0x0,0x1c,0x0,0x4,0x0
.long 0x700000,0x7800,0x780,0x567000,0x10000000,0x8c00,0xf17800,0x43100
.long 0x0,0x4,0x0,0x0,0x0,0x1,0x1,0x0
.long 0x743800,0x0,0x100,0x105080,0x700100,0x50,0xa01000,0x40020
.long 0x0,0x22,0x0,0x0,0x4,0x1,0x9,0x0
.long 0x743800,0x0,0x880,0x1a6080,0x70a100,0x1450,0xa08800,0x40120
.long 0x4,0x4,0x0,0x0,0x8,0x1,0x3,0x0
.long 0x743800,0x2800,0x100,0x247080,0x714100,0x2850,0xbb1000,0x41020
.long 0x4,0x22,0x0,0x0,0xc,0x1,0x1,0x0
.long 0x743800,0x2800,0x880,0x2e8080,0x71e100,0x3c50,0xbb8800,0x41120
.long 0x8,0x4,0x0,0x0,0x10,0x1,0x5,0x0
.long 0x743800,0x5000,0x100,0x389080,0x728100,0x5050,0xd61000,0x42020
.long 0x8,0x22,0x0,0x0,0x14,0x1,0x3,0x0
.long 0x743800,0x5000,0x880,0x42a080,0x732100,0x6450,0xd68800,0x42120
.long 0xc,0x4,0x0,0x0,0x18,0x1,0x7,0x0
.long 0x743800,0x7800,0x100,0x4cb080,0x73c100,0x7850,0xf11000,0x43020
.long 0xc,0x22,0x0,0x0,0x1c,0x1,0x5,0x0
.long 0x743800,0x7800,0x880,0x56c080,0x10000000,0x8c50,0xf18800,0x43120
.long 0x0,0x8,0x0,0x0,0x0,0x2,0x2,0x0
.long 0x787000,0x0,0x200,0x10a100,0x700200,0xa0,0xa02000,0x40040
.long 0x0,0x26,0x0,0x0,0x4,0x2,0x0,0x0
.long 0x787000,0x0,0x980,0x1ab100,0x70a200,0x14a0,0xa09800,0x40140
.long 0x4,0x8,0x0,0x0,0x8,0x2,0x4,0x0
.long 0x787000,0x2800,0x200,0x24c100,0x714200,0x28a0,0xbb2000,0x41040
.long 0x4,0x26,0x0,0x0,0xc,0x2,0x2,0x0
.long 0x787000,0x2800,0x980,0x2ed100,0x71e200,0x3ca0,0xbb9800,0x41140
.long 0x8,0x8,0x0,0x0,0x10,0x2,0x6,0x0
.long 0x787000,0x5000,0x200,0x38e100,0x728200,0x50a0,0xd62000,0x42040
.long 0x8,0x26,0x0,0x0,0x14,0x2,0x4,0x0
.long 0x787000,0x5000,0x980,0x42f100,0x732200,0x64a0,0xd69800,0x42140
.long 0xc,0x8,0x0,0x0,0x18,0x2,0x8,0x0
.long 0x787000,0x7800,0x200,0x4d0100,0x73c200,0x78a0,0xf12000,0x43040
.long 0xc,0x26,0x0,0x0,0x1c,0x2,0x6,0x0
.long 0x787000,0x7800,0x980,0x571100,0x10000000,0x8ca0,0xf19800,0x43140
.long 0x0,0xc,0x1,0x0,0x0,0x3,0x3,0x0
.long 0x7ca800,0x0,0x300,0x10f180,0x700300,0xf0,0xa03000,0x40060
.long 0x0,0x1b,0x2,0x14,0x4,0x3,0x1,0x0
.long 0x7ca800,0x0,0x680,0x1b0180,0x70a300,0x14f0,0xa06c00,0x40160
.long 0x4,0xc,0x1,0x28,0x8,0x3,0x5,0x0
.long 0x7ca800,0x2800,0x300,0x251180,0x714300,0x28f0,0xbb3000,0x41060
.long 0x4,0x1b,0x2,0x3c,0xc,0x3,0x3,0x0
.long 0x7ca800,0x2800,0x680,0x2f2180,0x71e300,0x3cf0,0xbb6c00,0x41160
.long 0x8,0xc,0x1,0x50,0x10,0x3,0x7,0x0
.long 0x7ca800,0x5000,0x300,0x393180,0x728300,0x50f0,0xd63000,0x42060
.long 0x8,0x1b,0x2,0x64,0x14,0x3,0x5,0x0
.long 0x7ca800,0x5000,0x680,0x434180,0x732300,0x64f0,0xd66c00,0x42160
.long 0xc,0xc,0x1,0x78,0x18,0x3,0x9,0x0
.long 0x7ca800,0x7800,0x300,0x4d5180,0x73c300,0x78f0,0xf13000,0x43060
.long 0xc,0x1b,0x2,0x8c,0x1c,0x3,0x7,0x0
.long 0x7ca800,0x7800,0x680,0x576180,0x10000000,0x8cf0,0xf16c00,0x43160
.long 0x0,0xf,0x2,0x1,0x0,0x4,0x4,0x0
.long 0x80e000,0x0,0x380,0x114200,0x701400,0x140,0xa03c00,0x40080
.long 0x0,0x2a,0x1,0x15,0x4,0x4,0x2,0x0
.long 0x80e000,0x0,0xa80,0x1b5200,0x70b400,0x1540,0xa0a800,0x40180
.long 0x4,0xf,0x2,0x29,0x8,0x4,0x6,0x0
.long 0x80e000,0x2800,0x380,0x256200,0x715400,0x2940,0xbb3c00,0x41080
.long 0x4,0x2a,0x1,0x3d,0xc,0x4,0x4,0x0
.long 0x80e000,0x2800,0xa80,0x2f7200,0x71f400,0x3d40,0xbba800,0x41180
.long 0x8,0xf,0x2,0x51,0x10,0x4,0x8,0x0
.long 0x80e000,0x5000,0x380,0x398200,0x729400,0x5140,0xd63c00,0x42080
.long 0x8,0x2a,0x1,0x65,0x14,0x4,0x6,0x0
.long 0x80e000,0x5000,0xa80,0x439200,0x733400,0x6540,0xd6a800,0x42180
.long 0xc,0xf,0x2,0x79,0x18,0x4,0x0,0x0
.long 0x80e000,0x7800,0x380,0x4da200,0x73d400,0x7940,0xf13c00,0x43080
.long 0xc,0x2a,0x1,0x8d,0x1c,0x4,0x8,0x0
.long 0x80e000,0x7800,0xa80,0x57b200,0x10000000,0x8d40,0xf1a800,0x43180
.long 0x0,0x12,0x1,0x2,0x0,0x5,0x5,0x0
.long 0x851800,0x0,0x480,0x119280,0x701500,0x190,0xa04800,0x400a0
.long 0x0,0x2d,0x2,0x16,0x4,0x5,0x3,0x0
.long 0x851800,0x0,0xb00,0x1ba280,0x70b500,0x1590,0xa0b400,0x401a0
.long 0x4,0x12,0x1,0x2a,0x8,0x5,0x7,0x0
.long 0x851800,0x2800,0x480,0x25b280,0x715500,0x2990,0xbb4800,0x410a0
.long 0x4,0x2d,0x2,0x3e,0xc,0x5,0x5,0x0
.long 0x851800,0x2800,0xb00,0x2fc280,0x71f500,0x3d90,0xbbb400,0x411a0
.long 0x8,0x12,0x1,0x52,0x10,0x5,0x9,0x0
.long 0x851800,0x5000,0x480,0x39d280,0x729500,0x5190,0xd64800,0x420a0
.long 0x8,0x2d,0x2,0x66,0x14,0x5,0x7,0x0
.long 0x851800,0x5000,0xb00,0x43e280,0x733500,0x6590,0xd6b400,0x421a0
.long 0xc,0x12,0x1,0x7a,0x18,0x5,0x1,0x0
.long 0x851800,0x7800,0x480,0x4df280,0x73d500,0x7990,0xf14800,0x430a0
.long 0xc,0x2d,0x2,0x8e,0x1c,0x5,0x9,0x0
.long 0x851800,0x7800,0xb00,0x580280,0x10000000,0x8d90,0xf1b400,0x431a0
.long 0x0,0x15,0x2,0x3,0x0,0x6,0x6,0x0
.long 0x895000,0x0,0x500,0x11e300,0x701600,0x1e0,0xa05400,0x400c0
.long 0x0,0x30,0x1,0x17,0x4,0x6,0x4,0x0
.long 0x895000,0x0,0xc00,0x1bf300,0x70b600,0x15e0,0xa0c000,0x401c0
.long 0x4,0x15,0x2,0x2b,0x8,0x6,0x8,0x0
.long 0x895000,0x2800,0x500,0x260300,0x715600,0x29e0,0xbb5400,0x410c0
.long 0x4,0x30,0x1,0x3f,0xc,0x6,0x6,0x0
.long 0x895000,0x2800,0xc00,0x301300,0x71f600,0x3de0,0xbbc000,0x411c0
.long 0x8,0x15,0x2,0x53,0x10,0x6,0x0,0x0
.long 0x895000,0x5000,0x500,0x3a2300,0x729600,0x51e0,0xd65400,0x420c0
.long 0x8,0x30,0x1,0x67,0x14,0x6,0x8,0x0
.long 0x895000,0x5000,0xc00,0x443300,0x733600,0x65e0,0xd6c000,0x421c0
.long 0xc,0x15,0x2,0x7b,0x18,0x6,0x2,0x0
.long 0x895000,0x7800,0x500,0x4e4300,0x73d600,0x79e0,0xf15400,0x430c0
.long 0xc,0x30,0x1,0x8f,0x1c,0x6,0x0,0x0
.long 0x895000,0x7800,0xc00,0x585300,0x10000000,0x8de0,0xf1c000,0x431c0
.long 0x0,0x18,0x1,0x4,0x0,0x7,0x7,0x0
.long 0x8d8800,0x0,0x600,0x123380,0x701700,0x230,0xa06000,0x400e0
.long 0x0,0x33,0x2,0x18,0x4,0x7,0x5,0x0
.long 0x8d8800,0x0,0xc80,0x1c4380,0x70b700,0x1630,0xa0cc00,0x401e0
.long 0x4,0x18,0x1,0x2c,0x8,0x7,0x9,0x0
.long 0x8d8800,0x2800,0x600,0x265380,0x715700,0x2a30,0xbb6000,0x410e0
.long 0x4,0x33,0x2,0x40,0xc,0x7,0x7,0x0
.long 0x8d8800,0x2800,0xc80,0x306380,0x71f700,0x3e30,0xbbcc00,0x411e0
.long 0x8,0x18,0x1,0x54,0x10,0x7,0x1,0x0
.long 0x8d8800,0x5000,0x600,0x3a7380,0x729700,0x5230,0xd66000,0x420e0
.long 0x8,0x33,0x2,0x68,0x14,0x7,0x9,0x0
.long 0x8d8800,0x5000,0xc80,0x448380,0x733700,0x6630,0xd6cc00,0x421e0
.long 0xc,0x18,0x1,0x7c,0x18,0x7,0x3,0x0
.long 0x8d8800,0x7800,0x600,0x4e9380,0x73d700,0x7a30,0xf16000,0x430e0
.long 0xc,0x33,0x2,0x90,0x1c,0x7,0x1,0x0
.long 0x8d8800,0x7800,0xc80,0x58a380,0x10000000,0x8e30,0xf1cc00,0x431e0
.long 0x1,0x0,0x0,0x0,0x1,0x0,0x3,0x0
.long 0x700000,0xa00,0x0,0x128400,0x702800,0x500,0xa6c000,0x40400
.long 0x1,0x1e,0x0,0x0,0x5,0x0,0x1,0x0
.long 0x700000,0xa00,0x780,0x1c9400,0x70c800,0x1900,0xa73800,0x40500
.long 0x5,0x0,0x0,0x0,0x9,0x0,0x5,0x0
.long 0x700000,0x3200,0x0,0x26a400,0x716800,0x2d00,0xc1c000,0x41400
.long 0x5,0x1e,0x0,0x0,0xd,0x0,0x3,0x0
.long 0x700000,0x3200,0x780,0x30b400,0x720800,0x4100,0xc23800,0x41500
.long 0x9,0x0,0x0,0x0,0x11,0x0,0x7,0x0
.long 0x700000,0x5a00,0x0,0x3ac400,0x72a800,0x5500,0xdcc000,0x42400
.long 0x9,0x1e,0x0,0x0,0x15,0x0,0x5,0x0
.long 0x700000,0x5a00,0x780,0x44d400,0x734800,0x6900,0xdd3800,0x42500
.long 0xd,0x0,0x0,0x0,0x19,0x0,0x9,0x0
.long 0x700000,0x8200,0x0,0x4ee400,0x73e800,0x7d00,0xf7c000,0x43400
.long 0xd,0x1e,0x0,0x0,0x1d,0x0,0x7,0x0
.long 0x700000,0x8200,0x780,0x58f400,0x10000000,0x9100,0xf83800,0x43500
.long 0x1,0x4,0x0,0x0,0x1,0x1,0x4,0x0
.long 0x743800,0xa00,0x100,0x12d480,0x702900,0x550,0xa6d000,0x40420
.long 0x1,0x22,0x0,0x0,0x5,0x1,0x2,0x0
.long 0x743800,0xa00,0x880,0x1ce480,0x70c900,0x1950,0xa74800,0x40520
.long 0x5,0x4,0x0,0x0,0x9,0x1,0x6,0x0
.long 0x743800,0x3200,0x100,0x26f480,0x716900,0x2d50,0xc1d000,0x41420
.long 0x5,0x22,0x0,0x0,0xd,0x1,0x4,0x0
.long 0x743800,0x3200,0x880,0x310480,0x720900,0x4150,0xc24800,0x41520
.long 0x9,0x4,0x0,0x0,0x11,0x1,0x8,0x0
.long 0x743800,0x5a00,0x100,0x3b1480,0x72a900,0x5550,0xdcd000,0x42420
.long 0x9,0x22,0x0,0x0,0x15,0x1,0x6,0x0
.long 0x743800,0x5a00,0x880,0x452480,0x734900,0x6950,0xdd4800,0x42520
.long 0xd,0x4,0x0,0x0,0x19,0x1,0x0,0x0
.long 0x743800,0x8200,0x100,0x4f3480,0x73e900,0x7d50,0xf7d000,0x43420
.long 0xd,0x22,0x0,0x0,0x1d,0x1,0x8,0x0
.long 0x743800,0x8200,0x880,0x594480,0x10000000,0x9150,0xf84800,0x43520
.long 0x1,0x8,0x0,0x0,0x1,0x2,0x5,0x0
.long 0x787000,0xa00,0x200,0x132500,0x702a00,0x5a0,0xa6e000,0x40440
.long 0x1,0x26,0x0,0x0,0x5,0x2,0x3,0x0
.long 0x787000,0xa00,0x980,0x1d3500,0x70ca00,0x19a0,0xa75800,0x40540
.long 0x5,0x8,0x0,0x0,0x9,0x2,0x7,0x0
.long 0x787000,0x3200,0x200,0x274500,0x716a00,0x2da0,0xc1e000,0x41440
.long 0x5,0x26,0x0,0x0,0xd,0x2,0x5,0x0
.long 0x787000,0x3200,0x980,0x315500,0x720a00,0x41a0,0xc25800,0x41540
.long 0x9,0x8,0x0,0x0,0x11,0x2,0x9,0x0
.long 0x787000,0x5a00,0x200,0x3b6500,0x72aa00,0x55a0,0xdce000,0x42440
.long 0x9,0x26,0x0,0x0,0x15,0x2,0x7,0x0
.long 0x787000,0x5a00,0x980,0x457500,0x734a00,0x69a0,0xdd5800,0x42540
.long 0xd,0x8,0x0,0x0,0x19,0x2,0x1,0x0
.long 0x787000,0x8200,0x200,0x4f8500,0x73ea00,0x7da0,0xf7e000,0x43440
.long 0xd,0x26,0x0,0x0,0x1d,0x2,0x9,0x0
.long 0x787000,0x8200,0x980,0x599500,0x10000000,0x91a0,0xf85800,0x43540
.long 0x1,0xc,0x1,0x5,0x1,0x3,0x6,0x0
.long 0x7ca800,0xa00,0x300,0x137580,0x702b00,0x5f0,0xa6f000,0x40460
.long 0x1,0x1b,0x2,0x19,0x5,0x3,0x4,0x0
.long 0x7ca800,0xa00,0x680,0x1d8580,0x70cb00,0x19f0,0xa72c00,0x40560
.long 0x5,0xc,0x1,0x2d,0x9,0x3,0x8,0x0
.long 0x7ca800,0x3200,0x300,0x279580,0x716b00,0x2df0,0xc1f000,0x41460
.long 0x5,0x1b,0x2,0x41,0xd,0x3,0x6,0x0
.long 0x7ca800,0x3200,0x680,0x31a580,0x720b00,0x41f0,0xc22c00,0x41560
.long 0x9,0xc,0x1,0x55,0x11,0x3,0x0,0x0
.long 0x7ca800,0x5a00,0x300,0x3bb580,0x72ab00,0x55f0,0xdcf000,0x42460
.long 0x9,0x1b,0x2,0x69,0x15,0x3,0x8,0x0
.long 0x7ca800,0x5a00,0x680,0x45c580,0x734b00,0x69f0,0xdd2c00,0x42560
.long 0xd,0xc,0x1,0x7d,0x19,0x3,0x2,0x0
.long 0x7ca800,0x8200,0x300,0x4fd580,0x73eb00,0x7df0,0xf7f000,0x43460
.long 0xd,0x1b,0x2,0x91,0x1d,0x3,0x0,0x0
.long 0x7ca800,0x8200,0x680,0x59e580,0x10000000,0x91f0,0xf82c00,0x43560
.long 0x1,0xf,0x2,0x6,0x1,0x4,0x7,0x0
.long 0x80e000,0xa00,0x380,0x13c600,0x703c00,0x640,0xa6fc00,0x40480
.long 0x1,0x2a,0x1,0x1a,0x5,0x4,0x5,0x0
.long 0x80e000,0xa00,0xa80,0x1dd600,0x70dc00,0x1a40,0xa76800,0x40580
.long 0x5,0xf,0x2,0x2e,0x9,0x4,0x9,0x0
.long 0x80e000,0x3200,0x380,0x27e600,0x717c00,0x2e40,0xc1fc00,0x41480
.long 0x5,0x2a,0x1,0x42,0xd,0x4,0x7,0x0
.long 0x80e000,0x3200,0xa80,0x31f600,0x721c00,0x4240,0xc26800,0x41580
.long 0x9,0xf,0x2,0x56,0x11,0x4,0x1,0x0
.long 0x80e000,0x5a00,0x380,0x3c0600,0x72bc00,0x5640,0xdcfc00,0x42480
.long 0x9,0x2a,0x1,0x6a,0x15,0x4,0x9,0x0
.long 0x80e000,0x5a00,0xa80,0x461600,0x735c00,0x6a40,0xdd6800,0x42580
.long 0xd,0xf,0x2,0x7e,0x19,0x4,0x3,0x0
.long 0x80e000,0x8200,0x380,0x502600,0x73fc00,0x7e40,0xf7fc00,0x43480
.long 0xd,0x2a,0x1,0x92,0x1d,0x4,0x1,0x0
.long 0x80e000,0x8200,0xa80,0x5a3600,0x10000000,0x9240,0xf86800,0x43580
.long 0x1,0x12,0x1,0x7,0x1,0x5,0x8,0x0
.long 0x851800,0xa00,0x480,0x141680,0x703d00,0x690,0xa70800,0x404a0
.long 0x1,0x2d,0x2,0x1b,0x5,0x5,0x6,0x0
.long 0x851800,0xa00,0xb00,0x1e2680,0x70dd00,0x1a90,0xa77400,0x405a0
.long 0x5,0x12,0x1,0x2f,0x9,0x5,0x0,0x0
.long 0x851800,0x3200,0x480,0x283680,0x717d00,0x2e90,0xc20800,0x414a0
.long 0x5,0x2d,0x2,0x43,0xd,0x5,0x8,0x0
.long 0x851800,0x3200,0xb00,0x324680,0x721d00,0x4290,0xc27400,0x415a0
.long 0x9,0x12,0x1,0x57,0x11,0x5,0x2,0x0
.long 0x851800,0x5a00,0x480,0x3c5680,0x72bd00,0x5690,0xdd0800,0x424a0
.long 0x9,0x2d,0x2,0x6b,0x15,0x5,0x0,0x0
.long 0x851800,0x5a00,0xb00,0x466680,0x735d00,0x6a90,0xdd7400,0x425a0
.long 0xd,0x12,0x1,0x7f,0x19,0x5,0x4,0x0
.long 0x851800,0x8200,0x480,0x507680,0x73fd00,0x7e90,0xf80800,0x434a0
.long 0xd,0x2d,0x2,0x93,0x1d,0x5,0x2,0x0
.long 0x851800,0x8200,0xb00,0x5a8680,0x10000000,0x9290,0xf87400,0x435a0
.long 0x1,0x15,0x2,0x8,0x1,0x6,0x9,0x0
.long 0x895000,0xa00,0x500,0x146700,0x703e00,0x6e0,0xa71400,0x404c0
.long 0x1,0x30,0x1,0x1c,0x5,0x6,0x7,0x0
.long 0x895000,0xa00,0xc00,0x1e7700,0x70de00,0x1ae0,0xa78000,0x405c0
.long 0x5,0x15,0x2,0x30,0x9,0x6,0x1,0x0
.long 0x895000,0x3200,0x500,0x288700,0x717e00,0x2ee0,0xc21400,0x414c0
.long 0x5,0x30,0x1,0x44,0xd,0x6,0x9,0x0
.long 0x895000,0x3200,0xc00,0x329700,0x721e00,0x42e0,0xc28000,0x415c0
.long 0x9,0x15,0x2,0x58,0x11,0x6,0x3,0x0
.long 0x895000,0x5a00,0x500,0x3ca700,0x72be00,0x56e0,0xdd1400,0x424c0
.long 0x9,0x30,0x1,0x6c,0x15,0x6,0x1,0x0
.long 0x895000,0x5a00,0xc00,0x46b700,0x735e00,0x6ae0,0xdd8000,0x425c0
.long 0xd,0x15,0x2,0x80,0x19,0x6,0x5,0x0
.long 0x895000,0x8200,0x500,0x50c700,0x73fe00,0x7ee0,0xf81400,0x434c0
.long 0xd,0x30,0x1,0x94,0x1d,0x6,0x3,0x0
.long 0x895000,0x8200,0xc00,0x5ad700,0x10000000,0x92e0,0xf88000,0x435c0
.long 0x1,0x18,0x1,0x9,0x1,0x7,0x0,0x0
.long 0x8d8800,0xa00,0x600,0x14b780,0x703f00,0x730,0xa72000,0x404e0
.long 0x1,0x33,0x2,0x1d,0x5,0x7,0x8,0x0
.long 0x8d8800,0xa00,0xc80,0x1ec780,0x70df00,0x1b30,0xa78c00,0x405e0
.long 0x5,0x18,0x1,0x31,0x9,0x7,0x2,0x0
.long 0x8d8800,0x3200,0x600,0x28d780,0x717f00,0x2f30,0xc22000,0x414e0
.long 0x5,0x33,0x2,0x45,0xd,0x7,0x0,0x0
.long 0x8d8800,0x3200,0xc80,0x32e780,0x721f00,0x4330,0xc28c00,0x415e0
.long 0x9,0x18,0x1,0x59,0x11,0x7,0x4,0x0
.long 0x8d8800,0x5a00,0x600,0x3cf780,0x72bf00,0x5730,0xdd2000,0x424e0
.long 0x9,0x33,0x2,0x6d,0x15,0x7,0x2,0x0
.long 0x8d8800,0x5a00,0xc80,0x470780,0x735f00,0x6b30,0xdd8c00,0x425e0
.long 0xd,0x18,0x1,0x81,0x19,0x7,0x6,0x0
.long 0x8d8800,0x8200,0x600,0x511780,0x73ff00,0x7f30,0xf82000,0x434e0
.long 0xd,0x33,0x2,0x95,0x1d,0x7,0x4,0x0
.long 0x8d8800,0x8200,0xc80,0x5b2780,0x10000000,0x9330,0xf88c00,0x435e0
.long 0x2,0x0,0x0,0x0,0x2,0x0,0x6,0x0
.long 0x700000,0x1400,0x0,0x150800,0x705000,0xa00,0xad8000,0x40800
.long 0x2,0x1e,0x0,0x0,0x6,0x0,0x4,0x0
.long 0x700000,0x1400,0x780,0x1f1800,0x70f000,0x1e00,0xadf800,0x40900
.long 0x6,0x0,0x0,0x0,0xa,0x0,0x8,0x0
.long 0x700000,0x3c00,0x0,0x292800,0x719000,0x3200,0xc88000,0x41800
.long 0x6,0x1e,0x0,0x0,0xe,0x0,0x6,0x0
.long 0x700000,0x3c00,0x780,0x333800,0x723000,0x4600,0xc8f800,0x41900
.long 0xa,0x0,0x0,0x0,0x12,0x0,0x0,0x0
.long 0x700000,0x6400,0x0,0x3d4800,0x72d000,0x5a00,0xe38000,0x42800
.long 0xa,0x1e,0x0,0x0,0x16,0x0,0x8,0x0
.long 0x700000,0x6400,0x780,0x475800,0x737000,0x6e00,0xe3f800,0x42900
.long 0xe,0x0,0x0,0x0,0x1a,0x0,0x2,0x0
.long 0x700000,0x8c00,0x0,0x516800,0x741000,0x8200,0xfe8000,0x43800
.long 0xe,0x1e,0x0,0x0,0x1e,0x0,0x0,0x0
.long 0x700000,0x8c00,0x780,0x5b7800,0x10000000,0x9600,0xfef800,0x43900
.long 0x2,0x4,0x0,0x0,0x2,0x1,0x7,0x0
.long 0x743800,0x1400,0x100,0x155880,0x705100,0xa50,0xad9000,0x40820
.long 0x2,0x22,0x0,0x0,0x6,0x1,0x5,0x0
.long 0x743800,0x1400,0x880,0x1f6880,0x70f100,0x1e50,0xae0800,0x40920
.long 0x6,0x4,0x0,0x0,0xa,0x1,0x9,0x0
.long 0x743800,0x3c00,0x100,0x297880,0x719100,0x3250,0xc89000,0x41820
.long 0x6,0x22,0x0,0x0,0xe,0x1,0x7,0x0
.long 0x743800,0x3c00,0x880,0x338880,0x723100,0x4650,0xc90800,0x41920
.long 0xa,0x4,0x0,0x0,0x12,0x1,0x1,0x0
.long 0x743800,0x6400,0x100,0x3d9880,0x72d100,0x5a50,0xe39000,0x42820
.long 0xa,0x22,0x0,0x0,0x16,0x1,0x9,0x0
.long 0x743800,0x6400,0x880,0x47a880,0x737100,0x6e50,0xe40800,0x42920
.long 0xe,0x4,0x0,0x0,0x1a,0x1,0x3,0x0
.long 0x743800,0x8c00,0x100,0x51b880,0x741100,0x8250,0xfe9000,0x43820
.long 0xe,0x22,0x0,0x0,0x1e,0x1,0x1,0x0
.long 0x743800,0x8c00,0x880,0x5bc880,0x10000000,0x9650,0xff0800,0x43920
.long 0x2,0x8,0x0,0x0,0x2,0x2,0x8,0x0
.long 0x787000,0x1400,0x200,0x15a900,0x705200,0xaa0,0xada000,0x40840
.long 0x2,0x26,0x0,0x0,0x6,0x2,0x6,0x0
.long 0x787000,0x1400,0x980,0x1fb900,0x70f200,0x1ea0,0xae1800,0x40940
.long 0x6,0x8,0x0,0x0,0xa,0x2,0x0,0x0
.long 0x787000,0x3c00,0x200,0x29c900,0x719200,0x32a0,0xc8a000,0x41840
.long 0x6,0x26,0x0,0x0,0xe,0x2,0x8,0x0
.long 0x787000,0x3c00,0x980,0x33d900,0x723200,0x46a0,0xc91800,0x41940
.long 0xa,0x8,0x0,0x0,0x12,0x2,0x2,0x0
.long 0x787000,0x6400,0x200,0x3de900,0x72d200,0x5aa0,0xe3a000,0x42840
.long 0xa,0x26,0x0,0x0,0x16,0x2,0x0,0x0
.long 0x787000,0x6400,0x980,0x47f900,0x737200,0x6ea0,0xe41800,0x42940
.long 0xe,0x8,0x0,0x0,0x1a,0x2,0x4,0x0
.long 0x787000,0x8c00,0x200,0x520900,0x741200,0x82a0,0xfea000,0x43840
.long 0xe,0x26,0x0,0x0,0x1e,0x2,0x2,0x0
.long 0x787000,0x8c00,0x980,0x5c1900,0x10000000,0x96a0,0xff1800,0x43940
.long 0x2,0xc,0x1,0xa,0x2,0x3,0x9,0x0
.long 0x7ca800,0x1400,0x300,0x15f980,0x705300,0xaf0,0xadb000,0x40860
.long 0x2,0x1b,0x2,0x1e,0x6,0x3,0x7,0x0
.long 0x7ca800,0x1400,0x680,0x200980,0x70f300,0x1ef0,0xadec00,0x40960
.long 0x6,0xc,0x1,0x32,0xa,0x3,0x1,0x0
.long 0x7ca800,0x3c00,0x300,0x2a1980,0x719300,0x32f0,0xc8b000,0x41860
.long 0x6,0x1b,0x2,0x46,0xe,0x3,0x9,0x0
.long 0x7ca800,0x3c00,0x680,0x342980,0x723300,0x46f0,0xc8ec00,0x41960
.long 0xa,0xc,0x1,0x5a,0x12,0x3,0x3,0x0
.long 0x7ca800,0x6400,0x300,0x3e3980,0x72d300,0x5af0,0xe3b000,0x42860
.long 0xa,0x1b,0x2,0x6e,0x16,0x3,0x1,0x0
.long 0x7ca800,0x6400,0x680,0x484980,0x737300,0x6ef0,0xe3ec00,0x42960
.long 0xe,0xc,0x1,0x82,0x1a,0x3,0x5,0x0
.long 0x7ca800,0x8c00,0x300,0x525980,0x741300,0x82f0,0xfeb000,0x43860
.long 0xe,0x1b,0x2,0x96,0x1e,0x3,0x3,0x0
.long 0x7ca800,0x8c00,0x680,0x5c6980,0x10000000,0x96f0,0xfeec00,0x43960
.long 0x2,0xf,0x2,0xb,0x2,0x4,0x0,0x0
.long 0x80e000,0x1400,0x380,0x164a00,0x706400,0xb40,0xadbc00,0x40880
.long 0x2,0x2a,0x1,0x1f,0x6,0x4,0x8,0x0
.long 0x80e000,0x1400,0xa80,0x205a00,0x710400,0x1f40,0xae2800,0x40980
.long 0x6,0xf,0x2,0x33,0xa,0x4,0x2,0x0
.long 0x80e000,0x3c00,0x380,0x2a6a00,0x71a400,0x3340,0xc8bc00,0x41880
.long 0x6,0x2a,0x1,0x47,0xe,0x4,0x0,0x0
.long 0x80e000,0x3c00,0xa80,0x347a00,0x724400,0x4740,0xc92800,0x41980
.long 0xa,0xf,0x2,0x5b,0x12,0x4,0x4,0x0
.long 0x80e000,0x6400,0x380,0x3e8a00,0x72e400,0x5b40,0xe3bc00,0x42880
.long 0xa,0x2a,0x1,0x6f,0x16,0x4,0x2,0x0
.long 0x80e000,0x6400,0xa80,0x489a00,0x738400,0x6f40,0xe42800,0x42980
.long 0xe,0xf,0x2,0x83,0x1a,0x4,0x6,0x0
.long 0x80e000,0x8c00,0x380,0x52aa00,0x742400,0x8340,0xfebc00,0x43880
.long 0xe,0x2a,0x1,0x97,0x1e,0x4,0x4,0x0
.long 0x80e000,0x8c00,0xa80,0x5cba00,0x10000000,0x9740,0xff2800,0x43980
.long 0x2,0x12,0x1,0xc,0x2,0x5,0x1,0x0
.long 0x851800,0x1400,0x480,0x169a80,0x706500,0xb90,0xadc800,0x408a0
.long 0x2,0x2d,0x2,0x20,0x6,0x5,0x9,0x0
.long 0x851800,0x1400,0xb00,0x20aa80,0x710500,0x1f90,0xae3400,0x409a0
.long 0x6,0x12,0x1,0x34,0xa,0x5,0x3,0x0
.long 0x851800,0x3c00,0x480,0x2aba80,0x71a500,0x3390,0xc8c800,0x418a0
.long 0x6,0x2d,0x2,0x48,0xe,0x5,0x1,0x0
.long 0x851800,0x3c00,0xb00,0x34ca80,0x724500,0x4790,0xc93400,0x419a0
.long 0xa,0x12,0x1,0x5c,0x12,0x5,0x5,0x0
.long 0x851800,0x6400,0x480,0x3eda80,0x72e500,0x5b90,0xe3c800,0x428a0
.long 0xa,0x2d,0x2,0x70,0x16,0x5,0x3,0x0
.long 0x851800,0x6400,0xb00,0x48ea80,0x738500,0x6f90,0xe43400,0x429a0
.long 0xe,0x12,0x1,0x84,0x1a,0x5,0x7,0x0
.long 0x851800,0x8c00,0x480,0x52fa80,0x742500,0x8390,0xfec800,0x438a0
.long 0xe,0x2d,0x2,0x98,0x1e,0x5,0x5,0x0
.long 0x851800,0x8c00,0xb00,0x5d0a80,0x10000000,0x9790,0xff3400,0x439a0
.long 0x2,0x15,0x2,0xd,0x2,0x6,0x2,0x0
.long 0x895000,0x1400,0x500,0x16eb00,0x706600,0xbe0,0xadd400,0x408c0
.long 0x2,0x30,0x1,0x21,0x6,0x6,0x0,0x0
.long 0x895000,0x1400,0xc00,0x20fb00,0x710600,0x1fe0,0xae4000,0x409c0
.long 0x6,0x15,0x2,0x35,0xa,0x6,0x4,0x0
.long 0x895000,0x3c00,0x500,0x2b0b00,0x71a600,0x33e0,0xc8d400,0x418c0
.long 0x6,0x30,0x1,0x49,0xe,0x6,0x2,0x0
.long 0x895000,0x3c00,0xc00,0x351b00,0x724600,0x47e0,0xc94000,0x419c0
.long 0xa,0x15,0x2,0x5d,0x12,0x6,0x6,0x0
.long 0x895000,0x6400,0x500,0x3f2b00,0x72e600,0x5be0,0xe3d400,0x428c0
.long 0xa,0x30,0x1,0x71,0x16,0x6,0x4,0x0
.long 0x895000,0x6400,0xc00,0x493b00,0x738600,0x6fe0,0xe44000,0x429c0
.long 0xe,0x15,0x2,0x85,0x1a,0x6,0x8,0x0
.long 0x895000,0x8c00,0x500,0x534b00,0x742600,0x83e0,0xfed400,0x438c0
.long 0xe,0x30,0x1,0x99,0x1e,0x6,0x6,0x0
.long 0x895000,0x8c00,0xc00,0x5d5b00,0x10000000,0x97e0,0xff4000,0x439c0
.long 0x2,0x18,0x1,0xe,0x2,0x7,0x3,0x0
.long 0x8d8800,0x1400,0x600,0x173b80,0x706700,0xc30,0xade000,0x408e0
.long 0x2,0x33,0x2,0x22,0x6,0x7,0x1,0x0
.long 0x8d8800,0x1400,0xc80,0x214b80,0x710700,0x2030,0xae4c00,0x409e0
.long 0x6,0x18,0x1,0x36,0xa,0x7,0x5,0x0
.long 0x8d8800,0x3c00,0x600,0x2b5b80,0x71a700,0x3430,0xc8e000,0x418e0
.long 0x6,0x33,0x2,0x4a,0xe,0x7,0x3,0x0
.long 0x8d8800,0x3c00,0xc80,0x356b80,0x724700,0x4830,0xc94c00,0x419e0
.long 0xa,0x18,0x1,0x5e,0x12,0x7,0x7,0x0
.long 0x8d8800,0x6400,0x600,0x3f7b80,0x72e700,0x5c30,0xe3e000,0x428e0
.long 0xa,0x33,0x2,0x72,0x16,0x7,0x5,0x0
.long 0x8d8800,0x6400,0xc80,0x498b80,0x738700,0x7030,0xe44c00,0x429e0
.long 0xe,0x18,0x1,0x86,0x1a,0x7,0x9,0x0
.long 0x8d8800,0x8c00,0x600,0x539b80,0x742700,0x8430,0xfee000,0x438e0
.long 0xe,0x33,0x2,0x9a,0x1e,0x7,0x7,0x0
.long 0x8d8800,0x8c00,0xc80,0x5dab80,0x10000000,0x9830,0xff4c00,0x439e0
.long 0x3,0x0,0x0,0x0,0x3,0x0,0x9,0x0
.long 0x700000,0x1e00,0x0,0x178c00,0x707800,0xf00,0xb44000,0x40c00
.long 0x3,0x1e,0x0,0x0,0x7,0x0,0x7,0x0
.long 0x700000,0x1e00,0x780,0x219c00,0x711800,0x2300,0xb4b800,0x40d00
.long 0x7,0x0,0x0,0x0,0xb,0x0,0x1,0x0
.long 0x700000,0x4600,0x0,0x2bac00,0x71b800,0x3700,0xcf4000,0x41c00
.long 0x7,0x1e,0x0,0x0,0xf,0x0,0x9,0x0
.long 0x700000,0x4600,0x780,0x35bc00,0x725800,0x4b00,0xcfb800,0x41d00
.long 0xb,0x0,0x0,0x0,0x13,0x0,0x3,0x0
.long 0x700000,0x6e00,0x0,0x3fcc00,0x72f800,0x5f00,0xea4000,0x42c00
.long 0xb,0x1e,0x0,0x0,0x17,0x0,0x1,0x0
.long 0x700000,0x6e00,0x780,0x49dc00,0x739800,0x7300,0xeab800,0x42d00
.long 0xf,0x0,0x0,0x0,0x1b,0x0,0x5,0x0
.long 0x700000,0x9600,0x0,0x53ec00,0x10000000,0x8700,0x1054000,0x43c00
.long 0xf,0x1e,0x0,0x0,0x1f,0x0,0x3,0x0
.long 0x700000,0x9600,0x780,0x5dfc00,0x10000000,0x9b00,0x105b800,0x43d00
.long 0x3,0x4,0x0,0x0,0x3,0x1,0x0,0x0
.long 0x743800,0x1e00,0x100,0x17dc80,0x707900,0xf50,0xb45000,0x40c20
.long 0x3,0x22,0x0,0x0,0x7,0x1,0x8,0x0
.long 0x743800,0x1e00,0x880,0x21ec80,0x711900,0x2350,0xb4c800,0x40d20
.long 0x7,0x4,0x0,0x0,0xb,0x1,0x2,0x0
.long 0x743800,0x4600,0x100,0x2bfc80,0x71b900,0x3750,0xcf5000,0x41c20
.long 0x7,0x22,0x0,0x0,0xf,0x1,0x0,0x0
.long 0x743800,0x4600,0x880,0x360c80,0x725900,0x4b50,0xcfc800,0x41d20
.long 0xb,0x4,0x0,0x0,0x13,0x1,0x4,0x0
.long 0x743800,0x6e00,0x100,0x401c80,0x72f900,0x5f50,0xea5000,0x42c20
.long 0xb,0x22,0x0,0x0,0x17,0x1,0x2,0x0
.long 0x743800,0x6e00,0x880,0x4a2c80,0x739900,0x7350,0xeac800,0x42d20
.long 0xf,0x4,0x0,0x0,0x1b,0x1,0x6,0x0
.long 0x743800,0x9600,0x100,0x543c80,0x10000000,0x8750,0x1055000,0x43c20
.long 0xf,0x22,0x0,0x0,0x1f,0x1,0x4,0x0
.long 0x743800,0x9600,0x880,0x5e4c80,0x10000000,0x9b50,0x105c800,0x43d20
.long 0x3,0x8,0x0,0x0,0x3,0x2,0x1,0x0
.long 0x787000,0x1e00,0x200,0x182d00,0x707a00,0xfa0,0xb46000,0x40c40
.long 0x3,0x26,0x0,0x0,0x7,0x2,0x9,0x0
.long 0x787000,0x1e00,0x980,0x223d00,0x711a00,0x23a0,0xb4d800,0x40d40
.long 0x7,0x8,0x0,0x0,0xb,0x2,0x3,0x0
.long 0x787000,0x4600,0x200,0x2c4d00,0x71ba00,0x37a0,0xcf6000,0x41c40
.long 0x7,0x26,0x0,0x0,0xf,0x2,0x1,0x0
.long 0x787000,0x4600,0x980,0x365d00,0x725a00,0x4ba0,0xcfd800,0x41d40
.long 0xb,0x8,0x0,0x0,0x13,0x2,0x5,0x0
.long 0x787000,0x6e00,0x200,0x406d00,0x72fa00,0x5fa0,0xea6000,0x42c40
.long 0xb,0x26,0x0,0x0,0x17,0x2,0x3,0x0
.long 0x787000,0x6e00,0x980,0x4a7d00,0x739a00,0x73a0,0xead800,0x42d40
.long 0xf,0x8,0x0,0x0,0x1b,0x2,0x7,0x0
.long 0x787000,0x9600,0x200,0x548d00,0x10000000,0x87a0,0x1056000,0x43c40
.long 0xf,0x26,0x0,0x0,0x1f,0x2,0x5,0x0
.long 0x787000,0x9600,0x980,0x5e9d00,0x10000000,0x9ba0,0x105d800,0x43d40
.long 0x3,0xc,0x1,0xf,0x3,0x3,0x2,0x0
.long 0x7ca800,0x1e00,0x300,0x187d80,0x707b00,0xff0,0xb47000,0x40c60
.long 0x3,0x1b,0x2,0x23,0x7,0x3,0x0,0x0
.long 0x7ca800,0x1e00,0x680,0x228d80,0x711b00,0x23f0,0xb4ac00,0x40d60
.long 0x7,0xc,0x1,0x37,0xb,0x3,0x4,0x0
.long 0x7ca800,0x4600,0x300,0x2c9d80,0x71bb00,0x37f0,0xcf7000,0x41c60
.long 0x7,0x1b,0x2,0x4b,0xf,0x3,0x2,0x0
.long 0x7ca800,0x4600,0x680,0x36ad80,0x725b00,0x4bf0,0xcfac00,0x41d60
.long 0xb,0xc,0x1,0x5f,0x13,0x3,0x6,0x0
.long 0x7ca800,0x6e00,0x300,0x40bd80,0x72fb00,0x5ff0,0xea7000,0x42c60
.long 0xb,0x1b,0x2,0x73,0x17,0x3,0x4,0x0
.long 0x7ca800,0x6e00,0x680,0x4acd80,0x739b00,0x73f0,0xeaac00,0x42d60
.long 0xf,0xc,0x1,0x87,0x1b,0x3,0x8,0x0
.long 0x7ca800,0x9600,0x300,0x54dd80,0x10000000,0x87f0,0x1057000,0x43c60
.long 0xf,0x1b,0x2,0x9b,0x1f,0x3,0x6,0x0
.long 0x7ca800,0x9600,0x680,0x5eed80,0x10000000,0x9bf0,0x105ac00,0x43d60
.long 0x3,0xf,0x2,0x10,0x3,0x4,0x3,0x0
.long 0x80e000,0x1e00,0x380,0x18ce00,0x708c00,0x1040,0xb47c00,0x40c80
.long 0x3,0x2a,0x1,0x24,0x7,0x4,0x1,0x0
.long 0x80e000,0x1e00,0xa80,0x22de00,0x712c00,0x2440,0xb4e800,0x40d80
.long 0x7,0xf,0x2,0x38,0xb,0x4,0x5,0x0
.long 0x80e000,0x4600,0x380,0x2cee00,0x71cc00,0x3840,0xcf7c00,0x41c80
.long 0x7,0x2a,0x1,0x4c,0xf,0x4,0x3,0x0
.long 0x80e000,0x4600,0xa80,0x36fe00,0x726c00,0x4c40,0xcfe800,0x41d80
.long 0xb,0xf,0x2,0x60,0x13,0x4,0x7,0x0
.long 0x80e000,0x6e00,0x380,0x410e00,0x730c00,0x6040,0xea7c00,0x42c80
.long 0xb,0x2a,0x1,0x74,0x17,0x4,0x5,0x0
.long 0x80e000,0x6e00,0xa80,0x4b1e00,0x73ac00,0x7440,0xeae800,0x42d80
.long 0xf,0xf,0x2,0x88,0x1b,0x4,0x9,0x0
.long 0x80e000,0x9600,0x380,0x552e00,0x10000000,0x8840,0x1057c00,0x43c80
.long 0xf,0x2a,0x1,0x9c,0x1f,0x4,0x7,0x0
.long 0x80e000,0x9600,0xa80,0x5f3e00,0x10000000,0x9c40,0x105e800,0x43d80
.long 0x3,0x12,0x1,0x11,0x3,0x5,0x4,0x0
.long 0x851800,0x1e00,0x480,0x191e80,0x708d00,0x1090,0xb48800,0x40ca0
.long 0x3,0x2d,0x2,0x25,0x7,0x5,0x2,0x0
.long 0x851800,0x1e00,0xb00,0x232e80,0x712d00,0x2490,0xb4f400,0x40da0
.long 0x7,0x12,0x1,0x39,0xb,0x5,0x6,0x0
.long 0x851800,0x4600,0x480,0x2d3e80,0x71cd00,0x3890,0xcf8800,0x41ca0
.long 0x7,0x2d,0x2,0x4d,0xf,0x5,0x4,0x0
.long 0x851800,0x4600,0xb00,0x374e80,0x726d00,0x4c90,0xcff400,0x41da0
.long 0xb,0x12,0x1,0x61,0x13,0x5,0x8,0x0
.long 0x851800,0x6e00,0x480,0x415e80,0x730d00,0x6090,0xea8800,0x42ca0
.long 0xb,0x2d,0x2,0x75,0x17,0x5,0x6,0x0
.long 0x851800,0x6e00,0xb00,0x4b6e80,0x73ad00,0x7490,0xeaf400,0x42da0
.long 0xf,0x12,0x1,0x89,0x1b,0x5,0x0,0x0
.long 0x851800,0x9600,0x480,0x557e80,0x10000000,0x8890,0x1058800,0x43ca0
.long 0xf,0x2d,0x2,0x9d,0x1f,0x5,0x8,0x0
.long 0x851800,0x9600,0xb00,0x5f8e80,0x10000000,0x9c90,0x105f400,0x43da0
.long 0x3,0x15,0x2,0x12,0x3,0x6,0x5,0x0
.long 0x895000,0x1e00,0x500,0x196f00,0x708e00,0x10e0,0xb49400,0x40cc0
.long 0x3,0x30,0x1,0x26,0x7,0x6,0x3,0x0
.long 0x895000,0x1e00,0xc00,0x237f00,0x712e00,0x24e0,0xb50000,0x40dc0
.long 0x7,0x15,0x2,0x3a,0xb,0x6,0x7,0x0
.long 0x895000,0x4600,0x500,0x2d8f00,0x71ce00,0x38e0,0xcf9400,0x41cc0
.long 0x7,0x30,0x1,0x4e,0xf,0x6,0x5,0x0
.long 0x895000,0x4600,0xc00,0x379f00,0x726e00,0x4ce0,0xd00000,0x41dc0
.long 0xb,0x15,0x2,0x62,0x13,0x6,0x9,0x0
.long 0x895000,0x6e00,0x500,0x41af00,0x730e00,0x60e0,0xea9400,0x42cc0
.long 0xb,0x30,0x1,0x76,0x17,0x6,0x7,0x0
.long 0x895000,0x6e00,0xc00,0x4bbf00,0x73ae00,0x74e0,0xeb0000,0x42dc0
.long 0xf,0x15,0x2,0x8a,0x1b,0x6,0x1,0x0
.long 0x895000,0x9600,0x500,0x55cf00,0x10000000,0x88e0,0x1059400,0x43cc0
.long 0xf,0x30,0x1,0x9e,0x1f,0x6,0x9,0x0
.long 0x895000,0x9600,0xc00,0x5fdf00,0x10000000,0x9ce0,0x1060000,0x43dc0
.long 0x3,0x18,0x1,0x13,0x3,0x7,0x6,0x0
.long 0x8d8800,0x1e00,0x600,0x19bf80,0x708f00,0x1130,0xb4a000,0x40ce0
.long 0x3,0x33,0x2,0x27,0x7,0x7,0x4,0x0
.long 0x8d8800,0x1e00,0xc80,0x23cf80,0x712f00,0x2530,0xb50c00,0x40de0
.long 0x7,0x18,0x1,0x3b,0xb,0x7,0x8,0x0
.long 0x8d8800,0x4600,0x600,0x2ddf80,0x71cf00,0x3930,0xcfa000,0x41ce0
.long 0x7,0x33,0x2,0x4f,0xf,0x7,0x6,0x0
.long 0x8d8800,0x4600,0xc80,0x37ef80,0x726f00,0x4d30,0xd00c00,0x41de0
.long 0xb,0x18,0x1,0x63,0x13,0x7,0x0,0x0
.long 0x8d8800,0x6e00,0x600,0x41ff80,0x730f00,0x6130,0xeaa000,0x42ce0
.long 0xb,0x33,0x2,0x77,0x17,0x7,0x8,0x0
.long 0x8d8800,0x6e00,0xc80,0x4c0f80,0x73af00,0x7530,0xeb0c00,0x42de0
.long 0xf,0x18,0x1,0x8b,0x1b,0x7,0x2,0x0
.long 0x8d8800,0x9600,0x600,0x561f80,0x10000000,0x8930,0x105a000,0x43ce0
.long 0xf,0x33,0x2,0x9f,0x1f,0x7,0x0,0x0
.long 0x8d8800,0x9600,0xc80,0x602f80,0x10000000,0x9d30,0x1060c00,0x43de0
tab_end:
.set tab_pf, tab_data + 49152
.size tab_data, 65536
.section .rodata,"a"
.p2align 6
.amdhsa_kernel recurrent_scan__spectral_gfnet__dense_activation_relu__prompt_kernel
  .amdhsa_next_free_vgpr 512
  .amdhsa_next_free_sgpr 102
  .amdhsa_accum_offset 256
  .amdhsa_group_segment_fixed_size 0
  .amdhsa_kernarg_size 72
  .amdhsa_user_sgpr_count 2
  .amdhsa_user_sgpr_kernarg_segment_ptr 1
  .amdhsa_system_sgpr_workgroup_id_x 1
.end_amdhsa_kernel
```
